```python
import torch

def _softmax(x, axis=-1):
    return torch.softmax(x, dim=axis)

def _gelu(x):
    return torch.nn.functional.gelu(x, approximate='tanh')

def _silu(x):
    return torch.nn.functional.silu(x)

def _sigmoid(x):
    return torch.sigmoid(x)

def _layernorm(x, axis=-1, eps=1e-05):
    m = x.mean(dim=axis, keepdim=True)
    v = x.var(dim=axis, keepdim=True, unbiased=False)
    return (x - m) / torch.sqrt(v + eps)

def _scatter_add(tgt, idx, src, axis=0):
    return tgt.clone().index_add_(axis, idx, src)

def _segment_sum(src, seg, n):
    out = torch.zeros((n,) + src.shape[1:], dtype=src.dtype)
    return out.index_add_(0, seg, src)

def _pad(x, pw):
    flat = tuple((v for pair in reversed(pw) for v in pair))
    return torch.nn.functional.pad(x, flat)
kernel_name = 'adaLN_cond__ssm_conv_h3__mixer_s_mlp__prompt'

def setup_inputs():

    _w = lambda a: (lambda t: t.to(torch.bfloat16) if t.is_floating_point() else t)(torch.as_tensor(a))

    def _A_setup():
        B, S, D = (1, 2048, 576)
        ks = 4
        return {'q': _w((lambda *s: torch.randn(*s, dtype=torch.bfloat16) * 0.05)(B, S, D)), 'k': _w((lambda *s: torch.randn(*s, dtype=torch.bfloat16) * 0.8)(B, S, D)), 'v': _w((lambda *s: torch.randn(*s, dtype=torch.bfloat16) * 0.8)(B, S, D)), 'shift_k': _w((lambda *s: torch.randn(*s, dtype=torch.bfloat16) * 0.8)(D, ks) * 0.5), 'ssm_k': _w((lambda *s: torch.randn(*s, dtype=torch.bfloat16) * 0.8)(D, S) * (1.0 / S ** 0.5)), 'ssm_D': _w((lambda *s: torch.randn(*s, dtype=torch.bfloat16) * 0.8)(D))}
    _A_in = _A_setup()

    def _B_setup():
        B, S, D, F = (1, 2048, 576, 4608)
        return {'x': _w((lambda *s: torch.randn(*s, dtype=torch.bfloat16) * 0.05)(B, S, D)), 'w1': _w((lambda *s: torch.randn(*s, dtype=torch.bfloat16) * 3.2)(D, D) * D ** (-0.5)), 'w2': _w((lambda *s: torch.randn(*s, dtype=torch.bfloat16) * 3.2)(D, D) * D ** (-0.5)), 'w3': _w((lambda *s: torch.randn(*s, dtype=torch.bfloat16) * 3.2)(D, F) * D ** (-0.5)), 'w4': _w((lambda *s: torch.randn(*s, dtype=torch.bfloat16) * 1.6)(F, D) * F ** (-0.5))}
    _B_in = _B_setup()
    return {'A_q': _A_in['q'], 'A_k': _A_in['k'], 'A_v': _A_in['v'], 'A_shift_k': _A_in['shift_k'], 'A_ssm_k': _A_in['ssm_k'], 'A_ssm_D': _A_in['ssm_D'], 'B_x': _B_in['x'], 'B_w1': _B_in['w1'], 'B_w2': _B_in['w2'], 'B_w3': _B_in['w3'], 'B_w4': _B_in['w4'], 'c': _w((lambda *s: torch.randn(*s, dtype=torch.bfloat16) * 0.1)(1, 576) * 8.0), 'w_mod': _w((lambda *s: torch.randn(*s, dtype=torch.bfloat16) * 0.1)(576, 6 * 576) * 576 ** (-0.5) * 8.0)}

def reference(A_q, A_k, A_v, A_shift_k, A_ssm_k, A_ssm_D, B_x, B_w1, B_w2, B_w3, B_w4, c, w_mod):

    def _A_ref(q, k, v, shift_k, ssm_k, ssm_D):
        B, S, D = q.shape
        ks = shift_k.shape[-1]
        k_pad = _pad(k, ((0, 0), (ks - 1, 0), (0, 0)))
        k_shift = torch.zeros_like(k)
        for t in range(ks):
            k_shift = k_shift + k_pad[:, t:t + S, :] * shift_k[:, ks - 1 - t][None, None, :]
        kv = k_shift * v
        L = 2 * S
        kv_pad = _pad(kv, ((0, 0), (0, S), (0, 0)))
        kf_pad = _pad(ssm_k, ((0, 0), (0, S)))
        kv_f = (lambda x, axes=(-2, -1): torch.fft.rfft2(x.float(), dim=axes))(kv_pad[:, None, :, :], axes=(1, 2))
        kf_f = (lambda x, axes=(-2, -1): torch.fft.rfft2(x.float(), dim=axes))(kf_pad[:, None, :], axes=(1, 2))
        kf_f = (lambda x, *d: x.permute(*d))(kf_f, 1, 2, 0)
        y_f = kv_f * kf_f[None, :, :, :]
        y = (lambda x, s, axes=(-2, -1): torch.fft.irfft2(x, s=s, dim=axes).to(torch.bfloat16))(y_f, (1, L), axes=(1, 2))[:, 0, :S, :]
        y = y + kv * ssm_D[None, None, :]
        return q * y

    def _B_ref(x, w1, w2, w3, w4):
        B, S, D = x.shape
        h = _gelu(_layernorm(x, axis=-1) @ w1)
        c = D // 4
        g0 = _pad(h[:, :, 0 * c:1 * c], ((0, 0), (1, 0), (0, 0)))[:, :S, :]
        g1 = _pad(h[:, :, 1 * c:2 * c], ((0, 0), (0, 1), (0, 0)))[:, 1:, :]
        g2 = _pad(h[:, :, 2 * c:3 * c], ((0, 0), (2, 0), (0, 0)))[:, :S, :]
        g3 = _pad(h[:, :, 3 * c:], ((0, 0), (0, 2), (0, 0)))[:, 2:, :]
        hs = torch.concatenate([g0, g1, g2, g3], axis=-1) @ w2
        x1 = x + hs
        h2 = _gelu(_layernorm(x1, axis=-1) @ w3) @ w4
        return x1 + h2
    x = A_q
    mod = (_silu(c) @ w_mod).reshape(c.shape[0], 6, 1, -1)
    sa, ca, ga, sb, cb, gb = (mod[:, 0].clone(), mod[:, 1].clone(), mod[:, 2].clone(), mod[:, 3].clone(), mod[:, 4].clone(), mod[:, 5].clone())
    h = _layernorm(x, axis=-1) * (1 + ca) + sa
    x = x + ga * _A_ref(h, A_k, A_v, A_shift_k, A_ssm_k, A_ssm_D)
    h = _layernorm(x, axis=-1) * (1 + cb) + sb
    x = x + gb * _B_ref(h, B_w1, B_w2, B_w3, B_w4)
    return x
```

```asm
; @launch grid=(256,1,1) block=(256,1,1) lds=147456
.amdgcn_target "amdgcn-amd-amdhsa--gfx950"
.text
.globl adaLN_cond__ssm_conv_h3__mixer_s_mlp__prompt_kernel
.p2align 8
.type adaLN_cond__ssm_conv_h3__mixer_s_mlp__prompt_kernel,@function
adaLN_cond__ssm_conv_h3__mixer_s_mlp__prompt_kernel:
L_code_start:
  s_load_dwordx16 s[16:31], s[0:1], 0
  s_load_dwordx16 s[32:47], s[0:1], 64
  v_lshrrev_b32 v2, 6, v0
  v_and_b32 v1, 63, v0
  v_readfirstlane_b32 s3, v2
  s_cmp_ge_u32 s2, 256
  s_cbranch_scc1 L_end
  s_mul_i32 s4, s2, 3
  s_add_u32 s4, s4, s3
  s_mul_i32 s5, s4, 3641
  s_lshr_b32 s5, s5, 16
  s_mul_i32 s6, s5, 18
  s_sub_u32 s6, s4, s6
  v_lshrrev_b32 v2, 2, v1
  v_and_b32 v3, 3, v1
  s_lshl_b32 s7, s5, 6
  v_lshl_add_u32 v4, v2, 2, s7
  s_lshl_b32 s8, s6, 6
  v_lshl_add_u32 v5, v3, 4, s8
  s_movk_i32 s9, 1152
  v_mad_u32_u24 v6, v4, s9, v5
  v_subrev_u32 v7, 3456, v6
  s_mov_b32 s50, 0x240000
  s_mov_b32 s51, 0x20000
  s_mov_b32 s54, 0x240000
  s_mov_b32 s55, 0x20000
  s_waitcnt lgkmcnt(0)
  s_cmp_ge_u32 s2, 192
  s_cbranch_scc1 L_pt
  s_cmp_eq_u32 s3, 3
  s_cbranch_scc1 L_kc
  s_mov_b32 s48, s18
  s_mov_b32 s49, s19
  s_mov_b32 s52, s20
  s_mov_b32 s53, s21
  buffer_load_dwordx4 v[8:11], v7, s[48:51], 0 offen offset:0
  buffer_load_dwordx4 v[12:15], v7, s[48:51], 0 offen offset:1152
  buffer_load_dwordx4 v[16:19], v7, s[48:51], 0 offen offset:2304
  buffer_load_dwordx4 v[20:23], v6, s[48:51], 0 offen offset:0
  buffer_load_dwordx4 v[24:27], v6, s[48:51], 0 offen offset:1152
  buffer_load_dwordx4 v[28:31], v6, s[48:51], 0 offen offset:2304
  buffer_load_dwordx4 v[32:35], v6, s[48:51], 0 offen offset:3456
  buffer_load_dwordx4 v[36:39], v6, s[52:55], 0 offen offset:0
  buffer_load_dwordx4 v[40:43], v6, s[52:55], 0 offen offset:1152
  buffer_load_dwordx4 v[44:47], v6, s[52:55], 0 offen offset:2304
  buffer_load_dwordx4 v[48:51], v6, s[52:55], 0 offen offset:3456
  s_mov_b32 s56, s22
  s_mov_b32 s57, s23
  s_mov_b32 s58, 0x1200
  s_mov_b32 s59, 0x20000
  v_lshlrev_b32 v68, 2, v5
  buffer_load_dwordx4 v[52:55], v68, s[56:59], 0 offen offset:0
  buffer_load_dwordx4 v[56:59], v68, s[56:59], 0 offen offset:16
  buffer_load_dwordx4 v[60:63], v68, s[56:59], 0 offen offset:32
  buffer_load_dwordx4 v[64:67], v68, s[56:59], 0 offen offset:48
  s_add_u32 s60, s46, 0x200000
  s_addc_u32 s61, s47, 0
  s_mov_b32 s62, 0x240000
  s_mov_b32 s63, 0x20000
  s_mov_b32 s72, s46
  s_mov_b32 s73, s47
  s_mov_b32 s74, 0x200000
  s_mov_b32 s75, 0x20000
  s_add_u32 s64, s46, 0x440000
  s_addc_u32 s65, s47, 0
  s_mov_b32 s66, 0x240000
  s_mov_b32 s67, 0x20000
  v_mov_b32 v144, -1
  v_mov_b32 v145, -1
  v_mov_b32 v146, -1
  v_mov_b32 v147, -1
  s_lshl_b32 s11, s4, 12
  v_lshl_add_u32 v148, v1, 4, s11
  buffer_store_dwordx4 v[144:147], v148, s[64:67], 0 offen offset:0 sc1
  buffer_store_dwordx4 v[144:147], v148, s[64:67], 0 offen offset:1024 sc1
  buffer_store_dwordx4 v[144:147], v148, s[64:67], 0 offen offset:2048 sc1
  buffer_store_dwordx4 v[144:147], v148, s[64:67], 0 offen offset:3072 sc1
  v_lshlrev_b32 v69, 11, v5
  v_lshlrev_b32 v70, 1, v4
  v_sub_u32 v69, v69, v70
  v_add_u32 v69, 4088, v69
  s_mov_b32 s10, 0xffff0000
  s_waitcnt vmcnt(7)
  v_lshlrev_b32 v72, 16, v52
  v_lshlrev_b32 v73, 16, v54
  v_and_b32 v74, s10, v52
  v_and_b32 v75, s10, v54
  v_lshlrev_b32 v76, 16, v53
  v_lshlrev_b32 v77, 16, v55
  v_and_b32 v78, s10, v53
  v_and_b32 v79, s10, v55
  v_lshlrev_b32 v80, 16, v8
  v_and_b32 v81, s10, v8
  v_lshlrev_b32 v82, 16, v12
  v_and_b32 v83, s10, v12
  v_lshlrev_b32 v84, 16, v16
  v_and_b32 v85, s10, v16
  v_lshlrev_b32 v86, 16, v20
  v_and_b32 v87, s10, v20
  v_lshlrev_b32 v88, 16, v24
  v_and_b32 v89, s10, v24
  v_lshlrev_b32 v90, 16, v28
  v_and_b32 v91, s10, v28
  v_lshlrev_b32 v92, 16, v32
  v_and_b32 v93, s10, v32
  v_lshlrev_b32 v94, 16, v36
  v_and_b32 v95, s10, v36
  v_lshlrev_b32 v96, 16, v40
  v_and_b32 v97, s10, v40
  v_lshlrev_b32 v98, 16, v44
  v_and_b32 v99, s10, v44
  v_lshlrev_b32 v100, 16, v48
  v_and_b32 v101, s10, v48
  v_pk_mul_f32 v[102:103], v[78:79], v[80:81]
  v_pk_fma_f32 v[102:103], v[76:77], v[82:83], v[102:103]
  v_pk_fma_f32 v[102:103], v[74:75], v[84:85], v[102:103]
  v_pk_fma_f32 v[102:103], v[72:73], v[86:87], v[102:103]
  v_pk_mul_f32 v[102:103], v[102:103], v[94:95]
  v_pk_mul_f32 v[104:105], v[78:79], v[82:83]
  v_pk_fma_f32 v[104:105], v[76:77], v[84:85], v[104:105]
  v_pk_fma_f32 v[104:105], v[74:75], v[86:87], v[104:105]
  v_pk_fma_f32 v[104:105], v[72:73], v[88:89], v[104:105]
  v_pk_mul_f32 v[104:105], v[104:105], v[96:97]
  v_pk_mul_f32 v[106:107], v[78:79], v[84:85]
  v_pk_fma_f32 v[106:107], v[76:77], v[86:87], v[106:107]
  v_pk_fma_f32 v[106:107], v[74:75], v[88:89], v[106:107]
  v_pk_fma_f32 v[106:107], v[72:73], v[90:91], v[106:107]
  v_pk_mul_f32 v[106:107], v[106:107], v[98:99]
  v_pk_mul_f32 v[108:109], v[78:79], v[86:87]
  v_pk_fma_f32 v[108:109], v[76:77], v[88:89], v[108:109]
  v_pk_fma_f32 v[108:109], v[74:75], v[90:91], v[108:109]
  v_pk_fma_f32 v[108:109], v[72:73], v[92:93], v[108:109]
  v_pk_mul_f32 v[108:109], v[108:109], v[100:101]
  v_cvt_pk_bf16_f32 v112, v108, v106
  v_cvt_pk_bf16_f32 v113, v104, v102
  v_cvt_pk_bf16_f32 v114, v109, v107
  v_cvt_pk_bf16_f32 v115, v105, v103
  s_mov_b32 s11, 0
  buffer_store_dwordx2 v[112:113], v69, s[60:63], s11 offen sc1
  s_mov_b32 s11, 4096
  buffer_store_dwordx2 v[114:115], v69, s[60:63], s11 offen sc1
  s_mov_b32 s64, s44
  s_mov_b32 s65, s45
  s_mov_b32 s66, 0x100
  s_mov_b32 s67, 0x20000
  v_mov_b32 v140, 0
  buffer_load_dword v140, v140, s[64:67], 0 offen sc1
  s_waitcnt vmcnt(9)
  v_lshlrev_b32 v72, 16, v56
  v_lshlrev_b32 v73, 16, v58
  v_and_b32 v74, s10, v56
  v_and_b32 v75, s10, v58
  v_lshlrev_b32 v76, 16, v57
  v_lshlrev_b32 v77, 16, v59
  v_and_b32 v78, s10, v57
  v_and_b32 v79, s10, v59
  v_lshlrev_b32 v80, 16, v9
  v_and_b32 v81, s10, v9
  v_lshlrev_b32 v82, 16, v13
  v_and_b32 v83, s10, v13
  v_lshlrev_b32 v84, 16, v17
  v_and_b32 v85, s10, v17
  v_lshlrev_b32 v86, 16, v21
  v_and_b32 v87, s10, v21
  v_lshlrev_b32 v88, 16, v25
  v_and_b32 v89, s10, v25
  v_lshlrev_b32 v90, 16, v29
  v_and_b32 v91, s10, v29
  v_lshlrev_b32 v92, 16, v33
  v_and_b32 v93, s10, v33
  v_lshlrev_b32 v94, 16, v37
  v_and_b32 v95, s10, v37
  v_lshlrev_b32 v96, 16, v41
  v_and_b32 v97, s10, v41
  v_lshlrev_b32 v98, 16, v45
  v_and_b32 v99, s10, v45
  v_lshlrev_b32 v100, 16, v49
  v_and_b32 v101, s10, v49
  v_pk_mul_f32 v[102:103], v[78:79], v[80:81]
  v_pk_fma_f32 v[102:103], v[76:77], v[82:83], v[102:103]
  v_pk_fma_f32 v[102:103], v[74:75], v[84:85], v[102:103]
  v_pk_fma_f32 v[102:103], v[72:73], v[86:87], v[102:103]
  v_pk_mul_f32 v[102:103], v[102:103], v[94:95]
  v_pk_mul_f32 v[104:105], v[78:79], v[82:83]
  v_pk_fma_f32 v[104:105], v[76:77], v[84:85], v[104:105]
  v_pk_fma_f32 v[104:105], v[74:75], v[86:87], v[104:105]
  v_pk_fma_f32 v[104:105], v[72:73], v[88:89], v[104:105]
  v_pk_mul_f32 v[104:105], v[104:105], v[96:97]
  v_pk_mul_f32 v[106:107], v[78:79], v[84:85]
  v_pk_fma_f32 v[106:107], v[76:77], v[86:87], v[106:107]
  v_pk_fma_f32 v[106:107], v[74:75], v[88:89], v[106:107]
  v_pk_fma_f32 v[106:107], v[72:73], v[90:91], v[106:107]
  v_pk_mul_f32 v[106:107], v[106:107], v[98:99]
  v_pk_mul_f32 v[108:109], v[78:79], v[86:87]
  v_pk_fma_f32 v[108:109], v[76:77], v[88:89], v[108:109]
  v_pk_fma_f32 v[108:109], v[74:75], v[90:91], v[108:109]
  v_pk_fma_f32 v[108:109], v[72:73], v[92:93], v[108:109]
  v_pk_mul_f32 v[108:109], v[108:109], v[100:101]
  v_cvt_pk_bf16_f32 v116, v108, v106
  v_cvt_pk_bf16_f32 v117, v104, v102
  v_cvt_pk_bf16_f32 v118, v109, v107
  v_cvt_pk_bf16_f32 v119, v105, v103
  s_mov_b32 s11, 8192
  buffer_store_dwordx2 v[116:117], v69, s[60:63], s11 offen sc1
  s_mov_b32 s11, 12288
  buffer_store_dwordx2 v[118:119], v69, s[60:63], s11 offen sc1
  s_waitcnt vmcnt(10)
  v_lshlrev_b32 v72, 16, v60
  v_lshlrev_b32 v73, 16, v62
  v_and_b32 v74, s10, v60
  v_and_b32 v75, s10, v62
  v_lshlrev_b32 v76, 16, v61
  v_lshlrev_b32 v77, 16, v63
  v_and_b32 v78, s10, v61
  v_and_b32 v79, s10, v63
  v_lshlrev_b32 v80, 16, v10
  v_and_b32 v81, s10, v10
  v_lshlrev_b32 v82, 16, v14
  v_and_b32 v83, s10, v14
  v_lshlrev_b32 v84, 16, v18
  v_and_b32 v85, s10, v18
  v_lshlrev_b32 v86, 16, v22
  v_and_b32 v87, s10, v22
  v_lshlrev_b32 v88, 16, v26
  v_and_b32 v89, s10, v26
  v_lshlrev_b32 v90, 16, v30
  v_and_b32 v91, s10, v30
  v_lshlrev_b32 v92, 16, v34
  v_and_b32 v93, s10, v34
  v_lshlrev_b32 v94, 16, v38
  v_and_b32 v95, s10, v38
  v_lshlrev_b32 v96, 16, v42
  v_and_b32 v97, s10, v42
  v_lshlrev_b32 v98, 16, v46
  v_and_b32 v99, s10, v46
  v_lshlrev_b32 v100, 16, v50
  v_and_b32 v101, s10, v50
  v_pk_mul_f32 v[102:103], v[78:79], v[80:81]
  v_pk_fma_f32 v[102:103], v[76:77], v[82:83], v[102:103]
  v_pk_fma_f32 v[102:103], v[74:75], v[84:85], v[102:103]
  v_pk_fma_f32 v[102:103], v[72:73], v[86:87], v[102:103]
  v_pk_mul_f32 v[102:103], v[102:103], v[94:95]
  v_pk_mul_f32 v[104:105], v[78:79], v[82:83]
  v_pk_fma_f32 v[104:105], v[76:77], v[84:85], v[104:105]
  v_pk_fma_f32 v[104:105], v[74:75], v[86:87], v[104:105]
  v_pk_fma_f32 v[104:105], v[72:73], v[88:89], v[104:105]
  v_pk_mul_f32 v[104:105], v[104:105], v[96:97]
  v_pk_mul_f32 v[106:107], v[78:79], v[84:85]
  v_pk_fma_f32 v[106:107], v[76:77], v[86:87], v[106:107]
  v_pk_fma_f32 v[106:107], v[74:75], v[88:89], v[106:107]
  v_pk_fma_f32 v[106:107], v[72:73], v[90:91], v[106:107]
  v_pk_mul_f32 v[106:107], v[106:107], v[98:99]
  v_pk_mul_f32 v[108:109], v[78:79], v[86:87]
  v_pk_fma_f32 v[108:109], v[76:77], v[88:89], v[108:109]
  v_pk_fma_f32 v[108:109], v[74:75], v[90:91], v[108:109]
  v_pk_fma_f32 v[108:109], v[72:73], v[92:93], v[108:109]
  v_pk_mul_f32 v[108:109], v[108:109], v[100:101]
  v_cvt_pk_bf16_f32 v120, v108, v106
  v_cvt_pk_bf16_f32 v121, v104, v102
  v_cvt_pk_bf16_f32 v122, v109, v107
  v_cvt_pk_bf16_f32 v123, v105, v103
  s_mov_b32 s11, 16384
  buffer_store_dwordx2 v[120:121], v69, s[60:63], s11 offen sc1
  s_mov_b32 s11, 20480
  buffer_store_dwordx2 v[122:123], v69, s[60:63], s11 offen sc1
  s_waitcnt vmcnt(11)
  v_lshlrev_b32 v72, 16, v64
  v_lshlrev_b32 v73, 16, v66
  v_and_b32 v74, s10, v64
  v_and_b32 v75, s10, v66
  v_lshlrev_b32 v76, 16, v65
  v_lshlrev_b32 v77, 16, v67
  v_and_b32 v78, s10, v65
  v_and_b32 v79, s10, v67
  v_lshlrev_b32 v80, 16, v11
  v_and_b32 v81, s10, v11
  v_lshlrev_b32 v82, 16, v15
  v_and_b32 v83, s10, v15
  v_lshlrev_b32 v84, 16, v19
  v_and_b32 v85, s10, v19
  v_lshlrev_b32 v86, 16, v23
  v_and_b32 v87, s10, v23
  v_lshlrev_b32 v88, 16, v27
  v_and_b32 v89, s10, v27
  v_lshlrev_b32 v90, 16, v31
  v_and_b32 v91, s10, v31
  v_lshlrev_b32 v92, 16, v35
  v_and_b32 v93, s10, v35
  v_lshlrev_b32 v94, 16, v39
  v_and_b32 v95, s10, v39
  v_lshlrev_b32 v96, 16, v43
  v_and_b32 v97, s10, v43
  v_lshlrev_b32 v98, 16, v47
  v_and_b32 v99, s10, v47
  v_lshlrev_b32 v100, 16, v51
  v_and_b32 v101, s10, v51
  v_pk_mul_f32 v[102:103], v[78:79], v[80:81]
  v_pk_fma_f32 v[102:103], v[76:77], v[82:83], v[102:103]
  v_pk_fma_f32 v[102:103], v[74:75], v[84:85], v[102:103]
  v_pk_fma_f32 v[102:103], v[72:73], v[86:87], v[102:103]
  v_pk_mul_f32 v[102:103], v[102:103], v[94:95]
  v_pk_mul_f32 v[104:105], v[78:79], v[82:83]
  v_pk_fma_f32 v[104:105], v[76:77], v[84:85], v[104:105]
  v_pk_fma_f32 v[104:105], v[74:75], v[86:87], v[104:105]
  v_pk_fma_f32 v[104:105], v[72:73], v[88:89], v[104:105]
  v_pk_mul_f32 v[104:105], v[104:105], v[96:97]
  v_pk_mul_f32 v[106:107], v[78:79], v[84:85]
  v_pk_fma_f32 v[106:107], v[76:77], v[86:87], v[106:107]
  v_pk_fma_f32 v[106:107], v[74:75], v[88:89], v[106:107]
  v_pk_fma_f32 v[106:107], v[72:73], v[90:91], v[106:107]
  v_pk_mul_f32 v[106:107], v[106:107], v[98:99]
  v_pk_mul_f32 v[108:109], v[78:79], v[86:87]
  v_pk_fma_f32 v[108:109], v[76:77], v[88:89], v[108:109]
  v_pk_fma_f32 v[108:109], v[74:75], v[90:91], v[108:109]
  v_pk_fma_f32 v[108:109], v[72:73], v[92:93], v[108:109]
  v_pk_mul_f32 v[108:109], v[108:109], v[100:101]
  v_cvt_pk_bf16_f32 v124, v108, v106
  v_cvt_pk_bf16_f32 v125, v104, v102
  v_cvt_pk_bf16_f32 v126, v109, v107
  v_cvt_pk_bf16_f32 v127, v105, v103
  s_mov_b32 s11, 24576
  buffer_store_dwordx2 v[124:125], v69, s[60:63], s11 offen sc1
  s_mov_b32 s11, 28672
  buffer_store_dwordx2 v[126:127], v69, s[60:63], s11 offen sc1
  s_mul_i32 s78, s2, 3
  s_add_u32 s78, s78, s3
  s_and_b32 s78, s78, 15
  s_waitcnt vmcnt(0) lgkmcnt(0)
  v_readfirstlane_b32 s76, v140
  s_nop 3
  s_cmp_lg_u32 s76, 0
  s_cbranch_scc1 L_rdy_done_2
  s_mov_b32 s8, s44
  s_mov_b32 s9, s45
  s_mov_b32 s10, 0x100
  s_mov_b32 s11, 0x20000
  s_mov_b32 s77, 0
  v_mov_b32 v252, 0
L_rdy_1:
  buffer_load_dword v253, v252, s[8:11], 0 offen sc1
  s_waitcnt vmcnt(0)
  v_readfirstlane_b32 s76, v253
  s_nop 3
  s_cmp_lg_u32 s76, 0
  s_cbranch_scc1 L_rdy_done_2
  s_sleep 2
  s_add_u32 s77, s77, 1
  s_cmp_lt_u32 s77, 131072
  s_cbranch_scc1 L_rdy_1
L_rdy_done_2:
  s_mov_b64 exec, 1
  s_mul_i32 s76, s78, 4352
  s_add_u32 s76, s76, 0
  v_mov_b32 v252, s76
  v_mov_b32 v253, 1
  buffer_atomic_add v253, v252, s[72:75], 0 offen sc1
L_ad_3:
  s_mov_b64 exec, -1
  s_lshr_b32 s5, s2, 3
  s_mul_i32 s4, s5, 21846
  s_lshr_b32 s4, s4, 16
  s_mul_i32 s6, s4, 3
  s_sub_u32 s5, s5, s6
  s_and_b32 s6, s2, 7
  s_lshl_b32 s6, s6, 3
  s_add_u32 s4, s4, s6
  s_mov_b32 s68, s16
  s_mov_b32 s69, s17
  s_mov_b32 s70, 0x240000
  s_mov_b32 s71, 0x20000
  v_lshrrev_b32 v172, 5, v1
  v_and_b32 v173, 31, v1
  s_lshl_b32 s6, s4, 5
  s_lshl_b32 s7, s3, 3
  s_add_u32 s6, s6, s7
  v_lshl_add_u32 v174, v172, 2, s6
  s_movk_i32 s7, 1152
  v_mul_lo_u32 v178, v174, s7
  v_lshl_add_u32 v178, v173, 2, v178
  v_add_u32 v179, 2304, v178
  buffer_load_dword v180, v178, s[68:71], 0 offen offset:0
  buffer_load_dword v181, v178, s[68:71], 0 offen offset:128
  buffer_load_dword v182, v178, s[68:71], 0 offen offset:256
  buffer_load_dword v183, v178, s[68:71], 0 offen offset:384
  buffer_load_dword v184, v178, s[68:71], 0 offen offset:512
  buffer_load_dword v185, v178, s[68:71], 0 offen offset:640
  buffer_load_dword v186, v178, s[68:71], 0 offen offset:768
  buffer_load_dword v187, v178, s[68:71], 0 offen offset:896
  buffer_load_dword v188, v178, s[68:71], 0 offen offset:1024
  buffer_load_dword v189, v178, s[68:71], 0 offen offset:1152
  buffer_load_dword v190, v178, s[68:71], 0 offen offset:1280
  buffer_load_dword v191, v178, s[68:71], 0 offen offset:1408
  buffer_load_dword v192, v178, s[68:71], 0 offen offset:1536
  buffer_load_dword v193, v178, s[68:71], 0 offen offset:1664
  buffer_load_dword v194, v178, s[68:71], 0 offen offset:1792
  buffer_load_dword v195, v178, s[68:71], 0 offen offset:1920
  buffer_load_dword v196, v178, s[68:71], 0 offen offset:2048
  buffer_load_dword v197, v178, s[68:71], 0 offen offset:2176
  buffer_load_dword v198, v179, s[68:71], 0 offen offset:0
  buffer_load_dword v199, v179, s[68:71], 0 offen offset:128
  buffer_load_dword v200, v179, s[68:71], 0 offen offset:256
  buffer_load_dword v201, v179, s[68:71], 0 offen offset:384
  buffer_load_dword v202, v179, s[68:71], 0 offen offset:512
  buffer_load_dword v203, v179, s[68:71], 0 offen offset:640
  buffer_load_dword v204, v179, s[68:71], 0 offen offset:768
  buffer_load_dword v205, v179, s[68:71], 0 offen offset:896
  buffer_load_dword v206, v179, s[68:71], 0 offen offset:1024
  buffer_load_dword v207, v179, s[68:71], 0 offen offset:1152
  buffer_load_dword v208, v179, s[68:71], 0 offen offset:1280
  buffer_load_dword v209, v179, s[68:71], 0 offen offset:1408
  buffer_load_dword v210, v179, s[68:71], 0 offen offset:1536
  buffer_load_dword v211, v179, s[68:71], 0 offen offset:1664
  buffer_load_dword v212, v179, s[68:71], 0 offen offset:1792
  buffer_load_dword v213, v179, s[68:71], 0 offen offset:1920
  buffer_load_dword v214, v179, s[68:71], 0 offen offset:2048
  buffer_load_dword v215, v179, s[68:71], 0 offen offset:2176
  s_waitcnt vmcnt(0)
  s_branch L_kv_done
L_kc:
  s_mov_b32 s72, s46
  s_mov_b32 s73, s47
  s_mov_b32 s74, 0x200000
  s_mov_b32 s75, 0x20000
  s_mul_i32 s4, s2, 12288
  s_add_u32 s5, s4, 0
  s_add_u32 s48, s24, s5
  s_addc_u32 s49, s25, 0
  s_mov_b32 s50, 0x1000
  s_mov_b32 s51, 0x20000
  s_add_u32 s5, s4, 4096
  s_add_u32 s52, s24, s5
  s_addc_u32 s53, s25, 0
  s_mov_b32 s54, 0x1000
  s_mov_b32 s55, 0x20000
  s_add_u32 s5, s4, 8192
  s_add_u32 s56, s24, s5
  s_addc_u32 s57, s25, 0
  s_mov_b32 s58, 0x1000
  s_mov_b32 s59, 0x20000
  v_lshlrev_b32 v2, 4, v1
  v_subrev_u32 v3, 128, v2
  buffer_load_dwordx4 v[16:19], v3, s[48:51], 0 offen
  v_subrev_u32 v4, 112, v2
  buffer_load_dwordx4 v[20:23], v4, s[48:51], 0 offen
  v_add_u32 v4, 896, v2
  buffer_load_dwordx4 v[24:27], v4, s[48:51], 0 offen
  buffer_load_dwordx4 v[28:31], v4, s[48:51], 0 offen offset:16
  v_add_u32 v4, 1920, v2
  buffer_load_dwordx4 v[32:35], v4, s[48:51], 0 offen
  buffer_load_dwordx4 v[36:39], v4, s[48:51], 0 offen offset:16
  v_add_u32 v4, 2944, v2
  buffer_load_dwordx4 v[40:43], v4, s[48:51], 0 offen
  buffer_load_dwordx4 v[44:47], v4, s[48:51], 0 offen offset:16
  v_add_u32 v4, 3968, v2
  buffer_load_dwordx4 v[48:51], v4, s[48:51], 0 offen
  buffer_load_dwordx4 v[52:55], v4, s[48:51], 0 offen offset:16
  buffer_load_dwordx4 v[56:59], v3, s[52:55], 0 offen
  v_subrev_u32 v4, 112, v2
  buffer_load_dwordx4 v[60:63], v4, s[52:55], 0 offen
  v_add_u32 v4, 896, v2
  buffer_load_dwordx4 v[64:67], v4, s[52:55], 0 offen
  buffer_load_dwordx4 v[68:71], v4, s[52:55], 0 offen offset:16
  v_add_u32 v4, 1920, v2
  buffer_load_dwordx4 v[72:75], v4, s[52:55], 0 offen
  buffer_load_dwordx4 v[76:79], v4, s[52:55], 0 offen offset:16
  v_add_u32 v4, 2944, v2
  buffer_load_dwordx4 v[80:83], v4, s[52:55], 0 offen
  buffer_load_dwordx4 v[84:87], v4, s[52:55], 0 offen offset:16
  v_add_u32 v4, 3968, v2
  buffer_load_dwordx4 v[88:91], v4, s[52:55], 0 offen
  buffer_load_dwordx4 v[92:95], v4, s[52:55], 0 offen offset:16
  buffer_load_dwordx4 v[96:99], v3, s[56:59], 0 offen
  v_subrev_u32 v4, 112, v2
  buffer_load_dwordx4 v[100:103], v4, s[56:59], 0 offen
  v_add_u32 v4, 896, v2
  buffer_load_dwordx4 v[104:107], v4, s[56:59], 0 offen
  buffer_load_dwordx4 v[108:111], v4, s[56:59], 0 offen offset:16
  v_add_u32 v4, 1920, v2
  buffer_load_dwordx4 v[112:115], v4, s[56:59], 0 offen
  buffer_load_dwordx4 v[116:119], v4, s[56:59], 0 offen offset:16
  v_add_u32 v4, 2944, v2
  buffer_load_dwordx4 v[120:123], v4, s[56:59], 0 offen
  buffer_load_dwordx4 v[124:127], v4, s[56:59], 0 offen offset:16
  v_add_u32 v4, 3968, v2
  buffer_load_dwordx4 v[128:131], v4, s[56:59], 0 offen
  buffer_load_dwordx4 v[132:135], v4, s[56:59], 0 offen offset:16
  s_getpc_b64 s[8:9]
L_pc_anchor_0:
  s_sub_u32 s8, s8, (L_pc_anchor_0 - L_code_start)
  s_subb_u32 s9, s9, 0
  s_lshr_b32 s10, s2, 3
  s_mul_i32 s10, s10, 2176
  v_lshl_add_u32 v248, v1, 7, s10
  s_mov_b64 exec, 0x1ffff
  global_load_dword v249, v248, s[8:9]
  s_mov_b64 exec, -1
  s_lshr_b32 s5, s2, 3
  s_mul_i32 s4, s5, 21846
  s_lshr_b32 s4, s4, 16
  s_mul_i32 s6, s4, 3
  s_sub_u32 s5, s5, s6
  s_and_b32 s6, s2, 7
  s_lshl_b32 s6, s6, 3
  s_add_u32 s4, s4, s6
  s_mov_b32 s68, s16
  s_mov_b32 s69, s17
  s_mov_b32 s70, 0x240000
  s_mov_b32 s71, 0x20000
  v_lshrrev_b32 v172, 5, v1
  v_and_b32 v173, 31, v1
  s_lshl_b32 s6, s4, 5
  s_lshl_b32 s7, s3, 3
  s_add_u32 s6, s6, s7
  v_lshl_add_u32 v174, v172, 2, s6
  s_movk_i32 s7, 1152
  v_mul_lo_u32 v178, v174, s7
  v_lshl_add_u32 v178, v173, 2, v178
  v_add_u32 v179, 2304, v178
  buffer_load_dword v180, v178, s[68:71], 0 offen offset:0
  buffer_load_dword v181, v178, s[68:71], 0 offen offset:128
  buffer_load_dword v182, v178, s[68:71], 0 offen offset:256
  buffer_load_dword v183, v178, s[68:71], 0 offen offset:384
  buffer_load_dword v184, v178, s[68:71], 0 offen offset:512
  buffer_load_dword v185, v178, s[68:71], 0 offen offset:640
  buffer_load_dword v186, v178, s[68:71], 0 offen offset:768
  buffer_load_dword v187, v178, s[68:71], 0 offen offset:896
  buffer_load_dword v188, v178, s[68:71], 0 offen offset:1024
  buffer_load_dword v189, v178, s[68:71], 0 offen offset:1152
  buffer_load_dword v190, v178, s[68:71], 0 offen offset:1280
  buffer_load_dword v191, v178, s[68:71], 0 offen offset:1408
  buffer_load_dword v192, v178, s[68:71], 0 offen offset:1536
  buffer_load_dword v193, v178, s[68:71], 0 offen offset:1664
  buffer_load_dword v194, v178, s[68:71], 0 offen offset:1792
  buffer_load_dword v195, v178, s[68:71], 0 offen offset:1920
  buffer_load_dword v196, v178, s[68:71], 0 offen offset:2048
  buffer_load_dword v197, v178, s[68:71], 0 offen offset:2176
  buffer_load_dword v198, v179, s[68:71], 0 offen offset:0
  buffer_load_dword v199, v179, s[68:71], 0 offen offset:128
  buffer_load_dword v200, v179, s[68:71], 0 offen offset:256
  buffer_load_dword v201, v179, s[68:71], 0 offen offset:384
  buffer_load_dword v202, v179, s[68:71], 0 offen offset:512
  buffer_load_dword v203, v179, s[68:71], 0 offen offset:640
  buffer_load_dword v204, v179, s[68:71], 0 offen offset:768
  buffer_load_dword v205, v179, s[68:71], 0 offen offset:896
  buffer_load_dword v206, v179, s[68:71], 0 offen offset:1024
  buffer_load_dword v207, v179, s[68:71], 0 offen offset:1152
  buffer_load_dword v208, v179, s[68:71], 0 offen offset:1280
  buffer_load_dword v209, v179, s[68:71], 0 offen offset:1408
  buffer_load_dword v210, v179, s[68:71], 0 offen offset:1536
  buffer_load_dword v211, v179, s[68:71], 0 offen offset:1664
  buffer_load_dword v212, v179, s[68:71], 0 offen offset:1792
  buffer_load_dword v213, v179, s[68:71], 0 offen offset:1920
  buffer_load_dword v214, v179, s[68:71], 0 offen offset:2048
  buffer_load_dword v215, v179, s[68:71], 0 offen offset:2176
  v_mov_b32 v8, 0
  v_mov_b32 v9, 0
  v_mov_b32 v10, 0
  v_mov_b32 v11, 0
  v_lshrrev_b32 v5, 4, v1
  v_and_b32 v6, 15, v1
  v_mul_u32_u24 v5, 48, v5
  v_add_u32 v5, v5, v6
  v_lshlrev_b32 v5, 4, v5
  v_add_u32 v5, 106496, v5
  ds_write_b128 v5, v[8:11] offset:0
  ds_write_b128 v5, v[8:11] offset:3072
  ds_write_b128 v5, v[8:11] offset:6144
  ds_write_b128 v5, v[8:11] offset:9216
  ds_write_b128 v5, v[8:11] offset:12288
  ds_write_b128 v5, v[8:11] offset:15360
  v_add_u32 v12, 35328, v2
  v_add_u32 v13, 70656, v2
  s_waitcnt vmcnt(63)
  v_alignbit_b32 v140, v17, v16, 16
  v_alignbit_b32 v141, v18, v17, 16
  v_alignbit_b32 v142, v19, v18, 16
  s_waitcnt vmcnt(63)
  v_alignbit_b32 v143, v20, v19, 16
  v_mov_b32 v144, v17
  v_mov_b32 v145, v18
  v_mov_b32 v146, v19
  v_mov_b32 v147, v20
  v_alignbit_b32 v148, v18, v17, 16
  v_alignbit_b32 v149, v19, v18, 16
  v_alignbit_b32 v150, v20, v19, 16
  v_alignbit_b32 v151, v21, v20, 16
  ds_write_b128 v2, v[140:143] offset:0
  ds_write_b128 v2, v[144:147] offset:4416
  ds_write_b128 v2, v[148:151] offset:8832
  ds_write_b128 v2, v[18:21] offset:13248
  v_alignbit_b32 v152, v19, v18, 16
  v_alignbit_b32 v153, v20, v19, 16
  v_alignbit_b32 v154, v21, v20, 16
  v_alignbit_b32 v155, v22, v21, 16
  ds_write_b128 v2, v[152:155] offset:17664
  v_mov_b32 v140, v19
  v_mov_b32 v141, v20
  v_mov_b32 v142, v21
  v_mov_b32 v143, v22
  v_alignbit_b32 v144, v20, v19, 16
  v_alignbit_b32 v145, v21, v20, 16
  v_alignbit_b32 v146, v22, v21, 16
  v_alignbit_b32 v147, v23, v22, 16
  ds_write_b128 v2, v[140:143] offset:22080
  ds_write_b128 v2, v[144:147] offset:26496
  ds_write_b128 v2, v[20:23] offset:30912
  s_waitcnt vmcnt(63)
  v_alignbit_b32 v156, v25, v24, 16
  v_alignbit_b32 v157, v26, v25, 16
  v_alignbit_b32 v158, v27, v26, 16
  s_waitcnt vmcnt(63)
  v_alignbit_b32 v159, v28, v27, 16
  v_mov_b32 v160, v25
  v_mov_b32 v161, v26
  v_mov_b32 v162, v27
  v_mov_b32 v163, v28
  v_alignbit_b32 v164, v26, v25, 16
  v_alignbit_b32 v165, v27, v26, 16
  v_alignbit_b32 v166, v28, v27, 16
  v_alignbit_b32 v167, v29, v28, 16
  ds_write_b128 v2, v[156:159] offset:1024
  ds_write_b128 v2, v[160:163] offset:5440
  ds_write_b128 v2, v[164:167] offset:9856
  ds_write_b128 v2, v[26:29] offset:14272
  v_alignbit_b32 v168, v27, v26, 16
  v_alignbit_b32 v169, v28, v27, 16
  v_alignbit_b32 v170, v29, v28, 16
  v_alignbit_b32 v171, v30, v29, 16
  ds_write_b128 v2, v[168:171] offset:18688
  v_mov_b32 v156, v27
  v_mov_b32 v157, v28
  v_mov_b32 v158, v29
  v_mov_b32 v159, v30
  v_alignbit_b32 v160, v28, v27, 16
  v_alignbit_b32 v161, v29, v28, 16
  v_alignbit_b32 v162, v30, v29, 16
  v_alignbit_b32 v163, v31, v30, 16
  ds_write_b128 v2, v[156:159] offset:23104
  ds_write_b128 v2, v[160:163] offset:27520
  ds_write_b128 v2, v[28:31] offset:31936
  s_waitcnt vmcnt(62)
  v_alignbit_b32 v140, v33, v32, 16
  v_alignbit_b32 v141, v34, v33, 16
  v_alignbit_b32 v142, v35, v34, 16
  s_waitcnt vmcnt(61)
  v_alignbit_b32 v143, v36, v35, 16
  v_mov_b32 v144, v33
  v_mov_b32 v145, v34
  v_mov_b32 v146, v35
  v_mov_b32 v147, v36
  v_alignbit_b32 v148, v34, v33, 16
  v_alignbit_b32 v149, v35, v34, 16
  v_alignbit_b32 v150, v36, v35, 16
  v_alignbit_b32 v151, v37, v36, 16
  ds_write_b128 v2, v[140:143] offset:2048
  ds_write_b128 v2, v[144:147] offset:6464
  ds_write_b128 v2, v[148:151] offset:10880
  ds_write_b128 v2, v[34:37] offset:15296
  v_alignbit_b32 v152, v35, v34, 16
  v_alignbit_b32 v153, v36, v35, 16
  v_alignbit_b32 v154, v37, v36, 16
  v_alignbit_b32 v155, v38, v37, 16
  ds_write_b128 v2, v[152:155] offset:19712
  v_mov_b32 v140, v35
  v_mov_b32 v141, v36
  v_mov_b32 v142, v37
  v_mov_b32 v143, v38
  v_alignbit_b32 v144, v36, v35, 16
  v_alignbit_b32 v145, v37, v36, 16
  v_alignbit_b32 v146, v38, v37, 16
  v_alignbit_b32 v147, v39, v38, 16
  ds_write_b128 v2, v[140:143] offset:24128
  ds_write_b128 v2, v[144:147] offset:28544
  ds_write_b128 v2, v[36:39] offset:32960
  s_waitcnt vmcnt(60)
  v_alignbit_b32 v156, v41, v40, 16
  v_alignbit_b32 v157, v42, v41, 16
  v_alignbit_b32 v158, v43, v42, 16
  s_waitcnt vmcnt(59)
  v_alignbit_b32 v159, v44, v43, 16
  v_mov_b32 v160, v41
  v_mov_b32 v161, v42
  v_mov_b32 v162, v43
  v_mov_b32 v163, v44
  v_alignbit_b32 v164, v42, v41, 16
  v_alignbit_b32 v165, v43, v42, 16
  v_alignbit_b32 v166, v44, v43, 16
  v_alignbit_b32 v167, v45, v44, 16
  ds_write_b128 v2, v[156:159] offset:3072
  ds_write_b128 v2, v[160:163] offset:7488
  ds_write_b128 v2, v[164:167] offset:11904
  ds_write_b128 v2, v[42:45] offset:16320
  v_alignbit_b32 v168, v43, v42, 16
  v_alignbit_b32 v169, v44, v43, 16
  v_alignbit_b32 v170, v45, v44, 16
  v_alignbit_b32 v171, v46, v45, 16
  ds_write_b128 v2, v[168:171] offset:20736
  v_mov_b32 v156, v43
  v_mov_b32 v157, v44
  v_mov_b32 v158, v45
  v_mov_b32 v159, v46
  v_alignbit_b32 v160, v44, v43, 16
  v_alignbit_b32 v161, v45, v44, 16
  v_alignbit_b32 v162, v46, v45, 16
  v_alignbit_b32 v163, v47, v46, 16
  ds_write_b128 v2, v[156:159] offset:25152
  ds_write_b128 v2, v[160:163] offset:29568
  ds_write_b128 v2, v[44:47] offset:33984
  s_mov_b64 exec, 0xfffff
  s_waitcnt vmcnt(58)
  v_alignbit_b32 v140, v49, v48, 16
  v_alignbit_b32 v141, v50, v49, 16
  v_alignbit_b32 v142, v51, v50, 16
  s_waitcnt vmcnt(57)
  v_alignbit_b32 v143, v52, v51, 16
  v_mov_b32 v144, v49
  v_mov_b32 v145, v50
  v_mov_b32 v146, v51
  v_mov_b32 v147, v52
  v_alignbit_b32 v148, v50, v49, 16
  v_alignbit_b32 v149, v51, v50, 16
  v_alignbit_b32 v150, v52, v51, 16
  v_alignbit_b32 v151, v53, v52, 16
  ds_write_b128 v2, v[140:143] offset:4096
  ds_write_b128 v2, v[144:147] offset:8512
  ds_write_b128 v2, v[148:151] offset:12928
  ds_write_b128 v2, v[50:53] offset:17344
  v_alignbit_b32 v152, v51, v50, 16
  v_alignbit_b32 v153, v52, v51, 16
  v_alignbit_b32 v154, v53, v52, 16
  v_alignbit_b32 v155, v54, v53, 16
  ds_write_b128 v2, v[152:155] offset:21760
  v_mov_b32 v140, v51
  v_mov_b32 v141, v52
  v_mov_b32 v142, v53
  v_mov_b32 v143, v54
  v_alignbit_b32 v144, v52, v51, 16
  v_alignbit_b32 v145, v53, v52, 16
  v_alignbit_b32 v146, v54, v53, 16
  v_alignbit_b32 v147, v55, v54, 16
  ds_write_b128 v2, v[140:143] offset:26176
  ds_write_b128 v2, v[144:147] offset:30592
  ds_write_b128 v2, v[52:55] offset:35008
  s_mov_b64 exec, -1
  s_waitcnt vmcnt(56)
  v_alignbit_b32 v156, v57, v56, 16
  v_alignbit_b32 v157, v58, v57, 16
  v_alignbit_b32 v158, v59, v58, 16
  s_waitcnt vmcnt(55)
  v_alignbit_b32 v159, v60, v59, 16
  v_mov_b32 v160, v57
  v_mov_b32 v161, v58
  v_mov_b32 v162, v59
  v_mov_b32 v163, v60
  v_alignbit_b32 v164, v58, v57, 16
  v_alignbit_b32 v165, v59, v58, 16
  v_alignbit_b32 v166, v60, v59, 16
  v_alignbit_b32 v167, v61, v60, 16
  ds_write_b128 v12, v[156:159] offset:0
  ds_write_b128 v12, v[160:163] offset:4416
  ds_write_b128 v12, v[164:167] offset:8832
  ds_write_b128 v12, v[58:61] offset:13248
  v_alignbit_b32 v168, v59, v58, 16
  v_alignbit_b32 v169, v60, v59, 16
  v_alignbit_b32 v170, v61, v60, 16
  v_alignbit_b32 v171, v62, v61, 16
  ds_write_b128 v12, v[168:171] offset:17664
  v_mov_b32 v156, v59
  v_mov_b32 v157, v60
  v_mov_b32 v158, v61
  v_mov_b32 v159, v62
  v_alignbit_b32 v160, v60, v59, 16
  v_alignbit_b32 v161, v61, v60, 16
  v_alignbit_b32 v162, v62, v61, 16
  v_alignbit_b32 v163, v63, v62, 16
  ds_write_b128 v12, v[156:159] offset:22080
  ds_write_b128 v12, v[160:163] offset:26496
  ds_write_b128 v12, v[60:63] offset:30912
  s_waitcnt vmcnt(54)
  v_alignbit_b32 v140, v65, v64, 16
  v_alignbit_b32 v141, v66, v65, 16
  v_alignbit_b32 v142, v67, v66, 16
  s_waitcnt vmcnt(53)
  v_alignbit_b32 v143, v68, v67, 16
  v_mov_b32 v144, v65
  v_mov_b32 v145, v66
  v_mov_b32 v146, v67
  v_mov_b32 v147, v68
  v_alignbit_b32 v148, v66, v65, 16
  v_alignbit_b32 v149, v67, v66, 16
  v_alignbit_b32 v150, v68, v67, 16
  v_alignbit_b32 v151, v69, v68, 16
  ds_write_b128 v12, v[140:143] offset:1024
  ds_write_b128 v12, v[144:147] offset:5440
  ds_write_b128 v12, v[148:151] offset:9856
  ds_write_b128 v12, v[66:69] offset:14272
  v_alignbit_b32 v152, v67, v66, 16
  v_alignbit_b32 v153, v68, v67, 16
  v_alignbit_b32 v154, v69, v68, 16
  v_alignbit_b32 v155, v70, v69, 16
  ds_write_b128 v12, v[152:155] offset:18688
  v_mov_b32 v140, v67
  v_mov_b32 v141, v68
  v_mov_b32 v142, v69
  v_mov_b32 v143, v70
  v_alignbit_b32 v144, v68, v67, 16
  v_alignbit_b32 v145, v69, v68, 16
  v_alignbit_b32 v146, v70, v69, 16
  v_alignbit_b32 v147, v71, v70, 16
  ds_write_b128 v12, v[140:143] offset:23104
  ds_write_b128 v12, v[144:147] offset:27520
  ds_write_b128 v12, v[68:71] offset:31936
  s_waitcnt vmcnt(52)
  v_alignbit_b32 v156, v73, v72, 16
  v_alignbit_b32 v157, v74, v73, 16
  v_alignbit_b32 v158, v75, v74, 16
  s_waitcnt vmcnt(51)
  v_alignbit_b32 v159, v76, v75, 16
  v_mov_b32 v160, v73
  v_mov_b32 v161, v74
  v_mov_b32 v162, v75
  v_mov_b32 v163, v76
  v_alignbit_b32 v164, v74, v73, 16
  v_alignbit_b32 v165, v75, v74, 16
  v_alignbit_b32 v166, v76, v75, 16
  v_alignbit_b32 v167, v77, v76, 16
  ds_write_b128 v12, v[156:159] offset:2048
  ds_write_b128 v12, v[160:163] offset:6464
  ds_write_b128 v12, v[164:167] offset:10880
  ds_write_b128 v12, v[74:77] offset:15296
  v_alignbit_b32 v168, v75, v74, 16
  v_alignbit_b32 v169, v76, v75, 16
  v_alignbit_b32 v170, v77, v76, 16
  v_alignbit_b32 v171, v78, v77, 16
  ds_write_b128 v12, v[168:171] offset:19712
  v_mov_b32 v156, v75
  v_mov_b32 v157, v76
  v_mov_b32 v158, v77
  v_mov_b32 v159, v78
  v_alignbit_b32 v160, v76, v75, 16
  v_alignbit_b32 v161, v77, v76, 16
  v_alignbit_b32 v162, v78, v77, 16
  v_alignbit_b32 v163, v79, v78, 16
  ds_write_b128 v12, v[156:159] offset:24128
  ds_write_b128 v12, v[160:163] offset:28544
  ds_write_b128 v12, v[76:79] offset:32960
  s_waitcnt vmcnt(50)
  v_alignbit_b32 v140, v81, v80, 16
  v_alignbit_b32 v141, v82, v81, 16
  v_alignbit_b32 v142, v83, v82, 16
  s_waitcnt vmcnt(49)
  v_alignbit_b32 v143, v84, v83, 16
  v_mov_b32 v144, v81
  v_mov_b32 v145, v82
  v_mov_b32 v146, v83
  v_mov_b32 v147, v84
  v_alignbit_b32 v148, v82, v81, 16
  v_alignbit_b32 v149, v83, v82, 16
  v_alignbit_b32 v150, v84, v83, 16
  v_alignbit_b32 v151, v85, v84, 16
  ds_write_b128 v12, v[140:143] offset:3072
  ds_write_b128 v12, v[144:147] offset:7488
  ds_write_b128 v12, v[148:151] offset:11904
  ds_write_b128 v12, v[82:85] offset:16320
  v_alignbit_b32 v152, v83, v82, 16
  v_alignbit_b32 v153, v84, v83, 16
  v_alignbit_b32 v154, v85, v84, 16
  v_alignbit_b32 v155, v86, v85, 16
  ds_write_b128 v12, v[152:155] offset:20736
  v_mov_b32 v140, v83
  v_mov_b32 v141, v84
  v_mov_b32 v142, v85
  v_mov_b32 v143, v86
  v_alignbit_b32 v144, v84, v83, 16
  v_alignbit_b32 v145, v85, v84, 16
  v_alignbit_b32 v146, v86, v85, 16
  v_alignbit_b32 v147, v87, v86, 16
  ds_write_b128 v12, v[140:143] offset:25152
  ds_write_b128 v12, v[144:147] offset:29568
  ds_write_b128 v12, v[84:87] offset:33984
  s_mov_b64 exec, 0xfffff
  s_waitcnt vmcnt(48)
  v_alignbit_b32 v156, v89, v88, 16
  v_alignbit_b32 v157, v90, v89, 16
  v_alignbit_b32 v158, v91, v90, 16
  s_waitcnt vmcnt(47)
  v_alignbit_b32 v159, v92, v91, 16
  v_mov_b32 v160, v89
  v_mov_b32 v161, v90
  v_mov_b32 v162, v91
  v_mov_b32 v163, v92
  v_alignbit_b32 v164, v90, v89, 16
  v_alignbit_b32 v165, v91, v90, 16
  v_alignbit_b32 v166, v92, v91, 16
  v_alignbit_b32 v167, v93, v92, 16
  ds_write_b128 v12, v[156:159] offset:4096
  ds_write_b128 v12, v[160:163] offset:8512
  ds_write_b128 v12, v[164:167] offset:12928
  ds_write_b128 v12, v[90:93] offset:17344
  v_alignbit_b32 v168, v91, v90, 16
  v_alignbit_b32 v169, v92, v91, 16
  v_alignbit_b32 v170, v93, v92, 16
  v_alignbit_b32 v171, v94, v93, 16
  ds_write_b128 v12, v[168:171] offset:21760
  v_mov_b32 v156, v91
  v_mov_b32 v157, v92
  v_mov_b32 v158, v93
  v_mov_b32 v159, v94
  v_alignbit_b32 v160, v92, v91, 16
  v_alignbit_b32 v161, v93, v92, 16
  v_alignbit_b32 v162, v94, v93, 16
  v_alignbit_b32 v163, v95, v94, 16
  ds_write_b128 v12, v[156:159] offset:26176
  ds_write_b128 v12, v[160:163] offset:30592
  ds_write_b128 v12, v[92:95] offset:35008
  s_mov_b64 exec, -1
  s_waitcnt vmcnt(46)
  v_alignbit_b32 v140, v97, v96, 16
  v_alignbit_b32 v141, v98, v97, 16
  v_alignbit_b32 v142, v99, v98, 16
  s_waitcnt vmcnt(45)
  v_alignbit_b32 v143, v100, v99, 16
  v_mov_b32 v144, v97
  v_mov_b32 v145, v98
  v_mov_b32 v146, v99
  v_mov_b32 v147, v100
  v_alignbit_b32 v148, v98, v97, 16
  v_alignbit_b32 v149, v99, v98, 16
  v_alignbit_b32 v150, v100, v99, 16
  v_alignbit_b32 v151, v101, v100, 16
  ds_write_b128 v13, v[140:143] offset:0
  ds_write_b128 v13, v[144:147] offset:4416
  ds_write_b128 v13, v[148:151] offset:8832
  ds_write_b128 v13, v[98:101] offset:13248
  v_alignbit_b32 v152, v99, v98, 16
  v_alignbit_b32 v153, v100, v99, 16
  v_alignbit_b32 v154, v101, v100, 16
  v_alignbit_b32 v155, v102, v101, 16
  ds_write_b128 v13, v[152:155] offset:17664
  v_mov_b32 v140, v99
  v_mov_b32 v141, v100
  v_mov_b32 v142, v101
  v_mov_b32 v143, v102
  v_alignbit_b32 v144, v100, v99, 16
  v_alignbit_b32 v145, v101, v100, 16
  v_alignbit_b32 v146, v102, v101, 16
  v_alignbit_b32 v147, v103, v102, 16
  ds_write_b128 v13, v[140:143] offset:22080
  ds_write_b128 v13, v[144:147] offset:26496
  ds_write_b128 v13, v[100:103] offset:30912
  s_waitcnt vmcnt(44)
  v_alignbit_b32 v156, v105, v104, 16
  v_alignbit_b32 v157, v106, v105, 16
  v_alignbit_b32 v158, v107, v106, 16
  s_waitcnt vmcnt(43)
  v_alignbit_b32 v159, v108, v107, 16
  v_mov_b32 v160, v105
  v_mov_b32 v161, v106
  v_mov_b32 v162, v107
  v_mov_b32 v163, v108
  v_alignbit_b32 v164, v106, v105, 16
  v_alignbit_b32 v165, v107, v106, 16
  v_alignbit_b32 v166, v108, v107, 16
  v_alignbit_b32 v167, v109, v108, 16
  ds_write_b128 v13, v[156:159] offset:1024
  ds_write_b128 v13, v[160:163] offset:5440
  ds_write_b128 v13, v[164:167] offset:9856
  ds_write_b128 v13, v[106:109] offset:14272
  v_alignbit_b32 v168, v107, v106, 16
  v_alignbit_b32 v169, v108, v107, 16
  v_alignbit_b32 v170, v109, v108, 16
  v_alignbit_b32 v171, v110, v109, 16
  ds_write_b128 v13, v[168:171] offset:18688
  v_mov_b32 v156, v107
  v_mov_b32 v157, v108
  v_mov_b32 v158, v109
  v_mov_b32 v159, v110
  v_alignbit_b32 v160, v108, v107, 16
  v_alignbit_b32 v161, v109, v108, 16
  v_alignbit_b32 v162, v110, v109, 16
  v_alignbit_b32 v163, v111, v110, 16
  ds_write_b128 v13, v[156:159] offset:23104
  ds_write_b128 v13, v[160:163] offset:27520
  ds_write_b128 v13, v[108:111] offset:31936
  s_waitcnt vmcnt(42)
  v_alignbit_b32 v140, v113, v112, 16
  v_alignbit_b32 v141, v114, v113, 16
  v_alignbit_b32 v142, v115, v114, 16
  s_waitcnt vmcnt(41)
  v_alignbit_b32 v143, v116, v115, 16
  v_mov_b32 v144, v113
  v_mov_b32 v145, v114
  v_mov_b32 v146, v115
  v_mov_b32 v147, v116
  v_alignbit_b32 v148, v114, v113, 16
  v_alignbit_b32 v149, v115, v114, 16
  v_alignbit_b32 v150, v116, v115, 16
  v_alignbit_b32 v151, v117, v116, 16
  ds_write_b128 v13, v[140:143] offset:2048
  ds_write_b128 v13, v[144:147] offset:6464
  ds_write_b128 v13, v[148:151] offset:10880
  ds_write_b128 v13, v[114:117] offset:15296
  v_alignbit_b32 v152, v115, v114, 16
  v_alignbit_b32 v153, v116, v115, 16
  v_alignbit_b32 v154, v117, v116, 16
  v_alignbit_b32 v155, v118, v117, 16
  ds_write_b128 v13, v[152:155] offset:19712
  v_mov_b32 v140, v115
  v_mov_b32 v141, v116
  v_mov_b32 v142, v117
  v_mov_b32 v143, v118
  v_alignbit_b32 v144, v116, v115, 16
  v_alignbit_b32 v145, v117, v116, 16
  v_alignbit_b32 v146, v118, v117, 16
  v_alignbit_b32 v147, v119, v118, 16
  ds_write_b128 v13, v[140:143] offset:24128
  ds_write_b128 v13, v[144:147] offset:28544
  ds_write_b128 v13, v[116:119] offset:32960
  s_waitcnt vmcnt(40)
  v_alignbit_b32 v156, v121, v120, 16
  v_alignbit_b32 v157, v122, v121, 16
  v_alignbit_b32 v158, v123, v122, 16
  s_waitcnt vmcnt(39)
  v_alignbit_b32 v159, v124, v123, 16
  v_mov_b32 v160, v121
  v_mov_b32 v161, v122
  v_mov_b32 v162, v123
  v_mov_b32 v163, v124
  v_alignbit_b32 v164, v122, v121, 16
  v_alignbit_b32 v165, v123, v122, 16
  v_alignbit_b32 v166, v124, v123, 16
  v_alignbit_b32 v167, v125, v124, 16
  ds_write_b128 v13, v[156:159] offset:3072
  ds_write_b128 v13, v[160:163] offset:7488
  ds_write_b128 v13, v[164:167] offset:11904
  ds_write_b128 v13, v[122:125] offset:16320
  v_alignbit_b32 v168, v123, v122, 16
  v_alignbit_b32 v169, v124, v123, 16
  v_alignbit_b32 v170, v125, v124, 16
  v_alignbit_b32 v171, v126, v125, 16
  ds_write_b128 v13, v[168:171] offset:20736
  v_mov_b32 v156, v123
  v_mov_b32 v157, v124
  v_mov_b32 v158, v125
  v_mov_b32 v159, v126
  v_alignbit_b32 v160, v124, v123, 16
  v_alignbit_b32 v161, v125, v124, 16
  v_alignbit_b32 v162, v126, v125, 16
  v_alignbit_b32 v163, v127, v126, 16
  ds_write_b128 v13, v[156:159] offset:25152
  ds_write_b128 v13, v[160:163] offset:29568
  ds_write_b128 v13, v[124:127] offset:33984
  s_mov_b64 exec, 0xfffff
  s_waitcnt vmcnt(38)
  v_alignbit_b32 v140, v129, v128, 16
  v_alignbit_b32 v141, v130, v129, 16
  v_alignbit_b32 v142, v131, v130, 16
  s_waitcnt vmcnt(37)
  v_alignbit_b32 v143, v132, v131, 16
  v_mov_b32 v144, v129
  v_mov_b32 v145, v130
  v_mov_b32 v146, v131
  v_mov_b32 v147, v132
  v_alignbit_b32 v148, v130, v129, 16
  v_alignbit_b32 v149, v131, v130, 16
  v_alignbit_b32 v150, v132, v131, 16
  v_alignbit_b32 v151, v133, v132, 16
  ds_write_b128 v13, v[140:143] offset:4096
  ds_write_b128 v13, v[144:147] offset:8512
  ds_write_b128 v13, v[148:151] offset:12928
  ds_write_b128 v13, v[130:133] offset:17344
  v_alignbit_b32 v152, v131, v130, 16
  v_alignbit_b32 v153, v132, v131, 16
  v_alignbit_b32 v154, v133, v132, 16
  v_alignbit_b32 v155, v134, v133, 16
  ds_write_b128 v13, v[152:155] offset:21760
  v_mov_b32 v140, v131
  v_mov_b32 v141, v132
  v_mov_b32 v142, v133
  v_mov_b32 v143, v134
  v_alignbit_b32 v144, v132, v131, 16
  v_alignbit_b32 v145, v133, v132, 16
  v_alignbit_b32 v146, v134, v133, 16
  v_alignbit_b32 v147, v135, v134, 16
  ds_write_b128 v13, v[140:143] offset:26176
  ds_write_b128 v13, v[144:147] offset:30592
  ds_write_b128 v13, v[132:135] offset:35008
  s_mov_b64 exec, -1
  s_waitcnt vmcnt(0) lgkmcnt(0)
L_kv_done:
  s_mov_b32 s99, 0xffff0000
  s_mov_b32 s98, 0x3ae38e39
  s_mov_b32 s97, 0x3727c5ac
  v_lshlrev_b32 v8, 16, v180
  v_and_b32 v9, s99, v180
  v_lshlrev_b32 v10, 16, v181
  v_and_b32 v11, s99, v181
  v_lshlrev_b32 v12, 16, v182
  v_and_b32 v13, s99, v182
  v_lshlrev_b32 v14, 16, v183
  v_and_b32 v15, s99, v183
  v_lshlrev_b32 v16, 16, v184
  v_and_b32 v17, s99, v184
  v_lshlrev_b32 v18, 16, v185
  v_and_b32 v19, s99, v185
  v_lshlrev_b32 v20, 16, v186
  v_and_b32 v21, s99, v186
  v_lshlrev_b32 v22, 16, v187
  v_and_b32 v23, s99, v187
  v_lshlrev_b32 v24, 16, v188
  v_and_b32 v25, s99, v188
  v_lshlrev_b32 v26, 16, v189
  v_and_b32 v27, s99, v189
  v_lshlrev_b32 v28, 16, v190
  v_and_b32 v29, s99, v190
  v_lshlrev_b32 v30, 16, v191
  v_and_b32 v31, s99, v191
  v_lshlrev_b32 v32, 16, v192
  v_and_b32 v33, s99, v192
  v_lshlrev_b32 v34, 16, v193
  v_and_b32 v35, s99, v193
  v_lshlrev_b32 v36, 16, v194
  v_and_b32 v37, s99, v194
  v_lshlrev_b32 v38, 16, v195
  v_and_b32 v39, s99, v195
  v_lshlrev_b32 v40, 16, v196
  v_and_b32 v41, s99, v196
  v_lshlrev_b32 v42, 16, v197
  v_and_b32 v43, s99, v197
  v_lshlrev_b32 v44, 16, v198
  v_and_b32 v45, s99, v198
  v_lshlrev_b32 v46, 16, v199
  v_and_b32 v47, s99, v199
  v_lshlrev_b32 v48, 16, v200
  v_and_b32 v49, s99, v200
  v_lshlrev_b32 v50, 16, v201
  v_and_b32 v51, s99, v201
  v_lshlrev_b32 v52, 16, v202
  v_and_b32 v53, s99, v202
  v_lshlrev_b32 v54, 16, v203
  v_and_b32 v55, s99, v203
  v_lshlrev_b32 v56, 16, v204
  v_and_b32 v57, s99, v204
  v_lshlrev_b32 v58, 16, v205
  v_and_b32 v59, s99, v205
  v_lshlrev_b32 v60, 16, v206
  v_and_b32 v61, s99, v206
  v_lshlrev_b32 v62, 16, v207
  v_and_b32 v63, s99, v207
  v_lshlrev_b32 v64, 16, v208
  v_and_b32 v65, s99, v208
  v_lshlrev_b32 v66, 16, v209
  v_and_b32 v67, s99, v209
  v_lshlrev_b32 v68, 16, v210
  v_and_b32 v69, s99, v210
  v_lshlrev_b32 v70, 16, v211
  v_and_b32 v71, s99, v211
  v_lshlrev_b32 v72, 16, v212
  v_and_b32 v73, s99, v212
  v_lshlrev_b32 v74, 16, v213
  v_and_b32 v75, s99, v213
  v_lshlrev_b32 v76, 16, v214
  v_and_b32 v77, s99, v214
  v_lshlrev_b32 v78, 16, v215
  v_and_b32 v79, s99, v215
  v_pk_mul_f32 v[218:219], v[8:9], v[8:9]
  v_pk_mul_f32 v[222:223], v[26:27], v[26:27]
  v_pk_mul_f32 v[226:227], v[44:45], v[44:45]
  v_pk_mul_f32 v[230:231], v[62:63], v[62:63]
  v_pk_fma_f32 v[218:219], v[10:11], v[10:11], v[218:219]
  v_pk_add_f32 v[216:217], v[8:9], v[10:11]
  v_pk_fma_f32 v[222:223], v[28:29], v[28:29], v[222:223]
  v_pk_add_f32 v[220:221], v[26:27], v[28:29]
  v_pk_fma_f32 v[226:227], v[46:47], v[46:47], v[226:227]
  v_pk_add_f32 v[224:225], v[44:45], v[46:47]
  v_pk_fma_f32 v[230:231], v[64:65], v[64:65], v[230:231]
  v_pk_add_f32 v[228:229], v[62:63], v[64:65]
  v_pk_fma_f32 v[218:219], v[12:13], v[12:13], v[218:219]
  v_pk_add_f32 v[216:217], v[216:217], v[12:13]
  v_pk_fma_f32 v[222:223], v[30:31], v[30:31], v[222:223]
  v_pk_add_f32 v[220:221], v[220:221], v[30:31]
  v_pk_fma_f32 v[226:227], v[48:49], v[48:49], v[226:227]
  v_pk_add_f32 v[224:225], v[224:225], v[48:49]
  v_pk_fma_f32 v[230:231], v[66:67], v[66:67], v[230:231]
  v_pk_add_f32 v[228:229], v[228:229], v[66:67]
  v_pk_fma_f32 v[218:219], v[14:15], v[14:15], v[218:219]
  v_pk_add_f32 v[216:217], v[216:217], v[14:15]
  v_pk_fma_f32 v[222:223], v[32:33], v[32:33], v[222:223]
  v_pk_add_f32 v[220:221], v[220:221], v[32:33]
  v_pk_fma_f32 v[226:227], v[50:51], v[50:51], v[226:227]
  v_pk_add_f32 v[224:225], v[224:225], v[50:51]
  v_pk_fma_f32 v[230:231], v[68:69], v[68:69], v[230:231]
  v_pk_add_f32 v[228:229], v[228:229], v[68:69]
  v_pk_fma_f32 v[218:219], v[16:17], v[16:17], v[218:219]
  v_pk_add_f32 v[216:217], v[216:217], v[16:17]
  v_pk_fma_f32 v[222:223], v[34:35], v[34:35], v[222:223]
  v_pk_add_f32 v[220:221], v[220:221], v[34:35]
  v_pk_fma_f32 v[226:227], v[52:53], v[52:53], v[226:227]
  v_pk_add_f32 v[224:225], v[224:225], v[52:53]
  v_pk_fma_f32 v[230:231], v[70:71], v[70:71], v[230:231]
  v_pk_add_f32 v[228:229], v[228:229], v[70:71]
  v_pk_fma_f32 v[218:219], v[18:19], v[18:19], v[218:219]
  v_pk_add_f32 v[216:217], v[216:217], v[18:19]
  v_pk_fma_f32 v[222:223], v[36:37], v[36:37], v[222:223]
  v_pk_add_f32 v[220:221], v[220:221], v[36:37]
  v_pk_fma_f32 v[226:227], v[54:55], v[54:55], v[226:227]
  v_pk_add_f32 v[224:225], v[224:225], v[54:55]
  v_pk_fma_f32 v[230:231], v[72:73], v[72:73], v[230:231]
  v_pk_add_f32 v[228:229], v[228:229], v[72:73]
  v_pk_fma_f32 v[218:219], v[20:21], v[20:21], v[218:219]
  v_pk_add_f32 v[216:217], v[216:217], v[20:21]
  v_pk_fma_f32 v[222:223], v[38:39], v[38:39], v[222:223]
  v_pk_add_f32 v[220:221], v[220:221], v[38:39]
  v_pk_fma_f32 v[226:227], v[56:57], v[56:57], v[226:227]
  v_pk_add_f32 v[224:225], v[224:225], v[56:57]
  v_pk_fma_f32 v[230:231], v[74:75], v[74:75], v[230:231]
  v_pk_add_f32 v[228:229], v[228:229], v[74:75]
  v_pk_fma_f32 v[218:219], v[22:23], v[22:23], v[218:219]
  v_pk_add_f32 v[216:217], v[216:217], v[22:23]
  v_pk_fma_f32 v[222:223], v[40:41], v[40:41], v[222:223]
  v_pk_add_f32 v[220:221], v[220:221], v[40:41]
  v_pk_fma_f32 v[226:227], v[58:59], v[58:59], v[226:227]
  v_pk_add_f32 v[224:225], v[224:225], v[58:59]
  v_pk_fma_f32 v[230:231], v[76:77], v[76:77], v[230:231]
  v_pk_add_f32 v[228:229], v[228:229], v[76:77]
  v_pk_fma_f32 v[218:219], v[24:25], v[24:25], v[218:219]
  v_pk_add_f32 v[216:217], v[216:217], v[24:25]
  v_pk_fma_f32 v[222:223], v[42:43], v[42:43], v[222:223]
  v_pk_add_f32 v[220:221], v[220:221], v[42:43]
  v_pk_fma_f32 v[226:227], v[60:61], v[60:61], v[226:227]
  v_pk_add_f32 v[224:225], v[224:225], v[60:61]
  v_pk_fma_f32 v[230:231], v[78:79], v[78:79], v[230:231]
  v_pk_add_f32 v[228:229], v[228:229], v[78:79]
  v_add_f32 v216, v216, v217
  v_add_f32 v218, v218, v219
  v_add_f32 v220, v220, v221
  v_add_f32 v222, v222, v223
  v_add_f32 v224, v224, v225
  v_add_f32 v226, v226, v227
  v_add_f32 v228, v228, v229
  v_add_f32 v230, v230, v231
  v_add_f32_dpp v216, v216, v216 row_ror:8 row_mask:0xf bank_mask:0xf
  v_add_f32_dpp v220, v220, v220 row_ror:8 row_mask:0xf bank_mask:0xf
  v_add_f32_dpp v224, v224, v224 row_ror:8 row_mask:0xf bank_mask:0xf
  v_add_f32_dpp v228, v228, v228 row_ror:8 row_mask:0xf bank_mask:0xf
  v_add_f32_dpp v218, v218, v218 row_ror:8 row_mask:0xf bank_mask:0xf
  v_add_f32_dpp v222, v222, v222 row_ror:8 row_mask:0xf bank_mask:0xf
  v_add_f32_dpp v226, v226, v226 row_ror:8 row_mask:0xf bank_mask:0xf
  v_add_f32_dpp v230, v230, v230 row_ror:8 row_mask:0xf bank_mask:0xf
  v_add_f32_dpp v216, v216, v216 row_ror:4 row_mask:0xf bank_mask:0xf
  v_add_f32_dpp v220, v220, v220 row_ror:4 row_mask:0xf bank_mask:0xf
  v_add_f32_dpp v224, v224, v224 row_ror:4 row_mask:0xf bank_mask:0xf
  v_add_f32_dpp v228, v228, v228 row_ror:4 row_mask:0xf bank_mask:0xf
  v_add_f32_dpp v218, v218, v218 row_ror:4 row_mask:0xf bank_mask:0xf
  v_add_f32_dpp v222, v222, v222 row_ror:4 row_mask:0xf bank_mask:0xf
  v_add_f32_dpp v226, v226, v226 row_ror:4 row_mask:0xf bank_mask:0xf
  v_add_f32_dpp v230, v230, v230 row_ror:4 row_mask:0xf bank_mask:0xf
  v_add_f32_dpp v216, v216, v216 row_ror:2 row_mask:0xf bank_mask:0xf
  v_add_f32_dpp v220, v220, v220 row_ror:2 row_mask:0xf bank_mask:0xf
  v_add_f32_dpp v224, v224, v224 row_ror:2 row_mask:0xf bank_mask:0xf
  v_add_f32_dpp v228, v228, v228 row_ror:2 row_mask:0xf bank_mask:0xf
  v_add_f32_dpp v218, v218, v218 row_ror:2 row_mask:0xf bank_mask:0xf
  v_add_f32_dpp v222, v222, v222 row_ror:2 row_mask:0xf bank_mask:0xf
  v_add_f32_dpp v226, v226, v226 row_ror:2 row_mask:0xf bank_mask:0xf
  v_add_f32_dpp v230, v230, v230 row_ror:2 row_mask:0xf bank_mask:0xf
  v_add_f32_dpp v216, v216, v216 row_ror:1 row_mask:0xf bank_mask:0xf
  v_add_f32_dpp v220, v220, v220 row_ror:1 row_mask:0xf bank_mask:0xf
  v_add_f32_dpp v224, v224, v224 row_ror:1 row_mask:0xf bank_mask:0xf
  v_add_f32_dpp v228, v228, v228 row_ror:1 row_mask:0xf bank_mask:0xf
  v_add_f32_dpp v218, v218, v218 row_ror:1 row_mask:0xf bank_mask:0xf
  v_add_f32_dpp v222, v222, v222 row_ror:1 row_mask:0xf bank_mask:0xf
  v_add_f32_dpp v226, v226, v226 row_ror:1 row_mask:0xf bank_mask:0xf
  v_add_f32_dpp v230, v230, v230 row_ror:1 row_mask:0xf bank_mask:0xf
  v_mov_b32 v232, v216
  v_mov_b32 v233, v220
  v_mov_b32 v234, v224
  v_mov_b32 v235, v228
  v_mov_b32 v236, v218
  v_mov_b32 v237, v222
  v_mov_b32 v238, v226
  v_mov_b32 v239, v230
  v_permlane16_swap_b32 v216, v232
  v_permlane16_swap_b32 v220, v233
  v_permlane16_swap_b32 v224, v234
  v_permlane16_swap_b32 v228, v235
  v_permlane16_swap_b32 v218, v236
  v_permlane16_swap_b32 v222, v237
  v_permlane16_swap_b32 v226, v238
  v_permlane16_swap_b32 v230, v239
  v_add_f32 v216, v216, v232
  v_add_f32 v220, v220, v233
  v_add_f32 v224, v224, v234
  v_add_f32 v228, v228, v235
  v_add_f32 v218, v218, v236
  v_add_f32 v222, v222, v237
  v_add_f32 v226, v226, v238
  v_add_f32 v230, v230, v239
  v_mul_f32 v216, s98, v216
  v_mul_f32 v218, s98, v218
  v_mul_f32 v220, s98, v220
  v_mul_f32 v222, s98, v222
  v_mul_f32 v224, s98, v224
  v_mul_f32 v226, s98, v226
  v_mul_f32 v228, s98, v228
  v_mul_f32 v230, s98, v230
  v_fma_f32 v218, -v216, v216, v218
  v_fma_f32 v222, -v220, v220, v222
  v_fma_f32 v226, -v224, v224, v226
  v_fma_f32 v230, -v228, v228, v230
  v_max_f32 v218, 0, v218
  v_max_f32 v222, 0, v222
  v_max_f32 v226, 0, v226
  v_max_f32 v230, 0, v230
  v_add_f32 v218, s97, v218
  v_add_f32 v222, s97, v222
  v_add_f32 v226, s97, v226
  v_add_f32 v230, s97, v230
  v_rsq_f32 v218, v218
  v_rsq_f32 v222, v222
  v_rsq_f32 v226, v226
  v_rsq_f32 v230, v230
  v_mul_f32 v217, -v216, v218
  v_mul_f32 v221, -v220, v222
  v_mul_f32 v225, -v224, v226
  v_mul_f32 v229, -v228, v230
  v_mov_b32 v216, v218
  v_mov_b32 v220, v222
  v_mov_b32 v224, v226
  v_mov_b32 v228, v230
  v_and_b32 v2, 15, v1
  v_mul_u32_u24 v2, 400, v2
  v_lshrrev_b32 v5, 4, v1
  v_lshl_add_u32 v2, v5, 3, v2
  s_mul_i32 s6, s3, 96
  s_add_u32 s6, s6, 100352
  v_add_u32 v2, s6, v2
  v_accvgpr_write_b32 a216, v2
  v_add_u32 v2, 0, v0
  v_mul_u32_u24 v5, 2731, v2
  v_lshrrev_b32 v5, 16, v5
  v_mul_u32_u24 v9, 24, v5
  v_sub_u32 v9, v2, v9
  v_mul_u32_u24 v10, 400, v5
  v_lshl_add_u32 v10, v9, 4, v10
  v_add_u32 v10, 100352, v10
  v_accvgpr_write_b32 a217, v10
  s_lshl_b32 s6, s4, 5
  v_add_u32 v5, s6, v5
  s_movk_i32 s7, 1152
  v_mul_lo_u32 v5, v5, s7
  v_lshl_add_u32 v5, v9, 4, v5
  s_mul_i32 s6, s5, 384
  v_add_u32 v5, s6, v5
  v_accvgpr_write_b32 a220, v5
  v_add_u32 v2, 256, v0
  v_mul_u32_u24 v5, 2731, v2
  v_lshrrev_b32 v5, 16, v5
  v_mul_u32_u24 v9, 24, v5
  v_sub_u32 v9, v2, v9
  v_mul_u32_u24 v10, 400, v5
  v_lshl_add_u32 v10, v9, 4, v10
  v_add_u32 v10, 100352, v10
  v_accvgpr_write_b32 a218, v10
  s_lshl_b32 s6, s4, 5
  v_add_u32 v5, s6, v5
  s_movk_i32 s7, 1152
  v_mul_lo_u32 v5, v5, s7
  v_lshl_add_u32 v5, v9, 4, v5
  s_mul_i32 s6, s5, 384
  v_add_u32 v5, s6, v5
  v_accvgpr_write_b32 a221, v5
  v_add_u32 v2, 512, v0
  v_mul_u32_u24 v5, 2731, v2
  v_lshrrev_b32 v5, 16, v5
  v_mul_u32_u24 v9, 24, v5
  v_sub_u32 v9, v2, v9
  v_mul_u32_u24 v10, 400, v5
  v_lshl_add_u32 v10, v9, 4, v10
  v_add_u32 v10, 100352, v10
  v_accvgpr_write_b32 a219, v10
  s_lshl_b32 s6, s4, 5
  v_add_u32 v5, s6, v5
  s_movk_i32 s7, 1152
  v_mul_lo_u32 v5, v5, s7
  v_lshl_add_u32 v5, v9, 4, v5
  s_mul_i32 s6, s5, 384
  v_add_u32 v5, s6, v5
  v_accvgpr_write_b32 a222, v5
  s_cmp_lg_u32 s3, 0
  s_cbranch_scc1 L_wt_4
  v_mov_b32 v252, 73984
  v_mov_b32 v254, 1
  v_mov_b32 v255, 169728
  v_cmp_eq_u32 vcc, 1, v1
  s_nop 1
  v_cndmask_b32 v252, v252, v255, vcc
  s_mov_b32 s77, 0
  s_mov_b64 exec, 0x3
L_poll_5:
  buffer_load_dword v253, v252, s[72:75], 0 offen sc1
  s_waitcnt vmcnt(0)
  v_cmp_lt_u32 vcc, v253, v254
  s_add_u32 s77, s77, 1
  s_cmp_ge_u32 s77, 131072
  s_cbranch_scc1 L_poll_5_x
  s_cbranch_vccz L_poll_5_x
  s_sleep 1
  s_branch L_poll_5
L_poll_5_x:
  s_mov_b64 exec, -1
L_wt_4:
  s_barrier
  s_add_u32 s48, s46, 0x200000
  s_addc_u32 s49, s47, 0
  s_mov_b32 s50, 0x240000
  s_mov_b32 s51, 0x20000
  s_add_u32 s52, s46, 0x440000
  s_addc_u32 s53, s47, 0
  s_mov_b32 s54, 0x240000
  s_mov_b32 s55, 0x20000
  s_mul_i32 s4, s2, 12288
  s_lshl_b32 s5, s3, 10
  s_add_u32 s5, s5, s4
  v_lshl_add_u32 v2, v1, 4, s5
  s_movk_i32 s6, 0
  buffer_load_dwordx4 v[8:11], v2, s[48:51], s6 offen sc1
  s_movk_i32 s6, 4096
  buffer_load_dwordx4 v[12:15], v2, s[48:51], s6 offen sc1
  s_movk_i32 s6, 8192
  buffer_load_dwordx4 v[16:19], v2, s[48:51], s6 offen sc1
  s_mov_b32 s60, s26
  s_mov_b32 s61, s27
  s_mov_b32 s62, 0x480
  s_mov_b32 s63, 0x20000
  s_mul_i32 s8, s2, 3
  s_min_u32 s9, s3, 2
  s_add_u32 s8, s8, s9
  s_lshl_b32 s8, s8, 1
  v_mov_b32 v20, s8
  buffer_load_ushort v23, v20, s[60:63], 0 offen
  v_and_b32 v3, 7, v1
  v_mul_u32_u24 v3, 48, v3
  v_lshrrev_b32 v4, 3, v1
  v_add_u32 v3, v3, v4
  s_lshl_b32 s6, s3, 3
  v_add_u32 v3, s6, v3
  v_lshlrev_b32 v3, 4, v3
  v_add_u32 v3, 105984, v3
  v_and_b32 v4, 7, v1
  v_mul_u32_u24 v4, 4416, v4
  v_lshrrev_b32 v5, 4, v1
  v_bfe_u32 v6, v1, 3, 1
  v_add_u32 v6, v6, v5
  v_lshl_add_u32 v24, v6, 4, v4
  v_mul_u32_u24 v4, 48, v5
  v_and_b32 v6, 15, v1
  v_sub_u32 v4, v4, v6
  v_add_u32 v4, 15, v4
  v_lshlrev_b32 v25, 4, v4
  s_lshr_b32 s5, s2, 3
  s_mul_i32 s4, s5, 21846
  s_lshr_b32 s4, s4, 16
  s_mul_i32 s6, s4, 3
  s_sub_u32 s5, s5, s6
  s_and_b32 s6, s2, 7
  s_lshl_b32 s6, s6, 3
  s_add_u32 s4, s4, s6
  s_add_u32 s64, s46, 0xf84000
  s_addc_u32 s65, s47, 0
  s_mov_b32 s66, 0xa2000
  s_mov_b32 s67, 0x20000
  s_mul_i32 s6, s5, 12
  s_mul_i32 s7, s3, 3
  s_add_u32 s6, s6, s7
  s_mul_i32 s6, s6, 18432
  v_lshl_add_u32 v160, v1, 4, s6
  v_add_u32 v161, 18432, v160
  v_add_u32 v162, 36864, v160
  s_waitcnt vmcnt(3)
  ds_write_b128 v3, v[8:11] offset:0
  s_waitcnt vmcnt(2)
  ds_write_b128 v3, v[12:15] offset:6144
  s_waitcnt vmcnt(1)
  ds_write_b128 v3, v[16:19] offset:12288
  s_waitcnt vmcnt(0)
  v_lshlrev_b32 v23, 16, v23
  s_waitcnt lgkmcnt(0)
  s_barrier
  s_cmp_eq_u32 s3, 3
  s_cbranch_scc1 L_cw3_6
  s_mul_i32 s14, s3, 35328
  v_add_u32 v26, s14, v24
  s_mul_i32 s14, s3, 6144
  s_add_u32 s14, s14, 105984
  v_add_u32 v27, s14, v25
  ds_read_b128 v[32:35], v26 offset:0
  ds_read_b128 v[36:39], v26 offset:32
  ds_read_b128 v[40:43], v26 offset:64
  ds_read_b128 v[44:47], v26 offset:96
  ds_read_b128 v[48:51], v26 offset:128
  ds_read_b128 v[52:55], v26 offset:160
  ds_read_b128 v[56:59], v26 offset:192
  ds_read_b128 v[60:63], v26 offset:224
  ds_read_b128 v[64:67], v26 offset:256
  ds_read_b128 v[68:71], v26 offset:288
  ds_read_b128 v[96:99], v27 offset:0
  ds_read_b128 v[112:115], v27 offset:256
  ds_read_b128 v[100:103], v27 offset:3072
  ds_read_b128 v[116:119], v27 offset:3328
  ds_read_b128 v[104:107], v27 offset:16
  ds_read_b128 v[120:123], v27 offset:272
  ds_read_b128 v[108:111], v27 offset:3088
  ds_read_b128 v[124:127], v27 offset:3344
  s_waitcnt lgkmcnt(7)
  v_mfma_f32_16x16x32_bf16 v[128:131], v[32:35], v[96:99], 0
  ds_read_b128 v[72:75], v26 offset:320
  ds_read_b128 v[76:79], v26 offset:352
  v_mfma_f32_16x16x32_bf16 v[132:135], v[36:39], v[96:99], 0
  v_mfma_f32_16x16x32_bf16 v[136:139], v[40:43], v[96:99], 0
  v_mfma_f32_16x16x32_bf16 v[140:143], v[44:47], v[96:99], 0
  ds_read_b128 v[96:99], v27 offset:32
  s_waitcnt lgkmcnt(9)
  v_mfma_f32_16x16x32_bf16 v[144:147], v[32:35], v[112:115], 0
  v_mfma_f32_16x16x32_bf16 v[148:151], v[36:39], v[112:115], 0
  v_mfma_f32_16x16x32_bf16 v[152:155], v[40:43], v[112:115], 0
  v_mfma_f32_16x16x32_bf16 v[156:159], v[44:47], v[112:115], 0
  ds_read_b128 v[112:115], v27 offset:288
  buffer_load_dwordx4 a[0:3], v160, s[64:67], 0 offen offset:0 sc1
  s_waitcnt lgkmcnt(9)
  v_mfma_f32_16x16x32_bf16 v[128:131], v[40:43], v[100:103], v[128:131]
  ds_read_b128 v[80:83], v26 offset:384
  ds_read_b128 v[84:87], v26 offset:416
  v_mfma_f32_16x16x32_bf16 v[132:135], v[44:47], v[100:103], v[132:135]
  v_mfma_f32_16x16x32_bf16 v[136:139], v[48:51], v[100:103], v[136:139]
  v_mfma_f32_16x16x32_bf16 v[140:143], v[52:55], v[100:103], v[140:143]
  ds_read_b128 v[100:103], v27 offset:3104
  s_waitcnt lgkmcnt(11)
  v_mfma_f32_16x16x32_bf16 v[144:147], v[40:43], v[116:119], v[144:147]
  v_mfma_f32_16x16x32_bf16 v[148:151], v[44:47], v[116:119], v[148:151]
  v_mfma_f32_16x16x32_bf16 v[152:155], v[48:51], v[116:119], v[152:155]
  v_mfma_f32_16x16x32_bf16 v[156:159], v[52:55], v[116:119], v[156:159]
  ds_read_b128 v[116:119], v27 offset:3360
  buffer_load_dwordx4 a[72:75], v161, s[64:67], 0 offen offset:0 sc1
  s_waitcnt lgkmcnt(11)
  v_mfma_f32_16x16x32_bf16 v[128:131], v[48:51], v[104:107], v[128:131]
  ds_read_b128 v[88:91], v26 offset:448
  ds_read_b128 v[92:95], v26 offset:480
  v_mfma_f32_16x16x32_bf16 v[132:135], v[52:55], v[104:107], v[132:135]
  v_mfma_f32_16x16x32_bf16 v[136:139], v[56:59], v[104:107], v[136:139]
  v_mfma_f32_16x16x32_bf16 v[140:143], v[60:63], v[104:107], v[140:143]
  ds_read_b128 v[104:107], v27 offset:48
  s_waitcnt lgkmcnt(13)
  v_mfma_f32_16x16x32_bf16 v[144:147], v[48:51], v[120:123], v[144:147]
  v_mfma_f32_16x16x32_bf16 v[148:151], v[52:55], v[120:123], v[148:151]
  v_mfma_f32_16x16x32_bf16 v[152:155], v[56:59], v[120:123], v[152:155]
  v_mfma_f32_16x16x32_bf16 v[156:159], v[60:63], v[120:123], v[156:159]
  ds_read_b128 v[120:123], v27 offset:304
  buffer_load_dwordx4 a[144:147], v162, s[64:67], 0 offen offset:0 sc1
  s_waitcnt lgkmcnt(13)
  v_mfma_f32_16x16x32_bf16 v[128:131], v[56:59], v[108:111], v[128:131]
  ds_read_b128 v[32:35], v26 offset:512
  ds_read_b128 v[36:39], v26 offset:544
  v_mfma_f32_16x16x32_bf16 v[132:135], v[60:63], v[108:111], v[132:135]
  v_mfma_f32_16x16x32_bf16 v[136:139], v[64:67], v[108:111], v[136:139]
  v_mfma_f32_16x16x32_bf16 v[140:143], v[68:71], v[108:111], v[140:143]
  ds_read_b128 v[108:111], v27 offset:3120
  s_waitcnt lgkmcnt(15)
  v_mfma_f32_16x16x32_bf16 v[144:147], v[56:59], v[124:127], v[144:147]
  v_mfma_f32_16x16x32_bf16 v[148:151], v[60:63], v[124:127], v[148:151]
  v_mfma_f32_16x16x32_bf16 v[152:155], v[64:67], v[124:127], v[152:155]
  v_mfma_f32_16x16x32_bf16 v[156:159], v[68:71], v[124:127], v[156:159]
  ds_read_b128 v[124:127], v27 offset:3376
  buffer_load_dwordx4 a[4:7], v160, s[64:67], 0 offen offset:1024 sc1
  s_waitcnt lgkmcnt(13)
  v_mfma_f32_16x16x32_bf16 v[128:131], v[64:67], v[96:99], v[128:131]
  ds_read_b128 v[40:43], v26 offset:576
  ds_read_b128 v[44:47], v26 offset:608
  v_mfma_f32_16x16x32_bf16 v[132:135], v[68:71], v[96:99], v[132:135]
  v_mfma_f32_16x16x32_bf16 v[136:139], v[72:75], v[96:99], v[136:139]
  v_mfma_f32_16x16x32_bf16 v[140:143], v[76:79], v[96:99], v[140:143]
  ds_read_b128 v[96:99], v27 offset:64
  s_waitcnt lgkmcnt(15)
  v_mfma_f32_16x16x32_bf16 v[144:147], v[64:67], v[112:115], v[144:147]
  v_mfma_f32_16x16x32_bf16 v[148:151], v[68:71], v[112:115], v[148:151]
  v_mfma_f32_16x16x32_bf16 v[152:155], v[72:75], v[112:115], v[152:155]
  v_mfma_f32_16x16x32_bf16 v[156:159], v[76:79], v[112:115], v[156:159]
  buffer_load_dwordx4 a[76:79], v161, s[64:67], 0 offen offset:1024 sc1
  s_waitcnt lgkmcnt(12)
  v_mfma_f32_16x16x32_bf16 v[128:131], v[72:75], v[100:103], v[128:131]
  ds_read_b128 v[48:51], v26 offset:640
  ds_read_b128 v[52:55], v26 offset:672
  v_mfma_f32_16x16x32_bf16 v[132:135], v[76:79], v[100:103], v[132:135]
  v_mfma_f32_16x16x32_bf16 v[136:139], v[80:83], v[100:103], v[136:139]
  v_mfma_f32_16x16x32_bf16 v[140:143], v[84:87], v[100:103], v[140:143]
  ds_read_b128 v[100:103], v27 offset:3136
  s_waitcnt lgkmcnt(14)
  v_mfma_f32_16x16x32_bf16 v[144:147], v[72:75], v[116:119], v[144:147]
  v_mfma_f32_16x16x32_bf16 v[148:151], v[76:79], v[116:119], v[148:151]
  v_mfma_f32_16x16x32_bf16 v[152:155], v[80:83], v[116:119], v[152:155]
  v_mfma_f32_16x16x32_bf16 v[156:159], v[84:87], v[116:119], v[156:159]
  buffer_load_dwordx4 a[148:151], v162, s[64:67], 0 offen offset:1024 sc1
  s_waitcnt lgkmcnt(11)
  v_mfma_f32_16x16x32_bf16 v[128:131], v[80:83], v[104:107], v[128:131]
  ds_read_b128 v[56:59], v26 offset:704
  ds_read_b128 v[60:63], v26 offset:736
  v_mfma_f32_16x16x32_bf16 v[132:135], v[84:87], v[104:107], v[132:135]
  v_mfma_f32_16x16x32_bf16 v[136:139], v[88:91], v[104:107], v[136:139]
  v_mfma_f32_16x16x32_bf16 v[140:143], v[92:95], v[104:107], v[140:143]
  ds_read_b128 v[104:107], v27 offset:80
  s_waitcnt lgkmcnt(13)
  v_mfma_f32_16x16x32_bf16 v[144:147], v[80:83], v[120:123], v[144:147]
  v_mfma_f32_16x16x32_bf16 v[148:151], v[84:87], v[120:123], v[148:151]
  v_mfma_f32_16x16x32_bf16 v[152:155], v[88:91], v[120:123], v[152:155]
  v_mfma_f32_16x16x32_bf16 v[156:159], v[92:95], v[120:123], v[156:159]
  buffer_load_dwordx4 a[8:11], v160, s[64:67], 0 offen offset:2048 sc1
  s_waitcnt lgkmcnt(10)
  v_mfma_f32_16x16x32_bf16 v[128:131], v[88:91], v[108:111], v[128:131]
  ds_read_b128 v[64:67], v26 offset:768
  ds_read_b128 v[68:71], v26 offset:800
  v_mfma_f32_16x16x32_bf16 v[132:135], v[92:95], v[108:111], v[132:135]
  v_mfma_f32_16x16x32_bf16 v[136:139], v[32:35], v[108:111], v[136:139]
  v_mfma_f32_16x16x32_bf16 v[140:143], v[36:39], v[108:111], v[140:143]
  ds_read_b128 v[108:111], v27 offset:3152
  s_waitcnt lgkmcnt(12)
  v_mfma_f32_16x16x32_bf16 v[144:147], v[88:91], v[124:127], v[144:147]
  v_mfma_f32_16x16x32_bf16 v[148:151], v[92:95], v[124:127], v[148:151]
  v_mfma_f32_16x16x32_bf16 v[152:155], v[32:35], v[124:127], v[152:155]
  v_mfma_f32_16x16x32_bf16 v[156:159], v[36:39], v[124:127], v[156:159]
  buffer_load_dwordx4 a[80:83], v161, s[64:67], 0 offen offset:2048 sc1
  s_waitcnt lgkmcnt(9)
  v_mfma_f32_16x16x32_bf16 v[128:131], v[32:35], v[96:99], v[128:131]
  ds_read_b128 v[72:75], v26 offset:832
  ds_read_b128 v[76:79], v26 offset:864
  v_mfma_f32_16x16x32_bf16 v[132:135], v[36:39], v[96:99], v[132:135]
  v_mfma_f32_16x16x32_bf16 v[136:139], v[40:43], v[96:99], v[136:139]
  v_mfma_f32_16x16x32_bf16 v[140:143], v[44:47], v[96:99], v[140:143]
  ds_read_b128 v[96:99], v27 offset:96
  buffer_load_dwordx4 a[152:155], v162, s[64:67], 0 offen offset:2048 sc1
  s_waitcnt lgkmcnt(9)
  v_mfma_f32_16x16x32_bf16 v[128:131], v[40:43], v[100:103], v[128:131]
  ds_read_b128 v[80:83], v26 offset:896
  ds_read_b128 v[84:87], v26 offset:928
  v_mfma_f32_16x16x32_bf16 v[132:135], v[44:47], v[100:103], v[132:135]
  v_mfma_f32_16x16x32_bf16 v[136:139], v[48:51], v[100:103], v[136:139]
  v_mfma_f32_16x16x32_bf16 v[140:143], v[52:55], v[100:103], v[140:143]
  ds_read_b128 v[100:103], v27 offset:3168
  buffer_load_dwordx4 a[12:15], v160, s[64:67], 0 offen offset:3072 sc1
  s_waitcnt lgkmcnt(9)
  v_mfma_f32_16x16x32_bf16 v[128:131], v[48:51], v[104:107], v[128:131]
  ds_read_b128 v[88:91], v26 offset:960
  ds_read_b128 v[92:95], v26 offset:992
  v_mfma_f32_16x16x32_bf16 v[132:135], v[52:55], v[104:107], v[132:135]
  v_mfma_f32_16x16x32_bf16 v[136:139], v[56:59], v[104:107], v[136:139]
  v_mfma_f32_16x16x32_bf16 v[140:143], v[60:63], v[104:107], v[140:143]
  ds_read_b128 v[104:107], v27 offset:112
  buffer_load_dwordx4 a[84:87], v161, s[64:67], 0 offen offset:3072 sc1
  s_waitcnt lgkmcnt(9)
  v_mfma_f32_16x16x32_bf16 v[128:131], v[56:59], v[108:111], v[128:131]
  ds_read_b128 v[32:35], v26 offset:1024
  ds_read_b128 v[36:39], v26 offset:1056
  v_mfma_f32_16x16x32_bf16 v[132:135], v[60:63], v[108:111], v[132:135]
  v_mfma_f32_16x16x32_bf16 v[136:139], v[64:67], v[108:111], v[136:139]
  v_mfma_f32_16x16x32_bf16 v[140:143], v[68:71], v[108:111], v[140:143]
  ds_read_b128 v[108:111], v27 offset:3184
  buffer_load_dwordx4 a[156:159], v162, s[64:67], 0 offen offset:3072 sc1
  s_waitcnt lgkmcnt(9)
  v_mfma_f32_16x16x32_bf16 v[128:131], v[64:67], v[96:99], v[128:131]
  ds_read_b128 v[40:43], v26 offset:1088
  ds_read_b128 v[44:47], v26 offset:1120
  v_mfma_f32_16x16x32_bf16 v[132:135], v[68:71], v[96:99], v[132:135]
  v_mfma_f32_16x16x32_bf16 v[136:139], v[72:75], v[96:99], v[136:139]
  v_mfma_f32_16x16x32_bf16 v[140:143], v[76:79], v[96:99], v[140:143]
  ds_read_b128 v[96:99], v27 offset:128
  v_add_u32 v160, 4096, v160
  buffer_load_dwordx4 a[16:19], v160, s[64:67], 0 offen offset:0 sc1
  s_waitcnt lgkmcnt(9)
  v_mfma_f32_16x16x32_bf16 v[128:131], v[72:75], v[100:103], v[128:131]
  ds_read_b128 v[48:51], v26 offset:1152
  ds_read_b128 v[52:55], v26 offset:1184
  v_mfma_f32_16x16x32_bf16 v[132:135], v[76:79], v[100:103], v[132:135]
  v_mfma_f32_16x16x32_bf16 v[136:139], v[80:83], v[100:103], v[136:139]
  v_mfma_f32_16x16x32_bf16 v[140:143], v[84:87], v[100:103], v[140:143]
  ds_read_b128 v[100:103], v27 offset:3200
  v_add_u32 v161, 4096, v161
  buffer_load_dwordx4 a[88:91], v161, s[64:67], 0 offen offset:0 sc1
  s_waitcnt lgkmcnt(9)
  v_mfma_f32_16x16x32_bf16 v[128:131], v[80:83], v[104:107], v[128:131]
  ds_read_b128 v[56:59], v26 offset:1216
  ds_read_b128 v[60:63], v26 offset:1248
  v_mfma_f32_16x16x32_bf16 v[132:135], v[84:87], v[104:107], v[132:135]
  v_mfma_f32_16x16x32_bf16 v[136:139], v[88:91], v[104:107], v[136:139]
  v_mfma_f32_16x16x32_bf16 v[140:143], v[92:95], v[104:107], v[140:143]
  ds_read_b128 v[104:107], v27 offset:144
  v_add_u32 v162, 4096, v162
  buffer_load_dwordx4 a[160:163], v162, s[64:67], 0 offen offset:0 sc1
  s_waitcnt lgkmcnt(9)
  v_mfma_f32_16x16x32_bf16 v[128:131], v[88:91], v[108:111], v[128:131]
  ds_read_b128 v[64:67], v26 offset:1280
  ds_read_b128 v[68:71], v26 offset:1312
  v_mfma_f32_16x16x32_bf16 v[132:135], v[92:95], v[108:111], v[132:135]
  v_mfma_f32_16x16x32_bf16 v[136:139], v[32:35], v[108:111], v[136:139]
  v_mfma_f32_16x16x32_bf16 v[140:143], v[36:39], v[108:111], v[140:143]
  ds_read_b128 v[108:111], v27 offset:3216
  buffer_load_dwordx4 a[20:23], v160, s[64:67], 0 offen offset:1024 sc1
  s_waitcnt lgkmcnt(9)
  v_mfma_f32_16x16x32_bf16 v[128:131], v[32:35], v[96:99], v[128:131]
  ds_read_b128 v[72:75], v26 offset:1344
  ds_read_b128 v[76:79], v26 offset:1376
  v_mfma_f32_16x16x32_bf16 v[132:135], v[36:39], v[96:99], v[132:135]
  v_mfma_f32_16x16x32_bf16 v[136:139], v[40:43], v[96:99], v[136:139]
  v_mfma_f32_16x16x32_bf16 v[140:143], v[44:47], v[96:99], v[140:143]
  ds_read_b128 v[96:99], v27 offset:160
  buffer_load_dwordx4 a[92:95], v161, s[64:67], 0 offen offset:1024 sc1
  s_waitcnt lgkmcnt(9)
  v_mfma_f32_16x16x32_bf16 v[128:131], v[40:43], v[100:103], v[128:131]
  ds_read_b128 v[80:83], v26 offset:1408
  ds_read_b128 v[84:87], v26 offset:1440
  v_mfma_f32_16x16x32_bf16 v[132:135], v[44:47], v[100:103], v[132:135]
  v_mfma_f32_16x16x32_bf16 v[136:139], v[48:51], v[100:103], v[136:139]
  v_mfma_f32_16x16x32_bf16 v[140:143], v[52:55], v[100:103], v[140:143]
  ds_read_b128 v[100:103], v27 offset:3232
  buffer_load_dwordx4 a[164:167], v162, s[64:67], 0 offen offset:1024 sc1
  s_waitcnt lgkmcnt(9)
  v_mfma_f32_16x16x32_bf16 v[128:131], v[48:51], v[104:107], v[128:131]
  ds_read_b128 v[88:91], v26 offset:1472
  ds_read_b128 v[92:95], v26 offset:1504
  v_mfma_f32_16x16x32_bf16 v[132:135], v[52:55], v[104:107], v[132:135]
  v_mfma_f32_16x16x32_bf16 v[136:139], v[56:59], v[104:107], v[136:139]
  v_mfma_f32_16x16x32_bf16 v[140:143], v[60:63], v[104:107], v[140:143]
  ds_read_b128 v[104:107], v27 offset:176
  buffer_load_dwordx4 a[24:27], v160, s[64:67], 0 offen offset:2048 sc1
  s_waitcnt lgkmcnt(9)
  v_mfma_f32_16x16x32_bf16 v[128:131], v[56:59], v[108:111], v[128:131]
  ds_read_b128 v[32:35], v26 offset:1536
  ds_read_b128 v[36:39], v26 offset:1568
  v_mfma_f32_16x16x32_bf16 v[132:135], v[60:63], v[108:111], v[132:135]
  v_mfma_f32_16x16x32_bf16 v[136:139], v[64:67], v[108:111], v[136:139]
  v_mfma_f32_16x16x32_bf16 v[140:143], v[68:71], v[108:111], v[140:143]
  ds_read_b128 v[108:111], v27 offset:3248
  buffer_load_dwordx4 a[96:99], v161, s[64:67], 0 offen offset:2048 sc1
  s_waitcnt lgkmcnt(9)
  v_mfma_f32_16x16x32_bf16 v[128:131], v[64:67], v[96:99], v[128:131]
  ds_read_b128 v[40:43], v26 offset:1600
  ds_read_b128 v[44:47], v26 offset:1632
  v_mfma_f32_16x16x32_bf16 v[132:135], v[68:71], v[96:99], v[132:135]
  v_mfma_f32_16x16x32_bf16 v[136:139], v[72:75], v[96:99], v[136:139]
  v_mfma_f32_16x16x32_bf16 v[140:143], v[76:79], v[96:99], v[140:143]
  ds_read_b128 v[96:99], v27 offset:192
  buffer_load_dwordx4 a[168:171], v162, s[64:67], 0 offen offset:2048 sc1
  s_waitcnt lgkmcnt(9)
  v_mfma_f32_16x16x32_bf16 v[128:131], v[72:75], v[100:103], v[128:131]
  ds_read_b128 v[48:51], v26 offset:1664
  ds_read_b128 v[52:55], v26 offset:1696
  v_mfma_f32_16x16x32_bf16 v[132:135], v[76:79], v[100:103], v[132:135]
  v_mfma_f32_16x16x32_bf16 v[136:139], v[80:83], v[100:103], v[136:139]
  v_mfma_f32_16x16x32_bf16 v[140:143], v[84:87], v[100:103], v[140:143]
  ds_read_b128 v[100:103], v27 offset:3264
  buffer_load_dwordx4 a[28:31], v160, s[64:67], 0 offen offset:3072 sc1
  s_waitcnt lgkmcnt(9)
  v_mfma_f32_16x16x32_bf16 v[128:131], v[80:83], v[104:107], v[128:131]
  ds_read_b128 v[56:59], v26 offset:1728
  ds_read_b128 v[60:63], v26 offset:1760
  v_mfma_f32_16x16x32_bf16 v[132:135], v[84:87], v[104:107], v[132:135]
  v_mfma_f32_16x16x32_bf16 v[136:139], v[88:91], v[104:107], v[136:139]
  v_mfma_f32_16x16x32_bf16 v[140:143], v[92:95], v[104:107], v[140:143]
  ds_read_b128 v[104:107], v27 offset:208
  buffer_load_dwordx4 a[100:103], v161, s[64:67], 0 offen offset:3072 sc1
  s_waitcnt lgkmcnt(9)
  v_mfma_f32_16x16x32_bf16 v[128:131], v[88:91], v[108:111], v[128:131]
  ds_read_b128 v[64:67], v26 offset:1792
  ds_read_b128 v[68:71], v26 offset:1824
  v_mfma_f32_16x16x32_bf16 v[132:135], v[92:95], v[108:111], v[132:135]
  v_mfma_f32_16x16x32_bf16 v[136:139], v[32:35], v[108:111], v[136:139]
  v_mfma_f32_16x16x32_bf16 v[140:143], v[36:39], v[108:111], v[140:143]
  ds_read_b128 v[108:111], v27 offset:3280
  buffer_load_dwordx4 a[172:175], v162, s[64:67], 0 offen offset:3072 sc1
  s_waitcnt lgkmcnt(9)
  v_mfma_f32_16x16x32_bf16 v[128:131], v[32:35], v[96:99], v[128:131]
  ds_read_b128 v[72:75], v26 offset:1856
  ds_read_b128 v[76:79], v26 offset:1888
  v_mfma_f32_16x16x32_bf16 v[132:135], v[36:39], v[96:99], v[132:135]
  v_mfma_f32_16x16x32_bf16 v[136:139], v[40:43], v[96:99], v[136:139]
  v_mfma_f32_16x16x32_bf16 v[140:143], v[44:47], v[96:99], v[140:143]
  ds_read_b128 v[96:99], v27 offset:224
  v_add_u32 v160, 4096, v160
  buffer_load_dwordx4 a[32:35], v160, s[64:67], 0 offen offset:0 sc1
  s_waitcnt lgkmcnt(9)
  v_mfma_f32_16x16x32_bf16 v[128:131], v[40:43], v[100:103], v[128:131]
  ds_read_b128 v[80:83], v26 offset:1920
  ds_read_b128 v[84:87], v26 offset:1952
  v_mfma_f32_16x16x32_bf16 v[132:135], v[44:47], v[100:103], v[132:135]
  v_mfma_f32_16x16x32_bf16 v[136:139], v[48:51], v[100:103], v[136:139]
  v_mfma_f32_16x16x32_bf16 v[140:143], v[52:55], v[100:103], v[140:143]
  ds_read_b128 v[100:103], v27 offset:3296
  v_add_u32 v161, 4096, v161
  buffer_load_dwordx4 a[104:107], v161, s[64:67], 0 offen offset:0 sc1
  s_waitcnt lgkmcnt(9)
  v_mfma_f32_16x16x32_bf16 v[128:131], v[48:51], v[104:107], v[128:131]
  ds_read_b128 v[88:91], v26 offset:1984
  ds_read_b128 v[92:95], v26 offset:2016
  v_mfma_f32_16x16x32_bf16 v[132:135], v[52:55], v[104:107], v[132:135]
  v_mfma_f32_16x16x32_bf16 v[136:139], v[56:59], v[104:107], v[136:139]
  v_mfma_f32_16x16x32_bf16 v[140:143], v[60:63], v[104:107], v[140:143]
  ds_read_b128 v[104:107], v27 offset:240
  v_add_u32 v162, 4096, v162
  buffer_load_dwordx4 a[176:179], v162, s[64:67], 0 offen offset:0 sc1
  s_waitcnt lgkmcnt(9)
  v_mfma_f32_16x16x32_bf16 v[128:131], v[56:59], v[108:111], v[128:131]
  ds_read_b128 v[32:35], v26 offset:2048
  ds_read_b128 v[36:39], v26 offset:2080
  v_mfma_f32_16x16x32_bf16 v[132:135], v[60:63], v[108:111], v[132:135]
  v_mfma_f32_16x16x32_bf16 v[136:139], v[64:67], v[108:111], v[136:139]
  v_mfma_f32_16x16x32_bf16 v[140:143], v[68:71], v[108:111], v[140:143]
  ds_read_b128 v[108:111], v27 offset:3312
  buffer_load_dwordx4 a[36:39], v160, s[64:67], 0 offen offset:1024 sc1
  s_waitcnt lgkmcnt(9)
  v_mfma_f32_16x16x32_bf16 v[128:131], v[64:67], v[96:99], v[128:131]
  ds_read_b128 v[40:43], v26 offset:2112
  ds_read_b128 v[44:47], v26 offset:2144
  v_mfma_f32_16x16x32_bf16 v[132:135], v[68:71], v[96:99], v[132:135]
  v_mfma_f32_16x16x32_bf16 v[136:139], v[72:75], v[96:99], v[136:139]
  v_mfma_f32_16x16x32_bf16 v[140:143], v[76:79], v[96:99], v[140:143]
  ds_read_b128 v[96:99], v27 offset:256
  buffer_load_dwordx4 a[108:111], v161, s[64:67], 0 offen offset:1024 sc1
  s_waitcnt lgkmcnt(9)
  v_mfma_f32_16x16x32_bf16 v[128:131], v[72:75], v[100:103], v[128:131]
  ds_read_b128 v[48:51], v26 offset:2176
  ds_read_b128 v[52:55], v26 offset:2208
  v_mfma_f32_16x16x32_bf16 v[132:135], v[76:79], v[100:103], v[132:135]
  v_mfma_f32_16x16x32_bf16 v[136:139], v[80:83], v[100:103], v[136:139]
  v_mfma_f32_16x16x32_bf16 v[140:143], v[84:87], v[100:103], v[140:143]
  ds_read_b128 v[100:103], v27 offset:3328
  buffer_load_dwordx4 a[180:183], v162, s[64:67], 0 offen offset:1024 sc1
  s_waitcnt lgkmcnt(9)
  v_mfma_f32_16x16x32_bf16 v[128:131], v[80:83], v[104:107], v[128:131]
  ds_read_b128 v[56:59], v26 offset:2240
  ds_read_b128 v[60:63], v26 offset:2272
  v_mfma_f32_16x16x32_bf16 v[132:135], v[84:87], v[104:107], v[132:135]
  v_mfma_f32_16x16x32_bf16 v[136:139], v[88:91], v[104:107], v[136:139]
  v_mfma_f32_16x16x32_bf16 v[140:143], v[92:95], v[104:107], v[140:143]
  ds_read_b128 v[104:107], v27 offset:272
  buffer_load_dwordx4 a[40:43], v160, s[64:67], 0 offen offset:2048 sc1
  s_waitcnt lgkmcnt(9)
  v_mfma_f32_16x16x32_bf16 v[128:131], v[88:91], v[108:111], v[128:131]
  ds_read_b128 v[64:67], v26 offset:2304
  ds_read_b128 v[68:71], v26 offset:2336
  v_mfma_f32_16x16x32_bf16 v[132:135], v[92:95], v[108:111], v[132:135]
  v_mfma_f32_16x16x32_bf16 v[136:139], v[32:35], v[108:111], v[136:139]
  v_mfma_f32_16x16x32_bf16 v[140:143], v[36:39], v[108:111], v[140:143]
  ds_read_b128 v[108:111], v27 offset:3344
  buffer_load_dwordx4 a[112:115], v161, s[64:67], 0 offen offset:2048 sc1
  s_waitcnt lgkmcnt(9)
  v_mfma_f32_16x16x32_bf16 v[128:131], v[32:35], v[96:99], v[128:131]
  ds_read_b128 v[72:75], v26 offset:2368
  ds_read_b128 v[76:79], v26 offset:2400
  v_mfma_f32_16x16x32_bf16 v[132:135], v[36:39], v[96:99], v[132:135]
  v_mfma_f32_16x16x32_bf16 v[136:139], v[40:43], v[96:99], v[136:139]
  v_mfma_f32_16x16x32_bf16 v[140:143], v[44:47], v[96:99], v[140:143]
  ds_read_b128 v[96:99], v27 offset:288
  buffer_load_dwordx4 a[184:187], v162, s[64:67], 0 offen offset:2048 sc1
  s_waitcnt lgkmcnt(9)
  v_mfma_f32_16x16x32_bf16 v[128:131], v[40:43], v[100:103], v[128:131]
  ds_read_b128 v[80:83], v26 offset:2432
  ds_read_b128 v[84:87], v26 offset:2464
  v_mfma_f32_16x16x32_bf16 v[132:135], v[44:47], v[100:103], v[132:135]
  v_mfma_f32_16x16x32_bf16 v[136:139], v[48:51], v[100:103], v[136:139]
  v_mfma_f32_16x16x32_bf16 v[140:143], v[52:55], v[100:103], v[140:143]
  ds_read_b128 v[100:103], v27 offset:3360
  buffer_load_dwordx4 a[44:47], v160, s[64:67], 0 offen offset:3072 sc1
  s_waitcnt lgkmcnt(9)
  v_mfma_f32_16x16x32_bf16 v[128:131], v[48:51], v[104:107], v[128:131]
  ds_read_b128 v[88:91], v26 offset:2496
  ds_read_b128 v[92:95], v26 offset:2528
  v_mfma_f32_16x16x32_bf16 v[132:135], v[52:55], v[104:107], v[132:135]
  v_mfma_f32_16x16x32_bf16 v[136:139], v[56:59], v[104:107], v[136:139]
  v_mfma_f32_16x16x32_bf16 v[140:143], v[60:63], v[104:107], v[140:143]
  ds_read_b128 v[104:107], v27 offset:304
  buffer_load_dwordx4 a[116:119], v161, s[64:67], 0 offen offset:3072 sc1
  s_waitcnt lgkmcnt(9)
  v_mfma_f32_16x16x32_bf16 v[128:131], v[56:59], v[108:111], v[128:131]
  ds_read_b128 v[32:35], v26 offset:2560
  ds_read_b128 v[36:39], v26 offset:2592
  v_mfma_f32_16x16x32_bf16 v[132:135], v[60:63], v[108:111], v[132:135]
  v_mfma_f32_16x16x32_bf16 v[136:139], v[64:67], v[108:111], v[136:139]
  v_mfma_f32_16x16x32_bf16 v[140:143], v[68:71], v[108:111], v[140:143]
  ds_read_b128 v[108:111], v27 offset:3376
  buffer_load_dwordx4 a[188:191], v162, s[64:67], 0 offen offset:3072 sc1
  s_waitcnt lgkmcnt(9)
  v_mfma_f32_16x16x32_bf16 v[128:131], v[64:67], v[96:99], v[128:131]
  ds_read_b128 v[40:43], v26 offset:2624
  ds_read_b128 v[44:47], v26 offset:2656
  v_mfma_f32_16x16x32_bf16 v[132:135], v[68:71], v[96:99], v[132:135]
  v_mfma_f32_16x16x32_bf16 v[136:139], v[72:75], v[96:99], v[136:139]
  v_mfma_f32_16x16x32_bf16 v[140:143], v[76:79], v[96:99], v[140:143]
  ds_read_b128 v[96:99], v27 offset:320
  v_add_u32 v160, 4096, v160
  buffer_load_dwordx4 a[48:51], v160, s[64:67], 0 offen offset:0 sc1
  s_waitcnt lgkmcnt(9)
  v_mfma_f32_16x16x32_bf16 v[128:131], v[72:75], v[100:103], v[128:131]
  ds_read_b128 v[48:51], v26 offset:2688
  ds_read_b128 v[52:55], v26 offset:2720
  v_mfma_f32_16x16x32_bf16 v[132:135], v[76:79], v[100:103], v[132:135]
  v_mfma_f32_16x16x32_bf16 v[136:139], v[80:83], v[100:103], v[136:139]
  v_mfma_f32_16x16x32_bf16 v[140:143], v[84:87], v[100:103], v[140:143]
  ds_read_b128 v[100:103], v27 offset:3392
  v_add_u32 v161, 4096, v161
  buffer_load_dwordx4 a[120:123], v161, s[64:67], 0 offen offset:0 sc1
  s_waitcnt lgkmcnt(9)
  v_mfma_f32_16x16x32_bf16 v[128:131], v[80:83], v[104:107], v[128:131]
  ds_read_b128 v[56:59], v26 offset:2752
  ds_read_b128 v[60:63], v26 offset:2784
  v_mfma_f32_16x16x32_bf16 v[132:135], v[84:87], v[104:107], v[132:135]
  v_mfma_f32_16x16x32_bf16 v[136:139], v[88:91], v[104:107], v[136:139]
  v_mfma_f32_16x16x32_bf16 v[140:143], v[92:95], v[104:107], v[140:143]
  ds_read_b128 v[104:107], v27 offset:336
  v_add_u32 v162, 4096, v162
  buffer_load_dwordx4 a[192:195], v162, s[64:67], 0 offen offset:0 sc1
  s_waitcnt lgkmcnt(9)
  v_mfma_f32_16x16x32_bf16 v[128:131], v[88:91], v[108:111], v[128:131]
  ds_read_b128 v[64:67], v26 offset:2816
  ds_read_b128 v[68:71], v26 offset:2848
  v_mfma_f32_16x16x32_bf16 v[132:135], v[92:95], v[108:111], v[132:135]
  v_mfma_f32_16x16x32_bf16 v[136:139], v[32:35], v[108:111], v[136:139]
  v_mfma_f32_16x16x32_bf16 v[140:143], v[36:39], v[108:111], v[140:143]
  ds_read_b128 v[108:111], v27 offset:3408
  buffer_load_dwordx4 a[52:55], v160, s[64:67], 0 offen offset:1024 sc1
  s_waitcnt lgkmcnt(9)
  v_mfma_f32_16x16x32_bf16 v[128:131], v[32:35], v[96:99], v[128:131]
  ds_read_b128 v[72:75], v26 offset:2880
  ds_read_b128 v[76:79], v26 offset:2912
  v_mfma_f32_16x16x32_bf16 v[132:135], v[36:39], v[96:99], v[132:135]
  v_mfma_f32_16x16x32_bf16 v[136:139], v[40:43], v[96:99], v[136:139]
  v_mfma_f32_16x16x32_bf16 v[140:143], v[44:47], v[96:99], v[140:143]
  ds_read_b128 v[96:99], v27 offset:352
  buffer_load_dwordx4 a[124:127], v161, s[64:67], 0 offen offset:1024 sc1
  s_waitcnt lgkmcnt(9)
  v_mfma_f32_16x16x32_bf16 v[128:131], v[40:43], v[100:103], v[128:131]
  ds_read_b128 v[80:83], v26 offset:2944
  ds_read_b128 v[84:87], v26 offset:2976
  v_mfma_f32_16x16x32_bf16 v[132:135], v[44:47], v[100:103], v[132:135]
  v_mfma_f32_16x16x32_bf16 v[136:139], v[48:51], v[100:103], v[136:139]
  v_mfma_f32_16x16x32_bf16 v[140:143], v[52:55], v[100:103], v[140:143]
  ds_read_b128 v[100:103], v27 offset:3424
  buffer_load_dwordx4 a[196:199], v162, s[64:67], 0 offen offset:1024 sc1
  s_waitcnt lgkmcnt(9)
  v_mfma_f32_16x16x32_bf16 v[128:131], v[48:51], v[104:107], v[128:131]
  ds_read_b128 v[88:91], v26 offset:3008
  ds_read_b128 v[92:95], v26 offset:3040
  v_mfma_f32_16x16x32_bf16 v[132:135], v[52:55], v[104:107], v[132:135]
  v_mfma_f32_16x16x32_bf16 v[136:139], v[56:59], v[104:107], v[136:139]
  v_mfma_f32_16x16x32_bf16 v[140:143], v[60:63], v[104:107], v[140:143]
  ds_read_b128 v[104:107], v27 offset:368
  buffer_load_dwordx4 a[56:59], v160, s[64:67], 0 offen offset:2048 sc1
  s_waitcnt lgkmcnt(9)
  v_mfma_f32_16x16x32_bf16 v[128:131], v[56:59], v[108:111], v[128:131]
  ds_read_b128 v[32:35], v26 offset:3072
  ds_read_b128 v[36:39], v26 offset:3104
  v_mfma_f32_16x16x32_bf16 v[132:135], v[60:63], v[108:111], v[132:135]
  v_mfma_f32_16x16x32_bf16 v[136:139], v[64:67], v[108:111], v[136:139]
  v_mfma_f32_16x16x32_bf16 v[140:143], v[68:71], v[108:111], v[140:143]
  ds_read_b128 v[108:111], v27 offset:3440
  buffer_load_dwordx4 a[128:131], v161, s[64:67], 0 offen offset:2048 sc1
  s_waitcnt lgkmcnt(9)
  v_mfma_f32_16x16x32_bf16 v[128:131], v[64:67], v[96:99], v[128:131]
  ds_read_b128 v[40:43], v26 offset:3136
  ds_read_b128 v[44:47], v26 offset:3168
  v_mfma_f32_16x16x32_bf16 v[132:135], v[68:71], v[96:99], v[132:135]
  v_mfma_f32_16x16x32_bf16 v[136:139], v[72:75], v[96:99], v[136:139]
  v_mfma_f32_16x16x32_bf16 v[140:143], v[76:79], v[96:99], v[140:143]
  ds_read_b128 v[96:99], v27 offset:384
  buffer_load_dwordx4 a[200:203], v162, s[64:67], 0 offen offset:2048 sc1
  s_waitcnt lgkmcnt(9)
  v_mfma_f32_16x16x32_bf16 v[128:131], v[72:75], v[100:103], v[128:131]
  ds_read_b128 v[48:51], v26 offset:3200
  ds_read_b128 v[52:55], v26 offset:3232
  v_mfma_f32_16x16x32_bf16 v[132:135], v[76:79], v[100:103], v[132:135]
  v_mfma_f32_16x16x32_bf16 v[136:139], v[80:83], v[100:103], v[136:139]
  v_mfma_f32_16x16x32_bf16 v[140:143], v[84:87], v[100:103], v[140:143]
  ds_read_b128 v[100:103], v27 offset:3456
  buffer_load_dwordx4 a[60:63], v160, s[64:67], 0 offen offset:3072 sc1
  s_waitcnt lgkmcnt(9)
  v_mfma_f32_16x16x32_bf16 v[128:131], v[80:83], v[104:107], v[128:131]
  ds_read_b128 v[56:59], v26 offset:3264
  ds_read_b128 v[60:63], v26 offset:3296
  v_mfma_f32_16x16x32_bf16 v[132:135], v[84:87], v[104:107], v[132:135]
  v_mfma_f32_16x16x32_bf16 v[136:139], v[88:91], v[104:107], v[136:139]
  v_mfma_f32_16x16x32_bf16 v[140:143], v[92:95], v[104:107], v[140:143]
  ds_read_b128 v[104:107], v27 offset:400
  buffer_load_dwordx4 a[132:135], v161, s[64:67], 0 offen offset:3072 sc1
  s_waitcnt lgkmcnt(9)
  v_mfma_f32_16x16x32_bf16 v[128:131], v[88:91], v[108:111], v[128:131]
  ds_read_b128 v[64:67], v26 offset:3328
  ds_read_b128 v[68:71], v26 offset:3360
  v_mfma_f32_16x16x32_bf16 v[132:135], v[92:95], v[108:111], v[132:135]
  v_mfma_f32_16x16x32_bf16 v[136:139], v[32:35], v[108:111], v[136:139]
  v_mfma_f32_16x16x32_bf16 v[140:143], v[36:39], v[108:111], v[140:143]
  ds_read_b128 v[108:111], v27 offset:3472
  buffer_load_dwordx4 a[204:207], v162, s[64:67], 0 offen offset:3072 sc1
  s_waitcnt lgkmcnt(9)
  v_mfma_f32_16x16x32_bf16 v[128:131], v[32:35], v[96:99], v[128:131]
  ds_read_b128 v[72:75], v26 offset:3392
  ds_read_b128 v[76:79], v26 offset:3424
  v_mfma_f32_16x16x32_bf16 v[132:135], v[36:39], v[96:99], v[132:135]
  v_mfma_f32_16x16x32_bf16 v[136:139], v[40:43], v[96:99], v[136:139]
  v_mfma_f32_16x16x32_bf16 v[140:143], v[44:47], v[96:99], v[140:143]
  ds_read_b128 v[96:99], v27 offset:416
  v_add_u32 v160, 4096, v160
  buffer_load_dwordx4 a[64:67], v160, s[64:67], 0 offen offset:0 sc1
  s_waitcnt lgkmcnt(9)
  v_mfma_f32_16x16x32_bf16 v[128:131], v[40:43], v[100:103], v[128:131]
  ds_read_b128 v[80:83], v26 offset:3456
  ds_read_b128 v[84:87], v26 offset:3488
  v_mfma_f32_16x16x32_bf16 v[132:135], v[44:47], v[100:103], v[132:135]
  v_mfma_f32_16x16x32_bf16 v[136:139], v[48:51], v[100:103], v[136:139]
  v_mfma_f32_16x16x32_bf16 v[140:143], v[52:55], v[100:103], v[140:143]
  ds_read_b128 v[100:103], v27 offset:3488
  v_add_u32 v161, 4096, v161
  buffer_load_dwordx4 a[136:139], v161, s[64:67], 0 offen offset:0 sc1
  s_waitcnt lgkmcnt(9)
  v_mfma_f32_16x16x32_bf16 v[128:131], v[48:51], v[104:107], v[128:131]
  ds_read_b128 v[88:91], v26 offset:3520
  ds_read_b128 v[92:95], v26 offset:3552
  v_mfma_f32_16x16x32_bf16 v[132:135], v[52:55], v[104:107], v[132:135]
  v_mfma_f32_16x16x32_bf16 v[136:139], v[56:59], v[104:107], v[136:139]
  v_mfma_f32_16x16x32_bf16 v[140:143], v[60:63], v[104:107], v[140:143]
  ds_read_b128 v[104:107], v27 offset:432
  v_add_u32 v162, 4096, v162
  buffer_load_dwordx4 a[208:211], v162, s[64:67], 0 offen offset:0 sc1
  s_waitcnt lgkmcnt(9)
  v_mfma_f32_16x16x32_bf16 v[128:131], v[56:59], v[108:111], v[128:131]
  ds_read_b128 v[32:35], v26 offset:3584
  ds_read_b128 v[36:39], v26 offset:3616
  v_mfma_f32_16x16x32_bf16 v[132:135], v[60:63], v[108:111], v[132:135]
  v_mfma_f32_16x16x32_bf16 v[136:139], v[64:67], v[108:111], v[136:139]
  v_mfma_f32_16x16x32_bf16 v[140:143], v[68:71], v[108:111], v[140:143]
  ds_read_b128 v[108:111], v27 offset:3504
  buffer_load_dwordx4 a[68:71], v160, s[64:67], 0 offen offset:1024 sc1
  s_waitcnt lgkmcnt(9)
  v_mfma_f32_16x16x32_bf16 v[128:131], v[64:67], v[96:99], v[128:131]
  ds_read_b128 v[40:43], v26 offset:3648
  ds_read_b128 v[44:47], v26 offset:3680
  v_mfma_f32_16x16x32_bf16 v[132:135], v[68:71], v[96:99], v[132:135]
  v_mfma_f32_16x16x32_bf16 v[136:139], v[72:75], v[96:99], v[136:139]
  v_mfma_f32_16x16x32_bf16 v[140:143], v[76:79], v[96:99], v[140:143]
  ds_read_b128 v[96:99], v27 offset:448
  buffer_load_dwordx4 a[140:143], v161, s[64:67], 0 offen offset:1024 sc1
  s_waitcnt lgkmcnt(9)
  v_mfma_f32_16x16x32_bf16 v[128:131], v[72:75], v[100:103], v[128:131]
  ds_read_b128 v[48:51], v26 offset:3712
  ds_read_b128 v[52:55], v26 offset:3744
  v_mfma_f32_16x16x32_bf16 v[132:135], v[76:79], v[100:103], v[132:135]
  v_mfma_f32_16x16x32_bf16 v[136:139], v[80:83], v[100:103], v[136:139]
  v_mfma_f32_16x16x32_bf16 v[140:143], v[84:87], v[100:103], v[140:143]
  ds_read_b128 v[100:103], v27 offset:3520
  buffer_load_dwordx4 a[212:215], v162, s[64:67], 0 offen offset:1024 sc1
  s_waitcnt lgkmcnt(9)
  v_mfma_f32_16x16x32_bf16 v[128:131], v[80:83], v[104:107], v[128:131]
  ds_read_b128 v[56:59], v26 offset:3776
  ds_read_b128 v[60:63], v26 offset:3808
  v_mfma_f32_16x16x32_bf16 v[132:135], v[84:87], v[104:107], v[132:135]
  v_mfma_f32_16x16x32_bf16 v[136:139], v[88:91], v[104:107], v[136:139]
  v_mfma_f32_16x16x32_bf16 v[140:143], v[92:95], v[104:107], v[140:143]
  ds_read_b128 v[104:107], v27 offset:464
  s_waitcnt lgkmcnt(9)
  v_mfma_f32_16x16x32_bf16 v[128:131], v[88:91], v[108:111], v[128:131]
  ds_read_b128 v[64:67], v26 offset:3840
  ds_read_b128 v[68:71], v26 offset:3872
  v_mfma_f32_16x16x32_bf16 v[132:135], v[92:95], v[108:111], v[132:135]
  v_mfma_f32_16x16x32_bf16 v[136:139], v[32:35], v[108:111], v[136:139]
  v_mfma_f32_16x16x32_bf16 v[140:143], v[36:39], v[108:111], v[140:143]
  ds_read_b128 v[108:111], v27 offset:3536
  s_waitcnt lgkmcnt(9)
  v_mfma_f32_16x16x32_bf16 v[128:131], v[32:35], v[96:99], v[128:131]
  ds_read_b128 v[72:75], v26 offset:3904
  ds_read_b128 v[76:79], v26 offset:3936
  v_mfma_f32_16x16x32_bf16 v[132:135], v[36:39], v[96:99], v[132:135]
  v_mfma_f32_16x16x32_bf16 v[136:139], v[40:43], v[96:99], v[136:139]
  v_mfma_f32_16x16x32_bf16 v[140:143], v[44:47], v[96:99], v[140:143]
  ds_read_b128 v[96:99], v27 offset:480
  s_waitcnt lgkmcnt(9)
  v_mfma_f32_16x16x32_bf16 v[128:131], v[40:43], v[100:103], v[128:131]
  ds_read_b128 v[80:83], v26 offset:3968
  ds_read_b128 v[84:87], v26 offset:4000
  v_mfma_f32_16x16x32_bf16 v[132:135], v[44:47], v[100:103], v[132:135]
  v_mfma_f32_16x16x32_bf16 v[136:139], v[48:51], v[100:103], v[136:139]
  v_mfma_f32_16x16x32_bf16 v[140:143], v[52:55], v[100:103], v[140:143]
  ds_read_b128 v[100:103], v27 offset:3552
  s_waitcnt lgkmcnt(9)
  v_mfma_f32_16x16x32_bf16 v[128:131], v[48:51], v[104:107], v[128:131]
  ds_read_b128 v[88:91], v26 offset:4032
  ds_read_b128 v[92:95], v26 offset:4064
  v_mfma_f32_16x16x32_bf16 v[132:135], v[52:55], v[104:107], v[132:135]
  v_mfma_f32_16x16x32_bf16 v[136:139], v[56:59], v[104:107], v[136:139]
  v_mfma_f32_16x16x32_bf16 v[140:143], v[60:63], v[104:107], v[140:143]
  ds_read_b128 v[104:107], v27 offset:496
  s_waitcnt lgkmcnt(9)
  v_mfma_f32_16x16x32_bf16 v[128:131], v[56:59], v[108:111], v[128:131]
  ds_read_b128 v[32:35], v26 offset:4096
  ds_read_b128 v[36:39], v26 offset:4128
  v_mfma_f32_16x16x32_bf16 v[132:135], v[60:63], v[108:111], v[132:135]
  v_mfma_f32_16x16x32_bf16 v[136:139], v[64:67], v[108:111], v[136:139]
  v_mfma_f32_16x16x32_bf16 v[140:143], v[68:71], v[108:111], v[140:143]
  ds_read_b128 v[108:111], v27 offset:3568
  s_waitcnt lgkmcnt(9)
  v_mfma_f32_16x16x32_bf16 v[128:131], v[64:67], v[96:99], v[128:131]
  v_mfma_f32_16x16x32_bf16 v[132:135], v[68:71], v[96:99], v[132:135]
  v_mfma_f32_16x16x32_bf16 v[136:139], v[72:75], v[96:99], v[136:139]
  v_mfma_f32_16x16x32_bf16 v[140:143], v[76:79], v[96:99], v[140:143]
  s_waitcnt lgkmcnt(6)
  v_mfma_f32_16x16x32_bf16 v[128:131], v[72:75], v[100:103], v[128:131]
  v_mfma_f32_16x16x32_bf16 v[132:135], v[76:79], v[100:103], v[132:135]
  v_mfma_f32_16x16x32_bf16 v[136:139], v[80:83], v[100:103], v[136:139]
  v_mfma_f32_16x16x32_bf16 v[140:143], v[84:87], v[100:103], v[140:143]
  s_waitcnt lgkmcnt(3)
  v_mfma_f32_16x16x32_bf16 v[128:131], v[80:83], v[104:107], v[128:131]
  v_mfma_f32_16x16x32_bf16 v[132:135], v[84:87], v[104:107], v[132:135]
  v_mfma_f32_16x16x32_bf16 v[136:139], v[88:91], v[104:107], v[136:139]
  v_mfma_f32_16x16x32_bf16 v[140:143], v[92:95], v[104:107], v[140:143]
  s_waitcnt lgkmcnt(0)
  v_mfma_f32_16x16x32_bf16 v[128:131], v[88:91], v[108:111], v[128:131]
  v_mfma_f32_16x16x32_bf16 v[132:135], v[92:95], v[108:111], v[132:135]
  v_mfma_f32_16x16x32_bf16 v[136:139], v[32:35], v[108:111], v[136:139]
  v_mfma_f32_16x16x32_bf16 v[140:143], v[36:39], v[108:111], v[140:143]
  v_mov_b32 v174, 161024
  buffer_load_dword v174, v174, s[72:75], 0 offen sc1
  s_branch L_cj_7
L_cw3_6:
  v_add_u32 v26, 0, v24
  v_add_u32 v27, 105984, v25
  ds_read_b128 v[32:35], v26 offset:512
  ds_read_b128 v[36:39], v26 offset:544
  ds_read_b128 v[40:43], v26 offset:576
  ds_read_b128 v[44:47], v26 offset:608
  ds_read_b128 v[48:51], v26 offset:640
  ds_read_b128 v[52:55], v26 offset:672
  ds_read_b128 v[56:59], v26 offset:704
  ds_read_b128 v[60:63], v26 offset:736
  ds_read_b128 v[64:67], v26 offset:768
  ds_read_b128 v[68:71], v26 offset:800
  ds_read_b128 v[112:115], v27 offset:320
  ds_read_b128 v[116:119], v27 offset:3392
  ds_read_b128 v[120:123], v27 offset:336
  ds_read_b128 v[124:127], v27 offset:3408
  s_waitcnt lgkmcnt(3)
  v_mfma_f32_16x16x32_bf16 v[144:147], v[32:35], v[112:115], 0
  ds_read_b128 v[72:75], v26 offset:832
  ds_read_b128 v[76:79], v26 offset:864
  v_mfma_f32_16x16x32_bf16 v[148:151], v[36:39], v[112:115], 0
  v_mfma_f32_16x16x32_bf16 v[152:155], v[40:43], v[112:115], 0
  v_mfma_f32_16x16x32_bf16 v[156:159], v[44:47], v[112:115], 0
  ds_read_b128 v[112:115], v27 offset:352
  buffer_load_dwordx4 a[0:3], v160, s[64:67], 0 offen offset:0 sc1
  s_waitcnt lgkmcnt(5)
  v_mfma_f32_16x16x32_bf16 v[144:147], v[40:43], v[116:119], v[144:147]
  ds_read_b128 v[80:83], v26 offset:896
  ds_read_b128 v[84:87], v26 offset:928
  v_mfma_f32_16x16x32_bf16 v[148:151], v[44:47], v[116:119], v[148:151]
  v_mfma_f32_16x16x32_bf16 v[152:155], v[48:51], v[116:119], v[152:155]
  v_mfma_f32_16x16x32_bf16 v[156:159], v[52:55], v[116:119], v[156:159]
  ds_read_b128 v[116:119], v27 offset:3424
  buffer_load_dwordx4 a[72:75], v161, s[64:67], 0 offen offset:0 sc1
  s_waitcnt lgkmcnt(7)
  v_mfma_f32_16x16x32_bf16 v[144:147], v[48:51], v[120:123], v[144:147]
  ds_read_b128 v[88:91], v26 offset:960
  ds_read_b128 v[92:95], v26 offset:992
  v_mfma_f32_16x16x32_bf16 v[148:151], v[52:55], v[120:123], v[148:151]
  v_mfma_f32_16x16x32_bf16 v[152:155], v[56:59], v[120:123], v[152:155]
  v_mfma_f32_16x16x32_bf16 v[156:159], v[60:63], v[120:123], v[156:159]
  ds_read_b128 v[120:123], v27 offset:368
  buffer_load_dwordx4 a[144:147], v162, s[64:67], 0 offen offset:0 sc1
  s_waitcnt lgkmcnt(9)
  v_mfma_f32_16x16x32_bf16 v[144:147], v[56:59], v[124:127], v[144:147]
  ds_read_b128 v[32:35], v26 offset:1024
  ds_read_b128 v[36:39], v26 offset:1056
  v_mfma_f32_16x16x32_bf16 v[148:151], v[60:63], v[124:127], v[148:151]
  v_mfma_f32_16x16x32_bf16 v[152:155], v[64:67], v[124:127], v[152:155]
  v_mfma_f32_16x16x32_bf16 v[156:159], v[68:71], v[124:127], v[156:159]
  ds_read_b128 v[124:127], v27 offset:3440
  buffer_load_dwordx4 a[4:7], v160, s[64:67], 0 offen offset:1024 sc1
  s_waitcnt lgkmcnt(9)
  v_mfma_f32_16x16x32_bf16 v[144:147], v[64:67], v[112:115], v[144:147]
  ds_read_b128 v[40:43], v26 offset:1088
  ds_read_b128 v[44:47], v26 offset:1120
  v_mfma_f32_16x16x32_bf16 v[148:151], v[68:71], v[112:115], v[148:151]
  v_mfma_f32_16x16x32_bf16 v[152:155], v[72:75], v[112:115], v[152:155]
  v_mfma_f32_16x16x32_bf16 v[156:159], v[76:79], v[112:115], v[156:159]
  ds_read_b128 v[112:115], v27 offset:384
  buffer_load_dwordx4 a[76:79], v161, s[64:67], 0 offen offset:1024 sc1
  s_waitcnt lgkmcnt(9)
  v_mfma_f32_16x16x32_bf16 v[144:147], v[72:75], v[116:119], v[144:147]
  ds_read_b128 v[48:51], v26 offset:1152
  ds_read_b128 v[52:55], v26 offset:1184
  v_mfma_f32_16x16x32_bf16 v[148:151], v[76:79], v[116:119], v[148:151]
  v_mfma_f32_16x16x32_bf16 v[152:155], v[80:83], v[116:119], v[152:155]
  v_mfma_f32_16x16x32_bf16 v[156:159], v[84:87], v[116:119], v[156:159]
  ds_read_b128 v[116:119], v27 offset:3456
  buffer_load_dwordx4 a[148:151], v162, s[64:67], 0 offen offset:1024 sc1
  s_waitcnt lgkmcnt(9)
  v_mfma_f32_16x16x32_bf16 v[144:147], v[80:83], v[120:123], v[144:147]
  ds_read_b128 v[56:59], v26 offset:1216
  ds_read_b128 v[60:63], v26 offset:1248
  v_mfma_f32_16x16x32_bf16 v[148:151], v[84:87], v[120:123], v[148:151]
  v_mfma_f32_16x16x32_bf16 v[152:155], v[88:91], v[120:123], v[152:155]
  v_mfma_f32_16x16x32_bf16 v[156:159], v[92:95], v[120:123], v[156:159]
  ds_read_b128 v[120:123], v27 offset:400
  buffer_load_dwordx4 a[8:11], v160, s[64:67], 0 offen offset:2048 sc1
  s_waitcnt lgkmcnt(9)
  v_mfma_f32_16x16x32_bf16 v[144:147], v[88:91], v[124:127], v[144:147]
  ds_read_b128 v[64:67], v26 offset:1280
  ds_read_b128 v[68:71], v26 offset:1312
  v_mfma_f32_16x16x32_bf16 v[148:151], v[92:95], v[124:127], v[148:151]
  v_mfma_f32_16x16x32_bf16 v[152:155], v[32:35], v[124:127], v[152:155]
  v_mfma_f32_16x16x32_bf16 v[156:159], v[36:39], v[124:127], v[156:159]
  ds_read_b128 v[124:127], v27 offset:3472
  buffer_load_dwordx4 a[80:83], v161, s[64:67], 0 offen offset:2048 sc1
  s_waitcnt lgkmcnt(9)
  v_mfma_f32_16x16x32_bf16 v[144:147], v[32:35], v[112:115], v[144:147]
  ds_read_b128 v[72:75], v26 offset:1344
  ds_read_b128 v[76:79], v26 offset:1376
  v_mfma_f32_16x16x32_bf16 v[148:151], v[36:39], v[112:115], v[148:151]
  v_mfma_f32_16x16x32_bf16 v[152:155], v[40:43], v[112:115], v[152:155]
  v_mfma_f32_16x16x32_bf16 v[156:159], v[44:47], v[112:115], v[156:159]
  ds_read_b128 v[112:115], v27 offset:416
  buffer_load_dwordx4 a[152:155], v162, s[64:67], 0 offen offset:2048 sc1
  s_waitcnt lgkmcnt(9)
  v_mfma_f32_16x16x32_bf16 v[144:147], v[40:43], v[116:119], v[144:147]
  ds_read_b128 v[80:83], v26 offset:1408
  ds_read_b128 v[84:87], v26 offset:1440
  v_mfma_f32_16x16x32_bf16 v[148:151], v[44:47], v[116:119], v[148:151]
  v_mfma_f32_16x16x32_bf16 v[152:155], v[48:51], v[116:119], v[152:155]
  v_mfma_f32_16x16x32_bf16 v[156:159], v[52:55], v[116:119], v[156:159]
  ds_read_b128 v[116:119], v27 offset:3488
  buffer_load_dwordx4 a[12:15], v160, s[64:67], 0 offen offset:3072 sc1
  s_waitcnt lgkmcnt(9)
  v_mfma_f32_16x16x32_bf16 v[144:147], v[48:51], v[120:123], v[144:147]
  ds_read_b128 v[88:91], v26 offset:1472
  ds_read_b128 v[92:95], v26 offset:1504
  v_mfma_f32_16x16x32_bf16 v[148:151], v[52:55], v[120:123], v[148:151]
  v_mfma_f32_16x16x32_bf16 v[152:155], v[56:59], v[120:123], v[152:155]
  v_mfma_f32_16x16x32_bf16 v[156:159], v[60:63], v[120:123], v[156:159]
  ds_read_b128 v[120:123], v27 offset:432
  buffer_load_dwordx4 a[84:87], v161, s[64:67], 0 offen offset:3072 sc1
  s_waitcnt lgkmcnt(9)
  v_mfma_f32_16x16x32_bf16 v[144:147], v[56:59], v[124:127], v[144:147]
  ds_read_b128 v[32:35], v26 offset:1536
  ds_read_b128 v[36:39], v26 offset:1568
  v_mfma_f32_16x16x32_bf16 v[148:151], v[60:63], v[124:127], v[148:151]
  v_mfma_f32_16x16x32_bf16 v[152:155], v[64:67], v[124:127], v[152:155]
  v_mfma_f32_16x16x32_bf16 v[156:159], v[68:71], v[124:127], v[156:159]
  ds_read_b128 v[124:127], v27 offset:3504
  buffer_load_dwordx4 a[156:159], v162, s[64:67], 0 offen offset:3072 sc1
  s_waitcnt lgkmcnt(9)
  v_mfma_f32_16x16x32_bf16 v[144:147], v[64:67], v[112:115], v[144:147]
  ds_read_b128 v[40:43], v26 offset:1600
  ds_read_b128 v[44:47], v26 offset:1632
  v_mfma_f32_16x16x32_bf16 v[148:151], v[68:71], v[112:115], v[148:151]
  v_mfma_f32_16x16x32_bf16 v[152:155], v[72:75], v[112:115], v[152:155]
  v_mfma_f32_16x16x32_bf16 v[156:159], v[76:79], v[112:115], v[156:159]
  ds_read_b128 v[112:115], v27 offset:448
  v_add_u32 v160, 4096, v160
  buffer_load_dwordx4 a[16:19], v160, s[64:67], 0 offen offset:0 sc1
  s_waitcnt lgkmcnt(9)
  v_mfma_f32_16x16x32_bf16 v[144:147], v[72:75], v[116:119], v[144:147]
  ds_read_b128 v[48:51], v26 offset:1664
  ds_read_b128 v[52:55], v26 offset:1696
  v_mfma_f32_16x16x32_bf16 v[148:151], v[76:79], v[116:119], v[148:151]
  v_mfma_f32_16x16x32_bf16 v[152:155], v[80:83], v[116:119], v[152:155]
  v_mfma_f32_16x16x32_bf16 v[156:159], v[84:87], v[116:119], v[156:159]
  ds_read_b128 v[116:119], v27 offset:3520
  v_add_u32 v161, 4096, v161
  buffer_load_dwordx4 a[88:91], v161, s[64:67], 0 offen offset:0 sc1
  s_waitcnt lgkmcnt(9)
  v_mfma_f32_16x16x32_bf16 v[144:147], v[80:83], v[120:123], v[144:147]
  ds_read_b128 v[56:59], v26 offset:1728
  ds_read_b128 v[60:63], v26 offset:1760
  v_mfma_f32_16x16x32_bf16 v[148:151], v[84:87], v[120:123], v[148:151]
  v_mfma_f32_16x16x32_bf16 v[152:155], v[88:91], v[120:123], v[152:155]
  v_mfma_f32_16x16x32_bf16 v[156:159], v[92:95], v[120:123], v[156:159]
  ds_read_b128 v[120:123], v27 offset:464
  v_add_u32 v162, 4096, v162
  buffer_load_dwordx4 a[160:163], v162, s[64:67], 0 offen offset:0 sc1
  s_waitcnt lgkmcnt(9)
  v_mfma_f32_16x16x32_bf16 v[144:147], v[88:91], v[124:127], v[144:147]
  ds_read_b128 v[64:67], v26 offset:1792
  ds_read_b128 v[68:71], v26 offset:1824
  v_mfma_f32_16x16x32_bf16 v[148:151], v[92:95], v[124:127], v[148:151]
  v_mfma_f32_16x16x32_bf16 v[152:155], v[32:35], v[124:127], v[152:155]
  v_mfma_f32_16x16x32_bf16 v[156:159], v[36:39], v[124:127], v[156:159]
  ds_read_b128 v[124:127], v27 offset:3536
  buffer_load_dwordx4 a[20:23], v160, s[64:67], 0 offen offset:1024 sc1
  s_waitcnt lgkmcnt(9)
  v_mfma_f32_16x16x32_bf16 v[144:147], v[32:35], v[112:115], v[144:147]
  ds_read_b128 v[72:75], v26 offset:1856
  ds_read_b128 v[76:79], v26 offset:1888
  v_mfma_f32_16x16x32_bf16 v[148:151], v[36:39], v[112:115], v[148:151]
  v_mfma_f32_16x16x32_bf16 v[152:155], v[40:43], v[112:115], v[152:155]
  v_mfma_f32_16x16x32_bf16 v[156:159], v[44:47], v[112:115], v[156:159]
  ds_read_b128 v[112:115], v27 offset:480
  buffer_load_dwordx4 a[92:95], v161, s[64:67], 0 offen offset:1024 sc1
  s_waitcnt lgkmcnt(9)
  v_mfma_f32_16x16x32_bf16 v[144:147], v[40:43], v[116:119], v[144:147]
  ds_read_b128 v[80:83], v26 offset:1920
  ds_read_b128 v[84:87], v26 offset:1952
  v_mfma_f32_16x16x32_bf16 v[148:151], v[44:47], v[116:119], v[148:151]
  v_mfma_f32_16x16x32_bf16 v[152:155], v[48:51], v[116:119], v[152:155]
  v_mfma_f32_16x16x32_bf16 v[156:159], v[52:55], v[116:119], v[156:159]
  ds_read_b128 v[116:119], v27 offset:3552
  buffer_load_dwordx4 a[164:167], v162, s[64:67], 0 offen offset:1024 sc1
  s_waitcnt lgkmcnt(9)
  v_mfma_f32_16x16x32_bf16 v[144:147], v[48:51], v[120:123], v[144:147]
  ds_read_b128 v[88:91], v26 offset:1984
  ds_read_b128 v[92:95], v26 offset:2016
  v_mfma_f32_16x16x32_bf16 v[148:151], v[52:55], v[120:123], v[148:151]
  v_mfma_f32_16x16x32_bf16 v[152:155], v[56:59], v[120:123], v[152:155]
  v_mfma_f32_16x16x32_bf16 v[156:159], v[60:63], v[120:123], v[156:159]
  ds_read_b128 v[120:123], v27 offset:496
  buffer_load_dwordx4 a[24:27], v160, s[64:67], 0 offen offset:2048 sc1
  s_waitcnt lgkmcnt(9)
  v_mfma_f32_16x16x32_bf16 v[144:147], v[56:59], v[124:127], v[144:147]
  ds_read_b128 v[32:35], v26 offset:2048
  ds_read_b128 v[36:39], v26 offset:2080
  v_mfma_f32_16x16x32_bf16 v[148:151], v[60:63], v[124:127], v[148:151]
  v_mfma_f32_16x16x32_bf16 v[152:155], v[64:67], v[124:127], v[152:155]
  v_mfma_f32_16x16x32_bf16 v[156:159], v[68:71], v[124:127], v[156:159]
  ds_read_b128 v[124:127], v27 offset:3568
  buffer_load_dwordx4 a[96:99], v161, s[64:67], 0 offen offset:2048 sc1
  s_waitcnt lgkmcnt(9)
  v_mfma_f32_16x16x32_bf16 v[144:147], v[64:67], v[112:115], v[144:147]
  v_mfma_f32_16x16x32_bf16 v[148:151], v[68:71], v[112:115], v[148:151]
  v_mfma_f32_16x16x32_bf16 v[152:155], v[72:75], v[112:115], v[152:155]
  v_mfma_f32_16x16x32_bf16 v[156:159], v[76:79], v[112:115], v[156:159]
  buffer_load_dwordx4 a[168:171], v162, s[64:67], 0 offen offset:2048 sc1
  s_waitcnt lgkmcnt(6)
  v_mfma_f32_16x16x32_bf16 v[144:147], v[72:75], v[116:119], v[144:147]
  v_mfma_f32_16x16x32_bf16 v[148:151], v[76:79], v[116:119], v[148:151]
  v_mfma_f32_16x16x32_bf16 v[152:155], v[80:83], v[116:119], v[152:155]
  v_mfma_f32_16x16x32_bf16 v[156:159], v[84:87], v[116:119], v[156:159]
  buffer_load_dwordx4 a[28:31], v160, s[64:67], 0 offen offset:3072 sc1
  s_waitcnt lgkmcnt(3)
  v_mfma_f32_16x16x32_bf16 v[144:147], v[80:83], v[120:123], v[144:147]
  v_mfma_f32_16x16x32_bf16 v[148:151], v[84:87], v[120:123], v[148:151]
  v_mfma_f32_16x16x32_bf16 v[152:155], v[88:91], v[120:123], v[152:155]
  v_mfma_f32_16x16x32_bf16 v[156:159], v[92:95], v[120:123], v[156:159]
  buffer_load_dwordx4 a[100:103], v161, s[64:67], 0 offen offset:3072 sc1
  s_waitcnt lgkmcnt(0)
  v_mfma_f32_16x16x32_bf16 v[144:147], v[88:91], v[124:127], v[144:147]
  v_mfma_f32_16x16x32_bf16 v[148:151], v[92:95], v[124:127], v[148:151]
  v_mfma_f32_16x16x32_bf16 v[152:155], v[32:35], v[124:127], v[152:155]
  v_mfma_f32_16x16x32_bf16 v[156:159], v[36:39], v[124:127], v[156:159]
  buffer_load_dwordx4 a[172:175], v162, s[64:67], 0 offen offset:3072 sc1
  v_lshlrev_b32 v2, 4, v1
  v_add_u32 v2, 124416, v2
  s_nop 1
  ds_write_b128 v2, v[144:147] offset:0
  s_nop 1
  ds_write_b128 v2, v[148:151] offset:1024
  s_nop 1
  ds_write_b128 v2, v[152:155] offset:2048
  s_nop 1
  ds_write_b128 v2, v[156:159] offset:3072
  v_add_u32 v26, 35328, v24
  v_add_u32 v27, 112128, v25
  ds_read_b128 v[32:35], v26 offset:512
  ds_read_b128 v[36:39], v26 offset:544
  ds_read_b128 v[40:43], v26 offset:576
  ds_read_b128 v[44:47], v26 offset:608
  ds_read_b128 v[48:51], v26 offset:640
  ds_read_b128 v[52:55], v26 offset:672
  ds_read_b128 v[56:59], v26 offset:704
  ds_read_b128 v[60:63], v26 offset:736
  ds_read_b128 v[64:67], v26 offset:768
  ds_read_b128 v[68:71], v26 offset:800
  ds_read_b128 v[112:115], v27 offset:320
  ds_read_b128 v[116:119], v27 offset:3392
  ds_read_b128 v[120:123], v27 offset:336
  ds_read_b128 v[124:127], v27 offset:3408
  s_waitcnt lgkmcnt(3)
  v_mfma_f32_16x16x32_bf16 v[128:131], v[32:35], v[112:115], 0
  ds_read_b128 v[72:75], v26 offset:832
  ds_read_b128 v[76:79], v26 offset:864
  v_mfma_f32_16x16x32_bf16 v[132:135], v[36:39], v[112:115], 0
  v_mfma_f32_16x16x32_bf16 v[136:139], v[40:43], v[112:115], 0
  v_mfma_f32_16x16x32_bf16 v[140:143], v[44:47], v[112:115], 0
  ds_read_b128 v[112:115], v27 offset:352
  v_add_u32 v160, 4096, v160
  buffer_load_dwordx4 a[32:35], v160, s[64:67], 0 offen offset:0 sc1
  s_waitcnt lgkmcnt(5)
  v_mfma_f32_16x16x32_bf16 v[128:131], v[40:43], v[116:119], v[128:131]
  ds_read_b128 v[80:83], v26 offset:896
  ds_read_b128 v[84:87], v26 offset:928
  v_mfma_f32_16x16x32_bf16 v[132:135], v[44:47], v[116:119], v[132:135]
  v_mfma_f32_16x16x32_bf16 v[136:139], v[48:51], v[116:119], v[136:139]
  v_mfma_f32_16x16x32_bf16 v[140:143], v[52:55], v[116:119], v[140:143]
  ds_read_b128 v[116:119], v27 offset:3424
  v_add_u32 v161, 4096, v161
  buffer_load_dwordx4 a[104:107], v161, s[64:67], 0 offen offset:0 sc1
  s_waitcnt lgkmcnt(7)
  v_mfma_f32_16x16x32_bf16 v[128:131], v[48:51], v[120:123], v[128:131]
  ds_read_b128 v[88:91], v26 offset:960
  ds_read_b128 v[92:95], v26 offset:992
  v_mfma_f32_16x16x32_bf16 v[132:135], v[52:55], v[120:123], v[132:135]
  v_mfma_f32_16x16x32_bf16 v[136:139], v[56:59], v[120:123], v[136:139]
  v_mfma_f32_16x16x32_bf16 v[140:143], v[60:63], v[120:123], v[140:143]
  ds_read_b128 v[120:123], v27 offset:368
  v_add_u32 v162, 4096, v162
  buffer_load_dwordx4 a[176:179], v162, s[64:67], 0 offen offset:0 sc1
  s_waitcnt lgkmcnt(9)
  v_mfma_f32_16x16x32_bf16 v[128:131], v[56:59], v[124:127], v[128:131]
  ds_read_b128 v[32:35], v26 offset:1024
  ds_read_b128 v[36:39], v26 offset:1056
  v_mfma_f32_16x16x32_bf16 v[132:135], v[60:63], v[124:127], v[132:135]
  v_mfma_f32_16x16x32_bf16 v[136:139], v[64:67], v[124:127], v[136:139]
  v_mfma_f32_16x16x32_bf16 v[140:143], v[68:71], v[124:127], v[140:143]
  ds_read_b128 v[124:127], v27 offset:3440
  buffer_load_dwordx4 a[36:39], v160, s[64:67], 0 offen offset:1024 sc1
  s_waitcnt lgkmcnt(9)
  v_mfma_f32_16x16x32_bf16 v[128:131], v[64:67], v[112:115], v[128:131]
  ds_read_b128 v[40:43], v26 offset:1088
  ds_read_b128 v[44:47], v26 offset:1120
  v_mfma_f32_16x16x32_bf16 v[132:135], v[68:71], v[112:115], v[132:135]
  v_mfma_f32_16x16x32_bf16 v[136:139], v[72:75], v[112:115], v[136:139]
  v_mfma_f32_16x16x32_bf16 v[140:143], v[76:79], v[112:115], v[140:143]
  ds_read_b128 v[112:115], v27 offset:384
  buffer_load_dwordx4 a[108:111], v161, s[64:67], 0 offen offset:1024 sc1
  s_waitcnt lgkmcnt(9)
  v_mfma_f32_16x16x32_bf16 v[128:131], v[72:75], v[116:119], v[128:131]
  ds_read_b128 v[48:51], v26 offset:1152
  ds_read_b128 v[52:55], v26 offset:1184
  v_mfma_f32_16x16x32_bf16 v[132:135], v[76:79], v[116:119], v[132:135]
  v_mfma_f32_16x16x32_bf16 v[136:139], v[80:83], v[116:119], v[136:139]
  v_mfma_f32_16x16x32_bf16 v[140:143], v[84:87], v[116:119], v[140:143]
  ds_read_b128 v[116:119], v27 offset:3456
  buffer_load_dwordx4 a[180:183], v162, s[64:67], 0 offen offset:1024 sc1
  s_waitcnt lgkmcnt(9)
  v_mfma_f32_16x16x32_bf16 v[128:131], v[80:83], v[120:123], v[128:131]
  ds_read_b128 v[56:59], v26 offset:1216
  ds_read_b128 v[60:63], v26 offset:1248
  v_mfma_f32_16x16x32_bf16 v[132:135], v[84:87], v[120:123], v[132:135]
  v_mfma_f32_16x16x32_bf16 v[136:139], v[88:91], v[120:123], v[136:139]
  v_mfma_f32_16x16x32_bf16 v[140:143], v[92:95], v[120:123], v[140:143]
  ds_read_b128 v[120:123], v27 offset:400
  buffer_load_dwordx4 a[40:43], v160, s[64:67], 0 offen offset:2048 sc1
  s_waitcnt lgkmcnt(9)
  v_mfma_f32_16x16x32_bf16 v[128:131], v[88:91], v[124:127], v[128:131]
  ds_read_b128 v[64:67], v26 offset:1280
  ds_read_b128 v[68:71], v26 offset:1312
  v_mfma_f32_16x16x32_bf16 v[132:135], v[92:95], v[124:127], v[132:135]
  v_mfma_f32_16x16x32_bf16 v[136:139], v[32:35], v[124:127], v[136:139]
  v_mfma_f32_16x16x32_bf16 v[140:143], v[36:39], v[124:127], v[140:143]
  ds_read_b128 v[124:127], v27 offset:3472
  buffer_load_dwordx4 a[112:115], v161, s[64:67], 0 offen offset:2048 sc1
  s_waitcnt lgkmcnt(9)
  v_mfma_f32_16x16x32_bf16 v[128:131], v[32:35], v[112:115], v[128:131]
  ds_read_b128 v[72:75], v26 offset:1344
  ds_read_b128 v[76:79], v26 offset:1376
  v_mfma_f32_16x16x32_bf16 v[132:135], v[36:39], v[112:115], v[132:135]
  v_mfma_f32_16x16x32_bf16 v[136:139], v[40:43], v[112:115], v[136:139]
  v_mfma_f32_16x16x32_bf16 v[140:143], v[44:47], v[112:115], v[140:143]
  ds_read_b128 v[112:115], v27 offset:416
  buffer_load_dwordx4 a[184:187], v162, s[64:67], 0 offen offset:2048 sc1
  s_waitcnt lgkmcnt(9)
  v_mfma_f32_16x16x32_bf16 v[128:131], v[40:43], v[116:119], v[128:131]
  ds_read_b128 v[80:83], v26 offset:1408
  ds_read_b128 v[84:87], v26 offset:1440
  v_mfma_f32_16x16x32_bf16 v[132:135], v[44:47], v[116:119], v[132:135]
  v_mfma_f32_16x16x32_bf16 v[136:139], v[48:51], v[116:119], v[136:139]
  v_mfma_f32_16x16x32_bf16 v[140:143], v[52:55], v[116:119], v[140:143]
  ds_read_b128 v[116:119], v27 offset:3488
  buffer_load_dwordx4 a[44:47], v160, s[64:67], 0 offen offset:3072 sc1
  s_waitcnt lgkmcnt(9)
  v_mfma_f32_16x16x32_bf16 v[128:131], v[48:51], v[120:123], v[128:131]
  ds_read_b128 v[88:91], v26 offset:1472
  ds_read_b128 v[92:95], v26 offset:1504
  v_mfma_f32_16x16x32_bf16 v[132:135], v[52:55], v[120:123], v[132:135]
  v_mfma_f32_16x16x32_bf16 v[136:139], v[56:59], v[120:123], v[136:139]
  v_mfma_f32_16x16x32_bf16 v[140:143], v[60:63], v[120:123], v[140:143]
  ds_read_b128 v[120:123], v27 offset:432
  buffer_load_dwordx4 a[116:119], v161, s[64:67], 0 offen offset:3072 sc1
  s_waitcnt lgkmcnt(9)
  v_mfma_f32_16x16x32_bf16 v[128:131], v[56:59], v[124:127], v[128:131]
  ds_read_b128 v[32:35], v26 offset:1536
  ds_read_b128 v[36:39], v26 offset:1568
  v_mfma_f32_16x16x32_bf16 v[132:135], v[60:63], v[124:127], v[132:135]
  v_mfma_f32_16x16x32_bf16 v[136:139], v[64:67], v[124:127], v[136:139]
  v_mfma_f32_16x16x32_bf16 v[140:143], v[68:71], v[124:127], v[140:143]
  ds_read_b128 v[124:127], v27 offset:3504
  buffer_load_dwordx4 a[188:191], v162, s[64:67], 0 offen offset:3072 sc1
  s_waitcnt lgkmcnt(9)
  v_mfma_f32_16x16x32_bf16 v[128:131], v[64:67], v[112:115], v[128:131]
  ds_read_b128 v[40:43], v26 offset:1600
  ds_read_b128 v[44:47], v26 offset:1632
  v_mfma_f32_16x16x32_bf16 v[132:135], v[68:71], v[112:115], v[132:135]
  v_mfma_f32_16x16x32_bf16 v[136:139], v[72:75], v[112:115], v[136:139]
  v_mfma_f32_16x16x32_bf16 v[140:143], v[76:79], v[112:115], v[140:143]
  ds_read_b128 v[112:115], v27 offset:448
  v_add_u32 v160, 4096, v160
  buffer_load_dwordx4 a[48:51], v160, s[64:67], 0 offen offset:0 sc1
  s_waitcnt lgkmcnt(9)
  v_mfma_f32_16x16x32_bf16 v[128:131], v[72:75], v[116:119], v[128:131]
  ds_read_b128 v[48:51], v26 offset:1664
  ds_read_b128 v[52:55], v26 offset:1696
  v_mfma_f32_16x16x32_bf16 v[132:135], v[76:79], v[116:119], v[132:135]
  v_mfma_f32_16x16x32_bf16 v[136:139], v[80:83], v[116:119], v[136:139]
  v_mfma_f32_16x16x32_bf16 v[140:143], v[84:87], v[116:119], v[140:143]
  ds_read_b128 v[116:119], v27 offset:3520
  v_add_u32 v161, 4096, v161
  buffer_load_dwordx4 a[120:123], v161, s[64:67], 0 offen offset:0 sc1
  s_waitcnt lgkmcnt(9)
  v_mfma_f32_16x16x32_bf16 v[128:131], v[80:83], v[120:123], v[128:131]
  ds_read_b128 v[56:59], v26 offset:1728
  ds_read_b128 v[60:63], v26 offset:1760
  v_mfma_f32_16x16x32_bf16 v[132:135], v[84:87], v[120:123], v[132:135]
  v_mfma_f32_16x16x32_bf16 v[136:139], v[88:91], v[120:123], v[136:139]
  v_mfma_f32_16x16x32_bf16 v[140:143], v[92:95], v[120:123], v[140:143]
  ds_read_b128 v[120:123], v27 offset:464
  v_add_u32 v162, 4096, v162
  buffer_load_dwordx4 a[192:195], v162, s[64:67], 0 offen offset:0 sc1
  s_waitcnt lgkmcnt(9)
  v_mfma_f32_16x16x32_bf16 v[128:131], v[88:91], v[124:127], v[128:131]
  ds_read_b128 v[64:67], v26 offset:1792
  ds_read_b128 v[68:71], v26 offset:1824
  v_mfma_f32_16x16x32_bf16 v[132:135], v[92:95], v[124:127], v[132:135]
  v_mfma_f32_16x16x32_bf16 v[136:139], v[32:35], v[124:127], v[136:139]
  v_mfma_f32_16x16x32_bf16 v[140:143], v[36:39], v[124:127], v[140:143]
  ds_read_b128 v[124:127], v27 offset:3536
  buffer_load_dwordx4 a[52:55], v160, s[64:67], 0 offen offset:1024 sc1
  s_waitcnt lgkmcnt(9)
  v_mfma_f32_16x16x32_bf16 v[128:131], v[32:35], v[112:115], v[128:131]
  ds_read_b128 v[72:75], v26 offset:1856
  ds_read_b128 v[76:79], v26 offset:1888
  v_mfma_f32_16x16x32_bf16 v[132:135], v[36:39], v[112:115], v[132:135]
  v_mfma_f32_16x16x32_bf16 v[136:139], v[40:43], v[112:115], v[136:139]
  v_mfma_f32_16x16x32_bf16 v[140:143], v[44:47], v[112:115], v[140:143]
  ds_read_b128 v[112:115], v27 offset:480
  buffer_load_dwordx4 a[124:127], v161, s[64:67], 0 offen offset:1024 sc1
  s_waitcnt lgkmcnt(9)
  v_mfma_f32_16x16x32_bf16 v[128:131], v[40:43], v[116:119], v[128:131]
  ds_read_b128 v[80:83], v26 offset:1920
  ds_read_b128 v[84:87], v26 offset:1952
  v_mfma_f32_16x16x32_bf16 v[132:135], v[44:47], v[116:119], v[132:135]
  v_mfma_f32_16x16x32_bf16 v[136:139], v[48:51], v[116:119], v[136:139]
  v_mfma_f32_16x16x32_bf16 v[140:143], v[52:55], v[116:119], v[140:143]
  ds_read_b128 v[116:119], v27 offset:3552
  buffer_load_dwordx4 a[196:199], v162, s[64:67], 0 offen offset:1024 sc1
  s_waitcnt lgkmcnt(9)
  v_mfma_f32_16x16x32_bf16 v[128:131], v[48:51], v[120:123], v[128:131]
  ds_read_b128 v[88:91], v26 offset:1984
  ds_read_b128 v[92:95], v26 offset:2016
  v_mfma_f32_16x16x32_bf16 v[132:135], v[52:55], v[120:123], v[132:135]
  v_mfma_f32_16x16x32_bf16 v[136:139], v[56:59], v[120:123], v[136:139]
  v_mfma_f32_16x16x32_bf16 v[140:143], v[60:63], v[120:123], v[140:143]
  ds_read_b128 v[120:123], v27 offset:496
  buffer_load_dwordx4 a[56:59], v160, s[64:67], 0 offen offset:2048 sc1
  s_waitcnt lgkmcnt(9)
  v_mfma_f32_16x16x32_bf16 v[128:131], v[56:59], v[124:127], v[128:131]
  ds_read_b128 v[32:35], v26 offset:2048
  ds_read_b128 v[36:39], v26 offset:2080
  v_mfma_f32_16x16x32_bf16 v[132:135], v[60:63], v[124:127], v[132:135]
  v_mfma_f32_16x16x32_bf16 v[136:139], v[64:67], v[124:127], v[136:139]
  v_mfma_f32_16x16x32_bf16 v[140:143], v[68:71], v[124:127], v[140:143]
  ds_read_b128 v[124:127], v27 offset:3568
  buffer_load_dwordx4 a[128:131], v161, s[64:67], 0 offen offset:2048 sc1
  s_waitcnt lgkmcnt(9)
  v_mfma_f32_16x16x32_bf16 v[128:131], v[64:67], v[112:115], v[128:131]
  v_mfma_f32_16x16x32_bf16 v[132:135], v[68:71], v[112:115], v[132:135]
  v_mfma_f32_16x16x32_bf16 v[136:139], v[72:75], v[112:115], v[136:139]
  v_mfma_f32_16x16x32_bf16 v[140:143], v[76:79], v[112:115], v[140:143]
  buffer_load_dwordx4 a[200:203], v162, s[64:67], 0 offen offset:2048 sc1
  s_waitcnt lgkmcnt(6)
  v_mfma_f32_16x16x32_bf16 v[128:131], v[72:75], v[116:119], v[128:131]
  v_mfma_f32_16x16x32_bf16 v[132:135], v[76:79], v[116:119], v[132:135]
  v_mfma_f32_16x16x32_bf16 v[136:139], v[80:83], v[116:119], v[136:139]
  v_mfma_f32_16x16x32_bf16 v[140:143], v[84:87], v[116:119], v[140:143]
  buffer_load_dwordx4 a[60:63], v160, s[64:67], 0 offen offset:3072 sc1
  s_waitcnt lgkmcnt(3)
  v_mfma_f32_16x16x32_bf16 v[128:131], v[80:83], v[120:123], v[128:131]
  v_mfma_f32_16x16x32_bf16 v[132:135], v[84:87], v[120:123], v[132:135]
  v_mfma_f32_16x16x32_bf16 v[136:139], v[88:91], v[120:123], v[136:139]
  v_mfma_f32_16x16x32_bf16 v[140:143], v[92:95], v[120:123], v[140:143]
  buffer_load_dwordx4 a[132:135], v161, s[64:67], 0 offen offset:3072 sc1
  s_waitcnt lgkmcnt(0)
  v_mfma_f32_16x16x32_bf16 v[128:131], v[88:91], v[124:127], v[128:131]
  v_mfma_f32_16x16x32_bf16 v[132:135], v[92:95], v[124:127], v[132:135]
  v_mfma_f32_16x16x32_bf16 v[136:139], v[32:35], v[124:127], v[136:139]
  v_mfma_f32_16x16x32_bf16 v[140:143], v[36:39], v[124:127], v[140:143]
  buffer_load_dwordx4 a[204:207], v162, s[64:67], 0 offen offset:3072 sc1
  v_lshlrev_b32 v2, 4, v1
  v_add_u32 v2, 128512, v2
  s_nop 1
  ds_write_b128 v2, v[128:131] offset:0
  s_nop 1
  ds_write_b128 v2, v[132:135] offset:1024
  s_nop 1
  ds_write_b128 v2, v[136:139] offset:2048
  s_nop 1
  ds_write_b128 v2, v[140:143] offset:3072
  v_add_u32 v26, 70656, v24
  v_add_u32 v27, 118272, v25
  ds_read_b128 v[32:35], v26 offset:512
  ds_read_b128 v[36:39], v26 offset:544
  ds_read_b128 v[40:43], v26 offset:576
  ds_read_b128 v[44:47], v26 offset:608
  ds_read_b128 v[48:51], v26 offset:640
  ds_read_b128 v[52:55], v26 offset:672
  ds_read_b128 v[56:59], v26 offset:704
  ds_read_b128 v[60:63], v26 offset:736
  ds_read_b128 v[64:67], v26 offset:768
  ds_read_b128 v[68:71], v26 offset:800
  ds_read_b128 v[112:115], v27 offset:320
  ds_read_b128 v[116:119], v27 offset:3392
  ds_read_b128 v[120:123], v27 offset:336
  ds_read_b128 v[124:127], v27 offset:3408
  s_waitcnt lgkmcnt(3)
  v_mfma_f32_16x16x32_bf16 v[144:147], v[32:35], v[112:115], 0
  ds_read_b128 v[72:75], v26 offset:832
  ds_read_b128 v[76:79], v26 offset:864
  v_mfma_f32_16x16x32_bf16 v[148:151], v[36:39], v[112:115], 0
  v_mfma_f32_16x16x32_bf16 v[152:155], v[40:43], v[112:115], 0
  v_mfma_f32_16x16x32_bf16 v[156:159], v[44:47], v[112:115], 0
  ds_read_b128 v[112:115], v27 offset:352
  v_add_u32 v160, 4096, v160
  buffer_load_dwordx4 a[64:67], v160, s[64:67], 0 offen offset:0 sc1
  s_waitcnt lgkmcnt(5)
  v_mfma_f32_16x16x32_bf16 v[144:147], v[40:43], v[116:119], v[144:147]
  ds_read_b128 v[80:83], v26 offset:896
  ds_read_b128 v[84:87], v26 offset:928
  v_mfma_f32_16x16x32_bf16 v[148:151], v[44:47], v[116:119], v[148:151]
  v_mfma_f32_16x16x32_bf16 v[152:155], v[48:51], v[116:119], v[152:155]
  v_mfma_f32_16x16x32_bf16 v[156:159], v[52:55], v[116:119], v[156:159]
  ds_read_b128 v[116:119], v27 offset:3424
  v_add_u32 v161, 4096, v161
  buffer_load_dwordx4 a[136:139], v161, s[64:67], 0 offen offset:0 sc1
  s_waitcnt lgkmcnt(7)
  v_mfma_f32_16x16x32_bf16 v[144:147], v[48:51], v[120:123], v[144:147]
  ds_read_b128 v[88:91], v26 offset:960
  ds_read_b128 v[92:95], v26 offset:992
  v_mfma_f32_16x16x32_bf16 v[148:151], v[52:55], v[120:123], v[148:151]
  v_mfma_f32_16x16x32_bf16 v[152:155], v[56:59], v[120:123], v[152:155]
  v_mfma_f32_16x16x32_bf16 v[156:159], v[60:63], v[120:123], v[156:159]
  ds_read_b128 v[120:123], v27 offset:368
  v_add_u32 v162, 4096, v162
  buffer_load_dwordx4 a[208:211], v162, s[64:67], 0 offen offset:0 sc1
  s_waitcnt lgkmcnt(9)
  v_mfma_f32_16x16x32_bf16 v[144:147], v[56:59], v[124:127], v[144:147]
  ds_read_b128 v[32:35], v26 offset:1024
  ds_read_b128 v[36:39], v26 offset:1056
  v_mfma_f32_16x16x32_bf16 v[148:151], v[60:63], v[124:127], v[148:151]
  v_mfma_f32_16x16x32_bf16 v[152:155], v[64:67], v[124:127], v[152:155]
  v_mfma_f32_16x16x32_bf16 v[156:159], v[68:71], v[124:127], v[156:159]
  ds_read_b128 v[124:127], v27 offset:3440
  buffer_load_dwordx4 a[68:71], v160, s[64:67], 0 offen offset:1024 sc1
  s_waitcnt lgkmcnt(9)
  v_mfma_f32_16x16x32_bf16 v[144:147], v[64:67], v[112:115], v[144:147]
  ds_read_b128 v[40:43], v26 offset:1088
  ds_read_b128 v[44:47], v26 offset:1120
  v_mfma_f32_16x16x32_bf16 v[148:151], v[68:71], v[112:115], v[148:151]
  v_mfma_f32_16x16x32_bf16 v[152:155], v[72:75], v[112:115], v[152:155]
  v_mfma_f32_16x16x32_bf16 v[156:159], v[76:79], v[112:115], v[156:159]
  ds_read_b128 v[112:115], v27 offset:384
  buffer_load_dwordx4 a[140:143], v161, s[64:67], 0 offen offset:1024 sc1
  s_waitcnt lgkmcnt(9)
  v_mfma_f32_16x16x32_bf16 v[144:147], v[72:75], v[116:119], v[144:147]
  ds_read_b128 v[48:51], v26 offset:1152
  ds_read_b128 v[52:55], v26 offset:1184
  v_mfma_f32_16x16x32_bf16 v[148:151], v[76:79], v[116:119], v[148:151]
  v_mfma_f32_16x16x32_bf16 v[152:155], v[80:83], v[116:119], v[152:155]
  v_mfma_f32_16x16x32_bf16 v[156:159], v[84:87], v[116:119], v[156:159]
  ds_read_b128 v[116:119], v27 offset:3456
  buffer_load_dwordx4 a[212:215], v162, s[64:67], 0 offen offset:1024 sc1
  s_waitcnt lgkmcnt(9)
  v_mfma_f32_16x16x32_bf16 v[144:147], v[80:83], v[120:123], v[144:147]
  ds_read_b128 v[56:59], v26 offset:1216
  ds_read_b128 v[60:63], v26 offset:1248
  v_mfma_f32_16x16x32_bf16 v[148:151], v[84:87], v[120:123], v[148:151]
  v_mfma_f32_16x16x32_bf16 v[152:155], v[88:91], v[120:123], v[152:155]
  v_mfma_f32_16x16x32_bf16 v[156:159], v[92:95], v[120:123], v[156:159]
  ds_read_b128 v[120:123], v27 offset:400
  s_waitcnt lgkmcnt(9)
  v_mfma_f32_16x16x32_bf16 v[144:147], v[88:91], v[124:127], v[144:147]
  ds_read_b128 v[64:67], v26 offset:1280
  ds_read_b128 v[68:71], v26 offset:1312
  v_mfma_f32_16x16x32_bf16 v[148:151], v[92:95], v[124:127], v[148:151]
  v_mfma_f32_16x16x32_bf16 v[152:155], v[32:35], v[124:127], v[152:155]
  v_mfma_f32_16x16x32_bf16 v[156:159], v[36:39], v[124:127], v[156:159]
  ds_read_b128 v[124:127], v27 offset:3472
  s_waitcnt lgkmcnt(9)
  v_mfma_f32_16x16x32_bf16 v[144:147], v[32:35], v[112:115], v[144:147]
  ds_read_b128 v[72:75], v26 offset:1344
  ds_read_b128 v[76:79], v26 offset:1376
  v_mfma_f32_16x16x32_bf16 v[148:151], v[36:39], v[112:115], v[148:151]
  v_mfma_f32_16x16x32_bf16 v[152:155], v[40:43], v[112:115], v[152:155]
  v_mfma_f32_16x16x32_bf16 v[156:159], v[44:47], v[112:115], v[156:159]
  ds_read_b128 v[112:115], v27 offset:416
  s_waitcnt lgkmcnt(9)
  v_mfma_f32_16x16x32_bf16 v[144:147], v[40:43], v[116:119], v[144:147]
  ds_read_b128 v[80:83], v26 offset:1408
  ds_read_b128 v[84:87], v26 offset:1440
  v_mfma_f32_16x16x32_bf16 v[148:151], v[44:47], v[116:119], v[148:151]
  v_mfma_f32_16x16x32_bf16 v[152:155], v[48:51], v[116:119], v[152:155]
  v_mfma_f32_16x16x32_bf16 v[156:159], v[52:55], v[116:119], v[156:159]
  ds_read_b128 v[116:119], v27 offset:3488
  s_waitcnt lgkmcnt(9)
  v_mfma_f32_16x16x32_bf16 v[144:147], v[48:51], v[120:123], v[144:147]
  ds_read_b128 v[88:91], v26 offset:1472
  ds_read_b128 v[92:95], v26 offset:1504
  v_mfma_f32_16x16x32_bf16 v[148:151], v[52:55], v[120:123], v[148:151]
  v_mfma_f32_16x16x32_bf16 v[152:155], v[56:59], v[120:123], v[152:155]
  v_mfma_f32_16x16x32_bf16 v[156:159], v[60:63], v[120:123], v[156:159]
  ds_read_b128 v[120:123], v27 offset:432
  s_waitcnt lgkmcnt(9)
  v_mfma_f32_16x16x32_bf16 v[144:147], v[56:59], v[124:127], v[144:147]
  ds_read_b128 v[32:35], v26 offset:1536
  ds_read_b128 v[36:39], v26 offset:1568
  v_mfma_f32_16x16x32_bf16 v[148:151], v[60:63], v[124:127], v[148:151]
  v_mfma_f32_16x16x32_bf16 v[152:155], v[64:67], v[124:127], v[152:155]
  v_mfma_f32_16x16x32_bf16 v[156:159], v[68:71], v[124:127], v[156:159]
  ds_read_b128 v[124:127], v27 offset:3504
  s_waitcnt lgkmcnt(9)
  v_mfma_f32_16x16x32_bf16 v[144:147], v[64:67], v[112:115], v[144:147]
  ds_read_b128 v[40:43], v26 offset:1600
  ds_read_b128 v[44:47], v26 offset:1632
  v_mfma_f32_16x16x32_bf16 v[148:151], v[68:71], v[112:115], v[148:151]
  v_mfma_f32_16x16x32_bf16 v[152:155], v[72:75], v[112:115], v[152:155]
  v_mfma_f32_16x16x32_bf16 v[156:159], v[76:79], v[112:115], v[156:159]
  ds_read_b128 v[112:115], v27 offset:448
  s_waitcnt lgkmcnt(9)
  v_mfma_f32_16x16x32_bf16 v[144:147], v[72:75], v[116:119], v[144:147]
  ds_read_b128 v[48:51], v26 offset:1664
  ds_read_b128 v[52:55], v26 offset:1696
  v_mfma_f32_16x16x32_bf16 v[148:151], v[76:79], v[116:119], v[148:151]
  v_mfma_f32_16x16x32_bf16 v[152:155], v[80:83], v[116:119], v[152:155]
  v_mfma_f32_16x16x32_bf16 v[156:159], v[84:87], v[116:119], v[156:159]
  ds_read_b128 v[116:119], v27 offset:3520
  s_waitcnt lgkmcnt(9)
  v_mfma_f32_16x16x32_bf16 v[144:147], v[80:83], v[120:123], v[144:147]
  ds_read_b128 v[56:59], v26 offset:1728
  ds_read_b128 v[60:63], v26 offset:1760
  v_mfma_f32_16x16x32_bf16 v[148:151], v[84:87], v[120:123], v[148:151]
  v_mfma_f32_16x16x32_bf16 v[152:155], v[88:91], v[120:123], v[152:155]
  v_mfma_f32_16x16x32_bf16 v[156:159], v[92:95], v[120:123], v[156:159]
  ds_read_b128 v[120:123], v27 offset:464
  s_waitcnt lgkmcnt(9)
  v_mfma_f32_16x16x32_bf16 v[144:147], v[88:91], v[124:127], v[144:147]
  ds_read_b128 v[64:67], v26 offset:1792
  ds_read_b128 v[68:71], v26 offset:1824
  v_mfma_f32_16x16x32_bf16 v[148:151], v[92:95], v[124:127], v[148:151]
  v_mfma_f32_16x16x32_bf16 v[152:155], v[32:35], v[124:127], v[152:155]
  v_mfma_f32_16x16x32_bf16 v[156:159], v[36:39], v[124:127], v[156:159]
  ds_read_b128 v[124:127], v27 offset:3536
  s_waitcnt lgkmcnt(9)
  v_mfma_f32_16x16x32_bf16 v[144:147], v[32:35], v[112:115], v[144:147]
  ds_read_b128 v[72:75], v26 offset:1856
  ds_read_b128 v[76:79], v26 offset:1888
  v_mfma_f32_16x16x32_bf16 v[148:151], v[36:39], v[112:115], v[148:151]
  v_mfma_f32_16x16x32_bf16 v[152:155], v[40:43], v[112:115], v[152:155]
  v_mfma_f32_16x16x32_bf16 v[156:159], v[44:47], v[112:115], v[156:159]
  ds_read_b128 v[112:115], v27 offset:480
  s_waitcnt lgkmcnt(9)
  v_mfma_f32_16x16x32_bf16 v[144:147], v[40:43], v[116:119], v[144:147]
  ds_read_b128 v[80:83], v26 offset:1920
  ds_read_b128 v[84:87], v26 offset:1952
  v_mfma_f32_16x16x32_bf16 v[148:151], v[44:47], v[116:119], v[148:151]
  v_mfma_f32_16x16x32_bf16 v[152:155], v[48:51], v[116:119], v[152:155]
  v_mfma_f32_16x16x32_bf16 v[156:159], v[52:55], v[116:119], v[156:159]
  ds_read_b128 v[116:119], v27 offset:3552
  s_waitcnt lgkmcnt(9)
  v_mfma_f32_16x16x32_bf16 v[144:147], v[48:51], v[120:123], v[144:147]
  ds_read_b128 v[88:91], v26 offset:1984
  ds_read_b128 v[92:95], v26 offset:2016
  v_mfma_f32_16x16x32_bf16 v[148:151], v[52:55], v[120:123], v[148:151]
  v_mfma_f32_16x16x32_bf16 v[152:155], v[56:59], v[120:123], v[152:155]
  v_mfma_f32_16x16x32_bf16 v[156:159], v[60:63], v[120:123], v[156:159]
  ds_read_b128 v[120:123], v27 offset:496
  s_waitcnt lgkmcnt(9)
  v_mfma_f32_16x16x32_bf16 v[144:147], v[56:59], v[124:127], v[144:147]
  ds_read_b128 v[32:35], v26 offset:2048
  ds_read_b128 v[36:39], v26 offset:2080
  v_mfma_f32_16x16x32_bf16 v[148:151], v[60:63], v[124:127], v[148:151]
  v_mfma_f32_16x16x32_bf16 v[152:155], v[64:67], v[124:127], v[152:155]
  v_mfma_f32_16x16x32_bf16 v[156:159], v[68:71], v[124:127], v[156:159]
  ds_read_b128 v[124:127], v27 offset:3568
  s_waitcnt lgkmcnt(9)
  v_mfma_f32_16x16x32_bf16 v[144:147], v[64:67], v[112:115], v[144:147]
  v_mfma_f32_16x16x32_bf16 v[148:151], v[68:71], v[112:115], v[148:151]
  v_mfma_f32_16x16x32_bf16 v[152:155], v[72:75], v[112:115], v[152:155]
  v_mfma_f32_16x16x32_bf16 v[156:159], v[76:79], v[112:115], v[156:159]
  s_waitcnt lgkmcnt(6)
  v_mfma_f32_16x16x32_bf16 v[144:147], v[72:75], v[116:119], v[144:147]
  v_mfma_f32_16x16x32_bf16 v[148:151], v[76:79], v[116:119], v[148:151]
  v_mfma_f32_16x16x32_bf16 v[152:155], v[80:83], v[116:119], v[152:155]
  v_mfma_f32_16x16x32_bf16 v[156:159], v[84:87], v[116:119], v[156:159]
  s_waitcnt lgkmcnt(3)
  v_mfma_f32_16x16x32_bf16 v[144:147], v[80:83], v[120:123], v[144:147]
  v_mfma_f32_16x16x32_bf16 v[148:151], v[84:87], v[120:123], v[148:151]
  v_mfma_f32_16x16x32_bf16 v[152:155], v[88:91], v[120:123], v[152:155]
  v_mfma_f32_16x16x32_bf16 v[156:159], v[92:95], v[120:123], v[156:159]
  s_waitcnt lgkmcnt(0)
  v_mfma_f32_16x16x32_bf16 v[144:147], v[88:91], v[124:127], v[144:147]
  v_mfma_f32_16x16x32_bf16 v[148:151], v[92:95], v[124:127], v[148:151]
  v_mfma_f32_16x16x32_bf16 v[152:155], v[32:35], v[124:127], v[152:155]
  v_mfma_f32_16x16x32_bf16 v[156:159], v[36:39], v[124:127], v[156:159]
  v_lshlrev_b32 v2, 4, v1
  v_add_u32 v2, 132608, v2
  s_nop 2
  ds_write_b128 v2, v[144:147] offset:0
  s_nop 2
  ds_write_b128 v2, v[148:151] offset:1024
  s_nop 2
  ds_write_b128 v2, v[152:155] offset:2048
  s_nop 2
  ds_write_b128 v2, v[156:159] offset:3072
  v_mov_b32 v174, 161024
  buffer_load_dword v174, v174, s[72:75], 0 offen sc1
L_cj_7:
  s_waitcnt vmcnt(0) lgkmcnt(0)
  s_barrier
  v_readfirstlane_b32 s76, v174
  s_nop 3
  s_cmp_lg_u32 s76, 0
  s_cbranch_scc1 L_mok_8
  v_mov_b32 v252, 161024
  v_mov_b32 v254, 1
  s_mov_b32 s77, 0
  s_mov_b64 exec, 0x1
L_ww_9:
  buffer_load_dword v253, v252, s[72:75], 0 offen sc1
  s_waitcnt vmcnt(0)
  v_cmp_lt_u32 vcc, v253, v254
  s_add_u32 s77, s77, 1
  s_cmp_ge_u32 s77, 131072
  s_cbranch_scc1 L_ww_9_x
  s_cbranch_vccz L_ww_9_x
  s_sleep 1
  s_branch L_ww_9
L_ww_9_x:
  s_mov_b64 exec, -1
L_mok_8:
  s_add_u32 s56, s46, 0x680000
  s_addc_u32 s57, s47, 0
  s_mov_b32 s58, 0x3600
  s_mov_b32 s59, 0x20000
  v_lshlrev_b32 v8, 4, v0
  s_movk_i32 s7, 0
  buffer_load_dwordx4 v[236:239], v8, s[56:59], s7 offen sc1
  s_movk_i32 s7, 4096
  buffer_load_dwordx4 v[240:243], v8, s[56:59], s7 offen sc1
  s_movk_i32 s7, 8192
  buffer_load_dwordx4 v[244:247], v8, s[56:59], s7 offen sc1
  s_cmp_eq_u32 s3, 3
  s_cbranch_scc1 L_conv_done_10
  s_lshl_b32 s14, s3, 12
  s_add_u32 s14, s14, 124416
  v_lshl_add_u32 v2, v1, 4, s14
  ds_read_b128 v[32:35], v2 offset:0
  ds_read_b128 v[36:39], v2 offset:1024
  ds_read_b128 v[40:43], v2 offset:2048
  ds_read_b128 v[44:47], v2 offset:3072
  v_lshrrev_b32 v5, 5, v1
  v_sub_u32 v5, 1, v5
  v_mul_u32_u24 v5, 48, v5
  v_and_b32 v6, 15, v1
  v_sub_u32 v5, v5, v6
  v_add_u32 v5, 15, v5
  v_lshlrev_b32 v5, 4, v5
  v_bfe_u32 v6, v1, 4, 1
  v_sub_u32 v6, 1, v6
  v_lshl_add_u32 v5, v6, 3, v5
  s_mul_i32 s14, s3, 6144
  s_add_u32 s14, s14, 105984
  v_add_u32 v5, s14, v5
  ds_read_b64 v[48:49], v5 offset:4864
  ds_read_b64 v[50:51], v5 offset:3328
  ds_read_b64 v[52:53], v5 offset:1792
  ds_read_b64 v[54:55], v5 offset:256
  ds_read_b64 v[56:57], v5 offset:4608
  ds_read_b64 v[58:59], v5 offset:3072
  ds_read_b64 v[60:61], v5 offset:1536
  ds_read_b64 v[62:63], v5 offset:0
  s_waitcnt lgkmcnt(11)
  v_add_f32 v144, v144, v32
  v_add_f32 v145, v145, v33
  v_add_f32 v146, v146, v34
  v_add_f32 v147, v147, v35
  s_waitcnt lgkmcnt(10)
  v_add_f32 v148, v148, v36
  v_add_f32 v149, v149, v37
  v_add_f32 v150, v150, v38
  v_add_f32 v151, v151, v39
  s_waitcnt lgkmcnt(9)
  v_add_f32 v152, v152, v40
  v_add_f32 v153, v153, v41
  v_add_f32 v154, v154, v42
  v_add_f32 v155, v155, v43
  s_waitcnt lgkmcnt(8)
  v_add_f32 v156, v156, v44
  v_add_f32 v157, v157, v45
  v_add_f32 v158, v158, v46
  v_add_f32 v159, v159, v47
  s_mul_i32 s14, s2, 3
  s_add_u32 s14, s14, s3
  s_lshl_b32 s14, s14, 12
  v_and_b32 v6, 7, v1
  v_lshl_add_u32 v6, v6, 7, s14
  v_lshrrev_b32 v7, 5, v1
  v_lshl_add_u32 v6, v7, 4, v6
  v_bfe_u32 v7, v1, 4, 1
  v_lshl_add_u32 v6, v7, 5, v6
  v_bfe_u32 v7, v1, 3, 1
  v_lshl_add_u32 v6, v7, 6, v6
  s_mov_b32 s10, 0xffff0000
  s_waitcnt lgkmcnt(7)
  v_and_b32 v80, s10, v49
  v_lshlrev_b32 v81, 16, v49
  v_and_b32 v82, s10, v48
  v_lshlrev_b32 v83, 16, v48
  v_fmac_f32 v144, v23, v80
  v_fmac_f32 v145, v23, v81
  v_fmac_f32 v146, v23, v82
  v_fmac_f32 v147, v23, v83
  v_cvt_pk_bf16_f32 v64, v144, v145
  v_cvt_pk_bf16_f32 v65, v146, v147
  s_waitcnt lgkmcnt(6)
  v_and_b32 v80, s10, v51
  v_lshlrev_b32 v81, 16, v51
  v_and_b32 v82, s10, v50
  v_lshlrev_b32 v83, 16, v50
  v_fmac_f32 v148, v23, v80
  v_fmac_f32 v149, v23, v81
  v_fmac_f32 v150, v23, v82
  v_fmac_f32 v151, v23, v83
  v_cvt_pk_bf16_f32 v66, v148, v149
  v_cvt_pk_bf16_f32 v67, v150, v151
  s_waitcnt lgkmcnt(5)
  v_and_b32 v80, s10, v53
  v_lshlrev_b32 v81, 16, v53
  v_and_b32 v82, s10, v52
  v_lshlrev_b32 v83, 16, v52
  v_fmac_f32 v152, v23, v80
  v_fmac_f32 v153, v23, v81
  v_fmac_f32 v154, v23, v82
  v_fmac_f32 v155, v23, v83
  v_cvt_pk_bf16_f32 v68, v152, v153
  v_cvt_pk_bf16_f32 v69, v154, v155
  s_waitcnt lgkmcnt(4)
  v_and_b32 v80, s10, v55
  v_lshlrev_b32 v81, 16, v55
  v_and_b32 v82, s10, v54
  v_lshlrev_b32 v83, 16, v54
  v_fmac_f32 v156, v23, v80
  v_fmac_f32 v157, v23, v81
  v_fmac_f32 v158, v23, v82
  v_fmac_f32 v159, v23, v83
  v_cvt_pk_bf16_f32 v70, v156, v157
  v_cvt_pk_bf16_f32 v71, v158, v159
  v_permlane16_swap_b32 v64, v66
  v_permlane16_swap_b32 v65, v67
  v_permlane16_swap_b32 v68, v70
  v_permlane16_swap_b32 v69, v71
  v_mov_b32 v84, v64
  v_mov_b32 v85, v65
  v_mov_b32 v86, v66
  v_mov_b32 v87, v67
  v_mov_b32_dpp v64, v68 row_ror:8 row_mask:0xf bank_mask:0xc
  v_mov_b32_dpp v65, v69 row_ror:8 row_mask:0xf bank_mask:0xc
  v_mov_b32_dpp v66, v70 row_ror:8 row_mask:0xf bank_mask:0xc
  v_mov_b32_dpp v67, v71 row_ror:8 row_mask:0xf bank_mask:0xc
  v_mov_b32_dpp v68, v84 row_ror:8 row_mask:0xf bank_mask:0x3
  v_mov_b32_dpp v69, v85 row_ror:8 row_mask:0xf bank_mask:0x3
  v_mov_b32_dpp v70, v86 row_ror:8 row_mask:0xf bank_mask:0x3
  v_mov_b32_dpp v71, v87 row_ror:8 row_mask:0xf bank_mask:0x3
  buffer_store_dwordx4 v[64:67], v6, s[52:55], 0 offen offset:0 sc1
  buffer_store_dwordx4 v[68:71], v6, s[52:55], 0 offen offset:1024 sc1
  s_waitcnt lgkmcnt(3)
  v_and_b32 v80, s10, v57
  v_lshlrev_b32 v81, 16, v57
  v_and_b32 v82, s10, v56
  v_lshlrev_b32 v83, 16, v56
  v_fmac_f32 v128, v23, v80
  v_fmac_f32 v129, v23, v81
  v_fmac_f32 v130, v23, v82
  v_fmac_f32 v131, v23, v83
  v_cvt_pk_bf16_f32 v72, v128, v129
  v_cvt_pk_bf16_f32 v73, v130, v131
  s_waitcnt lgkmcnt(2)
  v_and_b32 v80, s10, v59
  v_lshlrev_b32 v81, 16, v59
  v_and_b32 v82, s10, v58
  v_lshlrev_b32 v83, 16, v58
  v_fmac_f32 v132, v23, v80
  v_fmac_f32 v133, v23, v81
  v_fmac_f32 v134, v23, v82
  v_fmac_f32 v135, v23, v83
  v_cvt_pk_bf16_f32 v74, v132, v133
  v_cvt_pk_bf16_f32 v75, v134, v135
  s_waitcnt lgkmcnt(1)
  v_and_b32 v80, s10, v61
  v_lshlrev_b32 v81, 16, v61
  v_and_b32 v82, s10, v60
  v_lshlrev_b32 v83, 16, v60
  v_fmac_f32 v136, v23, v80
  v_fmac_f32 v137, v23, v81
  v_fmac_f32 v138, v23, v82
  v_fmac_f32 v139, v23, v83
  v_cvt_pk_bf16_f32 v76, v136, v137
  v_cvt_pk_bf16_f32 v77, v138, v139
  s_waitcnt lgkmcnt(0)
  v_and_b32 v80, s10, v63
  v_lshlrev_b32 v81, 16, v63
  v_and_b32 v82, s10, v62
  v_lshlrev_b32 v83, 16, v62
  v_fmac_f32 v140, v23, v80
  v_fmac_f32 v141, v23, v81
  v_fmac_f32 v142, v23, v82
  v_fmac_f32 v143, v23, v83
  v_cvt_pk_bf16_f32 v78, v140, v141
  v_cvt_pk_bf16_f32 v79, v142, v143
  v_permlane16_swap_b32 v72, v74
  v_permlane16_swap_b32 v73, v75
  v_permlane16_swap_b32 v76, v78
  v_permlane16_swap_b32 v77, v79
  v_mov_b32 v84, v72
  v_mov_b32 v85, v73
  v_mov_b32 v86, v74
  v_mov_b32 v87, v75
  v_mov_b32_dpp v72, v76 row_ror:8 row_mask:0xf bank_mask:0xc
  v_mov_b32_dpp v73, v77 row_ror:8 row_mask:0xf bank_mask:0xc
  v_mov_b32_dpp v74, v78 row_ror:8 row_mask:0xf bank_mask:0xc
  v_mov_b32_dpp v75, v79 row_ror:8 row_mask:0xf bank_mask:0xc
  v_mov_b32_dpp v76, v84 row_ror:8 row_mask:0xf bank_mask:0x3
  v_mov_b32_dpp v77, v85 row_ror:8 row_mask:0xf bank_mask:0x3
  v_mov_b32_dpp v78, v86 row_ror:8 row_mask:0xf bank_mask:0x3
  v_mov_b32_dpp v79, v87 row_ror:8 row_mask:0xf bank_mask:0x3
  buffer_store_dwordx4 v[72:75], v6, s[52:55], 0 offen offset:2048 sc1
  buffer_store_dwordx4 v[76:79], v6, s[52:55], 0 offen offset:3072 sc1
L_conv_done_10:
  s_waitcnt lgkmcnt(0)
  s_barrier
  s_lshr_b32 s5, s2, 3
  s_mul_i32 s4, s5, 21846
  s_lshr_b32 s4, s4, 16
  s_mul_i32 s6, s4, 3
  s_sub_u32 s5, s5, s6
  s_and_b32 s6, s2, 7
  s_lshl_b32 s6, s6, 3
  s_add_u32 s4, s4, s6
  s_mov_b32 s99, 0xffff0000
  s_mov_b32 s98, 0x3ae38e39
  s_mov_b32 s97, 0x3727c5ac
  v_lshrrev_b32 v3, 5, v1
  v_and_b32 v4, 31, v1
  v_mov_b32 v6, v178
  v_mov_b32 v7, v179
  v_lshlrev_b32 v8, 4, v0
  v_lshlrev_b32 v16, 16, v180
  v_and_b32 v17, s99, v180
  v_lshlrev_b32 v18, 16, v181
  v_and_b32 v19, s99, v181
  v_lshlrev_b32 v20, 16, v182
  v_and_b32 v21, s99, v182
  v_lshlrev_b32 v22, 16, v183
  v_and_b32 v23, s99, v183
  v_lshlrev_b32 v24, 16, v184
  v_and_b32 v25, s99, v184
  v_lshlrev_b32 v26, 16, v185
  v_and_b32 v27, s99, v185
  v_lshlrev_b32 v28, 16, v186
  v_and_b32 v29, s99, v186
  v_lshlrev_b32 v30, 16, v187
  v_and_b32 v31, s99, v187
  v_lshlrev_b32 v32, 16, v188
  v_and_b32 v33, s99, v188
  v_lshlrev_b32 v34, 16, v189
  v_and_b32 v35, s99, v189
  v_lshlrev_b32 v36, 16, v190
  v_and_b32 v37, s99, v190
  v_lshlrev_b32 v38, 16, v191
  v_and_b32 v39, s99, v191
  v_lshlrev_b32 v40, 16, v192
  v_and_b32 v41, s99, v192
  v_lshlrev_b32 v42, 16, v193
  v_and_b32 v43, s99, v193
  v_lshlrev_b32 v44, 16, v194
  v_and_b32 v45, s99, v194
  v_lshlrev_b32 v46, 16, v195
  v_and_b32 v47, s99, v195
  v_lshlrev_b32 v48, 16, v196
  v_and_b32 v49, s99, v196
  v_lshlrev_b32 v50, 16, v197
  v_and_b32 v51, s99, v197
  v_lshlrev_b32 v52, 16, v198
  v_and_b32 v53, s99, v198
  v_lshlrev_b32 v54, 16, v199
  v_and_b32 v55, s99, v199
  v_lshlrev_b32 v56, 16, v200
  v_and_b32 v57, s99, v200
  v_lshlrev_b32 v58, 16, v201
  v_and_b32 v59, s99, v201
  v_lshlrev_b32 v60, 16, v202
  v_and_b32 v61, s99, v202
  v_lshlrev_b32 v62, 16, v203
  v_and_b32 v63, s99, v203
  v_lshlrev_b32 v64, 16, v204
  v_and_b32 v65, s99, v204
  v_lshlrev_b32 v66, 16, v205
  v_and_b32 v67, s99, v205
  v_lshlrev_b32 v68, 16, v206
  v_and_b32 v69, s99, v206
  v_lshlrev_b32 v70, 16, v207
  v_and_b32 v71, s99, v207
  v_lshlrev_b32 v72, 16, v208
  v_and_b32 v73, s99, v208
  v_lshlrev_b32 v74, 16, v209
  v_and_b32 v75, s99, v209
  v_lshlrev_b32 v76, 16, v210
  v_and_b32 v77, s99, v210
  v_lshlrev_b32 v78, 16, v211
  v_and_b32 v79, s99, v211
  v_lshlrev_b32 v80, 16, v212
  v_and_b32 v81, s99, v212
  v_lshlrev_b32 v82, 16, v213
  v_and_b32 v83, s99, v213
  v_lshlrev_b32 v84, 16, v214
  v_and_b32 v85, s99, v214
  v_lshlrev_b32 v86, 16, v215
  v_and_b32 v87, s99, v215
  v_pk_fma_f32 v[88:89], v[16:17], v[216:217], v[216:217] op_sel:[0,0,1] op_sel_hi:[1,0,1]
  v_pk_fma_f32 v[90:91], v[18:19], v[216:217], v[216:217] op_sel:[0,0,1] op_sel_hi:[1,0,1]
  v_pk_fma_f32 v[92:93], v[20:21], v[216:217], v[216:217] op_sel:[0,0,1] op_sel_hi:[1,0,1]
  v_pk_fma_f32 v[94:95], v[22:23], v[216:217], v[216:217] op_sel:[0,0,1] op_sel_hi:[1,0,1]
  v_pk_fma_f32 v[96:97], v[24:25], v[216:217], v[216:217] op_sel:[0,0,1] op_sel_hi:[1,0,1]
  v_pk_fma_f32 v[98:99], v[26:27], v[216:217], v[216:217] op_sel:[0,0,1] op_sel_hi:[1,0,1]
  v_pk_fma_f32 v[100:101], v[28:29], v[216:217], v[216:217] op_sel:[0,0,1] op_sel_hi:[1,0,1]
  v_pk_fma_f32 v[102:103], v[30:31], v[216:217], v[216:217] op_sel:[0,0,1] op_sel_hi:[1,0,1]
  v_pk_fma_f32 v[104:105], v[32:33], v[216:217], v[216:217] op_sel:[0,0,1] op_sel_hi:[1,0,1]
  v_pk_fma_f32 v[106:107], v[34:35], v[220:221], v[220:221] op_sel:[0,0,1] op_sel_hi:[1,0,1]
  v_pk_fma_f32 v[108:109], v[36:37], v[220:221], v[220:221] op_sel:[0,0,1] op_sel_hi:[1,0,1]
  v_pk_fma_f32 v[110:111], v[38:39], v[220:221], v[220:221] op_sel:[0,0,1] op_sel_hi:[1,0,1]
  v_pk_fma_f32 v[112:113], v[40:41], v[220:221], v[220:221] op_sel:[0,0,1] op_sel_hi:[1,0,1]
  v_pk_fma_f32 v[114:115], v[42:43], v[220:221], v[220:221] op_sel:[0,0,1] op_sel_hi:[1,0,1]
  v_pk_fma_f32 v[116:117], v[44:45], v[220:221], v[220:221] op_sel:[0,0,1] op_sel_hi:[1,0,1]
  v_pk_fma_f32 v[118:119], v[46:47], v[220:221], v[220:221] op_sel:[0,0,1] op_sel_hi:[1,0,1]
  v_pk_fma_f32 v[120:121], v[48:49], v[220:221], v[220:221] op_sel:[0,0,1] op_sel_hi:[1,0,1]
  v_pk_fma_f32 v[122:123], v[50:51], v[220:221], v[220:221] op_sel:[0,0,1] op_sel_hi:[1,0,1]
  v_pk_fma_f32 v[124:125], v[52:53], v[224:225], v[224:225] op_sel:[0,0,1] op_sel_hi:[1,0,1]
  v_pk_fma_f32 v[126:127], v[54:55], v[224:225], v[224:225] op_sel:[0,0,1] op_sel_hi:[1,0,1]
  v_pk_fma_f32 v[128:129], v[56:57], v[224:225], v[224:225] op_sel:[0,0,1] op_sel_hi:[1,0,1]
  v_pk_fma_f32 v[130:131], v[58:59], v[224:225], v[224:225] op_sel:[0,0,1] op_sel_hi:[1,0,1]
  v_pk_fma_f32 v[132:133], v[60:61], v[224:225], v[224:225] op_sel:[0,0,1] op_sel_hi:[1,0,1]
  v_pk_fma_f32 v[134:135], v[62:63], v[224:225], v[224:225] op_sel:[0,0,1] op_sel_hi:[1,0,1]
  v_pk_fma_f32 v[136:137], v[64:65], v[224:225], v[224:225] op_sel:[0,0,1] op_sel_hi:[1,0,1]
  v_pk_fma_f32 v[138:139], v[66:67], v[224:225], v[224:225] op_sel:[0,0,1] op_sel_hi:[1,0,1]
  v_pk_fma_f32 v[140:141], v[68:69], v[224:225], v[224:225] op_sel:[0,0,1] op_sel_hi:[1,0,1]
  v_pk_fma_f32 v[142:143], v[70:71], v[228:229], v[228:229] op_sel:[0,0,1] op_sel_hi:[1,0,1]
  v_pk_fma_f32 v[144:145], v[72:73], v[228:229], v[228:229] op_sel:[0,0,1] op_sel_hi:[1,0,1]
  v_pk_fma_f32 v[146:147], v[74:75], v[228:229], v[228:229] op_sel:[0,0,1] op_sel_hi:[1,0,1]
  v_pk_fma_f32 v[148:149], v[76:77], v[228:229], v[228:229] op_sel:[0,0,1] op_sel_hi:[1,0,1]
  v_pk_fma_f32 v[150:151], v[78:79], v[228:229], v[228:229] op_sel:[0,0,1] op_sel_hi:[1,0,1]
  v_pk_fma_f32 v[152:153], v[80:81], v[228:229], v[228:229] op_sel:[0,0,1] op_sel_hi:[1,0,1]
  v_pk_fma_f32 v[154:155], v[82:83], v[228:229], v[228:229] op_sel:[0,0,1] op_sel_hi:[1,0,1]
  v_pk_fma_f32 v[156:157], v[84:85], v[228:229], v[228:229] op_sel:[0,0,1] op_sel_hi:[1,0,1]
  v_pk_fma_f32 v[158:159], v[86:87], v[228:229], v[228:229] op_sel:[0,0,1] op_sel_hi:[1,0,1]
  s_waitcnt vmcnt(0)
  v_add_u32 v9, 73728, v8
  ds_write_b128 v9, v[236:239] offset:0
  ds_write_b128 v9, v[240:243] offset:4096
  ds_write_b128 v9, v[244:247] offset:8192
  s_waitcnt lgkmcnt(0)
  s_barrier
  v_lshlrev_b32 v10, 3, v4
  v_add_u32 v10, 73728, v10
  ds_read_b64 v[196:197], v10 offset:0
  ds_read_b64 v[198:199], v10 offset:256
  ds_read_b64 v[200:201], v10 offset:512
  ds_read_b64 v[202:203], v10 offset:768
  ds_read_b64 v[204:205], v10 offset:1024
  ds_read_b64 v[206:207], v10 offset:1280
  ds_read_b64 v[208:209], v10 offset:1536
  ds_read_b64 v[210:211], v10 offset:1792
  ds_read_b64 v[212:213], v10 offset:2048
  ds_read_b64 v[214:215], v10 offset:2304
  ds_read_b64 v[216:217], v10 offset:2560
  ds_read_b64 v[218:219], v10 offset:2816
  ds_read_b64 v[220:221], v10 offset:3072
  ds_read_b64 v[222:223], v10 offset:3328
  ds_read_b64 v[224:225], v10 offset:3584
  ds_read_b64 v[226:227], v10 offset:3840
  ds_read_b64 v[228:229], v10 offset:4096
  ds_read_b64 v[230:231], v10 offset:4352
  ds_read_b64 v[232:233], v10 offset:4608
  ds_read_b64 v[234:235], v10 offset:4864
  ds_read_b64 v[236:237], v10 offset:5120
  ds_read_b64 v[238:239], v10 offset:5376
  ds_read_b64 v[240:241], v10 offset:5632
  ds_read_b64 v[242:243], v10 offset:5888
  ds_read_b64 v[244:245], v10 offset:6144
  ds_read_b64 v[246:247], v10 offset:6400
  ds_read_b64 v[248:249], v10 offset:6656
  ds_read_b64 v[178:179], v10 offset:6912
  ds_read_b64 v[180:181], v10 offset:7168
  ds_read_b64 v[182:183], v10 offset:7424
  ds_read_b64 v[184:185], v10 offset:7680
  ds_read_b64 v[186:187], v10 offset:7936
  ds_read_b64 v[188:189], v10 offset:8192
  ds_read_b64 v[190:191], v10 offset:8448
  ds_read_b64 v[192:193], v10 offset:8704
  ds_read_b64 v[194:195], v10 offset:8960
  ds_read_b64 v[160:161], v10 offset:9216
  ds_read_b64 v[162:163], v10 offset:9472
  ds_read_b64 v[164:165], v10 offset:9728
  ds_read_b64 v[166:167], v10 offset:9984
  ds_read_b64 v[168:169], v10 offset:10240
  ds_read_b64 v[170:171], v10 offset:10496
  ds_read_b64 v[172:173], v10 offset:10752
  ds_read_b64 v[174:175], v10 offset:11008
  ds_read_b64 v[176:177], v10 offset:11264
  s_waitcnt lgkmcnt(15)
  v_pk_mul_f32 v[214:215], v[214:215], v[232:233]
  v_pk_mul_f32 v[196:197], v[196:197], v[232:233]
  s_waitcnt lgkmcnt(15)
  v_pk_mul_f32 v[216:217], v[216:217], v[234:235]
  v_pk_mul_f32 v[198:199], v[198:199], v[234:235]
  s_waitcnt lgkmcnt(15)
  v_pk_mul_f32 v[218:219], v[218:219], v[236:237]
  v_pk_mul_f32 v[200:201], v[200:201], v[236:237]
  s_waitcnt lgkmcnt(15)
  v_pk_mul_f32 v[220:221], v[220:221], v[238:239]
  v_pk_mul_f32 v[202:203], v[202:203], v[238:239]
  s_waitcnt lgkmcnt(15)
  v_pk_mul_f32 v[222:223], v[222:223], v[240:241]
  v_pk_mul_f32 v[204:205], v[204:205], v[240:241]
  s_waitcnt lgkmcnt(15)
  v_pk_mul_f32 v[224:225], v[224:225], v[242:243]
  v_pk_mul_f32 v[206:207], v[206:207], v[242:243]
  s_waitcnt lgkmcnt(15)
  v_pk_mul_f32 v[226:227], v[226:227], v[244:245]
  v_pk_mul_f32 v[208:209], v[208:209], v[244:245]
  s_waitcnt lgkmcnt(15)
  v_pk_mul_f32 v[228:229], v[228:229], v[246:247]
  v_pk_mul_f32 v[210:211], v[210:211], v[246:247]
  s_waitcnt lgkmcnt(15)
  v_pk_mul_f32 v[230:231], v[230:231], v[248:249]
  v_pk_mul_f32 v[212:213], v[212:213], v[248:249]
  v_pk_fma_f32 v[88:89], v[88:89], v[214:215], v[196:197]
  v_pk_fma_f32 v[90:91], v[90:91], v[216:217], v[198:199]
  v_pk_fma_f32 v[92:93], v[92:93], v[218:219], v[200:201]
  v_pk_fma_f32 v[94:95], v[94:95], v[220:221], v[202:203]
  v_pk_fma_f32 v[96:97], v[96:97], v[222:223], v[204:205]
  v_pk_fma_f32 v[98:99], v[98:99], v[224:225], v[206:207]
  v_pk_fma_f32 v[100:101], v[100:101], v[226:227], v[208:209]
  v_pk_fma_f32 v[102:103], v[102:103], v[228:229], v[210:211]
  v_pk_fma_f32 v[104:105], v[104:105], v[230:231], v[212:213]
  v_pk_fma_f32 v[106:107], v[106:107], v[214:215], v[196:197]
  v_pk_fma_f32 v[108:109], v[108:109], v[216:217], v[198:199]
  v_pk_fma_f32 v[110:111], v[110:111], v[218:219], v[200:201]
  v_pk_fma_f32 v[112:113], v[112:113], v[220:221], v[202:203]
  v_pk_fma_f32 v[114:115], v[114:115], v[222:223], v[204:205]
  v_pk_fma_f32 v[116:117], v[116:117], v[224:225], v[206:207]
  v_pk_fma_f32 v[118:119], v[118:119], v[226:227], v[208:209]
  v_pk_fma_f32 v[120:121], v[120:121], v[228:229], v[210:211]
  v_pk_fma_f32 v[122:123], v[122:123], v[230:231], v[212:213]
  v_pk_fma_f32 v[124:125], v[124:125], v[214:215], v[196:197]
  v_pk_fma_f32 v[126:127], v[126:127], v[216:217], v[198:199]
  v_pk_fma_f32 v[128:129], v[128:129], v[218:219], v[200:201]
  v_pk_fma_f32 v[130:131], v[130:131], v[220:221], v[202:203]
  v_pk_fma_f32 v[132:133], v[132:133], v[222:223], v[204:205]
  v_pk_fma_f32 v[134:135], v[134:135], v[224:225], v[206:207]
  v_pk_fma_f32 v[136:137], v[136:137], v[226:227], v[208:209]
  v_pk_fma_f32 v[138:139], v[138:139], v[228:229], v[210:211]
  v_pk_fma_f32 v[140:141], v[140:141], v[230:231], v[212:213]
  v_pk_fma_f32 v[142:143], v[142:143], v[214:215], v[196:197]
  v_pk_fma_f32 v[144:145], v[144:145], v[216:217], v[198:199]
  v_pk_fma_f32 v[146:147], v[146:147], v[218:219], v[200:201]
  v_pk_fma_f32 v[148:149], v[148:149], v[220:221], v[202:203]
  v_pk_fma_f32 v[150:151], v[150:151], v[222:223], v[204:205]
  v_pk_fma_f32 v[152:153], v[152:153], v[224:225], v[206:207]
  v_pk_fma_f32 v[154:155], v[154:155], v[226:227], v[208:209]
  v_pk_fma_f32 v[156:157], v[156:157], v[228:229], v[210:211]
  v_pk_fma_f32 v[158:159], v[158:159], v[230:231], v[212:213]
  s_waitcnt lgkmcnt(0)
  s_barrier
  s_add_u32 s48, s46, 0x440000
  s_addc_u32 s49, s47, 0
  s_mov_b32 s50, 0x240000
  s_mov_b32 s51, 0x20000
  s_add_u32 s52, s46, 0x684000
  s_addc_u32 s53, s47, 0
  s_mov_b32 s54, 0x240000
  s_mov_b32 s55, 0x20000
  s_add_u32 s56, s46, 0x8c4000
  s_addc_u32 s57, s47, 0
  s_mov_b32 s58, 0x240000
  s_mov_b32 s59, 0x20000
  s_add_u32 s60, s46, 0xb04000
  s_addc_u32 s61, s47, 0
  s_mov_b32 s62, 0x240000
  s_mov_b32 s63, 0x20000
  v_lshrrev_b32 v8, 2, v1
  v_and_b32 v9, 3, v1
  v_lshlrev_b32 v10, 13, v8
  v_lshl_add_u32 v10, v9, 4, v10
  s_lshl_b32 s6, s4, 6
  v_add_u32 v10, s6, v10
  s_lshl_b32 s6, s3, 17
  v_add_u32 v10, s6, v10
  s_movk_i32 s8, 4096
  v_add_u32 v240, 0, v10
  v_add_u32 v241, 524288, v10
  v_add_u32 v242, 1048576, v10
  v_add_u32 v243, 1572864, v10
  v_add_u32 v244, 2097152, v10
  s_mov_b32 s77, 0
L_tm_11:
  buffer_load_dwordx4 v[196:199], v240, s[48:51], 0 offen sc1
  buffer_load_dwordx4 v[200:203], v240, s[48:51], s8 offen sc1
  buffer_load_dwordx4 v[204:207], v241, s[48:51], 0 offen sc1
  buffer_load_dwordx4 v[208:211], v241, s[48:51], s8 offen sc1
  buffer_load_dwordx4 v[212:215], v242, s[48:51], 0 offen sc1
  buffer_load_dwordx4 v[216:219], v242, s[48:51], s8 offen sc1
  buffer_load_dwordx4 v[220:223], v243, s[48:51], 0 offen sc1
  buffer_load_dwordx4 v[224:227], v243, s[48:51], s8 offen sc1
  buffer_load_dwordx4 v[228:231], v244, s[48:51], 0 offen sc1
  buffer_load_dwordx4 v[232:235], v244, s[48:51], s8 offen sc1
  s_waitcnt vmcnt(0)
  v_max_u32 v251, v197, v201
  v_max3_u32 v251, v251, v205, v209
  v_max3_u32 v251, v251, v213, v217
  v_max3_u32 v251, v251, v221, v225
  v_max3_u32 v251, v251, v229, v233
  v_max3_u32 v251, v251, v199, v203
  v_max3_u32 v251, v251, v207, v211
  v_max3_u32 v251, v251, v215, v219
  v_max3_u32 v251, v251, v223, v227
  v_max3_u32 v251, v251, v231, v235
  v_cmp_eq_u32 vcc, -1, v251
  s_add_u32 s77, s77, 1
  s_nop 1
  s_cbranch_vccz L_tmok_12
  s_cmp_ge_u32 s77, 131072
  s_cbranch_scc1 L_tmok_12
  s_mov_b64 exec, vcc
  s_branch L_tm_11
L_tmok_12:
  s_mov_b64 exec, -1
  v_bfe_u32 v11, v8, 1, 3
  v_lshlrev_b32 v12, 1, v9
  v_xor_b32 v11, v11, v12
  v_lshlrev_b32 v11, 4, v11
  v_lshl_add_u32 v11, v8, 7, v11
  s_lshl_b32 s6, s3, 11
  v_add_u32 v11, s6, v11
  v_xor_b32 v12, 16, v11
  s_mov_b32 s8, 0x05040100
  s_mov_b32 s9, 0x07060302
  v_perm_b32 v236, v200, v196, s8
  v_perm_b32 v237, v200, v196, s9
  v_perm_b32 v238, v201, v197, s8
  v_perm_b32 v239, v201, v197, s9
  v_perm_b32 v240, v202, v198, s8
  v_perm_b32 v241, v202, v198, s9
  v_perm_b32 v242, v203, v199, s8
  v_perm_b32 v243, v203, v199, s9
  ds_write_b128 v11, v[236:239] offset:0
  ds_write_b128 v12, v[240:243] offset:0
  v_perm_b32 v244, v208, v204, s8
  v_perm_b32 v245, v208, v204, s9
  v_perm_b32 v246, v209, v205, s8
  v_perm_b32 v247, v209, v205, s9
  v_perm_b32 v248, v210, v206, s8
  v_perm_b32 v249, v210, v206, s9
  v_perm_b32 v250, v211, v207, s8
  v_perm_b32 v251, v211, v207, s9
  ds_write_b128 v11, v[244:247] offset:8192
  ds_write_b128 v12, v[248:251] offset:8192
  v_perm_b32 v236, v216, v212, s8
  v_perm_b32 v237, v216, v212, s9
  v_perm_b32 v238, v217, v213, s8
  v_perm_b32 v239, v217, v213, s9
  v_perm_b32 v240, v218, v214, s8
  v_perm_b32 v241, v218, v214, s9
  v_perm_b32 v242, v219, v215, s8
  v_perm_b32 v243, v219, v215, s9
  ds_write_b128 v11, v[236:239] offset:16384
  ds_write_b128 v12, v[240:243] offset:16384
  v_perm_b32 v244, v224, v220, s8
  v_perm_b32 v245, v224, v220, s9
  v_perm_b32 v246, v225, v221, s8
  v_perm_b32 v247, v225, v221, s9
  v_perm_b32 v248, v226, v222, s8
  v_perm_b32 v249, v226, v222, s9
  v_perm_b32 v250, v227, v223, s8
  v_perm_b32 v251, v227, v223, s9
  ds_write_b128 v11, v[244:247] offset:24576
  ds_write_b128 v12, v[248:251] offset:24576
  v_perm_b32 v236, v232, v228, s8
  v_perm_b32 v237, v232, v228, s9
  v_perm_b32 v238, v233, v229, s8
  v_perm_b32 v239, v233, v229, s9
  v_perm_b32 v240, v234, v230, s8
  v_perm_b32 v241, v234, v230, s9
  v_perm_b32 v242, v235, v231, s8
  v_perm_b32 v243, v235, v231, s9
  ds_write_b128 v11, v[236:239] offset:32768
  ds_write_b128 v12, v[240:243] offset:32768
  s_waitcnt vmcnt(0) lgkmcnt(0)
  s_barrier
  s_lshl_b32 s6, s3, 1
  v_add_u32 v8, s6, v3
  v_bfe_u32 v9, v4, 1, 3
  v_xor_b32 v8, v8, v9
  v_lshlrev_b32 v8, 4, v8
  v_lshl_add_u32 v8, v4, 7, v8
  ds_read_b128 v[196:199], v8 offset:0
  ds_read_b128 v[200:203], v8 offset:4096
  ds_read_b128 v[204:207], v8 offset:8192
  ds_read_b128 v[208:211], v8 offset:12288
  ds_read_b128 v[212:215], v8 offset:16384
  ds_read_b128 v[216:219], v8 offset:20480
  ds_read_b128 v[220:223], v8 offset:24576
  ds_read_b128 v[224:227], v8 offset:28672
  ds_read_b128 v[228:231], v8 offset:32768
  s_waitcnt lgkmcnt(8)
  v_lshlrev_b32 v232, 16, v196
  v_and_b32 v233, s99, v196
  v_lshlrev_b32 v234, 16, v197
  v_and_b32 v235, s99, v197
  v_lshlrev_b32 v236, 16, v198
  v_and_b32 v237, s99, v198
  v_lshlrev_b32 v238, 16, v199
  v_and_b32 v239, s99, v199
  v_pk_fma_f32 v[88:89], v[88:89], v[232:233], v[16:17]
  v_pk_fma_f32 v[106:107], v[106:107], v[234:235], v[34:35]
  v_pk_fma_f32 v[124:125], v[124:125], v[236:237], v[52:53]
  v_pk_fma_f32 v[142:143], v[142:143], v[238:239], v[70:71]
  v_cvt_pk_bf16_f32 v16, v88, v89
  v_cvt_pk_bf16_f32 v34, v106, v107
  v_cvt_pk_bf16_f32 v52, v124, v125
  v_cvt_pk_bf16_f32 v70, v142, v143
  s_waitcnt lgkmcnt(7)
  v_lshlrev_b32 v232, 16, v200
  v_and_b32 v233, s99, v200
  v_lshlrev_b32 v234, 16, v201
  v_and_b32 v235, s99, v201
  v_lshlrev_b32 v236, 16, v202
  v_and_b32 v237, s99, v202
  v_lshlrev_b32 v238, 16, v203
  v_and_b32 v239, s99, v203
  v_pk_fma_f32 v[90:91], v[90:91], v[232:233], v[18:19]
  v_pk_fma_f32 v[108:109], v[108:109], v[234:235], v[36:37]
  v_pk_fma_f32 v[126:127], v[126:127], v[236:237], v[54:55]
  v_pk_fma_f32 v[144:145], v[144:145], v[238:239], v[72:73]
  v_cvt_pk_bf16_f32 v18, v90, v91
  v_cvt_pk_bf16_f32 v36, v108, v109
  v_cvt_pk_bf16_f32 v54, v126, v127
  v_cvt_pk_bf16_f32 v72, v144, v145
  s_waitcnt lgkmcnt(6)
  v_lshlrev_b32 v232, 16, v204
  v_and_b32 v233, s99, v204
  v_lshlrev_b32 v234, 16, v205
  v_and_b32 v235, s99, v205
  v_lshlrev_b32 v236, 16, v206
  v_and_b32 v237, s99, v206
  v_lshlrev_b32 v238, 16, v207
  v_and_b32 v239, s99, v207
  v_pk_fma_f32 v[92:93], v[92:93], v[232:233], v[20:21]
  v_pk_fma_f32 v[110:111], v[110:111], v[234:235], v[38:39]
  v_pk_fma_f32 v[128:129], v[128:129], v[236:237], v[56:57]
  v_pk_fma_f32 v[146:147], v[146:147], v[238:239], v[74:75]
  v_cvt_pk_bf16_f32 v20, v92, v93
  v_cvt_pk_bf16_f32 v38, v110, v111
  v_cvt_pk_bf16_f32 v56, v128, v129
  v_cvt_pk_bf16_f32 v74, v146, v147
  s_waitcnt lgkmcnt(5)
  v_lshlrev_b32 v232, 16, v208
  v_and_b32 v233, s99, v208
  v_lshlrev_b32 v234, 16, v209
  v_and_b32 v235, s99, v209
  v_lshlrev_b32 v236, 16, v210
  v_and_b32 v237, s99, v210
  v_lshlrev_b32 v238, 16, v211
  v_and_b32 v239, s99, v211
  v_pk_fma_f32 v[94:95], v[94:95], v[232:233], v[22:23]
  v_pk_fma_f32 v[112:113], v[112:113], v[234:235], v[40:41]
  v_pk_fma_f32 v[130:131], v[130:131], v[236:237], v[58:59]
  v_pk_fma_f32 v[148:149], v[148:149], v[238:239], v[76:77]
  v_cvt_pk_bf16_f32 v22, v94, v95
  v_cvt_pk_bf16_f32 v40, v112, v113
  v_cvt_pk_bf16_f32 v58, v130, v131
  v_cvt_pk_bf16_f32 v76, v148, v149
  s_waitcnt lgkmcnt(4)
  v_lshlrev_b32 v232, 16, v212
  v_and_b32 v233, s99, v212
  v_lshlrev_b32 v234, 16, v213
  v_and_b32 v235, s99, v213
  v_lshlrev_b32 v236, 16, v214
  v_and_b32 v237, s99, v214
  v_lshlrev_b32 v238, 16, v215
  v_and_b32 v239, s99, v215
  v_pk_fma_f32 v[96:97], v[96:97], v[232:233], v[24:25]
  v_pk_fma_f32 v[114:115], v[114:115], v[234:235], v[42:43]
  v_pk_fma_f32 v[132:133], v[132:133], v[236:237], v[60:61]
  v_pk_fma_f32 v[150:151], v[150:151], v[238:239], v[78:79]
  v_cvt_pk_bf16_f32 v24, v96, v97
  v_cvt_pk_bf16_f32 v42, v114, v115
  v_cvt_pk_bf16_f32 v60, v132, v133
  v_cvt_pk_bf16_f32 v78, v150, v151
  s_waitcnt lgkmcnt(3)
  v_lshlrev_b32 v232, 16, v216
  v_and_b32 v233, s99, v216
  v_lshlrev_b32 v234, 16, v217
  v_and_b32 v235, s99, v217
  v_lshlrev_b32 v236, 16, v218
  v_and_b32 v237, s99, v218
  v_lshlrev_b32 v238, 16, v219
  v_and_b32 v239, s99, v219
  v_pk_fma_f32 v[98:99], v[98:99], v[232:233], v[26:27]
  v_pk_fma_f32 v[116:117], v[116:117], v[234:235], v[44:45]
  v_pk_fma_f32 v[134:135], v[134:135], v[236:237], v[62:63]
  v_pk_fma_f32 v[152:153], v[152:153], v[238:239], v[80:81]
  v_cvt_pk_bf16_f32 v26, v98, v99
  v_cvt_pk_bf16_f32 v44, v116, v117
  v_cvt_pk_bf16_f32 v62, v134, v135
  v_cvt_pk_bf16_f32 v80, v152, v153
  s_waitcnt lgkmcnt(2)
  v_lshlrev_b32 v232, 16, v220
  v_and_b32 v233, s99, v220
  v_lshlrev_b32 v234, 16, v221
  v_and_b32 v235, s99, v221
  v_lshlrev_b32 v236, 16, v222
  v_and_b32 v237, s99, v222
  v_lshlrev_b32 v238, 16, v223
  v_and_b32 v239, s99, v223
  v_pk_fma_f32 v[100:101], v[100:101], v[232:233], v[28:29]
  v_pk_fma_f32 v[118:119], v[118:119], v[234:235], v[46:47]
  v_pk_fma_f32 v[136:137], v[136:137], v[236:237], v[64:65]
  v_pk_fma_f32 v[154:155], v[154:155], v[238:239], v[82:83]
  v_cvt_pk_bf16_f32 v28, v100, v101
  v_cvt_pk_bf16_f32 v46, v118, v119
  v_cvt_pk_bf16_f32 v64, v136, v137
  v_cvt_pk_bf16_f32 v82, v154, v155
  s_waitcnt lgkmcnt(1)
  v_lshlrev_b32 v232, 16, v224
  v_and_b32 v233, s99, v224
  v_lshlrev_b32 v234, 16, v225
  v_and_b32 v235, s99, v225
  v_lshlrev_b32 v236, 16, v226
  v_and_b32 v237, s99, v226
  v_lshlrev_b32 v238, 16, v227
  v_and_b32 v239, s99, v227
  v_pk_fma_f32 v[102:103], v[102:103], v[232:233], v[30:31]
  v_pk_fma_f32 v[120:121], v[120:121], v[234:235], v[48:49]
  v_pk_fma_f32 v[138:139], v[138:139], v[236:237], v[66:67]
  v_pk_fma_f32 v[156:157], v[156:157], v[238:239], v[84:85]
  v_cvt_pk_bf16_f32 v30, v102, v103
  v_cvt_pk_bf16_f32 v48, v120, v121
  v_cvt_pk_bf16_f32 v66, v138, v139
  v_cvt_pk_bf16_f32 v84, v156, v157
  s_waitcnt lgkmcnt(0)
  v_lshlrev_b32 v232, 16, v228
  v_and_b32 v233, s99, v228
  v_lshlrev_b32 v234, 16, v229
  v_and_b32 v235, s99, v229
  v_lshlrev_b32 v236, 16, v230
  v_and_b32 v237, s99, v230
  v_lshlrev_b32 v238, 16, v231
  v_and_b32 v239, s99, v231
  v_pk_fma_f32 v[104:105], v[104:105], v[232:233], v[32:33]
  v_pk_fma_f32 v[122:123], v[122:123], v[234:235], v[50:51]
  v_pk_fma_f32 v[140:141], v[140:141], v[236:237], v[68:69]
  v_pk_fma_f32 v[158:159], v[158:159], v[238:239], v[86:87]
  v_cvt_pk_bf16_f32 v32, v104, v105
  v_cvt_pk_bf16_f32 v50, v122, v123
  v_cvt_pk_bf16_f32 v68, v140, v141
  v_cvt_pk_bf16_f32 v86, v158, v159
  v_pk_mul_f32 v[198:199], v[88:89], v[88:89]
  v_pk_mul_f32 v[202:203], v[106:107], v[106:107]
  v_pk_mul_f32 v[206:207], v[124:125], v[124:125]
  v_pk_mul_f32 v[210:211], v[142:143], v[142:143]
  v_pk_fma_f32 v[198:199], v[90:91], v[90:91], v[198:199]
  v_pk_add_f32 v[196:197], v[88:89], v[90:91]
  v_pk_fma_f32 v[202:203], v[108:109], v[108:109], v[202:203]
  v_pk_add_f32 v[200:201], v[106:107], v[108:109]
  v_pk_fma_f32 v[206:207], v[126:127], v[126:127], v[206:207]
  v_pk_add_f32 v[204:205], v[124:125], v[126:127]
  v_pk_fma_f32 v[210:211], v[144:145], v[144:145], v[210:211]
  v_pk_add_f32 v[208:209], v[142:143], v[144:145]
  v_pk_fma_f32 v[198:199], v[92:93], v[92:93], v[198:199]
  v_pk_add_f32 v[196:197], v[196:197], v[92:93]
  v_pk_fma_f32 v[202:203], v[110:111], v[110:111], v[202:203]
  v_pk_add_f32 v[200:201], v[200:201], v[110:111]
  v_pk_fma_f32 v[206:207], v[128:129], v[128:129], v[206:207]
  v_pk_add_f32 v[204:205], v[204:205], v[128:129]
  v_pk_fma_f32 v[210:211], v[146:147], v[146:147], v[210:211]
  v_pk_add_f32 v[208:209], v[208:209], v[146:147]
  v_pk_fma_f32 v[198:199], v[94:95], v[94:95], v[198:199]
  v_pk_add_f32 v[196:197], v[196:197], v[94:95]
  v_pk_fma_f32 v[202:203], v[112:113], v[112:113], v[202:203]
  v_pk_add_f32 v[200:201], v[200:201], v[112:113]
  v_pk_fma_f32 v[206:207], v[130:131], v[130:131], v[206:207]
  v_pk_add_f32 v[204:205], v[204:205], v[130:131]
  v_pk_fma_f32 v[210:211], v[148:149], v[148:149], v[210:211]
  v_pk_add_f32 v[208:209], v[208:209], v[148:149]
  v_pk_fma_f32 v[198:199], v[96:97], v[96:97], v[198:199]
  v_pk_add_f32 v[196:197], v[196:197], v[96:97]
  v_pk_fma_f32 v[202:203], v[114:115], v[114:115], v[202:203]
  v_pk_add_f32 v[200:201], v[200:201], v[114:115]
  v_pk_fma_f32 v[206:207], v[132:133], v[132:133], v[206:207]
  v_pk_add_f32 v[204:205], v[204:205], v[132:133]
  v_pk_fma_f32 v[210:211], v[150:151], v[150:151], v[210:211]
  v_pk_add_f32 v[208:209], v[208:209], v[150:151]
  v_pk_fma_f32 v[198:199], v[98:99], v[98:99], v[198:199]
  v_pk_add_f32 v[196:197], v[196:197], v[98:99]
  v_pk_fma_f32 v[202:203], v[116:117], v[116:117], v[202:203]
  v_pk_add_f32 v[200:201], v[200:201], v[116:117]
  v_pk_fma_f32 v[206:207], v[134:135], v[134:135], v[206:207]
  v_pk_add_f32 v[204:205], v[204:205], v[134:135]
  v_pk_fma_f32 v[210:211], v[152:153], v[152:153], v[210:211]
  v_pk_add_f32 v[208:209], v[208:209], v[152:153]
  v_pk_fma_f32 v[198:199], v[100:101], v[100:101], v[198:199]
  v_pk_add_f32 v[196:197], v[196:197], v[100:101]
  v_pk_fma_f32 v[202:203], v[118:119], v[118:119], v[202:203]
  v_pk_add_f32 v[200:201], v[200:201], v[118:119]
  v_pk_fma_f32 v[206:207], v[136:137], v[136:137], v[206:207]
  v_pk_add_f32 v[204:205], v[204:205], v[136:137]
  v_pk_fma_f32 v[210:211], v[154:155], v[154:155], v[210:211]
  v_pk_add_f32 v[208:209], v[208:209], v[154:155]
  v_pk_fma_f32 v[198:199], v[102:103], v[102:103], v[198:199]
  v_pk_add_f32 v[196:197], v[196:197], v[102:103]
  v_pk_fma_f32 v[202:203], v[120:121], v[120:121], v[202:203]
  v_pk_add_f32 v[200:201], v[200:201], v[120:121]
  v_pk_fma_f32 v[206:207], v[138:139], v[138:139], v[206:207]
  v_pk_add_f32 v[204:205], v[204:205], v[138:139]
  v_pk_fma_f32 v[210:211], v[156:157], v[156:157], v[210:211]
  v_pk_add_f32 v[208:209], v[208:209], v[156:157]
  v_pk_fma_f32 v[198:199], v[104:105], v[104:105], v[198:199]
  v_pk_add_f32 v[196:197], v[196:197], v[104:105]
  v_pk_fma_f32 v[202:203], v[122:123], v[122:123], v[202:203]
  v_pk_add_f32 v[200:201], v[200:201], v[122:123]
  v_pk_fma_f32 v[206:207], v[140:141], v[140:141], v[206:207]
  v_pk_add_f32 v[204:205], v[204:205], v[140:141]
  v_pk_fma_f32 v[210:211], v[158:159], v[158:159], v[210:211]
  v_pk_add_f32 v[208:209], v[208:209], v[158:159]
  v_add_f32 v196, v196, v197
  v_add_f32 v198, v198, v199
  v_add_f32 v200, v200, v201
  v_add_f32 v202, v202, v203
  v_add_f32 v204, v204, v205
  v_add_f32 v206, v206, v207
  v_add_f32 v208, v208, v209
  v_add_f32 v210, v210, v211
  v_add_f32_dpp v196, v196, v196 row_ror:8 row_mask:0xf bank_mask:0xf
  v_add_f32_dpp v200, v200, v200 row_ror:8 row_mask:0xf bank_mask:0xf
  v_add_f32_dpp v204, v204, v204 row_ror:8 row_mask:0xf bank_mask:0xf
  v_add_f32_dpp v208, v208, v208 row_ror:8 row_mask:0xf bank_mask:0xf
  v_add_f32_dpp v198, v198, v198 row_ror:8 row_mask:0xf bank_mask:0xf
  v_add_f32_dpp v202, v202, v202 row_ror:8 row_mask:0xf bank_mask:0xf
  v_add_f32_dpp v206, v206, v206 row_ror:8 row_mask:0xf bank_mask:0xf
  v_add_f32_dpp v210, v210, v210 row_ror:8 row_mask:0xf bank_mask:0xf
  v_add_f32_dpp v196, v196, v196 row_ror:4 row_mask:0xf bank_mask:0xf
  v_add_f32_dpp v200, v200, v200 row_ror:4 row_mask:0xf bank_mask:0xf
  v_add_f32_dpp v204, v204, v204 row_ror:4 row_mask:0xf bank_mask:0xf
  v_add_f32_dpp v208, v208, v208 row_ror:4 row_mask:0xf bank_mask:0xf
  v_add_f32_dpp v198, v198, v198 row_ror:4 row_mask:0xf bank_mask:0xf
  v_add_f32_dpp v202, v202, v202 row_ror:4 row_mask:0xf bank_mask:0xf
  v_add_f32_dpp v206, v206, v206 row_ror:4 row_mask:0xf bank_mask:0xf
  v_add_f32_dpp v210, v210, v210 row_ror:4 row_mask:0xf bank_mask:0xf
  v_add_f32_dpp v196, v196, v196 row_ror:2 row_mask:0xf bank_mask:0xf
  v_add_f32_dpp v200, v200, v200 row_ror:2 row_mask:0xf bank_mask:0xf
  v_add_f32_dpp v204, v204, v204 row_ror:2 row_mask:0xf bank_mask:0xf
  v_add_f32_dpp v208, v208, v208 row_ror:2 row_mask:0xf bank_mask:0xf
  v_add_f32_dpp v198, v198, v198 row_ror:2 row_mask:0xf bank_mask:0xf
  v_add_f32_dpp v202, v202, v202 row_ror:2 row_mask:0xf bank_mask:0xf
  v_add_f32_dpp v206, v206, v206 row_ror:2 row_mask:0xf bank_mask:0xf
  v_add_f32_dpp v210, v210, v210 row_ror:2 row_mask:0xf bank_mask:0xf
  v_add_f32_dpp v196, v196, v196 row_ror:1 row_mask:0xf bank_mask:0xf
  v_add_f32_dpp v200, v200, v200 row_ror:1 row_mask:0xf bank_mask:0xf
  v_add_f32_dpp v204, v204, v204 row_ror:1 row_mask:0xf bank_mask:0xf
  v_add_f32_dpp v208, v208, v208 row_ror:1 row_mask:0xf bank_mask:0xf
  v_add_f32_dpp v198, v198, v198 row_ror:1 row_mask:0xf bank_mask:0xf
  v_add_f32_dpp v202, v202, v202 row_ror:1 row_mask:0xf bank_mask:0xf
  v_add_f32_dpp v206, v206, v206 row_ror:1 row_mask:0xf bank_mask:0xf
  v_add_f32_dpp v210, v210, v210 row_ror:1 row_mask:0xf bank_mask:0xf
  v_mov_b32 v212, v196
  v_mov_b32 v213, v200
  v_mov_b32 v214, v204
  v_mov_b32 v215, v208
  v_mov_b32 v216, v198
  v_mov_b32 v217, v202
  v_mov_b32 v218, v206
  v_mov_b32 v219, v210
  v_permlane16_swap_b32 v196, v212
  v_permlane16_swap_b32 v200, v213
  v_permlane16_swap_b32 v204, v214
  v_permlane16_swap_b32 v208, v215
  v_permlane16_swap_b32 v198, v216
  v_permlane16_swap_b32 v202, v217
  v_permlane16_swap_b32 v206, v218
  v_permlane16_swap_b32 v210, v219
  v_add_f32 v196, v196, v212
  v_add_f32 v200, v200, v213
  v_add_f32 v204, v204, v214
  v_add_f32 v208, v208, v215
  v_add_f32 v198, v198, v216
  v_add_f32 v202, v202, v217
  v_add_f32 v206, v206, v218
  v_add_f32 v210, v210, v219
  v_mul_f32 v196, s98, v196
  v_mul_f32 v198, s98, v198
  v_mul_f32 v200, s98, v200
  v_mul_f32 v202, s98, v202
  v_mul_f32 v204, s98, v204
  v_mul_f32 v206, s98, v206
  v_mul_f32 v208, s98, v208
  v_mul_f32 v210, s98, v210
  v_fma_f32 v198, -v196, v196, v198
  v_fma_f32 v202, -v200, v200, v202
  v_fma_f32 v206, -v204, v204, v206
  v_fma_f32 v210, -v208, v208, v210
  v_max_f32 v198, 0, v198
  v_max_f32 v202, 0, v202
  v_max_f32 v206, 0, v206
  v_max_f32 v210, 0, v210
  v_add_f32 v198, s97, v198
  v_add_f32 v202, s97, v202
  v_add_f32 v206, s97, v206
  v_add_f32 v210, s97, v210
  v_rsq_f32 v198, v198
  v_rsq_f32 v202, v202
  v_rsq_f32 v206, v206
  v_rsq_f32 v210, v210
  v_mul_f32 v197, -v196, v198
  v_mul_f32 v201, -v200, v202
  v_mul_f32 v205, -v204, v206
  v_mul_f32 v209, -v208, v210
  v_mov_b32 v196, v198
  v_mov_b32 v200, v202
  v_mov_b32 v204, v206
  v_mov_b32 v208, v210
  v_pk_fma_f32 v[88:89], v[88:89], v[196:197], v[196:197] op_sel:[0,0,1] op_sel_hi:[1,0,1]
  v_pk_fma_f32 v[106:107], v[106:107], v[200:201], v[200:201] op_sel:[0,0,1] op_sel_hi:[1,0,1]
  v_pk_fma_f32 v[124:125], v[124:125], v[204:205], v[204:205] op_sel:[0,0,1] op_sel_hi:[1,0,1]
  v_pk_fma_f32 v[142:143], v[142:143], v[208:209], v[208:209] op_sel:[0,0,1] op_sel_hi:[1,0,1]
  v_pk_fma_f32 v[88:89], v[88:89], v[160:161], v[178:179]
  v_pk_fma_f32 v[106:107], v[106:107], v[160:161], v[178:179]
  v_pk_fma_f32 v[124:125], v[124:125], v[160:161], v[178:179]
  v_pk_fma_f32 v[142:143], v[142:143], v[160:161], v[178:179]
  v_cvt_pk_bf16_f32 v17, v88, v89
  v_cvt_pk_bf16_f32 v35, v106, v107
  v_cvt_pk_bf16_f32 v53, v124, v125
  v_cvt_pk_bf16_f32 v71, v142, v143
  v_pk_fma_f32 v[90:91], v[90:91], v[196:197], v[196:197] op_sel:[0,0,1] op_sel_hi:[1,0,1]
  v_pk_fma_f32 v[108:109], v[108:109], v[200:201], v[200:201] op_sel:[0,0,1] op_sel_hi:[1,0,1]
  v_pk_fma_f32 v[126:127], v[126:127], v[204:205], v[204:205] op_sel:[0,0,1] op_sel_hi:[1,0,1]
  v_pk_fma_f32 v[144:145], v[144:145], v[208:209], v[208:209] op_sel:[0,0,1] op_sel_hi:[1,0,1]
  v_pk_fma_f32 v[90:91], v[90:91], v[162:163], v[180:181]
  v_pk_fma_f32 v[108:109], v[108:109], v[162:163], v[180:181]
  v_pk_fma_f32 v[126:127], v[126:127], v[162:163], v[180:181]
  v_pk_fma_f32 v[144:145], v[144:145], v[162:163], v[180:181]
  v_cvt_pk_bf16_f32 v19, v90, v91
  v_cvt_pk_bf16_f32 v37, v108, v109
  v_cvt_pk_bf16_f32 v55, v126, v127
  v_cvt_pk_bf16_f32 v73, v144, v145
  v_pk_fma_f32 v[92:93], v[92:93], v[196:197], v[196:197] op_sel:[0,0,1] op_sel_hi:[1,0,1]
  v_pk_fma_f32 v[110:111], v[110:111], v[200:201], v[200:201] op_sel:[0,0,1] op_sel_hi:[1,0,1]
  v_pk_fma_f32 v[128:129], v[128:129], v[204:205], v[204:205] op_sel:[0,0,1] op_sel_hi:[1,0,1]
  v_pk_fma_f32 v[146:147], v[146:147], v[208:209], v[208:209] op_sel:[0,0,1] op_sel_hi:[1,0,1]
  v_pk_fma_f32 v[92:93], v[92:93], v[164:165], v[182:183]
  v_pk_fma_f32 v[110:111], v[110:111], v[164:165], v[182:183]
  v_pk_fma_f32 v[128:129], v[128:129], v[164:165], v[182:183]
  v_pk_fma_f32 v[146:147], v[146:147], v[164:165], v[182:183]
  v_cvt_pk_bf16_f32 v21, v92, v93
  v_cvt_pk_bf16_f32 v39, v110, v111
  v_cvt_pk_bf16_f32 v57, v128, v129
  v_cvt_pk_bf16_f32 v75, v146, v147
  v_pk_fma_f32 v[94:95], v[94:95], v[196:197], v[196:197] op_sel:[0,0,1] op_sel_hi:[1,0,1]
  v_pk_fma_f32 v[112:113], v[112:113], v[200:201], v[200:201] op_sel:[0,0,1] op_sel_hi:[1,0,1]
  v_pk_fma_f32 v[130:131], v[130:131], v[204:205], v[204:205] op_sel:[0,0,1] op_sel_hi:[1,0,1]
  v_pk_fma_f32 v[148:149], v[148:149], v[208:209], v[208:209] op_sel:[0,0,1] op_sel_hi:[1,0,1]
  v_pk_fma_f32 v[94:95], v[94:95], v[166:167], v[184:185]
  v_pk_fma_f32 v[112:113], v[112:113], v[166:167], v[184:185]
  v_pk_fma_f32 v[130:131], v[130:131], v[166:167], v[184:185]
  v_pk_fma_f32 v[148:149], v[148:149], v[166:167], v[184:185]
  v_cvt_pk_bf16_f32 v23, v94, v95
  v_cvt_pk_bf16_f32 v41, v112, v113
  v_cvt_pk_bf16_f32 v59, v130, v131
  v_cvt_pk_bf16_f32 v77, v148, v149
  v_pk_fma_f32 v[96:97], v[96:97], v[196:197], v[196:197] op_sel:[0,0,1] op_sel_hi:[1,0,1]
  v_pk_fma_f32 v[114:115], v[114:115], v[200:201], v[200:201] op_sel:[0,0,1] op_sel_hi:[1,0,1]
  v_pk_fma_f32 v[132:133], v[132:133], v[204:205], v[204:205] op_sel:[0,0,1] op_sel_hi:[1,0,1]
  v_pk_fma_f32 v[150:151], v[150:151], v[208:209], v[208:209] op_sel:[0,0,1] op_sel_hi:[1,0,1]
  v_pk_fma_f32 v[96:97], v[96:97], v[168:169], v[186:187]
  v_pk_fma_f32 v[114:115], v[114:115], v[168:169], v[186:187]
  v_pk_fma_f32 v[132:133], v[132:133], v[168:169], v[186:187]
  v_pk_fma_f32 v[150:151], v[150:151], v[168:169], v[186:187]
  v_cvt_pk_bf16_f32 v25, v96, v97
  v_cvt_pk_bf16_f32 v43, v114, v115
  v_cvt_pk_bf16_f32 v61, v132, v133
  v_cvt_pk_bf16_f32 v79, v150, v151
  v_pk_fma_f32 v[98:99], v[98:99], v[196:197], v[196:197] op_sel:[0,0,1] op_sel_hi:[1,0,1]
  v_pk_fma_f32 v[116:117], v[116:117], v[200:201], v[200:201] op_sel:[0,0,1] op_sel_hi:[1,0,1]
  v_pk_fma_f32 v[134:135], v[134:135], v[204:205], v[204:205] op_sel:[0,0,1] op_sel_hi:[1,0,1]
  v_pk_fma_f32 v[152:153], v[152:153], v[208:209], v[208:209] op_sel:[0,0,1] op_sel_hi:[1,0,1]
  v_pk_fma_f32 v[98:99], v[98:99], v[170:171], v[188:189]
  v_pk_fma_f32 v[116:117], v[116:117], v[170:171], v[188:189]
  v_pk_fma_f32 v[134:135], v[134:135], v[170:171], v[188:189]
  v_pk_fma_f32 v[152:153], v[152:153], v[170:171], v[188:189]
  v_cvt_pk_bf16_f32 v27, v98, v99
  v_cvt_pk_bf16_f32 v45, v116, v117
  v_cvt_pk_bf16_f32 v63, v134, v135
  v_cvt_pk_bf16_f32 v81, v152, v153
  v_pk_fma_f32 v[100:101], v[100:101], v[196:197], v[196:197] op_sel:[0,0,1] op_sel_hi:[1,0,1]
  v_pk_fma_f32 v[118:119], v[118:119], v[200:201], v[200:201] op_sel:[0,0,1] op_sel_hi:[1,0,1]
  v_pk_fma_f32 v[136:137], v[136:137], v[204:205], v[204:205] op_sel:[0,0,1] op_sel_hi:[1,0,1]
  v_pk_fma_f32 v[154:155], v[154:155], v[208:209], v[208:209] op_sel:[0,0,1] op_sel_hi:[1,0,1]
  v_pk_fma_f32 v[100:101], v[100:101], v[172:173], v[190:191]
  v_pk_fma_f32 v[118:119], v[118:119], v[172:173], v[190:191]
  v_pk_fma_f32 v[136:137], v[136:137], v[172:173], v[190:191]
  v_pk_fma_f32 v[154:155], v[154:155], v[172:173], v[190:191]
  v_cvt_pk_bf16_f32 v29, v100, v101
  v_cvt_pk_bf16_f32 v47, v118, v119
  v_cvt_pk_bf16_f32 v65, v136, v137
  v_cvt_pk_bf16_f32 v83, v154, v155
  v_pk_fma_f32 v[102:103], v[102:103], v[196:197], v[196:197] op_sel:[0,0,1] op_sel_hi:[1,0,1]
  v_pk_fma_f32 v[120:121], v[120:121], v[200:201], v[200:201] op_sel:[0,0,1] op_sel_hi:[1,0,1]
  v_pk_fma_f32 v[138:139], v[138:139], v[204:205], v[204:205] op_sel:[0,0,1] op_sel_hi:[1,0,1]
  v_pk_fma_f32 v[156:157], v[156:157], v[208:209], v[208:209] op_sel:[0,0,1] op_sel_hi:[1,0,1]
  v_pk_fma_f32 v[102:103], v[102:103], v[174:175], v[192:193]
  v_pk_fma_f32 v[120:121], v[120:121], v[174:175], v[192:193]
  v_pk_fma_f32 v[138:139], v[138:139], v[174:175], v[192:193]
  v_pk_fma_f32 v[156:157], v[156:157], v[174:175], v[192:193]
  v_cvt_pk_bf16_f32 v31, v102, v103
  v_cvt_pk_bf16_f32 v49, v120, v121
  v_cvt_pk_bf16_f32 v67, v138, v139
  v_cvt_pk_bf16_f32 v85, v156, v157
  v_pk_fma_f32 v[104:105], v[104:105], v[196:197], v[196:197] op_sel:[0,0,1] op_sel_hi:[1,0,1]
  v_pk_fma_f32 v[122:123], v[122:123], v[200:201], v[200:201] op_sel:[0,0,1] op_sel_hi:[1,0,1]
  v_pk_fma_f32 v[140:141], v[140:141], v[204:205], v[204:205] op_sel:[0,0,1] op_sel_hi:[1,0,1]
  v_pk_fma_f32 v[158:159], v[158:159], v[208:209], v[208:209] op_sel:[0,0,1] op_sel_hi:[1,0,1]
  v_pk_fma_f32 v[104:105], v[104:105], v[176:177], v[194:195]
  v_pk_fma_f32 v[122:123], v[122:123], v[176:177], v[194:195]
  v_pk_fma_f32 v[140:141], v[140:141], v[176:177], v[194:195]
  v_pk_fma_f32 v[158:159], v[158:159], v[176:177], v[194:195]
  v_cvt_pk_bf16_f32 v33, v104, v105
  v_cvt_pk_bf16_f32 v51, v122, v123
  v_cvt_pk_bf16_f32 v69, v140, v141
  v_cvt_pk_bf16_f32 v87, v158, v159
  v_pk_mul_f32 v[198:199], v[88:89], v[88:89]
  v_pk_mul_f32 v[202:203], v[106:107], v[106:107]
  v_pk_mul_f32 v[206:207], v[124:125], v[124:125]
  v_pk_mul_f32 v[210:211], v[142:143], v[142:143]
  v_pk_fma_f32 v[198:199], v[90:91], v[90:91], v[198:199]
  v_pk_add_f32 v[196:197], v[88:89], v[90:91]
  v_pk_fma_f32 v[202:203], v[108:109], v[108:109], v[202:203]
  v_pk_add_f32 v[200:201], v[106:107], v[108:109]
  v_pk_fma_f32 v[206:207], v[126:127], v[126:127], v[206:207]
  v_pk_add_f32 v[204:205], v[124:125], v[126:127]
  v_pk_fma_f32 v[210:211], v[144:145], v[144:145], v[210:211]
  v_pk_add_f32 v[208:209], v[142:143], v[144:145]
  v_pk_fma_f32 v[198:199], v[92:93], v[92:93], v[198:199]
  v_pk_add_f32 v[196:197], v[196:197], v[92:93]
  v_pk_fma_f32 v[202:203], v[110:111], v[110:111], v[202:203]
  v_pk_add_f32 v[200:201], v[200:201], v[110:111]
  v_pk_fma_f32 v[206:207], v[128:129], v[128:129], v[206:207]
  v_pk_add_f32 v[204:205], v[204:205], v[128:129]
  v_pk_fma_f32 v[210:211], v[146:147], v[146:147], v[210:211]
  v_pk_add_f32 v[208:209], v[208:209], v[146:147]
  v_pk_fma_f32 v[198:199], v[94:95], v[94:95], v[198:199]
  v_pk_add_f32 v[196:197], v[196:197], v[94:95]
  v_pk_fma_f32 v[202:203], v[112:113], v[112:113], v[202:203]
  v_pk_add_f32 v[200:201], v[200:201], v[112:113]
  v_pk_fma_f32 v[206:207], v[130:131], v[130:131], v[206:207]
  v_pk_add_f32 v[204:205], v[204:205], v[130:131]
  v_pk_fma_f32 v[210:211], v[148:149], v[148:149], v[210:211]
  v_pk_add_f32 v[208:209], v[208:209], v[148:149]
  v_pk_fma_f32 v[198:199], v[96:97], v[96:97], v[198:199]
  v_pk_add_f32 v[196:197], v[196:197], v[96:97]
  v_pk_fma_f32 v[202:203], v[114:115], v[114:115], v[202:203]
  v_pk_add_f32 v[200:201], v[200:201], v[114:115]
  v_pk_fma_f32 v[206:207], v[132:133], v[132:133], v[206:207]
  v_pk_add_f32 v[204:205], v[204:205], v[132:133]
  v_pk_fma_f32 v[210:211], v[150:151], v[150:151], v[210:211]
  v_pk_add_f32 v[208:209], v[208:209], v[150:151]
  v_pk_fma_f32 v[198:199], v[98:99], v[98:99], v[198:199]
  v_pk_add_f32 v[196:197], v[196:197], v[98:99]
  v_pk_fma_f32 v[202:203], v[116:117], v[116:117], v[202:203]
  v_pk_add_f32 v[200:201], v[200:201], v[116:117]
  v_pk_fma_f32 v[206:207], v[134:135], v[134:135], v[206:207]
  v_pk_add_f32 v[204:205], v[204:205], v[134:135]
  v_pk_fma_f32 v[210:211], v[152:153], v[152:153], v[210:211]
  v_pk_add_f32 v[208:209], v[208:209], v[152:153]
  v_pk_fma_f32 v[198:199], v[100:101], v[100:101], v[198:199]
  v_pk_add_f32 v[196:197], v[196:197], v[100:101]
  v_pk_fma_f32 v[202:203], v[118:119], v[118:119], v[202:203]
  v_pk_add_f32 v[200:201], v[200:201], v[118:119]
  v_pk_fma_f32 v[206:207], v[136:137], v[136:137], v[206:207]
  v_pk_add_f32 v[204:205], v[204:205], v[136:137]
  v_pk_fma_f32 v[210:211], v[154:155], v[154:155], v[210:211]
  v_pk_add_f32 v[208:209], v[208:209], v[154:155]
  v_pk_fma_f32 v[198:199], v[102:103], v[102:103], v[198:199]
  v_pk_add_f32 v[196:197], v[196:197], v[102:103]
  v_pk_fma_f32 v[202:203], v[120:121], v[120:121], v[202:203]
  v_pk_add_f32 v[200:201], v[200:201], v[120:121]
  v_pk_fma_f32 v[206:207], v[138:139], v[138:139], v[206:207]
  v_pk_add_f32 v[204:205], v[204:205], v[138:139]
  v_pk_fma_f32 v[210:211], v[156:157], v[156:157], v[210:211]
  v_pk_add_f32 v[208:209], v[208:209], v[156:157]
  v_pk_fma_f32 v[198:199], v[104:105], v[104:105], v[198:199]
  v_pk_add_f32 v[196:197], v[196:197], v[104:105]
  v_pk_fma_f32 v[202:203], v[122:123], v[122:123], v[202:203]
  v_pk_add_f32 v[200:201], v[200:201], v[122:123]
  v_pk_fma_f32 v[206:207], v[140:141], v[140:141], v[206:207]
  v_pk_add_f32 v[204:205], v[204:205], v[140:141]
  v_pk_fma_f32 v[210:211], v[158:159], v[158:159], v[210:211]
  v_pk_add_f32 v[208:209], v[208:209], v[158:159]
  v_add_f32 v196, v196, v197
  v_add_f32 v198, v198, v199
  v_add_f32 v200, v200, v201
  v_add_f32 v202, v202, v203
  v_add_f32 v204, v204, v205
  v_add_f32 v206, v206, v207
  v_add_f32 v208, v208, v209
  v_add_f32 v210, v210, v211
  v_add_f32_dpp v196, v196, v196 row_ror:8 row_mask:0xf bank_mask:0xf
  v_add_f32_dpp v200, v200, v200 row_ror:8 row_mask:0xf bank_mask:0xf
  v_add_f32_dpp v204, v204, v204 row_ror:8 row_mask:0xf bank_mask:0xf
  v_add_f32_dpp v208, v208, v208 row_ror:8 row_mask:0xf bank_mask:0xf
  v_add_f32_dpp v198, v198, v198 row_ror:8 row_mask:0xf bank_mask:0xf
  v_add_f32_dpp v202, v202, v202 row_ror:8 row_mask:0xf bank_mask:0xf
  v_add_f32_dpp v206, v206, v206 row_ror:8 row_mask:0xf bank_mask:0xf
  v_add_f32_dpp v210, v210, v210 row_ror:8 row_mask:0xf bank_mask:0xf
  v_add_f32_dpp v196, v196, v196 row_ror:4 row_mask:0xf bank_mask:0xf
  v_add_f32_dpp v200, v200, v200 row_ror:4 row_mask:0xf bank_mask:0xf
  v_add_f32_dpp v204, v204, v204 row_ror:4 row_mask:0xf bank_mask:0xf
  v_add_f32_dpp v208, v208, v208 row_ror:4 row_mask:0xf bank_mask:0xf
  v_add_f32_dpp v198, v198, v198 row_ror:4 row_mask:0xf bank_mask:0xf
  v_add_f32_dpp v202, v202, v202 row_ror:4 row_mask:0xf bank_mask:0xf
  v_add_f32_dpp v206, v206, v206 row_ror:4 row_mask:0xf bank_mask:0xf
  v_add_f32_dpp v210, v210, v210 row_ror:4 row_mask:0xf bank_mask:0xf
  v_add_f32_dpp v196, v196, v196 row_ror:2 row_mask:0xf bank_mask:0xf
  v_add_f32_dpp v200, v200, v200 row_ror:2 row_mask:0xf bank_mask:0xf
  v_add_f32_dpp v204, v204, v204 row_ror:2 row_mask:0xf bank_mask:0xf
  v_add_f32_dpp v208, v208, v208 row_ror:2 row_mask:0xf bank_mask:0xf
  v_add_f32_dpp v198, v198, v198 row_ror:2 row_mask:0xf bank_mask:0xf
  v_add_f32_dpp v202, v202, v202 row_ror:2 row_mask:0xf bank_mask:0xf
  v_add_f32_dpp v206, v206, v206 row_ror:2 row_mask:0xf bank_mask:0xf
  v_add_f32_dpp v210, v210, v210 row_ror:2 row_mask:0xf bank_mask:0xf
  v_add_f32_dpp v196, v196, v196 row_ror:1 row_mask:0xf bank_mask:0xf
  v_add_f32_dpp v200, v200, v200 row_ror:1 row_mask:0xf bank_mask:0xf
  v_add_f32_dpp v204, v204, v204 row_ror:1 row_mask:0xf bank_mask:0xf
  v_add_f32_dpp v208, v208, v208 row_ror:1 row_mask:0xf bank_mask:0xf
  v_add_f32_dpp v198, v198, v198 row_ror:1 row_mask:0xf bank_mask:0xf
  v_add_f32_dpp v202, v202, v202 row_ror:1 row_mask:0xf bank_mask:0xf
  v_add_f32_dpp v206, v206, v206 row_ror:1 row_mask:0xf bank_mask:0xf
  v_add_f32_dpp v210, v210, v210 row_ror:1 row_mask:0xf bank_mask:0xf
  v_mov_b32 v212, v196
  v_mov_b32 v213, v200
  v_mov_b32 v214, v204
  v_mov_b32 v215, v208
  v_mov_b32 v216, v198
  v_mov_b32 v217, v202
  v_mov_b32 v218, v206
  v_mov_b32 v219, v210
  v_permlane16_swap_b32 v196, v212
  v_permlane16_swap_b32 v200, v213
  v_permlane16_swap_b32 v204, v214
  v_permlane16_swap_b32 v208, v215
  v_permlane16_swap_b32 v198, v216
  v_permlane16_swap_b32 v202, v217
  v_permlane16_swap_b32 v206, v218
  v_permlane16_swap_b32 v210, v219
  v_add_f32 v196, v196, v212
  v_add_f32 v200, v200, v213
  v_add_f32 v204, v204, v214
  v_add_f32 v208, v208, v215
  v_add_f32 v198, v198, v216
  v_add_f32 v202, v202, v217
  v_add_f32 v206, v206, v218
  v_add_f32 v210, v210, v219
  v_mul_f32 v196, s98, v196
  v_mul_f32 v198, s98, v198
  v_mul_f32 v200, s98, v200
  v_mul_f32 v202, s98, v202
  v_mul_f32 v204, s98, v204
  v_mul_f32 v206, s98, v206
  v_mul_f32 v208, s98, v208
  v_mul_f32 v210, s98, v210
  v_fma_f32 v198, -v196, v196, v198
  v_fma_f32 v202, -v200, v200, v202
  v_fma_f32 v206, -v204, v204, v206
  v_fma_f32 v210, -v208, v208, v210
  v_max_f32 v198, 0, v198
  v_max_f32 v202, 0, v202
  v_max_f32 v206, 0, v206
  v_max_f32 v210, 0, v210
  v_add_f32 v198, s97, v198
  v_add_f32 v202, s97, v202
  v_add_f32 v206, s97, v206
  v_add_f32 v210, s97, v210
  v_rsq_f32 v198, v198
  v_rsq_f32 v202, v202
  v_rsq_f32 v206, v206
  v_rsq_f32 v210, v210
  v_mul_f32 v197, -v196, v198
  v_mul_f32 v201, -v200, v202
  v_mul_f32 v205, -v204, v206
  v_mul_f32 v209, -v208, v210
  v_mov_b32 v196, v198
  v_mov_b32 v200, v202
  v_mov_b32 v204, v206
  v_mov_b32 v208, v210
  v_bfe_u32 v8, v4, 2, 2
  v_lshrrev_b32 v9, 4, v4
  v_lshlrev_b32 v9, 11, v9
  s_lshr_b32 s6, s3, 1
  s_lshl_b32 s6, s6, 10
  s_and_b32 s7, s3, 1
  s_lshl_b32 s7, s7, 7
  s_add_u32 s6, s6, s7
  s_add_u32 s6, s6, 36864
  v_add_u32 v9, s6, v9
  v_lshl_add_u32 v9, v8, 8, v9
  v_lshl_add_u32 v9, v3, 6, v9
  v_and_b32 v10, 3, v4
  v_lshl_add_u32 v9, v10, 2, v9
  v_xor_b32 v10, 0, v8
  v_lshl_add_u32 v12, v10, 4, v9
  v_xor_b32 v10, 1, v8
  v_lshl_add_u32 v13, v10, 4, v9
  v_xor_b32 v10, 2, v8
  v_lshl_add_u32 v14, v10, 4, v9
  v_xor_b32 v10, 3, v8
  v_lshl_add_u32 v15, v10, 4, v9
  v_pk_fma_f32 v[232:233], v[88:89], v[196:197], v[196:197] op_sel:[0,0,1] op_sel_hi:[1,0,1]
  v_pk_fma_f32 v[234:235], v[106:107], v[200:201], v[200:201] op_sel:[0,0,1] op_sel_hi:[1,0,1]
  v_pk_fma_f32 v[236:237], v[124:125], v[204:205], v[204:205] op_sel:[0,0,1] op_sel_hi:[1,0,1]
  v_pk_fma_f32 v[238:239], v[142:143], v[208:209], v[208:209] op_sel:[0,0,1] op_sel_hi:[1,0,1]
  v_cvt_pk_bf16_f32 v232, v232, v233
  v_cvt_pk_bf16_f32 v234, v234, v235
  v_cvt_pk_bf16_f32 v236, v236, v237
  v_cvt_pk_bf16_f32 v238, v238, v239
  ds_write_b32 v12, v232 offset:0
  ds_write_b32 v13, v234 offset:0
  ds_write_b32 v14, v236 offset:0
  ds_write_b32 v15, v238 offset:0
  v_pk_fma_f32 v[232:233], v[90:91], v[196:197], v[196:197] op_sel:[0,0,1] op_sel_hi:[1,0,1]
  v_pk_fma_f32 v[234:235], v[108:109], v[200:201], v[200:201] op_sel:[0,0,1] op_sel_hi:[1,0,1]
  v_pk_fma_f32 v[236:237], v[126:127], v[204:205], v[204:205] op_sel:[0,0,1] op_sel_hi:[1,0,1]
  v_pk_fma_f32 v[238:239], v[144:145], v[208:209], v[208:209] op_sel:[0,0,1] op_sel_hi:[1,0,1]
  v_cvt_pk_bf16_f32 v232, v232, v233
  v_cvt_pk_bf16_f32 v234, v234, v235
  v_cvt_pk_bf16_f32 v236, v236, v237
  v_cvt_pk_bf16_f32 v238, v238, v239
  ds_write_b32 v12, v232 offset:4096
  ds_write_b32 v13, v234 offset:4096
  ds_write_b32 v14, v236 offset:4096
  ds_write_b32 v15, v238 offset:4096
  v_pk_fma_f32 v[232:233], v[92:93], v[196:197], v[196:197] op_sel:[0,0,1] op_sel_hi:[1,0,1]
  v_pk_fma_f32 v[234:235], v[110:111], v[200:201], v[200:201] op_sel:[0,0,1] op_sel_hi:[1,0,1]
  v_pk_fma_f32 v[236:237], v[128:129], v[204:205], v[204:205] op_sel:[0,0,1] op_sel_hi:[1,0,1]
  v_pk_fma_f32 v[238:239], v[146:147], v[208:209], v[208:209] op_sel:[0,0,1] op_sel_hi:[1,0,1]
  v_cvt_pk_bf16_f32 v232, v232, v233
  v_cvt_pk_bf16_f32 v234, v234, v235
  v_cvt_pk_bf16_f32 v236, v236, v237
  v_cvt_pk_bf16_f32 v238, v238, v239
  ds_write_b32 v12, v232 offset:8192
  ds_write_b32 v13, v234 offset:8192
  ds_write_b32 v14, v236 offset:8192
  ds_write_b32 v15, v238 offset:8192
  v_pk_fma_f32 v[232:233], v[94:95], v[196:197], v[196:197] op_sel:[0,0,1] op_sel_hi:[1,0,1]
  v_pk_fma_f32 v[234:235], v[112:113], v[200:201], v[200:201] op_sel:[0,0,1] op_sel_hi:[1,0,1]
  v_pk_fma_f32 v[236:237], v[130:131], v[204:205], v[204:205] op_sel:[0,0,1] op_sel_hi:[1,0,1]
  v_pk_fma_f32 v[238:239], v[148:149], v[208:209], v[208:209] op_sel:[0,0,1] op_sel_hi:[1,0,1]
  v_cvt_pk_bf16_f32 v232, v232, v233
  v_cvt_pk_bf16_f32 v234, v234, v235
  v_cvt_pk_bf16_f32 v236, v236, v237
  v_cvt_pk_bf16_f32 v238, v238, v239
  ds_write_b32 v12, v232 offset:12288
  ds_write_b32 v13, v234 offset:12288
  ds_write_b32 v14, v236 offset:12288
  ds_write_b32 v15, v238 offset:12288
  v_pk_fma_f32 v[232:233], v[96:97], v[196:197], v[196:197] op_sel:[0,0,1] op_sel_hi:[1,0,1]
  v_pk_fma_f32 v[234:235], v[114:115], v[200:201], v[200:201] op_sel:[0,0,1] op_sel_hi:[1,0,1]
  v_pk_fma_f32 v[236:237], v[132:133], v[204:205], v[204:205] op_sel:[0,0,1] op_sel_hi:[1,0,1]
  v_pk_fma_f32 v[238:239], v[150:151], v[208:209], v[208:209] op_sel:[0,0,1] op_sel_hi:[1,0,1]
  v_cvt_pk_bf16_f32 v232, v232, v233
  v_cvt_pk_bf16_f32 v234, v234, v235
  v_cvt_pk_bf16_f32 v236, v236, v237
  v_cvt_pk_bf16_f32 v238, v238, v239
  ds_write_b32 v12, v232 offset:16384
  ds_write_b32 v13, v234 offset:16384
  ds_write_b32 v14, v236 offset:16384
  ds_write_b32 v15, v238 offset:16384
  v_pk_fma_f32 v[232:233], v[98:99], v[196:197], v[196:197] op_sel:[0,0,1] op_sel_hi:[1,0,1]
  v_pk_fma_f32 v[234:235], v[116:117], v[200:201], v[200:201] op_sel:[0,0,1] op_sel_hi:[1,0,1]
  v_pk_fma_f32 v[236:237], v[134:135], v[204:205], v[204:205] op_sel:[0,0,1] op_sel_hi:[1,0,1]
  v_pk_fma_f32 v[238:239], v[152:153], v[208:209], v[208:209] op_sel:[0,0,1] op_sel_hi:[1,0,1]
  v_cvt_pk_bf16_f32 v232, v232, v233
  v_cvt_pk_bf16_f32 v234, v234, v235
  v_cvt_pk_bf16_f32 v236, v236, v237
  v_cvt_pk_bf16_f32 v238, v238, v239
  ds_write_b32 v12, v232 offset:20480
  ds_write_b32 v13, v234 offset:20480
  ds_write_b32 v14, v236 offset:20480
  ds_write_b32 v15, v238 offset:20480
  v_pk_fma_f32 v[232:233], v[100:101], v[196:197], v[196:197] op_sel:[0,0,1] op_sel_hi:[1,0,1]
  v_pk_fma_f32 v[234:235], v[118:119], v[200:201], v[200:201] op_sel:[0,0,1] op_sel_hi:[1,0,1]
  v_pk_fma_f32 v[236:237], v[136:137], v[204:205], v[204:205] op_sel:[0,0,1] op_sel_hi:[1,0,1]
  v_pk_fma_f32 v[238:239], v[154:155], v[208:209], v[208:209] op_sel:[0,0,1] op_sel_hi:[1,0,1]
  v_cvt_pk_bf16_f32 v232, v232, v233
  v_cvt_pk_bf16_f32 v234, v234, v235
  v_cvt_pk_bf16_f32 v236, v236, v237
  v_cvt_pk_bf16_f32 v238, v238, v239
  ds_write_b32 v12, v232 offset:24576
  ds_write_b32 v13, v234 offset:24576
  ds_write_b32 v14, v236 offset:24576
  ds_write_b32 v15, v238 offset:24576
  v_pk_fma_f32 v[232:233], v[102:103], v[196:197], v[196:197] op_sel:[0,0,1] op_sel_hi:[1,0,1]
  v_pk_fma_f32 v[234:235], v[120:121], v[200:201], v[200:201] op_sel:[0,0,1] op_sel_hi:[1,0,1]
  v_pk_fma_f32 v[236:237], v[138:139], v[204:205], v[204:205] op_sel:[0,0,1] op_sel_hi:[1,0,1]
  v_pk_fma_f32 v[238:239], v[156:157], v[208:209], v[208:209] op_sel:[0,0,1] op_sel_hi:[1,0,1]
  v_cvt_pk_bf16_f32 v232, v232, v233
  v_cvt_pk_bf16_f32 v234, v234, v235
  v_cvt_pk_bf16_f32 v236, v236, v237
  v_cvt_pk_bf16_f32 v238, v238, v239
  ds_write_b32 v12, v232 offset:28672
  ds_write_b32 v13, v234 offset:28672
  ds_write_b32 v14, v236 offset:28672
  ds_write_b32 v15, v238 offset:28672
  v_pk_fma_f32 v[232:233], v[104:105], v[196:197], v[196:197] op_sel:[0,0,1] op_sel_hi:[1,0,1]
  v_pk_fma_f32 v[234:235], v[122:123], v[200:201], v[200:201] op_sel:[0,0,1] op_sel_hi:[1,0,1]
  v_pk_fma_f32 v[236:237], v[140:141], v[204:205], v[204:205] op_sel:[0,0,1] op_sel_hi:[1,0,1]
  v_pk_fma_f32 v[238:239], v[158:159], v[208:209], v[208:209] op_sel:[0,0,1] op_sel_hi:[1,0,1]
  v_cvt_pk_bf16_f32 v232, v232, v233
  v_cvt_pk_bf16_f32 v234, v234, v235
  v_cvt_pk_bf16_f32 v236, v236, v237
  v_cvt_pk_bf16_f32 v238, v238, v239
  ds_write_b32 v12, v232 offset:32768
  ds_write_b32 v13, v234 offset:32768
  ds_write_b32 v14, v236 offset:32768
  ds_write_b32 v15, v238 offset:32768
  s_lshl_b32 s6, s3, 3
  v_lshl_add_u32 v11, v3, 2, s6
  v_mul_u32_u24 v11, 400, v11
  v_lshl_add_u32 v11, v4, 2, v11
  v_add_u32 v11, 86016, v11
  s_cmp_lg_u32 s5, 0
  s_cbranch_scc1 L_st_13
  buffer_store_dword v16, v6, s[52:55], 0 offen offset:0 sc1
  ds_write_b32 v11, v17 offset:0
  buffer_store_dword v34, v6, s[52:55], 0 offen offset:1152 sc1
  ds_write_b32 v11, v35 offset:400
  buffer_store_dword v52, v7, s[52:55], 0 offen offset:0 sc1
  ds_write_b32 v11, v53 offset:800
  buffer_store_dword v70, v7, s[52:55], 0 offen offset:1152 sc1
  ds_write_b32 v11, v71 offset:1200
  buffer_store_dword v18, v6, s[52:55], 0 offen offset:128 sc1
  ds_write_b32 v11, v19 offset:128
  buffer_store_dword v36, v6, s[52:55], 0 offen offset:1280 sc1
  ds_write_b32 v11, v37 offset:528
  buffer_store_dword v54, v7, s[52:55], 0 offen offset:128 sc1
  ds_write_b32 v11, v55 offset:928
  buffer_store_dword v72, v7, s[52:55], 0 offen offset:1280 sc1
  ds_write_b32 v11, v73 offset:1328
  buffer_store_dword v20, v6, s[52:55], 0 offen offset:256 sc1
  ds_write_b32 v11, v21 offset:256
  buffer_store_dword v38, v6, s[52:55], 0 offen offset:1408 sc1
  ds_write_b32 v11, v39 offset:656
  buffer_store_dword v56, v7, s[52:55], 0 offen offset:256 sc1
  ds_write_b32 v11, v57 offset:1056
  buffer_store_dword v74, v7, s[52:55], 0 offen offset:1408 sc1
  ds_write_b32 v11, v75 offset:1456
L_st_13:
  s_cmp_lg_u32 s5, 1
  s_cbranch_scc1 L_st_14
  buffer_store_dword v22, v6, s[52:55], 0 offen offset:384 sc1
  ds_write_b32 v11, v23 offset:0
  buffer_store_dword v40, v6, s[52:55], 0 offen offset:1536 sc1
  ds_write_b32 v11, v41 offset:400
  buffer_store_dword v58, v7, s[52:55], 0 offen offset:384 sc1
  ds_write_b32 v11, v59 offset:800
  buffer_store_dword v76, v7, s[52:55], 0 offen offset:1536 sc1
  ds_write_b32 v11, v77 offset:1200
  buffer_store_dword v24, v6, s[52:55], 0 offen offset:512 sc1
  ds_write_b32 v11, v25 offset:128
  buffer_store_dword v42, v6, s[52:55], 0 offen offset:1664 sc1
  ds_write_b32 v11, v43 offset:528
  buffer_store_dword v60, v7, s[52:55], 0 offen offset:512 sc1
  ds_write_b32 v11, v61 offset:928
  buffer_store_dword v78, v7, s[52:55], 0 offen offset:1664 sc1
  ds_write_b32 v11, v79 offset:1328
  buffer_store_dword v26, v6, s[52:55], 0 offen offset:640 sc1
  ds_write_b32 v11, v27 offset:256
  buffer_store_dword v44, v6, s[52:55], 0 offen offset:1792 sc1
  ds_write_b32 v11, v45 offset:656
  buffer_store_dword v62, v7, s[52:55], 0 offen offset:640 sc1
  ds_write_b32 v11, v63 offset:1056
  buffer_store_dword v80, v7, s[52:55], 0 offen offset:1792 sc1
  ds_write_b32 v11, v81 offset:1456
L_st_14:
  s_cmp_lg_u32 s5, 2
  s_cbranch_scc1 L_st_15
  buffer_store_dword v28, v6, s[52:55], 0 offen offset:768 sc1
  ds_write_b32 v11, v29 offset:0
  buffer_store_dword v46, v6, s[52:55], 0 offen offset:1920 sc1
  ds_write_b32 v11, v47 offset:400
  buffer_store_dword v64, v7, s[52:55], 0 offen offset:768 sc1
  ds_write_b32 v11, v65 offset:800
  buffer_store_dword v82, v7, s[52:55], 0 offen offset:1920 sc1
  ds_write_b32 v11, v83 offset:1200
  buffer_store_dword v30, v6, s[52:55], 0 offen offset:896 sc1
  ds_write_b32 v11, v31 offset:128
  buffer_store_dword v48, v6, s[52:55], 0 offen offset:2048 sc1
  ds_write_b32 v11, v49 offset:528
  buffer_store_dword v66, v7, s[52:55], 0 offen offset:896 sc1
  ds_write_b32 v11, v67 offset:928
  buffer_store_dword v84, v7, s[52:55], 0 offen offset:2048 sc1
  ds_write_b32 v11, v85 offset:1328
  buffer_store_dword v32, v6, s[52:55], 0 offen offset:1024 sc1
  ds_write_b32 v11, v33 offset:256
  buffer_store_dword v50, v6, s[52:55], 0 offen offset:2176 sc1
  ds_write_b32 v11, v51 offset:656
  buffer_store_dword v68, v7, s[52:55], 0 offen offset:1024 sc1
  ds_write_b32 v11, v69 offset:1056
  buffer_store_dword v86, v7, s[52:55], 0 offen offset:2176 sc1
  ds_write_b32 v11, v87 offset:1456
L_st_15:
  s_waitcnt lgkmcnt(0)
  s_barrier
  s_add_u32 s64, s46, 0x1026000
  s_addc_u32 s65, s47, 0
  s_mov_b32 s66, 0xa2000
  s_mov_b32 s67, 0x20000
  s_mul_i32 s6, s5, 12
  s_mul_i32 s7, s3, 3
  s_add_u32 s6, s6, s7
  s_mul_i32 s6, s6, 18432
  v_lshl_add_u32 v156, v1, 4, s6
  v_add_u32 v157, 18432, v156
  v_add_u32 v158, 36864, v156
  v_and_b32 v2, 15, v1
  v_lshrrev_b32 v8, 4, v1
  v_xor_b32 v2, v2, v8
  v_lshl_add_u32 v2, v8, 4, v2
  v_lshlrev_b32 v2, 4, v2
  v_add_u32 v2, 36864, v2
  ds_read_b128 v[128:131], v2 offset:0
  ds_read_b128 v[132:135], v2 offset:1024
  ds_read_b128 v[136:139], v2 offset:2048
  ds_read_b128 v[140:143], v2 offset:3072
  ds_read_b128 v[144:147], v2 offset:4096
  ds_read_b128 v[148:151], v2 offset:5120
  s_waitcnt lgkmcnt(5)
  v_mfma_f32_16x16x32_bf16 v[100:103], a[0:3], v[128:131], 0
  s_waitcnt lgkmcnt(4)
  v_mfma_f32_16x16x32_bf16 v[104:107], a[0:3], v[132:135], 0
  v_mfma_f32_16x16x32_bf16 v[108:111], a[72:75], v[128:131], 0
  v_mfma_f32_16x16x32_bf16 v[112:115], a[72:75], v[132:135], 0
  v_mfma_f32_16x16x32_bf16 v[116:119], a[144:147], v[128:131], 0
  v_mfma_f32_16x16x32_bf16 v[120:123], a[144:147], v[132:135], 0
  buffer_load_dwordx4 a[0:3], v156, s[64:67], 0 offen offset:0 sc1
  buffer_load_dwordx4 a[72:75], v157, s[64:67], 0 offen offset:0 sc1
  buffer_load_dwordx4 a[144:147], v158, s[64:67], 0 offen offset:0 sc1
  ds_read_b128 v[128:131], v2 offset:6144
  ds_read_b128 v[132:135], v2 offset:7168
  s_waitcnt lgkmcnt(5)
  v_mfma_f32_16x16x32_bf16 v[100:103], a[4:7], v[136:139], v[100:103]
  s_waitcnt lgkmcnt(4)
  v_mfma_f32_16x16x32_bf16 v[104:107], a[4:7], v[140:143], v[104:107]
  v_mfma_f32_16x16x32_bf16 v[108:111], a[76:79], v[136:139], v[108:111]
  v_mfma_f32_16x16x32_bf16 v[112:115], a[76:79], v[140:143], v[112:115]
  v_mfma_f32_16x16x32_bf16 v[116:119], a[148:151], v[136:139], v[116:119]
  v_mfma_f32_16x16x32_bf16 v[120:123], a[148:151], v[140:143], v[120:123]
  buffer_load_dwordx4 a[4:7], v156, s[64:67], 0 offen offset:1024 sc1
  buffer_load_dwordx4 a[76:79], v157, s[64:67], 0 offen offset:1024 sc1
  buffer_load_dwordx4 a[148:151], v158, s[64:67], 0 offen offset:1024 sc1
  ds_read_b128 v[136:139], v2 offset:8192
  ds_read_b128 v[140:143], v2 offset:9216
  s_waitcnt lgkmcnt(5)
  v_mfma_f32_16x16x32_bf16 v[100:103], a[8:11], v[144:147], v[100:103]
  s_waitcnt lgkmcnt(4)
  v_mfma_f32_16x16x32_bf16 v[104:107], a[8:11], v[148:151], v[104:107]
  v_mfma_f32_16x16x32_bf16 v[108:111], a[80:83], v[144:147], v[108:111]
  v_mfma_f32_16x16x32_bf16 v[112:115], a[80:83], v[148:151], v[112:115]
  v_mfma_f32_16x16x32_bf16 v[116:119], a[152:155], v[144:147], v[116:119]
  v_mfma_f32_16x16x32_bf16 v[120:123], a[152:155], v[148:151], v[120:123]
  buffer_load_dwordx4 a[8:11], v156, s[64:67], 0 offen offset:2048 sc1
  buffer_load_dwordx4 a[80:83], v157, s[64:67], 0 offen offset:2048 sc1
  buffer_load_dwordx4 a[152:155], v158, s[64:67], 0 offen offset:2048 sc1
  ds_read_b128 v[144:147], v2 offset:10240
  ds_read_b128 v[148:151], v2 offset:11264
  s_waitcnt lgkmcnt(5)
  v_mfma_f32_16x16x32_bf16 v[100:103], a[12:15], v[128:131], v[100:103]
  s_waitcnt lgkmcnt(4)
  v_mfma_f32_16x16x32_bf16 v[104:107], a[12:15], v[132:135], v[104:107]
  v_mfma_f32_16x16x32_bf16 v[108:111], a[84:87], v[128:131], v[108:111]
  v_mfma_f32_16x16x32_bf16 v[112:115], a[84:87], v[132:135], v[112:115]
  v_mfma_f32_16x16x32_bf16 v[116:119], a[156:159], v[128:131], v[116:119]
  v_mfma_f32_16x16x32_bf16 v[120:123], a[156:159], v[132:135], v[120:123]
  buffer_load_dwordx4 a[12:15], v156, s[64:67], 0 offen offset:3072 sc1
  buffer_load_dwordx4 a[84:87], v157, s[64:67], 0 offen offset:3072 sc1
  buffer_load_dwordx4 a[156:159], v158, s[64:67], 0 offen offset:3072 sc1
  ds_read_b128 v[128:131], v2 offset:12288
  ds_read_b128 v[132:135], v2 offset:13312
  s_waitcnt lgkmcnt(5)
  v_mfma_f32_16x16x32_bf16 v[100:103], a[16:19], v[136:139], v[100:103]
  s_waitcnt lgkmcnt(4)
  v_mfma_f32_16x16x32_bf16 v[104:107], a[16:19], v[140:143], v[104:107]
  v_mfma_f32_16x16x32_bf16 v[108:111], a[88:91], v[136:139], v[108:111]
  v_mfma_f32_16x16x32_bf16 v[112:115], a[88:91], v[140:143], v[112:115]
  v_mfma_f32_16x16x32_bf16 v[116:119], a[160:163], v[136:139], v[116:119]
  v_mfma_f32_16x16x32_bf16 v[120:123], a[160:163], v[140:143], v[120:123]
  v_add_u32 v156, 4096, v156
  buffer_load_dwordx4 a[16:19], v156, s[64:67], 0 offen offset:0 sc1
  v_add_u32 v157, 4096, v157
  buffer_load_dwordx4 a[88:91], v157, s[64:67], 0 offen offset:0 sc1
  v_add_u32 v158, 4096, v158
  buffer_load_dwordx4 a[160:163], v158, s[64:67], 0 offen offset:0 sc1
  ds_read_b128 v[136:139], v2 offset:14336
  ds_read_b128 v[140:143], v2 offset:15360
  s_waitcnt lgkmcnt(5)
  v_mfma_f32_16x16x32_bf16 v[100:103], a[20:23], v[144:147], v[100:103]
  s_waitcnt lgkmcnt(4)
  v_mfma_f32_16x16x32_bf16 v[104:107], a[20:23], v[148:151], v[104:107]
  v_mfma_f32_16x16x32_bf16 v[108:111], a[92:95], v[144:147], v[108:111]
  v_mfma_f32_16x16x32_bf16 v[112:115], a[92:95], v[148:151], v[112:115]
  v_mfma_f32_16x16x32_bf16 v[116:119], a[164:167], v[144:147], v[116:119]
  v_mfma_f32_16x16x32_bf16 v[120:123], a[164:167], v[148:151], v[120:123]
  buffer_load_dwordx4 a[20:23], v156, s[64:67], 0 offen offset:1024 sc1
  buffer_load_dwordx4 a[92:95], v157, s[64:67], 0 offen offset:1024 sc1
  buffer_load_dwordx4 a[164:167], v158, s[64:67], 0 offen offset:1024 sc1
  ds_read_b128 v[144:147], v2 offset:16384
  ds_read_b128 v[148:151], v2 offset:17408
  s_waitcnt lgkmcnt(5)
  v_mfma_f32_16x16x32_bf16 v[100:103], a[24:27], v[128:131], v[100:103]
  s_waitcnt lgkmcnt(4)
  v_mfma_f32_16x16x32_bf16 v[104:107], a[24:27], v[132:135], v[104:107]
  v_mfma_f32_16x16x32_bf16 v[108:111], a[96:99], v[128:131], v[108:111]
  v_mfma_f32_16x16x32_bf16 v[112:115], a[96:99], v[132:135], v[112:115]
  v_mfma_f32_16x16x32_bf16 v[116:119], a[168:171], v[128:131], v[116:119]
  v_mfma_f32_16x16x32_bf16 v[120:123], a[168:171], v[132:135], v[120:123]
  buffer_load_dwordx4 a[24:27], v156, s[64:67], 0 offen offset:2048 sc1
  buffer_load_dwordx4 a[96:99], v157, s[64:67], 0 offen offset:2048 sc1
  buffer_load_dwordx4 a[168:171], v158, s[64:67], 0 offen offset:2048 sc1
  ds_read_b128 v[128:131], v2 offset:18432
  ds_read_b128 v[132:135], v2 offset:19456
  s_waitcnt lgkmcnt(5)
  v_mfma_f32_16x16x32_bf16 v[100:103], a[28:31], v[136:139], v[100:103]
  s_waitcnt lgkmcnt(4)
  v_mfma_f32_16x16x32_bf16 v[104:107], a[28:31], v[140:143], v[104:107]
  v_mfma_f32_16x16x32_bf16 v[108:111], a[100:103], v[136:139], v[108:111]
  v_mfma_f32_16x16x32_bf16 v[112:115], a[100:103], v[140:143], v[112:115]
  v_mfma_f32_16x16x32_bf16 v[116:119], a[172:175], v[136:139], v[116:119]
  v_mfma_f32_16x16x32_bf16 v[120:123], a[172:175], v[140:143], v[120:123]
  buffer_load_dwordx4 a[28:31], v156, s[64:67], 0 offen offset:3072 sc1
  buffer_load_dwordx4 a[100:103], v157, s[64:67], 0 offen offset:3072 sc1
  buffer_load_dwordx4 a[172:175], v158, s[64:67], 0 offen offset:3072 sc1
  ds_read_b128 v[136:139], v2 offset:20480
  ds_read_b128 v[140:143], v2 offset:21504
  s_waitcnt lgkmcnt(5)
  v_mfma_f32_16x16x32_bf16 v[100:103], a[32:35], v[144:147], v[100:103]
  s_waitcnt lgkmcnt(4)
  v_mfma_f32_16x16x32_bf16 v[104:107], a[32:35], v[148:151], v[104:107]
  v_mfma_f32_16x16x32_bf16 v[108:111], a[104:107], v[144:147], v[108:111]
  v_mfma_f32_16x16x32_bf16 v[112:115], a[104:107], v[148:151], v[112:115]
  v_mfma_f32_16x16x32_bf16 v[116:119], a[176:179], v[144:147], v[116:119]
  v_mfma_f32_16x16x32_bf16 v[120:123], a[176:179], v[148:151], v[120:123]
  v_add_u32 v156, 4096, v156
  buffer_load_dwordx4 a[32:35], v156, s[64:67], 0 offen offset:0 sc1
  v_add_u32 v157, 4096, v157
  buffer_load_dwordx4 a[104:107], v157, s[64:67], 0 offen offset:0 sc1
  v_add_u32 v158, 4096, v158
  buffer_load_dwordx4 a[176:179], v158, s[64:67], 0 offen offset:0 sc1
  ds_read_b128 v[144:147], v2 offset:22528
  ds_read_b128 v[148:151], v2 offset:23552
  s_waitcnt lgkmcnt(5)
  v_mfma_f32_16x16x32_bf16 v[100:103], a[36:39], v[128:131], v[100:103]
  s_waitcnt lgkmcnt(4)
  v_mfma_f32_16x16x32_bf16 v[104:107], a[36:39], v[132:135], v[104:107]
  v_mfma_f32_16x16x32_bf16 v[108:111], a[108:111], v[128:131], v[108:111]
  v_mfma_f32_16x16x32_bf16 v[112:115], a[108:111], v[132:135], v[112:115]
  v_mfma_f32_16x16x32_bf16 v[116:119], a[180:183], v[128:131], v[116:119]
  v_mfma_f32_16x16x32_bf16 v[120:123], a[180:183], v[132:135], v[120:123]
  ds_read_b128 v[128:131], v2 offset:24576
  ds_read_b128 v[132:135], v2 offset:25600
  s_waitcnt lgkmcnt(5)
  v_mfma_f32_16x16x32_bf16 v[100:103], a[40:43], v[136:139], v[100:103]
  s_waitcnt lgkmcnt(4)
  v_mfma_f32_16x16x32_bf16 v[104:107], a[40:43], v[140:143], v[104:107]
  v_mfma_f32_16x16x32_bf16 v[108:111], a[112:115], v[136:139], v[108:111]
  v_mfma_f32_16x16x32_bf16 v[112:115], a[112:115], v[140:143], v[112:115]
  v_mfma_f32_16x16x32_bf16 v[116:119], a[184:187], v[136:139], v[116:119]
  v_mfma_f32_16x16x32_bf16 v[120:123], a[184:187], v[140:143], v[120:123]
  ds_read_b128 v[136:139], v2 offset:26624
  ds_read_b128 v[140:143], v2 offset:27648
  s_waitcnt lgkmcnt(5)
  v_mfma_f32_16x16x32_bf16 v[100:103], a[44:47], v[144:147], v[100:103]
  s_waitcnt lgkmcnt(4)
  v_mfma_f32_16x16x32_bf16 v[104:107], a[44:47], v[148:151], v[104:107]
  v_mfma_f32_16x16x32_bf16 v[108:111], a[116:119], v[144:147], v[108:111]
  v_mfma_f32_16x16x32_bf16 v[112:115], a[116:119], v[148:151], v[112:115]
  v_mfma_f32_16x16x32_bf16 v[116:119], a[188:191], v[144:147], v[116:119]
  v_mfma_f32_16x16x32_bf16 v[120:123], a[188:191], v[148:151], v[120:123]
  ds_read_b128 v[144:147], v2 offset:28672
  ds_read_b128 v[148:151], v2 offset:29696
  s_waitcnt lgkmcnt(5)
  v_mfma_f32_16x16x32_bf16 v[100:103], a[48:51], v[128:131], v[100:103]
  s_waitcnt lgkmcnt(4)
  v_mfma_f32_16x16x32_bf16 v[104:107], a[48:51], v[132:135], v[104:107]
  v_mfma_f32_16x16x32_bf16 v[108:111], a[120:123], v[128:131], v[108:111]
  v_mfma_f32_16x16x32_bf16 v[112:115], a[120:123], v[132:135], v[112:115]
  v_mfma_f32_16x16x32_bf16 v[116:119], a[192:195], v[128:131], v[116:119]
  v_mfma_f32_16x16x32_bf16 v[120:123], a[192:195], v[132:135], v[120:123]
  ds_read_b128 v[128:131], v2 offset:30720
  ds_read_b128 v[132:135], v2 offset:31744
  s_waitcnt lgkmcnt(5)
  v_mfma_f32_16x16x32_bf16 v[100:103], a[52:55], v[136:139], v[100:103]
  s_waitcnt lgkmcnt(4)
  v_mfma_f32_16x16x32_bf16 v[104:107], a[52:55], v[140:143], v[104:107]
  v_mfma_f32_16x16x32_bf16 v[108:111], a[124:127], v[136:139], v[108:111]
  v_mfma_f32_16x16x32_bf16 v[112:115], a[124:127], v[140:143], v[112:115]
  v_mfma_f32_16x16x32_bf16 v[116:119], a[196:199], v[136:139], v[116:119]
  v_mfma_f32_16x16x32_bf16 v[120:123], a[196:199], v[140:143], v[120:123]
  ds_read_b128 v[136:139], v2 offset:32768
  ds_read_b128 v[140:143], v2 offset:33792
  s_waitcnt lgkmcnt(5)
  v_mfma_f32_16x16x32_bf16 v[100:103], a[56:59], v[144:147], v[100:103]
  s_waitcnt lgkmcnt(4)
  v_mfma_f32_16x16x32_bf16 v[104:107], a[56:59], v[148:151], v[104:107]
  v_mfma_f32_16x16x32_bf16 v[108:111], a[128:131], v[144:147], v[108:111]
  v_mfma_f32_16x16x32_bf16 v[112:115], a[128:131], v[148:151], v[112:115]
  v_mfma_f32_16x16x32_bf16 v[116:119], a[200:203], v[144:147], v[116:119]
  v_mfma_f32_16x16x32_bf16 v[120:123], a[200:203], v[148:151], v[120:123]
  ds_read_b128 v[144:147], v2 offset:34816
  ds_read_b128 v[148:151], v2 offset:35840
  s_waitcnt lgkmcnt(5)
  v_mfma_f32_16x16x32_bf16 v[100:103], a[60:63], v[128:131], v[100:103]
  s_waitcnt lgkmcnt(4)
  v_mfma_f32_16x16x32_bf16 v[104:107], a[60:63], v[132:135], v[104:107]
  v_mfma_f32_16x16x32_bf16 v[108:111], a[132:135], v[128:131], v[108:111]
  v_mfma_f32_16x16x32_bf16 v[112:115], a[132:135], v[132:135], v[112:115]
  v_mfma_f32_16x16x32_bf16 v[116:119], a[204:207], v[128:131], v[116:119]
  v_mfma_f32_16x16x32_bf16 v[120:123], a[204:207], v[132:135], v[120:123]
  s_waitcnt lgkmcnt(3)
  v_mfma_f32_16x16x32_bf16 v[100:103], a[64:67], v[136:139], v[100:103]
  s_waitcnt lgkmcnt(2)
  v_mfma_f32_16x16x32_bf16 v[104:107], a[64:67], v[140:143], v[104:107]
  v_mfma_f32_16x16x32_bf16 v[108:111], a[136:139], v[136:139], v[108:111]
  v_mfma_f32_16x16x32_bf16 v[112:115], a[136:139], v[140:143], v[112:115]
  v_mfma_f32_16x16x32_bf16 v[116:119], a[208:211], v[136:139], v[116:119]
  v_mfma_f32_16x16x32_bf16 v[120:123], a[208:211], v[140:143], v[120:123]
  s_waitcnt lgkmcnt(1)
  v_mfma_f32_16x16x32_bf16 v[100:103], a[68:71], v[144:147], v[100:103]
  s_waitcnt lgkmcnt(0)
  v_mfma_f32_16x16x32_bf16 v[104:107], a[68:71], v[148:151], v[104:107]
  v_mfma_f32_16x16x32_bf16 v[108:111], a[140:143], v[144:147], v[108:111]
  v_mfma_f32_16x16x32_bf16 v[112:115], a[140:143], v[148:151], v[112:115]
  v_mfma_f32_16x16x32_bf16 v[116:119], a[212:215], v[144:147], v[116:119]
  v_mfma_f32_16x16x32_bf16 v[120:123], a[212:215], v[148:151], v[120:123]
  s_mov_b32 s8, 0xc0135761
  s_mov_b32 s9, 0xbdd2d3e8
  v_mov_b32 v8, s9
  v_mul_f32 v160, v100, v100
  v_mul_f32 v161, v101, v101
  v_mul_f32 v162, v102, v102
  v_mul_f32 v163, v103, v103
  v_mul_f32 v164, v104, v104
  v_mul_f32 v165, v105, v105
  v_mul_f32 v166, v106, v106
  v_mul_f32 v167, v107, v107
  v_mul_f32 v168, v108, v108
  v_mul_f32 v169, v109, v109
  v_mul_f32 v170, v110, v110
  v_mul_f32 v171, v111, v111
  v_mul_f32 v172, v112, v112
  v_mul_f32 v173, v113, v113
  v_mul_f32 v174, v114, v114
  v_mul_f32 v175, v115, v115
  v_mul_f32 v176, v116, v116
  v_mul_f32 v177, v117, v117
  v_mul_f32 v178, v118, v118
  v_mul_f32 v179, v119, v119
  v_mul_f32 v180, v120, v120
  v_mul_f32 v181, v121, v121
  v_mul_f32 v182, v122, v122
  v_mul_f32 v183, v123, v123
  v_fma_f32 v160, v160, v8, s8
  v_fma_f32 v161, v161, v8, s8
  v_fma_f32 v162, v162, v8, s8
  v_fma_f32 v163, v163, v8, s8
  v_fma_f32 v164, v164, v8, s8
  v_fma_f32 v165, v165, v8, s8
  v_fma_f32 v166, v166, v8, s8
  v_fma_f32 v167, v167, v8, s8
  v_fma_f32 v168, v168, v8, s8
  v_fma_f32 v169, v169, v8, s8
  v_fma_f32 v170, v170, v8, s8
  v_fma_f32 v171, v171, v8, s8
  v_fma_f32 v172, v172, v8, s8
  v_fma_f32 v173, v173, v8, s8
  v_fma_f32 v174, v174, v8, s8
  v_fma_f32 v175, v175, v8, s8
  v_fma_f32 v176, v176, v8, s8
  v_fma_f32 v177, v177, v8, s8
  v_fma_f32 v178, v178, v8, s8
  v_fma_f32 v179, v179, v8, s8
  v_fma_f32 v180, v180, v8, s8
  v_fma_f32 v181, v181, v8, s8
  v_fma_f32 v182, v182, v8, s8
  v_fma_f32 v183, v183, v8, s8
  v_mul_f32 v160, v160, v100
  v_mul_f32 v161, v161, v101
  v_mul_f32 v162, v162, v102
  v_mul_f32 v163, v163, v103
  v_mul_f32 v164, v164, v104
  v_mul_f32 v165, v165, v105
  v_mul_f32 v166, v166, v106
  v_mul_f32 v167, v167, v107
  v_mul_f32 v168, v168, v108
  v_mul_f32 v169, v169, v109
  v_mul_f32 v170, v170, v110
  v_mul_f32 v171, v171, v111
  v_mul_f32 v172, v172, v112
  v_mul_f32 v173, v173, v113
  v_mul_f32 v174, v174, v114
  v_mul_f32 v175, v175, v115
  v_mul_f32 v176, v176, v116
  v_mul_f32 v177, v177, v117
  v_mul_f32 v178, v178, v118
  v_mul_f32 v179, v179, v119
  v_mul_f32 v180, v180, v120
  v_mul_f32 v181, v181, v121
  v_mul_f32 v182, v182, v122
  v_mul_f32 v183, v183, v123
  v_exp_f32 v160, v160
  v_exp_f32 v161, v161
  v_exp_f32 v162, v162
  v_exp_f32 v163, v163
  v_exp_f32 v164, v164
  v_exp_f32 v165, v165
  v_exp_f32 v166, v166
  v_exp_f32 v167, v167
  v_exp_f32 v168, v168
  v_exp_f32 v169, v169
  v_exp_f32 v170, v170
  v_exp_f32 v171, v171
  v_exp_f32 v172, v172
  v_exp_f32 v173, v173
  v_exp_f32 v174, v174
  v_exp_f32 v175, v175
  v_exp_f32 v176, v176
  v_exp_f32 v177, v177
  v_exp_f32 v178, v178
  v_exp_f32 v179, v179
  v_exp_f32 v180, v180
  v_exp_f32 v181, v181
  v_exp_f32 v182, v182
  v_exp_f32 v183, v183
  v_add_f32 v160, 1.0, v160
  v_add_f32 v161, 1.0, v161
  v_add_f32 v162, 1.0, v162
  v_add_f32 v163, 1.0, v163
  v_add_f32 v164, 1.0, v164
  v_add_f32 v165, 1.0, v165
  v_add_f32 v166, 1.0, v166
  v_add_f32 v167, 1.0, v167
  v_add_f32 v168, 1.0, v168
  v_add_f32 v169, 1.0, v169
  v_add_f32 v170, 1.0, v170
  v_add_f32 v171, 1.0, v171
  v_add_f32 v172, 1.0, v172
  v_add_f32 v173, 1.0, v173
  v_add_f32 v174, 1.0, v174
  v_add_f32 v175, 1.0, v175
  v_add_f32 v176, 1.0, v176
  v_add_f32 v177, 1.0, v177
  v_add_f32 v178, 1.0, v178
  v_add_f32 v179, 1.0, v179
  v_add_f32 v180, 1.0, v180
  v_add_f32 v181, 1.0, v181
  v_add_f32 v182, 1.0, v182
  v_add_f32 v183, 1.0, v183
  v_rcp_f32 v160, v160
  v_rcp_f32 v161, v161
  v_rcp_f32 v162, v162
  v_rcp_f32 v163, v163
  v_rcp_f32 v164, v164
  v_rcp_f32 v165, v165
  v_rcp_f32 v166, v166
  v_rcp_f32 v167, v167
  v_rcp_f32 v168, v168
  v_rcp_f32 v169, v169
  v_rcp_f32 v170, v170
  v_rcp_f32 v171, v171
  v_rcp_f32 v172, v172
  v_rcp_f32 v173, v173
  v_rcp_f32 v174, v174
  v_rcp_f32 v175, v175
  v_rcp_f32 v176, v176
  v_rcp_f32 v177, v177
  v_rcp_f32 v178, v178
  v_rcp_f32 v179, v179
  v_rcp_f32 v180, v180
  v_rcp_f32 v181, v181
  v_rcp_f32 v182, v182
  v_rcp_f32 v183, v183
  v_mul_f32 v100, v100, v160
  v_mul_f32 v101, v101, v161
  v_mul_f32 v102, v102, v162
  v_mul_f32 v103, v103, v163
  v_mul_f32 v104, v104, v164
  v_mul_f32 v105, v105, v165
  v_mul_f32 v106, v106, v166
  v_mul_f32 v107, v107, v167
  v_mul_f32 v108, v108, v168
  v_mul_f32 v109, v109, v169
  v_mul_f32 v110, v110, v170
  v_mul_f32 v111, v111, v171
  v_mul_f32 v112, v112, v172
  v_mul_f32 v113, v113, v173
  v_mul_f32 v114, v114, v174
  v_mul_f32 v115, v115, v175
  v_mul_f32 v116, v116, v176
  v_mul_f32 v117, v117, v177
  v_mul_f32 v118, v118, v178
  v_mul_f32 v119, v119, v179
  v_mul_f32 v120, v120, v180
  v_mul_f32 v121, v121, v181
  v_mul_f32 v122, v122, v182
  v_mul_f32 v123, v123, v183
  v_cvt_pk_bf16_f32 v190, v100, v101
  v_cvt_pk_bf16_f32 v191, v102, v103
  v_cvt_pk_bf16_f32 v192, v104, v105
  v_cvt_pk_bf16_f32 v193, v106, v107
  v_cvt_pk_bf16_f32 v194, v108, v109
  v_cvt_pk_bf16_f32 v195, v110, v111
  v_cvt_pk_bf16_f32 v196, v112, v113
  v_cvt_pk_bf16_f32 v197, v114, v115
  v_cvt_pk_bf16_f32 v198, v116, v117
  v_cvt_pk_bf16_f32 v199, v118, v119
  v_cvt_pk_bf16_f32 v200, v120, v121
  v_cvt_pk_bf16_f32 v201, v122, v123
  v_accvgpr_read_b32 v2, a216
  v_accvgpr_read_b32 v204, a217
  v_accvgpr_read_b32 v205, a218
  v_accvgpr_read_b32 v206, a219
  v_accvgpr_read_b32 v207, a220
  v_accvgpr_read_b32 v208, a221
  v_accvgpr_read_b32 v209, a222
  ds_write_b64 v2, v[190:191] offset:0
  ds_write_b64 v2, v[192:193] offset:6400
  ds_write_b64 v2, v[194:195] offset:32
  ds_write_b64 v2, v[196:197] offset:6432
  ds_write_b64 v2, v[198:199] offset:64
  ds_write_b64 v2, v[200:201] offset:6464
  s_waitcnt lgkmcnt(0)
  s_barrier
  ds_read_b128 v[212:215], v204
  ds_read_b128 v[216:219], v205
  ds_read_b128 v[220:223], v206
  s_waitcnt lgkmcnt(2)
  buffer_store_dwordx4 v[212:215], v207, s[60:63], 0 offen sc1
  s_waitcnt lgkmcnt(1)
  buffer_store_dwordx4 v[216:219], v208, s[60:63], 0 offen sc1
  s_waitcnt lgkmcnt(0)
  buffer_store_dwordx4 v[220:223], v209, s[60:63], 0 offen sc1
  s_waitcnt vmcnt(0) lgkmcnt(0)
  s_barrier
  s_cmp_lg_u32 s3, 0
  s_cbranch_scc1 L_arr_16
  s_mov_b64 exec, 1
  s_mul_i32 s76, s4, 4352
  s_add_u32 s76, s76, 182784
  v_mov_b32 v252, s76
  v_mov_b32 v253, 1
  buffer_atomic_add v253, v252, s[72:75], 0 offen sc1
L_ad_17:
  s_mov_b64 exec, -1
L_arr_16:
  s_add_u32 s48, s46, 0xb04000
  s_addc_u32 s49, s47, 0
  s_mov_b32 s50, 0x240000
  s_mov_b32 s51, 0x20000
  s_add_u32 s52, s46, 0x8c4000
  s_addc_u32 s53, s47, 0
  s_mov_b32 s54, 0x240000
  s_mov_b32 s55, 0x20000
  s_add_u32 s56, s46, 0xd44000
  s_addc_u32 s57, s47, 0
  s_mov_b32 s58, 0x240000
  s_mov_b32 s59, 0x20000
  s_mov_b32 s99, 0xffff0000
  v_lshrrev_b32 v3, 4, v1
  v_and_b32 v4, 15, v1
  s_lshr_b32 s6, s3, 1
  s_lshl_b32 s6, s6, 5
  v_lshl_add_u32 v5, v3, 3, s6
  s_lshl_b32 s6, s4, 5
  s_and_b32 s7, s3, 1
  s_lshl_b32 s7, s7, 4
  s_add_u32 s6, s6, s7
  v_add_u32 v6, s6, v4
  s_movk_i32 s7, 1152
  v_mul_lo_u32 v6, v6, s7
  v_lshl_add_u32 v6, v5, 1, v6
  v_subrev_u32 v8, 1152, v6
  v_add_u32 v9, 1152, v6
  v_subrev_u32 v10, 2304, v6
  v_add_u32 v11, 2304, v6
  v_cmp_gt_u32 vcc, 16, v5
  s_nop 1
  v_cndmask_b32 v12, v9, v8, vcc
  v_cmp_gt_u32 vcc, 32, v5
  s_nop 1
  v_cndmask_b32 v13, v10, v9, vcc
  v_cmp_gt_u32 vcc, 48, v5
  s_nop 1
  v_cndmask_b32 v14, v11, v10, vcc
  v_mul_u32_u24 v15, 400, v4
  v_lshl_add_u32 v15, v3, 3, v15
  s_mul_i32 s6, s3, 96
  s_add_u32 s6, s6, 86016
  v_add_u32 v15, s6, v15
  v_xor_b32 v7, v4, v3
  v_lshl_add_u32 v7, v3, 4, v7
  v_lshlrev_b32 v7, 4, v7
  s_lshl_b32 s6, s3, 10
  v_add_u32 v7, s6, v7
  s_cmp_eq_u32 s3, 0
  s_cbranch_scc1 L_aw0_18
  buffer_load_dwordx4 a[36:39], v156, s[64:67], 0 offen offset:1024 sc1
  buffer_load_dwordx4 a[108:111], v157, s[64:67], 0 offen offset:1024 sc1
  buffer_load_dwordx4 a[180:183], v158, s[64:67], 0 offen offset:1024 sc1
  buffer_load_dwordx4 a[40:43], v156, s[64:67], 0 offen offset:2048 sc1
  buffer_load_dwordx4 a[112:115], v157, s[64:67], 0 offen offset:2048 sc1
  buffer_load_dwordx4 a[184:187], v158, s[64:67], 0 offen offset:2048 sc1
  buffer_load_dwordx4 a[44:47], v156, s[64:67], 0 offen offset:3072 sc1
  buffer_load_dwordx4 a[116:119], v157, s[64:67], 0 offen offset:3072 sc1
  buffer_load_dwordx4 a[188:191], v158, s[64:67], 0 offen offset:3072 sc1
  v_add_u32 v156, 4096, v156
  buffer_load_dwordx4 a[48:51], v156, s[64:67], 0 offen offset:0 sc1
  v_add_u32 v157, 4096, v157
  buffer_load_dwordx4 a[120:123], v157, s[64:67], 0 offen offset:0 sc1
  v_add_u32 v158, 4096, v158
  buffer_load_dwordx4 a[192:195], v158, s[64:67], 0 offen offset:0 sc1
  buffer_load_dwordx4 a[52:55], v156, s[64:67], 0 offen offset:1024 sc1
  buffer_load_dwordx4 a[124:127], v157, s[64:67], 0 offen offset:1024 sc1
  buffer_load_dwordx4 a[196:199], v158, s[64:67], 0 offen offset:1024 sc1
  buffer_load_dwordx4 a[56:59], v156, s[64:67], 0 offen offset:2048 sc1
  buffer_load_dwordx4 a[128:131], v157, s[64:67], 0 offen offset:2048 sc1
  buffer_load_dwordx4 a[200:203], v158, s[64:67], 0 offen offset:2048 sc1
  buffer_load_dwordx4 a[60:63], v156, s[64:67], 0 offen offset:3072 sc1
  buffer_load_dwordx4 a[132:135], v157, s[64:67], 0 offen offset:3072 sc1
  buffer_load_dwordx4 a[204:207], v158, s[64:67], 0 offen offset:3072 sc1
  v_add_u32 v156, 4096, v156
  buffer_load_dwordx4 a[64:67], v156, s[64:67], 0 offen offset:0 sc1
  v_add_u32 v157, 4096, v157
  buffer_load_dwordx4 a[136:139], v157, s[64:67], 0 offen offset:0 sc1
  v_add_u32 v158, 4096, v158
  buffer_load_dwordx4 a[208:211], v158, s[64:67], 0 offen offset:0 sc1
  buffer_load_dwordx4 a[68:71], v156, s[64:67], 0 offen offset:1024 sc1
  buffer_load_dwordx4 a[140:143], v157, s[64:67], 0 offen offset:1024 sc1
  buffer_load_dwordx4 a[212:215], v158, s[64:67], 0 offen offset:1024 sc1
L_aw0_18:
  s_cmp_lg_u32 s3, 0
  s_cbranch_scc1 L_wt_20
  s_sub_u32 s6, s4, 1
  v_add_u32 v252, s6, v1
  v_max_i32 v252, 0, v252
  v_min_i32 v252, 63, v252
  v_mul_u32_u24 v252, 4352, v252
  v_add_u32 v252, 182784, v252
  v_mov_b32 v254, 3
  v_mov_b32 v255, 918272
  v_mov_b32 v251, 1
  v_cmp_eq_u32 vcc, 3, v1
  s_nop 1
  v_cndmask_b32 v252, v252, v255, vcc
  s_nop 0
  v_cndmask_b32 v254, v254, v251, vcc
  s_mov_b32 s77, 0
  s_mov_b64 exec, 0x7
L_poll_21:
  buffer_load_dword v253, v252, s[72:75], 0 offen sc1
  s_waitcnt vmcnt(0)
  v_cmp_lt_u32 vcc, v253, v254
  s_add_u32 s77, s77, 1
  s_cmp_ge_u32 s77, 131072
  s_cbranch_scc1 L_poll_21_x
  s_cbranch_vccz L_poll_21_x
  s_sleep 1
  s_branch L_poll_21
L_poll_21_x:
  s_mov_b64 exec, -1
L_wt_20:
  s_barrier
  s_cmp_lg_u32 s3, 0
  s_cbranch_scc1 L_aw1_19
  buffer_load_dwordx4 a[36:39], v156, s[64:67], 0 offen offset:1024 sc1
  buffer_load_dwordx4 a[108:111], v157, s[64:67], 0 offen offset:1024 sc1
  buffer_load_dwordx4 a[180:183], v158, s[64:67], 0 offen offset:1024 sc1
  buffer_load_dwordx4 a[40:43], v156, s[64:67], 0 offen offset:2048 sc1
  buffer_load_dwordx4 a[112:115], v157, s[64:67], 0 offen offset:2048 sc1
  buffer_load_dwordx4 a[184:187], v158, s[64:67], 0 offen offset:2048 sc1
  buffer_load_dwordx4 a[44:47], v156, s[64:67], 0 offen offset:3072 sc1
  buffer_load_dwordx4 a[116:119], v157, s[64:67], 0 offen offset:3072 sc1
  buffer_load_dwordx4 a[188:191], v158, s[64:67], 0 offen offset:3072 sc1
  v_add_u32 v156, 4096, v156
  buffer_load_dwordx4 a[48:51], v156, s[64:67], 0 offen offset:0 sc1
  v_add_u32 v157, 4096, v157
  buffer_load_dwordx4 a[120:123], v157, s[64:67], 0 offen offset:0 sc1
  v_add_u32 v158, 4096, v158
  buffer_load_dwordx4 a[192:195], v158, s[64:67], 0 offen offset:0 sc1
  buffer_load_dwordx4 a[52:55], v156, s[64:67], 0 offen offset:1024 sc1
  buffer_load_dwordx4 a[124:127], v157, s[64:67], 0 offen offset:1024 sc1
  buffer_load_dwordx4 a[196:199], v158, s[64:67], 0 offen offset:1024 sc1
  buffer_load_dwordx4 a[56:59], v156, s[64:67], 0 offen offset:2048 sc1
  buffer_load_dwordx4 a[128:131], v157, s[64:67], 0 offen offset:2048 sc1
  buffer_load_dwordx4 a[200:203], v158, s[64:67], 0 offen offset:2048 sc1
  buffer_load_dwordx4 a[60:63], v156, s[64:67], 0 offen offset:3072 sc1
  buffer_load_dwordx4 a[132:135], v157, s[64:67], 0 offen offset:3072 sc1
  buffer_load_dwordx4 a[204:207], v158, s[64:67], 0 offen offset:3072 sc1
  v_add_u32 v156, 4096, v156
  buffer_load_dwordx4 a[64:67], v156, s[64:67], 0 offen offset:0 sc1
  v_add_u32 v157, 4096, v157
  buffer_load_dwordx4 a[136:139], v157, s[64:67], 0 offen offset:0 sc1
  v_add_u32 v158, 4096, v158
  buffer_load_dwordx4 a[208:211], v158, s[64:67], 0 offen offset:0 sc1
  buffer_load_dwordx4 a[68:71], v156, s[64:67], 0 offen offset:1024 sc1
  buffer_load_dwordx4 a[140:143], v157, s[64:67], 0 offen offset:1024 sc1
  buffer_load_dwordx4 a[212:215], v158, s[64:67], 0 offen offset:1024 sc1
L_aw1_19:
  buffer_load_dwordx4 v[16:19], v8, s[48:51], 0 offen offset:0 sc1
  buffer_load_dwordx4 v[20:23], v8, s[48:51], 0 offen offset:128 sc1
  buffer_load_dwordx4 v[24:27], v12, s[48:51], 0 offen offset:256 sc1
  buffer_load_dwordx4 v[28:31], v9, s[48:51], 0 offen offset:384 sc1
  buffer_load_dwordx4 v[32:35], v13, s[48:51], 0 offen offset:512 sc1
  buffer_load_dwordx4 v[36:39], v10, s[48:51], 0 offen offset:640 sc1
  buffer_load_dwordx4 v[40:43], v14, s[48:51], 0 offen offset:768 sc1
  buffer_load_dwordx4 v[44:47], v11, s[48:51], 0 offen offset:896 sc1
  buffer_load_dwordx4 v[48:51], v11, s[48:51], 0 offen offset:1024 sc1
  ds_read_b64 v[108:109], v15 offset:0
  ds_read_b64 v[110:111], v15 offset:6400
  ds_read_b64 v[112:113], v15 offset:32
  ds_read_b64 v[114:115], v15 offset:6432
  ds_read_b64 v[116:117], v15 offset:64
  ds_read_b64 v[118:119], v15 offset:6464
  s_waitcnt vmcnt(8)
  ds_write_b128 v7, v[16:19] offset:0
  s_waitcnt vmcnt(7)
  ds_write_b128 v7, v[20:23] offset:4096
  s_waitcnt vmcnt(6)
  ds_write_b128 v7, v[24:27] offset:8192
  s_waitcnt vmcnt(5)
  ds_write_b128 v7, v[28:31] offset:12288
  s_waitcnt vmcnt(4)
  ds_write_b128 v7, v[32:35] offset:16384
  s_waitcnt vmcnt(3)
  ds_write_b128 v7, v[36:39] offset:20480
  s_waitcnt vmcnt(2)
  ds_write_b128 v7, v[40:43] offset:24576
  s_waitcnt vmcnt(1)
  ds_write_b128 v7, v[44:47] offset:28672
  s_waitcnt vmcnt(0)
  ds_write_b128 v7, v[48:51] offset:32768
  s_waitcnt lgkmcnt(0)
  s_barrier
  s_and_b32 s10, s2, 3
  s_lshl_b32 s10, s10, 1
  s_bfe_u32 s76, s2, 0x10003
  s_add_u32 s10, s10, s76
  s_bfe_u32 s11, s2, 0x10002
  s_lshl_b32 s11, s11, 4
  s_lshr_b32 s76, s2, 4
  s_add_u32 s11, s11, s76
  s_add_u32 s64, s46, 0x10c8000
  s_addc_u32 s65, s47, 0
  s_mov_b32 s66, 0xa20000
  s_mov_b32 s67, 0x20000
  s_lshl_b32 s6, s10, 2
  s_add_u32 s6, s6, s3
  s_mul_i32 s6, s6, 331776
  v_lshl_add_u32 v160, v1, 4, s6
  v_and_b32 v2, 15, v1
  v_lshrrev_b32 v8, 4, v1
  v_xor_b32 v2, v2, v8
  v_lshl_add_u32 v2, v8, 4, v2
  v_lshlrev_b32 v2, 4, v2
  v_add_u32 v2, 0, v2
  ds_read_b128 v[80:83], v2 offset:0
  ds_read_b128 v[84:87], v2 offset:1024
  ds_read_b128 v[88:91], v2 offset:2048
  ds_read_b128 v[92:95], v2 offset:3072
  ds_read_b128 v[96:99], v2 offset:4096
  ds_read_b128 v[100:103], v2 offset:5120
  s_waitcnt lgkmcnt(5)
  v_mfma_f32_16x16x32_bf16 v[52:55], a[0:3], v[80:83], 0
  s_waitcnt lgkmcnt(4)
  v_mfma_f32_16x16x32_bf16 v[56:59], a[0:3], v[84:87], 0
  v_mfma_f32_16x16x32_bf16 v[60:63], a[72:75], v[80:83], 0
  v_mfma_f32_16x16x32_bf16 v[64:67], a[72:75], v[84:87], 0
  v_mfma_f32_16x16x32_bf16 v[68:71], a[144:147], v[80:83], 0
  v_mfma_f32_16x16x32_bf16 v[72:75], a[144:147], v[84:87], 0
  ds_read_b128 v[80:83], v2 offset:6144
  ds_read_b128 v[84:87], v2 offset:7168
  s_waitcnt lgkmcnt(5)
  v_mfma_f32_16x16x32_bf16 v[52:55], a[4:7], v[88:91], v[52:55]
  s_waitcnt lgkmcnt(4)
  v_mfma_f32_16x16x32_bf16 v[56:59], a[4:7], v[92:95], v[56:59]
  v_mfma_f32_16x16x32_bf16 v[60:63], a[76:79], v[88:91], v[60:63]
  v_mfma_f32_16x16x32_bf16 v[64:67], a[76:79], v[92:95], v[64:67]
  v_mfma_f32_16x16x32_bf16 v[68:71], a[148:151], v[88:91], v[68:71]
  v_mfma_f32_16x16x32_bf16 v[72:75], a[148:151], v[92:95], v[72:75]
  ds_read_b128 v[88:91], v2 offset:8192
  ds_read_b128 v[92:95], v2 offset:9216
  s_waitcnt lgkmcnt(5)
  v_mfma_f32_16x16x32_bf16 v[52:55], a[8:11], v[96:99], v[52:55]
  s_waitcnt lgkmcnt(4)
  v_mfma_f32_16x16x32_bf16 v[56:59], a[8:11], v[100:103], v[56:59]
  v_mfma_f32_16x16x32_bf16 v[60:63], a[80:83], v[96:99], v[60:63]
  v_mfma_f32_16x16x32_bf16 v[64:67], a[80:83], v[100:103], v[64:67]
  v_mfma_f32_16x16x32_bf16 v[68:71], a[152:155], v[96:99], v[68:71]
  v_mfma_f32_16x16x32_bf16 v[72:75], a[152:155], v[100:103], v[72:75]
  ds_read_b128 v[96:99], v2 offset:10240
  ds_read_b128 v[100:103], v2 offset:11264
  s_waitcnt lgkmcnt(5)
  v_mfma_f32_16x16x32_bf16 v[52:55], a[12:15], v[80:83], v[52:55]
  s_waitcnt lgkmcnt(4)
  v_mfma_f32_16x16x32_bf16 v[56:59], a[12:15], v[84:87], v[56:59]
  v_mfma_f32_16x16x32_bf16 v[60:63], a[84:87], v[80:83], v[60:63]
  v_mfma_f32_16x16x32_bf16 v[64:67], a[84:87], v[84:87], v[64:67]
  v_mfma_f32_16x16x32_bf16 v[68:71], a[156:159], v[80:83], v[68:71]
  v_mfma_f32_16x16x32_bf16 v[72:75], a[156:159], v[84:87], v[72:75]
  ds_read_b128 v[80:83], v2 offset:12288
  ds_read_b128 v[84:87], v2 offset:13312
  s_waitcnt lgkmcnt(5)
  v_mfma_f32_16x16x32_bf16 v[52:55], a[16:19], v[88:91], v[52:55]
  s_waitcnt lgkmcnt(4)
  v_mfma_f32_16x16x32_bf16 v[56:59], a[16:19], v[92:95], v[56:59]
  v_mfma_f32_16x16x32_bf16 v[60:63], a[88:91], v[88:91], v[60:63]
  v_mfma_f32_16x16x32_bf16 v[64:67], a[88:91], v[92:95], v[64:67]
  v_mfma_f32_16x16x32_bf16 v[68:71], a[160:163], v[88:91], v[68:71]
  v_mfma_f32_16x16x32_bf16 v[72:75], a[160:163], v[92:95], v[72:75]
  ds_read_b128 v[88:91], v2 offset:14336
  ds_read_b128 v[92:95], v2 offset:15360
  s_waitcnt lgkmcnt(5)
  v_mfma_f32_16x16x32_bf16 v[52:55], a[20:23], v[96:99], v[52:55]
  s_waitcnt lgkmcnt(4)
  v_mfma_f32_16x16x32_bf16 v[56:59], a[20:23], v[100:103], v[56:59]
  v_mfma_f32_16x16x32_bf16 v[60:63], a[92:95], v[96:99], v[60:63]
  v_mfma_f32_16x16x32_bf16 v[64:67], a[92:95], v[100:103], v[64:67]
  v_mfma_f32_16x16x32_bf16 v[68:71], a[164:167], v[96:99], v[68:71]
  v_mfma_f32_16x16x32_bf16 v[72:75], a[164:167], v[100:103], v[72:75]
  ds_read_b128 v[96:99], v2 offset:16384
  ds_read_b128 v[100:103], v2 offset:17408
  s_waitcnt lgkmcnt(5)
  v_mfma_f32_16x16x32_bf16 v[52:55], a[24:27], v[80:83], v[52:55]
  s_waitcnt lgkmcnt(4)
  v_mfma_f32_16x16x32_bf16 v[56:59], a[24:27], v[84:87], v[56:59]
  v_mfma_f32_16x16x32_bf16 v[60:63], a[96:99], v[80:83], v[60:63]
  v_mfma_f32_16x16x32_bf16 v[64:67], a[96:99], v[84:87], v[64:67]
  v_mfma_f32_16x16x32_bf16 v[68:71], a[168:171], v[80:83], v[68:71]
  v_mfma_f32_16x16x32_bf16 v[72:75], a[168:171], v[84:87], v[72:75]
  ds_read_b128 v[80:83], v2 offset:18432
  ds_read_b128 v[84:87], v2 offset:19456
  s_waitcnt lgkmcnt(5)
  v_mfma_f32_16x16x32_bf16 v[52:55], a[28:31], v[88:91], v[52:55]
  s_waitcnt lgkmcnt(4)
  v_mfma_f32_16x16x32_bf16 v[56:59], a[28:31], v[92:95], v[56:59]
  v_mfma_f32_16x16x32_bf16 v[60:63], a[100:103], v[88:91], v[60:63]
  v_mfma_f32_16x16x32_bf16 v[64:67], a[100:103], v[92:95], v[64:67]
  v_mfma_f32_16x16x32_bf16 v[68:71], a[172:175], v[88:91], v[68:71]
  v_mfma_f32_16x16x32_bf16 v[72:75], a[172:175], v[92:95], v[72:75]
  ds_read_b128 v[88:91], v2 offset:20480
  ds_read_b128 v[92:95], v2 offset:21504
  s_waitcnt lgkmcnt(5)
  v_mfma_f32_16x16x32_bf16 v[52:55], a[32:35], v[96:99], v[52:55]
  s_waitcnt lgkmcnt(4)
  v_mfma_f32_16x16x32_bf16 v[56:59], a[32:35], v[100:103], v[56:59]
  v_mfma_f32_16x16x32_bf16 v[60:63], a[104:107], v[96:99], v[60:63]
  v_mfma_f32_16x16x32_bf16 v[64:67], a[104:107], v[100:103], v[64:67]
  v_mfma_f32_16x16x32_bf16 v[68:71], a[176:179], v[96:99], v[68:71]
  v_mfma_f32_16x16x32_bf16 v[72:75], a[176:179], v[100:103], v[72:75]
  ds_read_b128 v[96:99], v2 offset:22528
  ds_read_b128 v[100:103], v2 offset:23552
  s_waitcnt lgkmcnt(5)
  v_mfma_f32_16x16x32_bf16 v[52:55], a[36:39], v[80:83], v[52:55]
  s_waitcnt lgkmcnt(4)
  v_mfma_f32_16x16x32_bf16 v[56:59], a[36:39], v[84:87], v[56:59]
  v_mfma_f32_16x16x32_bf16 v[60:63], a[108:111], v[80:83], v[60:63]
  v_mfma_f32_16x16x32_bf16 v[64:67], a[108:111], v[84:87], v[64:67]
  v_mfma_f32_16x16x32_bf16 v[68:71], a[180:183], v[80:83], v[68:71]
  v_mfma_f32_16x16x32_bf16 v[72:75], a[180:183], v[84:87], v[72:75]
  ds_read_b128 v[80:83], v2 offset:24576
  ds_read_b128 v[84:87], v2 offset:25600
  s_waitcnt lgkmcnt(5)
  v_mfma_f32_16x16x32_bf16 v[52:55], a[40:43], v[88:91], v[52:55]
  s_waitcnt lgkmcnt(4)
  v_mfma_f32_16x16x32_bf16 v[56:59], a[40:43], v[92:95], v[56:59]
  v_mfma_f32_16x16x32_bf16 v[60:63], a[112:115], v[88:91], v[60:63]
  v_mfma_f32_16x16x32_bf16 v[64:67], a[112:115], v[92:95], v[64:67]
  v_mfma_f32_16x16x32_bf16 v[68:71], a[184:187], v[88:91], v[68:71]
  v_mfma_f32_16x16x32_bf16 v[72:75], a[184:187], v[92:95], v[72:75]
  ds_read_b128 v[88:91], v2 offset:26624
  ds_read_b128 v[92:95], v2 offset:27648
  s_waitcnt lgkmcnt(5)
  v_mfma_f32_16x16x32_bf16 v[52:55], a[44:47], v[96:99], v[52:55]
  s_waitcnt lgkmcnt(4)
  v_mfma_f32_16x16x32_bf16 v[56:59], a[44:47], v[100:103], v[56:59]
  v_mfma_f32_16x16x32_bf16 v[60:63], a[116:119], v[96:99], v[60:63]
  v_mfma_f32_16x16x32_bf16 v[64:67], a[116:119], v[100:103], v[64:67]
  v_mfma_f32_16x16x32_bf16 v[68:71], a[188:191], v[96:99], v[68:71]
  v_mfma_f32_16x16x32_bf16 v[72:75], a[188:191], v[100:103], v[72:75]
  ds_read_b128 v[96:99], v2 offset:28672
  ds_read_b128 v[100:103], v2 offset:29696
  s_waitcnt lgkmcnt(5)
  v_mfma_f32_16x16x32_bf16 v[52:55], a[48:51], v[80:83], v[52:55]
  s_waitcnt lgkmcnt(4)
  v_mfma_f32_16x16x32_bf16 v[56:59], a[48:51], v[84:87], v[56:59]
  v_mfma_f32_16x16x32_bf16 v[60:63], a[120:123], v[80:83], v[60:63]
  v_mfma_f32_16x16x32_bf16 v[64:67], a[120:123], v[84:87], v[64:67]
  v_mfma_f32_16x16x32_bf16 v[68:71], a[192:195], v[80:83], v[68:71]
  v_mfma_f32_16x16x32_bf16 v[72:75], a[192:195], v[84:87], v[72:75]
  ds_read_b128 v[80:83], v2 offset:30720
  ds_read_b128 v[84:87], v2 offset:31744
  s_waitcnt lgkmcnt(5)
  v_mfma_f32_16x16x32_bf16 v[52:55], a[52:55], v[88:91], v[52:55]
  s_waitcnt lgkmcnt(4)
  v_mfma_f32_16x16x32_bf16 v[56:59], a[52:55], v[92:95], v[56:59]
  v_mfma_f32_16x16x32_bf16 v[60:63], a[124:127], v[88:91], v[60:63]
  v_mfma_f32_16x16x32_bf16 v[64:67], a[124:127], v[92:95], v[64:67]
  v_mfma_f32_16x16x32_bf16 v[68:71], a[196:199], v[88:91], v[68:71]
  v_mfma_f32_16x16x32_bf16 v[72:75], a[196:199], v[92:95], v[72:75]
  ds_read_b128 v[88:91], v2 offset:32768
  ds_read_b128 v[92:95], v2 offset:33792
  s_waitcnt lgkmcnt(5)
  v_mfma_f32_16x16x32_bf16 v[52:55], a[56:59], v[96:99], v[52:55]
  s_waitcnt lgkmcnt(4)
  v_mfma_f32_16x16x32_bf16 v[56:59], a[56:59], v[100:103], v[56:59]
  v_mfma_f32_16x16x32_bf16 v[60:63], a[128:131], v[96:99], v[60:63]
  v_mfma_f32_16x16x32_bf16 v[64:67], a[128:131], v[100:103], v[64:67]
  v_mfma_f32_16x16x32_bf16 v[68:71], a[200:203], v[96:99], v[68:71]
  v_mfma_f32_16x16x32_bf16 v[72:75], a[200:203], v[100:103], v[72:75]
  ds_read_b128 v[96:99], v2 offset:34816
  ds_read_b128 v[100:103], v2 offset:35840
  s_waitcnt lgkmcnt(5)
  v_mfma_f32_16x16x32_bf16 v[52:55], a[60:63], v[80:83], v[52:55]
  s_waitcnt lgkmcnt(4)
  v_mfma_f32_16x16x32_bf16 v[56:59], a[60:63], v[84:87], v[56:59]
  v_mfma_f32_16x16x32_bf16 v[60:63], a[132:135], v[80:83], v[60:63]
  v_mfma_f32_16x16x32_bf16 v[64:67], a[132:135], v[84:87], v[64:67]
  v_mfma_f32_16x16x32_bf16 v[68:71], a[204:207], v[80:83], v[68:71]
  v_mfma_f32_16x16x32_bf16 v[72:75], a[204:207], v[84:87], v[72:75]
  s_waitcnt lgkmcnt(3)
  v_mfma_f32_16x16x32_bf16 v[52:55], a[64:67], v[88:91], v[52:55]
  s_waitcnt lgkmcnt(2)
  v_mfma_f32_16x16x32_bf16 v[56:59], a[64:67], v[92:95], v[56:59]
  v_mfma_f32_16x16x32_bf16 v[60:63], a[136:139], v[88:91], v[60:63]
  v_mfma_f32_16x16x32_bf16 v[64:67], a[136:139], v[92:95], v[64:67]
  v_mfma_f32_16x16x32_bf16 v[68:71], a[208:211], v[88:91], v[68:71]
  v_mfma_f32_16x16x32_bf16 v[72:75], a[208:211], v[92:95], v[72:75]
  s_waitcnt lgkmcnt(1)
  v_mfma_f32_16x16x32_bf16 v[52:55], a[68:71], v[96:99], v[52:55]
  s_waitcnt lgkmcnt(0)
  v_mfma_f32_16x16x32_bf16 v[56:59], a[68:71], v[100:103], v[56:59]
  v_mfma_f32_16x16x32_bf16 v[60:63], a[140:143], v[96:99], v[60:63]
  v_mfma_f32_16x16x32_bf16 v[64:67], a[140:143], v[100:103], v[64:67]
  v_mfma_f32_16x16x32_bf16 v[68:71], a[212:215], v[96:99], v[68:71]
  v_mfma_f32_16x16x32_bf16 v[72:75], a[212:215], v[100:103], v[72:75]
  v_lshlrev_b32 v120, 16, v108
  v_and_b32 v121, s99, v108
  v_lshlrev_b32 v122, 16, v109
  v_and_b32 v123, s99, v109
  v_pk_add_f32 v[52:53], v[52:53], v[120:121]
  v_pk_add_f32 v[54:55], v[54:55], v[122:123]
  v_cvt_pk_bf16_f32 v128, v52, v53
  v_cvt_pk_bf16_f32 v129, v54, v55
  v_pk_add_f32 v[140:141], v[52:53], v[54:55]
  v_pk_mul_f32 v[142:143], v[52:53], v[52:53]
  v_pk_fma_f32 v[142:143], v[54:55], v[54:55], v[142:143]
  v_lshlrev_b32 v120, 16, v110
  v_and_b32 v121, s99, v110
  v_lshlrev_b32 v122, 16, v111
  v_and_b32 v123, s99, v111
  v_pk_add_f32 v[56:57], v[56:57], v[120:121]
  v_pk_add_f32 v[58:59], v[58:59], v[122:123]
  v_cvt_pk_bf16_f32 v130, v56, v57
  v_cvt_pk_bf16_f32 v131, v58, v59
  v_pk_add_f32 v[144:145], v[56:57], v[58:59]
  v_pk_mul_f32 v[146:147], v[56:57], v[56:57]
  v_pk_fma_f32 v[146:147], v[58:59], v[58:59], v[146:147]
  v_lshlrev_b32 v120, 16, v112
  v_and_b32 v121, s99, v112
  v_lshlrev_b32 v122, 16, v113
  v_and_b32 v123, s99, v113
  v_pk_add_f32 v[60:61], v[60:61], v[120:121]
  v_pk_add_f32 v[62:63], v[62:63], v[122:123]
  v_cvt_pk_bf16_f32 v132, v60, v61
  v_cvt_pk_bf16_f32 v133, v62, v63
  v_pk_add_f32 v[140:141], v[140:141], v[60:61]
  v_pk_add_f32 v[140:141], v[140:141], v[62:63]
  v_pk_fma_f32 v[142:143], v[60:61], v[60:61], v[142:143]
  v_pk_fma_f32 v[142:143], v[62:63], v[62:63], v[142:143]
  v_lshlrev_b32 v120, 16, v114
  v_and_b32 v121, s99, v114
  v_lshlrev_b32 v122, 16, v115
  v_and_b32 v123, s99, v115
  v_pk_add_f32 v[64:65], v[64:65], v[120:121]
  v_pk_add_f32 v[66:67], v[66:67], v[122:123]
  v_cvt_pk_bf16_f32 v134, v64, v65
  v_cvt_pk_bf16_f32 v135, v66, v67
  v_pk_add_f32 v[144:145], v[144:145], v[64:65]
  v_pk_add_f32 v[144:145], v[144:145], v[66:67]
  v_pk_fma_f32 v[146:147], v[64:65], v[64:65], v[146:147]
  v_pk_fma_f32 v[146:147], v[66:67], v[66:67], v[146:147]
  v_lshlrev_b32 v120, 16, v116
  v_and_b32 v121, s99, v116
  v_lshlrev_b32 v122, 16, v117
  v_and_b32 v123, s99, v117
  v_pk_add_f32 v[68:69], v[68:69], v[120:121]
  v_pk_add_f32 v[70:71], v[70:71], v[122:123]
  v_cvt_pk_bf16_f32 v136, v68, v69
  v_cvt_pk_bf16_f32 v137, v70, v71
  v_pk_add_f32 v[140:141], v[140:141], v[68:69]
  v_pk_add_f32 v[140:141], v[140:141], v[70:71]
  v_pk_fma_f32 v[142:143], v[68:69], v[68:69], v[142:143]
  v_pk_fma_f32 v[142:143], v[70:71], v[70:71], v[142:143]
  v_lshlrev_b32 v120, 16, v118
  v_and_b32 v121, s99, v118
  v_lshlrev_b32 v122, 16, v119
  v_and_b32 v123, s99, v119
  v_pk_add_f32 v[72:73], v[72:73], v[120:121]
  v_pk_add_f32 v[74:75], v[74:75], v[122:123]
  v_cvt_pk_bf16_f32 v138, v72, v73
  v_cvt_pk_bf16_f32 v139, v74, v75
  v_pk_add_f32 v[144:145], v[144:145], v[72:73]
  v_pk_add_f32 v[144:145], v[144:145], v[74:75]
  v_pk_fma_f32 v[146:147], v[72:73], v[72:73], v[146:147]
  v_pk_fma_f32 v[146:147], v[74:75], v[74:75], v[146:147]
  v_add_f32 v140, v140, v141
  v_add_f32 v142, v142, v143
  v_add_f32 v144, v144, v145
  v_add_f32 v146, v146, v147
  v_mov_b32 v141, v140
  v_mov_b32 v143, v142
  v_mov_b32 v145, v144
  v_mov_b32 v147, v146
  v_permlane16_swap_b32 v140, v141
  v_permlane16_swap_b32 v142, v143
  v_permlane16_swap_b32 v144, v145
  v_permlane16_swap_b32 v146, v147
  v_add_f32 v140, v140, v141
  v_add_f32 v142, v142, v143
  v_add_f32 v144, v144, v145
  v_add_f32 v146, v146, v147
  v_mov_b32 v141, v140
  v_mov_b32 v143, v142
  v_mov_b32 v145, v144
  v_mov_b32 v147, v146
  v_permlane32_swap_b32 v140, v141
  v_permlane32_swap_b32 v142, v143
  v_permlane32_swap_b32 v144, v145
  v_permlane32_swap_b32 v146, v147
  v_add_f32 v140, v140, v141
  v_add_f32 v142, v142, v143
  v_add_f32 v144, v144, v145
  v_add_f32 v146, v146, v147
  v_mov_b32 v141, v142
  v_mov_b32 v145, v146
  v_and_b32 v150, 15, v1
  v_lshlrev_b32 v150, 3, v150
  s_lshl_b32 s6, s3, 8
  s_add_u32 s6, s6, 113152
  v_add_u32 v150, s6, v150
  s_mov_b64 exec, 0xffff
  ds_write_b64 v150, v[140:141]
  ds_write_b64 v150, v[144:145] offset:128
  s_mov_b64 exec, -1
  v_accvgpr_read_b32 v2, a216
  v_accvgpr_read_b32 v204, a217
  v_accvgpr_read_b32 v205, a218
  v_accvgpr_read_b32 v206, a219
  v_accvgpr_read_b32 v207, a220
  v_accvgpr_read_b32 v208, a221
  v_accvgpr_read_b32 v209, a222
  ds_write_b64 v2, v[128:129] offset:0
  ds_write_b64 v2, v[130:131] offset:6400
  ds_write_b64 v2, v[132:133] offset:32
  ds_write_b64 v2, v[134:135] offset:6432
  ds_write_b64 v2, v[136:137] offset:64
  ds_write_b64 v2, v[138:139] offset:6464
  s_waitcnt lgkmcnt(0)
  s_barrier
  ds_read_b128 v[212:215], v204
  ds_read_b128 v[216:219], v205
  ds_read_b128 v[220:223], v206
  s_waitcnt lgkmcnt(2)
  buffer_store_dwordx4 v[212:215], v207, s[56:59], 0 offen sc1
  s_waitcnt lgkmcnt(1)
  buffer_store_dwordx4 v[216:219], v208, s[56:59], 0 offen sc1
  s_waitcnt lgkmcnt(0)
  buffer_store_dwordx4 v[220:223], v209, s[56:59], 0 offen sc1
  s_cmp_lg_u32 s3, 0
  s_cbranch_scc1 L_st3_22
  s_add_u32 s52, s46, 0x2ce8000
  s_addc_u32 s53, s47, 0
  s_mov_b32 s54, 0xc000
  s_mov_b32 s55, 0x20000
  v_lshlrev_b32 v150, 3, v1
  v_add_u32 v150, 113152, v150
  ds_read_b64 v[140:141], v150 offset:0
  ds_read_b64 v[142:143], v150 offset:256
  ds_read_b64 v[144:145], v150 offset:512
  ds_read_b64 v[146:147], v150 offset:768
  s_waitcnt lgkmcnt(2)
  v_pk_add_f32 v[140:141], v[140:141], v[142:143]
  s_waitcnt lgkmcnt(0)
  v_pk_add_f32 v[144:145], v[144:145], v[146:147]
  v_pk_add_f32 v[140:141], v[140:141], v[144:145]
  s_mul_i32 s6, s5, 16384
  s_lshl_b32 s7, s4, 8
  s_add_u32 s6, s6, s7
  v_lshl_add_u32 v151, v1, 3, s6
  s_mov_b64 exec, 0xffffffff
  buffer_store_dwordx2 v[140:141], v151, s[52:55], 0 offen sc1
  s_mov_b64 exec, -1
L_st3_22:
  s_waitcnt vmcnt(0) lgkmcnt(0)
  s_barrier
  s_cmp_lg_u32 s3, 0
  s_cbranch_scc1 L_arr_23
  s_mov_b64 exec, 1
  s_mul_i32 s76, s4, 4352
  s_add_u32 s76, s76, 461312
  v_mov_b32 v252, s76
  v_mov_b32 v253, 1
  buffer_atomic_add v253, v252, s[72:75], 0 offen sc1
L_ad_24:
  s_mov_b64 exec, -1
L_arr_23:
  v_mov_b32 v252, 918272
  v_mov_b32 v254, 1
  s_mov_b32 s77, 0
  s_mov_b64 exec, 0x1
L_ww_25:
  buffer_load_dword v253, v252, s[72:75], 0 offen sc1
  s_waitcnt vmcnt(0)
  v_cmp_lt_u32 vcc, v253, v254
  s_add_u32 s77, s77, 1
  s_cmp_ge_u32 s77, 131072
  s_cbranch_scc1 L_ww_25_x
  s_cbranch_vccz L_ww_25_x
  s_sleep 1
  s_branch L_ww_25
L_ww_25_x:
  s_mov_b64 exec, -1
  s_and_b32 s10, s2, 3
  s_lshl_b32 s10, s10, 1
  s_bfe_u32 s76, s2, 0x10003
  s_add_u32 s10, s10, s76
  s_bfe_u32 s11, s2, 0x10002
  s_lshl_b32 s11, s11, 4
  s_lshr_b32 s76, s2, 4
  s_add_u32 s11, s11, s76
  s_add_u32 s64, s46, 0x10c8000
  s_addc_u32 s65, s47, 0
  s_mov_b32 s66, 0xa20000
  s_mov_b32 s67, 0x20000
  s_lshl_b32 s6, s10, 2
  s_add_u32 s6, s6, s3
  s_mul_i32 s6, s6, 331776
  v_lshl_add_u32 v160, v1, 4, s6
  s_and_b32 s4, s2, 3
  s_lshl_b32 s4, s4, 1
  s_bfe_u32 s76, s2, 0x10003
  s_add_u32 s4, s4, s76
  s_bfe_u32 s5, s2, 0x10002
  s_lshl_b32 s5, s5, 4
  s_lshr_b32 s76, s2, 4
  s_add_u32 s5, s5, s76
  s_cmp_eq_u32 s3, 0
  s_cbranch_scc1 L_aw0_26
  buffer_load_dwordx4 a[0:3], v160, s[64:67], 0 offen offset:0 sc1
  buffer_load_dwordx4 a[72:75], v160, s[64:67], 0 offen offset:1024 sc1
  buffer_load_dwordx4 a[144:147], v160, s[64:67], 0 offen offset:2048 sc1
  buffer_load_dwordx4 a[4:7], v160, s[64:67], 0 offen offset:3072 sc1
  v_add_u32 v160, 4096, v160
  buffer_load_dwordx4 a[76:79], v160, s[64:67], 0 offen offset:0 sc1
  buffer_load_dwordx4 a[148:151], v160, s[64:67], 0 offen offset:1024 sc1
  buffer_load_dwordx4 a[8:11], v160, s[64:67], 0 offen offset:2048 sc1
  buffer_load_dwordx4 a[80:83], v160, s[64:67], 0 offen offset:3072 sc1
  v_add_u32 v160, 4096, v160
  buffer_load_dwordx4 a[152:155], v160, s[64:67], 0 offen offset:0 sc1
  buffer_load_dwordx4 a[12:15], v160, s[64:67], 0 offen offset:1024 sc1
  buffer_load_dwordx4 a[84:87], v160, s[64:67], 0 offen offset:2048 sc1
  buffer_load_dwordx4 a[156:159], v160, s[64:67], 0 offen offset:3072 sc1
  v_add_u32 v160, 4096, v160
  buffer_load_dwordx4 a[16:19], v160, s[64:67], 0 offen offset:0 sc1
  buffer_load_dwordx4 a[88:91], v160, s[64:67], 0 offen offset:1024 sc1
  buffer_load_dwordx4 a[160:163], v160, s[64:67], 0 offen offset:2048 sc1
  buffer_load_dwordx4 a[20:23], v160, s[64:67], 0 offen offset:3072 sc1
  v_add_u32 v160, 4096, v160
  buffer_load_dwordx4 a[92:95], v160, s[64:67], 0 offen offset:0 sc1
  buffer_load_dwordx4 a[164:167], v160, s[64:67], 0 offen offset:1024 sc1
  buffer_load_dwordx4 a[24:27], v160, s[64:67], 0 offen offset:2048 sc1
  buffer_load_dwordx4 a[96:99], v160, s[64:67], 0 offen offset:3072 sc1
  v_add_u32 v160, 4096, v160
  buffer_load_dwordx4 a[168:171], v160, s[64:67], 0 offen offset:0 sc1
  buffer_load_dwordx4 a[28:31], v160, s[64:67], 0 offen offset:1024 sc1
  buffer_load_dwordx4 a[100:103], v160, s[64:67], 0 offen offset:2048 sc1
  buffer_load_dwordx4 a[172:175], v160, s[64:67], 0 offen offset:3072 sc1
  v_add_u32 v160, 4096, v160
  buffer_load_dwordx4 a[32:35], v160, s[64:67], 0 offen offset:0 sc1
  buffer_load_dwordx4 a[104:107], v160, s[64:67], 0 offen offset:1024 sc1
  buffer_load_dwordx4 a[176:179], v160, s[64:67], 0 offen offset:2048 sc1
L_aw0_26:
  s_cmp_lg_u32 s3, 0
  s_cbranch_scc1 L_wt_28
  s_lshl_b32 s6, s5, 1
  v_add_u32 v252, s6, v1
  v_mul_u32_u24 v252, 4352, v252
  v_add_u32 v252, 461312, v252
  v_mov_b32 v254, 3
  v_mov_b32 v255, 178432
  v_mov_b32 v251, 1
  v_cmp_eq_u32 vcc, 2, v1
  s_nop 1
  v_cndmask_b32 v252, v252, v255, vcc
  s_nop 0
  v_cndmask_b32 v254, v254, v251, vcc
  s_mov_b32 s77, 0
  s_mov_b64 exec, 0x7
L_poll_29:
  buffer_load_dword v253, v252, s[72:75], 0 offen sc1
  s_waitcnt vmcnt(0)
  v_cmp_lt_u32 vcc, v253, v254
  s_add_u32 s77, s77, 1
  s_cmp_ge_u32 s77, 131072
  s_cbranch_scc1 L_poll_29_x
  s_cbranch_vccz L_poll_29_x
  s_sleep 1
  s_branch L_poll_29
L_poll_29_x:
  s_mov_b64 exec, -1
L_wt_28:
  s_barrier
  s_cmp_lg_u32 s3, 0
  s_cbranch_scc1 L_aw1_27
  buffer_load_dwordx4 a[0:3], v160, s[64:67], 0 offen offset:0 sc1
  buffer_load_dwordx4 a[72:75], v160, s[64:67], 0 offen offset:1024 sc1
  buffer_load_dwordx4 a[144:147], v160, s[64:67], 0 offen offset:2048 sc1
  buffer_load_dwordx4 a[4:7], v160, s[64:67], 0 offen offset:3072 sc1
  v_add_u32 v160, 4096, v160
  buffer_load_dwordx4 a[76:79], v160, s[64:67], 0 offen offset:0 sc1
  buffer_load_dwordx4 a[148:151], v160, s[64:67], 0 offen offset:1024 sc1
  buffer_load_dwordx4 a[8:11], v160, s[64:67], 0 offen offset:2048 sc1
  buffer_load_dwordx4 a[80:83], v160, s[64:67], 0 offen offset:3072 sc1
  v_add_u32 v160, 4096, v160
  buffer_load_dwordx4 a[152:155], v160, s[64:67], 0 offen offset:0 sc1
  buffer_load_dwordx4 a[12:15], v160, s[64:67], 0 offen offset:1024 sc1
  buffer_load_dwordx4 a[84:87], v160, s[64:67], 0 offen offset:2048 sc1
  buffer_load_dwordx4 a[156:159], v160, s[64:67], 0 offen offset:3072 sc1
  v_add_u32 v160, 4096, v160
  buffer_load_dwordx4 a[16:19], v160, s[64:67], 0 offen offset:0 sc1
  buffer_load_dwordx4 a[88:91], v160, s[64:67], 0 offen offset:1024 sc1
  buffer_load_dwordx4 a[160:163], v160, s[64:67], 0 offen offset:2048 sc1
  buffer_load_dwordx4 a[20:23], v160, s[64:67], 0 offen offset:3072 sc1
  v_add_u32 v160, 4096, v160
  buffer_load_dwordx4 a[92:95], v160, s[64:67], 0 offen offset:0 sc1
  buffer_load_dwordx4 a[164:167], v160, s[64:67], 0 offen offset:1024 sc1
  buffer_load_dwordx4 a[24:27], v160, s[64:67], 0 offen offset:2048 sc1
  buffer_load_dwordx4 a[96:99], v160, s[64:67], 0 offen offset:3072 sc1
  v_add_u32 v160, 4096, v160
  buffer_load_dwordx4 a[168:171], v160, s[64:67], 0 offen offset:0 sc1
  buffer_load_dwordx4 a[28:31], v160, s[64:67], 0 offen offset:1024 sc1
  buffer_load_dwordx4 a[100:103], v160, s[64:67], 0 offen offset:2048 sc1
  buffer_load_dwordx4 a[172:175], v160, s[64:67], 0 offen offset:3072 sc1
  v_add_u32 v160, 4096, v160
  buffer_load_dwordx4 a[32:35], v160, s[64:67], 0 offen offset:0 sc1
  buffer_load_dwordx4 a[104:107], v160, s[64:67], 0 offen offset:1024 sc1
  buffer_load_dwordx4 a[176:179], v160, s[64:67], 0 offen offset:2048 sc1
L_aw1_27:
  s_branch L_mlp2
L_pt:
  s_mov_b32 s72, s46
  s_mov_b32 s73, s47
  s_mov_b32 s74, 0x200000
  s_mov_b32 s75, 0x20000
  s_cmp_lg_u32 s3, 3
  s_cbranch_scc1 L_pf_30
  s_getpc_b64 s[8:9]
L_pc_anchor_1:
  s_sub_u32 s8, s8, (L_pc_anchor_1 - L_code_start)
  s_subb_u32 s9, s9, 0
  s_lshr_b32 s10, s2, 3
  s_mul_i32 s10, s10, 2176
  v_lshl_add_u32 v248, v1, 7, s10
  s_mov_b64 exec, 0x1ffff
  global_load_dword v249, v248, s[8:9]
  s_mov_b64 exec, -1
L_pf_30:
  s_cmp_lg_u32 s2, 255
  s_cbranch_scc1 L_zero_31
  s_cmp_lg_u32 s3, 0
  s_cbranch_scc1 L_zero_31
  v_mul_u32_u24 v2, 4352, v1
  v_mov_b32 v3, 0
  buffer_store_dword v3, v2, s[72:75], 0 offen sc1
  v_add_u32 v2, 278528, v2
  buffer_store_dword v3, v2, s[72:75], 0 offen sc1
  v_add_u32 v2, 278528, v2
  buffer_store_dword v3, v2, s[72:75], 0 offen sc1
  v_add_u32 v2, 278528, v2
  buffer_store_dword v3, v2, s[72:75], 0 offen sc1
  v_add_u32 v2, 278528, v2
  buffer_store_dword v3, v2, s[72:75], 0 offen sc1
  v_add_u32 v2, 278528, v2
  s_mov_b32 s68, s44
  s_mov_b32 s69, s45
  s_mov_b32 s70, 0x100
  s_mov_b32 s71, 0x20000
  s_waitcnt vmcnt(0)
  v_mov_b32 v2, 0
  v_mov_b32 v3, 1
  s_mov_b64 exec, 1
  buffer_store_dword v3, v2, s[68:71], 0 offen sc1
  s_mov_b64 exec, -1
L_zero_31:
  v_lshrrev_b32 v2, 3, v1
  v_and_b32 v3, 7, v1
  v_lshlrev_b32 v3, 4, v3
  v_lshrrev_b32 v4, 4, v1
  v_bfe_u32 v5, v1, 2, 2
  v_and_b32 v9, 3, v1
  v_lshl_add_u32 v6, v4, 3, v5
  v_lshlrev_b32 v6, 7, v6
  v_lshl_add_u32 v6, v9, 3, v6
  v_lshl_add_u32 v7, v4, 2, v5
  v_lshlrev_b32 v7, 7, v7
  v_lshl_add_u32 v7, v9, 5, v7
  v_lshlrev_b32 v8, 4, v1
  s_mul_i32 s96, s3, 16384
  s_mov_b32 s48, s30
  s_mov_b32 s49, s31
  s_mov_b32 s50, 0xa2000
  s_mov_b32 s51, 0x20000
  s_mov_b32 s52, s32
  s_mov_b32 s53, s33
  s_mov_b32 s54, 0xa2000
  s_mov_b32 s55, 0x20000
  s_mov_b32 s56, s34
  s_mov_b32 s57, s35
  s_mov_b32 s58, 0x510000
  s_mov_b32 s59, 0x20000
  s_mov_b32 s60, s36
  s_mov_b32 s61, s37
  s_mov_b32 s62, 0x510000
  s_mov_b32 s63, 0x20000
  s_add_u32 s68, s46, 0xf84000
  s_addc_u32 s69, s47, 0
  s_mov_b32 s70, 0xb64000
  s_mov_b32 s71, 0x20000
  s_sub_u32 s4, s2, 192
  s_lshl_b32 s4, s4, 2
  s_add_u32 s78, s4, s3
  s_mov_b32 s86, s78
  s_mov_b32 s87, s78
  s_mov_b32 s88, s96
  s_mov_b32 s89, s96
  s_add_u32 s90, s96, 16384
  s_cmp_ge_u32 s86, 162
  s_cselect_b32 s15, 1, 0
  s_cselect_b32 s7, 162, 0
  s_sub_u32 s7, s86, s7
  s_mul_i32 s8, s7, 7282
  s_lshr_b32 s8, s8, 16
  s_mul_i32 s9, s8, 9
  s_sub_u32 s9, s7, s9
  s_movk_i32 s11, 1152
  s_cmp_eq_u32 s15, 1
  s_cselect_b32 s64, s52, s48
  s_cselect_b32 s65, s53, s49
  s_cselect_b32 s66, s54, s50
  s_cselect_b32 s67, s55, s51
  s_mul_i32 s10, s8, s11
  s_lshl_b32 s10, s10, 5
  s_lshl_b32 s12, s9, 7
  s_add_u32 s10, s10, s12
  s_cmp_ge_u32 s86, 324
  s_cselect_b32 s10, 0x7f000000, s10
  v_mad_u32_u24 v9, v2, s11, v3
  v_add_u32 v9, s10, v9
  s_lshl_b32 s12, s11, 3
  s_add_u32 m0, s88, 0
  s_nop 0
  buffer_load_dwordx4 v9, s[64:67], 0 offen lds
  s_add_u32 m0, s88, 1024
  v_add_u32 v9, s12, v9
  buffer_load_dwordx4 v9, s[64:67], 0 offen lds
  s_add_u32 m0, s88, 2048
  v_add_u32 v9, s12, v9
  buffer_load_dwordx4 v9, s[64:67], 0 offen lds
  s_add_u32 m0, s88, 3072
  v_add_u32 v9, s12, v9
  buffer_load_dwordx4 v9, s[64:67], 0 offen lds
  s_add_u32 s88, s88, 4096
  s_cmp_ge_u32 s88, s90
  s_cselect_b32 s88, s96, s88
  s_add_u32 s86, s86, 256
  s_cmp_ge_u32 s86, 162
  s_cselect_b32 s15, 1, 0
  s_cselect_b32 s7, 162, 0
  s_sub_u32 s7, s86, s7
  s_mul_i32 s8, s7, 7282
  s_lshr_b32 s8, s8, 16
  s_mul_i32 s9, s8, 9
  s_sub_u32 s9, s7, s9
  s_movk_i32 s11, 1152
  s_cmp_eq_u32 s15, 1
  s_cselect_b32 s64, s52, s48
  s_cselect_b32 s65, s53, s49
  s_cselect_b32 s66, s54, s50
  s_cselect_b32 s67, s55, s51
  s_mul_i32 s10, s8, s11
  s_lshl_b32 s10, s10, 5
  s_lshl_b32 s12, s9, 7
  s_add_u32 s10, s10, s12
  s_cmp_ge_u32 s86, 324
  s_cselect_b32 s10, 0x7f000000, s10
  v_mad_u32_u24 v9, v2, s11, v3
  v_add_u32 v9, s10, v9
  s_lshl_b32 s12, s11, 3
  s_add_u32 m0, s88, 0
  s_nop 0
  buffer_load_dwordx4 v9, s[64:67], 0 offen lds
  s_add_u32 m0, s88, 1024
  v_add_u32 v9, s12, v9
  buffer_load_dwordx4 v9, s[64:67], 0 offen lds
  s_add_u32 m0, s88, 2048
  v_add_u32 v9, s12, v9
  buffer_load_dwordx4 v9, s[64:67], 0 offen lds
  s_add_u32 m0, s88, 3072
  v_add_u32 v9, s12, v9
  buffer_load_dwordx4 v9, s[64:67], 0 offen lds
  s_add_u32 s88, s88, 4096
  s_cmp_ge_u32 s88, s90
  s_cselect_b32 s88, s96, s88
  s_add_u32 s86, s86, 256
  s_cmp_ge_u32 s86, 162
  s_cselect_b32 s15, 1, 0
  s_cselect_b32 s7, 162, 0
  s_sub_u32 s7, s86, s7
  s_mul_i32 s8, s7, 7282
  s_lshr_b32 s8, s8, 16
  s_mul_i32 s9, s8, 9
  s_sub_u32 s9, s7, s9
  s_movk_i32 s11, 1152
  s_cmp_eq_u32 s15, 1
  s_cselect_b32 s64, s52, s48
  s_cselect_b32 s65, s53, s49
  s_cselect_b32 s66, s54, s50
  s_cselect_b32 s67, s55, s51
  s_mul_i32 s10, s8, s11
  s_lshl_b32 s10, s10, 5
  s_lshl_b32 s12, s9, 7
  s_add_u32 s10, s10, s12
  s_cmp_ge_u32 s86, 324
  s_cselect_b32 s10, 0x7f000000, s10
  v_mad_u32_u24 v9, v2, s11, v3
  v_add_u32 v9, s10, v9
  s_lshl_b32 s12, s11, 3
  s_add_u32 m0, s88, 0
  s_nop 0
  buffer_load_dwordx4 v9, s[64:67], 0 offen lds
  s_add_u32 m0, s88, 1024
  v_add_u32 v9, s12, v9
  buffer_load_dwordx4 v9, s[64:67], 0 offen lds
  s_add_u32 m0, s88, 2048
  v_add_u32 v9, s12, v9
  buffer_load_dwordx4 v9, s[64:67], 0 offen lds
  s_add_u32 m0, s88, 3072
  v_add_u32 v9, s12, v9
  buffer_load_dwordx4 v9, s[64:67], 0 offen lds
  s_add_u32 s88, s88, 4096
  s_cmp_ge_u32 s88, s90
  s_cselect_b32 s88, s96, s88
  s_add_u32 s86, s86, 256
L_pt_32:
  s_cmp_ge_u32 s87, 324
  s_cbranch_scc1 L_pt_done_33
  s_cmp_ge_u32 s86, 162
  s_cselect_b32 s15, 1, 0
  s_cselect_b32 s7, 162, 0
  s_sub_u32 s7, s86, s7
  s_mul_i32 s8, s7, 7282
  s_lshr_b32 s8, s8, 16
  s_mul_i32 s9, s8, 9
  s_sub_u32 s9, s7, s9
  s_movk_i32 s11, 1152
  s_cmp_eq_u32 s15, 1
  s_cselect_b32 s64, s52, s48
  s_cselect_b32 s65, s53, s49
  s_cselect_b32 s66, s54, s50
  s_cselect_b32 s67, s55, s51
  s_mul_i32 s10, s8, s11
  s_lshl_b32 s10, s10, 5
  s_lshl_b32 s12, s9, 7
  s_add_u32 s10, s10, s12
  s_cmp_ge_u32 s86, 324
  s_cselect_b32 s10, 0x7f000000, s10
  v_mad_u32_u24 v9, v2, s11, v3
  v_add_u32 v9, s10, v9
  s_lshl_b32 s12, s11, 3
  s_add_u32 m0, s88, 0
  s_nop 0
  buffer_load_dwordx4 v9, s[64:67], 0 offen lds
  s_add_u32 m0, s88, 1024
  v_add_u32 v9, s12, v9
  buffer_load_dwordx4 v9, s[64:67], 0 offen lds
  s_add_u32 m0, s88, 2048
  v_add_u32 v9, s12, v9
  buffer_load_dwordx4 v9, s[64:67], 0 offen lds
  s_add_u32 m0, s88, 3072
  v_add_u32 v9, s12, v9
  buffer_load_dwordx4 v9, s[64:67], 0 offen lds
  s_add_u32 s88, s88, 4096
  s_cmp_ge_u32 s88, s90
  s_cselect_b32 s88, s96, s88
  s_add_u32 s86, s86, 256
  s_waitcnt vmcnt(12)
  s_cmp_ge_u32 s87, 162
  s_cselect_b32 s15, 1, 0
  s_cselect_b32 s7, 162, 0
  s_sub_u32 s7, s87, s7
  s_mul_i32 s8, s7, 7282
  s_lshr_b32 s8, s8, 16
  s_mul_i32 s9, s8, 9
  s_sub_u32 s9, s7, s9
  s_movk_i32 s11, 1152
  s_cmp_eq_u32 s15, 1
  s_cselect_b32 s64, s52, s48
  s_cselect_b32 s65, s53, s49
  s_cselect_b32 s66, s54, s50
  s_cselect_b32 s67, s55, s51
  s_mul_i32 s10, s8, s11
  s_lshl_b32 s10, s10, 5
  s_lshl_b32 s12, s9, 7
  s_add_u32 s10, s10, s12
  s_cmp_ge_u32 s87, 324
  s_cselect_b32 s10, 0x7f000000, s10
  s_mul_i32 s12, s9, 73728
  s_lshl_b32 s13, s8, 10
  s_add_u32 s12, s12, s13
  s_mul_i32 s13, s15, 663552
  s_add_u32 s12, s12, s13
  s_add_u32 s80, s12, 0
  s_add_u32 s81, s12, 18432
  s_add_u32 s82, s12, 36864
  s_add_u32 s83, s12, 55296
  s_cmp_ge_u32 s87, 324
  s_cselect_b32 s80, 0x7f000000, s80
  s_cselect_b32 s81, 0x7f000000, s81
  s_cselect_b32 s82, 0x7f000000, s82
  s_cselect_b32 s83, 0x7f000000, s83
  v_add_u32 v10, s89, v6
  ds_read_b64_tr_b16 v[16:17], v10 offset:0
  ds_read_b64_tr_b16 v[18:19], v10 offset:512
  ds_read_b64_tr_b16 v[20:21], v10 offset:32
  ds_read_b64_tr_b16 v[22:23], v10 offset:544
  ds_read_b64_tr_b16 v[24:25], v10 offset:64
  ds_read_b64_tr_b16 v[26:27], v10 offset:576
  ds_read_b64_tr_b16 v[28:29], v10 offset:96
  ds_read_b64_tr_b16 v[30:31], v10 offset:608
  s_waitcnt lgkmcnt(0)
  v_add_u32 v11, s80, v8
  buffer_store_dwordx4 v[16:19], v11, s[68:71], 0 offen sc1
  s_nop 1
  v_add_u32 v11, s81, v8
  buffer_store_dwordx4 v[20:23], v11, s[68:71], 0 offen sc1
  s_nop 1
  v_add_u32 v11, s82, v8
  buffer_store_dwordx4 v[24:27], v11, s[68:71], 0 offen sc1
  s_nop 1
  v_add_u32 v11, s83, v8
  buffer_store_dwordx4 v[28:31], v11, s[68:71], 0 offen sc1
  s_add_u32 s89, s89, 4096
  s_cmp_ge_u32 s89, s90
  s_cselect_b32 s89, s96, s89
  s_add_u32 s87, s87, 256
  s_branch L_pt_32
L_pt_done_33:
  s_waitcnt vmcnt(0)
  s_waitcnt vmcnt(0) lgkmcnt(0)
  s_barrier
  s_cmp_lg_u32 s3, 0
  s_cbranch_scc1 L_arr_34
  s_mov_b32 s8, s44
  s_mov_b32 s9, s45
  s_mov_b32 s10, 0x100
  s_mov_b32 s11, 0x20000
  s_mov_b32 s77, 0
  v_mov_b32 v252, 0
L_rdy_35:
  buffer_load_dword v253, v252, s[8:11], 0 offen sc1
  s_waitcnt vmcnt(0)
  v_readfirstlane_b32 s76, v253
  s_nop 3
  s_cmp_lg_u32 s76, 0
  s_cbranch_scc1 L_rdy_done_36
  s_sleep 2
  s_add_u32 s77, s77, 1
  s_cmp_lt_u32 s77, 131072
  s_cbranch_scc1 L_rdy_35
L_rdy_done_36:
  s_mov_b64 exec, 1
  v_mov_b32 v252, 165376
  v_mov_b32 v253, 1
  buffer_atomic_add v253, v252, s[72:75], 0 offen sc1
L_ad_37:
  s_mov_b64 exec, -1
L_arr_34:
  s_cmp_lg_u32 s2, 255
  s_cbranch_scc1 L_nomon_38
  s_cmp_lg_u32 s3, 0
  s_cbranch_scc1 L_nomon_38
  s_mov_b32 s8, s44
  s_mov_b32 s9, s45
  s_mov_b32 s10, 0x100
  s_mov_b32 s11, 0x20000
  s_mov_b32 s77, 0
  v_mov_b32 v252, 0
L_rdy_39:
  buffer_load_dword v253, v252, s[8:11], 0 offen sc1
  s_waitcnt vmcnt(0)
  v_readfirstlane_b32 s76, v253
  s_nop 3
  s_cmp_lg_u32 s76, 0
  s_cbranch_scc1 L_rdy_done_40
  s_sleep 2
  s_add_u32 s77, s77, 1
  s_cmp_lt_u32 s77, 131072
  s_cbranch_scc1 L_rdy_39
L_rdy_done_40:
  v_mov_b32 v20, 0
  v_mov_b32 v21, 36
  v_mul_u32_u24 v22, 4352, v1
  v_add_u32 v20, v20, v22
  v_subrev_u32 v23, 16, v1
  v_mul_u32_u24 v23, 4352, v23
  v_add_u32 v23, 78336, v23
  v_cmp_le_u32 vcc, 16, v1
  s_nop 1
  v_cndmask_b32 v20, v20, v23, vcc
  v_mov_b32 v24, 0
  v_cndmask_b32 v21, v21, v24, vcc
  v_mov_b32 v23, 156672
  v_mov_b32 v24, 54
  v_cmp_eq_u32 vcc, 32, v1
  s_nop 1
  v_cndmask_b32 v20, v20, v23, vcc
  s_nop 0
  v_cndmask_b32 v21, v21, v24, vcc
  v_mov_b32 v23, 165376
  v_mov_b32 v24, 64
  v_cmp_eq_u32 vcc, 33, v1
  s_nop 1
  v_cndmask_b32 v20, v20, v23, vcc
  s_nop 0
  v_cndmask_b32 v21, v21, v24, vcc
  v_mov_b32 v23, 913920
  v_mov_b32 v24, 63
  v_cmp_eq_u32 vcc, 34, v1
  s_nop 1
  v_cndmask_b32 v20, v20, v23, vcc
  s_nop 0
  v_cndmask_b32 v21, v21, v24, vcc
  s_mov_b32 s9, 0
  s_mov_b32 s10, 0
  v_mov_b32 v25, 1
L_mon_41:
  s_mov_b32 exec_lo, -1
  s_mov_b32 exec_hi, 7
  buffer_load_dword v26, v20, s[72:75], 0 offen sc1
  s_waitcnt vmcnt(0)
  v_cmp_lt_u32 vcc, v26, v21
  s_nop 4
  s_mov_b64 s[6:7], vcc
  s_mov_b64 exec, 1
  s_bitcmp1_b32 s9, 0
  s_cbranch_scc1 L_ms_43
  s_and_b32 s8, s6, 0xffff
  s_cmp_lg_u32 s8, 0
  s_cbranch_scc1 L_ms_43
  v_mov_b32 v27, 73984
  buffer_store_dword v25, v27, s[72:75], 0 offen sc1
  s_bitset1_b32 s9, 0
L_ms_43:
  s_bitcmp1_b32 s9, 1
  s_cbranch_scc1 L_ms_44
  s_lshr_b32 s8, s6, 16
  s_cmp_lg_u32 s8, 0
  s_cbranch_scc1 L_ms_44
  v_mov_b32 v27, 152320
  buffer_store_dword v25, v27, s[72:75], 0 offen sc1
  s_bitset1_b32 s9, 1
L_ms_44:
  s_bitcmp1_b32 s9, 2
  s_cbranch_scc1 L_ms_45
  s_and_b32 s8, s7, 1
  s_cmp_lg_u32 s8, 0
  s_cbranch_scc1 L_ms_45
  v_mov_b32 v27, 161024
  buffer_store_dword v25, v27, s[72:75], 0 offen sc1
  s_bitset1_b32 s9, 2
L_ms_45:
  s_bitcmp1_b32 s9, 3
  s_cbranch_scc1 L_ms_46
  s_and_b32 s8, s7, 2
  s_cmp_lg_u32 s8, 0
  s_cbranch_scc1 L_ms_46
  v_mov_b32 v27, 169728
  buffer_store_dword v25, v27, s[72:75], 0 offen sc1
  s_bitset1_b32 s9, 3
L_ms_46:
  s_bitcmp1_b32 s9, 4
  s_cbranch_scc1 L_ms_47
  s_and_b32 s8, s7, 4
  s_cmp_lg_u32 s8, 0
  s_cbranch_scc1 L_ms_47
  v_mov_b32 v27, 918272
  buffer_store_dword v25, v27, s[72:75], 0 offen sc1
  s_bitset1_b32 s9, 4
L_ms_47:
  s_cmp_eq_u32 s9, 31
  s_cbranch_scc1 L_mon_done_42
  s_add_u32 s10, s10, 1
  s_cmp_lt_u32 s10, 131072
  s_cbranch_scc1 L_mon_41
L_mon_done_42:
  s_mov_b64 exec, -1
  s_waitcnt vmcnt(0)
L_nomon_38:
  s_cmp_eq_u32 s2, 255
  s_cbranch_scc1 L_pt_skip
  s_cmp_ge_u32 s2, 246
  s_cbranch_scc1 L_nomod_48
  s_sub_u32 s4, s2, 192
  s_mov_b32 s8, s38
  s_mov_b32 s9, s39
  s_mov_b32 s10, 0x480
  s_mov_b32 s11, 0x20000
  s_mov_b32 s52, s40
  s_mov_b32 s53, s41
  s_mov_b32 s54, 0x3cc000
  s_mov_b32 s55, 0x20000
  v_lshlrev_b32 v90, 1, v0
  buffer_load_ushort v172, v90, s[8:11], 0 offen offset:0
  buffer_load_ushort v173, v90, s[8:11], 0 offen offset:512
  buffer_load_ushort v174, v90, s[8:11], 0 offen offset:1024
  v_lshrrev_b32 v91, 3, v0
  v_and_b32 v92, 7, v0
  s_lshl_b32 s6, s4, 7
  v_lshl_add_u32 v93, v92, 4, s6
  s_movk_i32 s7, 6912
  v_mad_u32_u24 v93, v91, s7, v93
  buffer_load_dwordx4 v[100:103], v93, s[52:55], 0 offen
  v_add_u32 v93, 221184, v93
  buffer_load_dwordx4 v[104:107], v93, s[52:55], 0 offen
  v_add_u32 v93, 221184, v93
  buffer_load_dwordx4 v[108:111], v93, s[52:55], 0 offen
  v_add_u32 v93, 221184, v93
  buffer_load_dwordx4 v[112:115], v93, s[52:55], 0 offen
  v_add_u32 v93, 221184, v93
  buffer_load_dwordx4 v[116:119], v93, s[52:55], 0 offen
  v_add_u32 v93, 221184, v93
  buffer_load_dwordx4 v[120:123], v93, s[52:55], 0 offen
  v_add_u32 v93, 221184, v93
  buffer_load_dwordx4 v[124:127], v93, s[52:55], 0 offen
  v_add_u32 v93, 221184, v93
  buffer_load_dwordx4 v[128:131], v93, s[52:55], 0 offen
  v_add_u32 v93, 221184, v93
  buffer_load_dwordx4 v[132:135], v93, s[52:55], 0 offen
  v_add_u32 v93, 221184, v93
  buffer_load_dwordx4 v[136:139], v93, s[52:55], 0 offen
  v_add_u32 v93, 221184, v93
  buffer_load_dwordx4 v[140:143], v93, s[52:55], 0 offen
  v_add_u32 v93, 221184, v93
  buffer_load_dwordx4 v[144:147], v93, s[52:55], 0 offen
  v_add_u32 v93, 221184, v93
  buffer_load_dwordx4 v[148:151], v93, s[52:55], 0 offen
  v_add_u32 v93, 221184, v93
  buffer_load_dwordx4 v[152:155], v93, s[52:55], 0 offen
  v_add_u32 v93, 221184, v93
  buffer_load_dwordx4 v[156:159], v93, s[52:55], 0 offen
  v_add_u32 v93, 221184, v93
  buffer_load_dwordx4 v[160:163], v93, s[52:55], 0 offen
  v_add_u32 v93, 221184, v93
  buffer_load_dwordx4 v[164:167], v93, s[52:55], 0 offen
  v_add_u32 v93, 221184, v93
  buffer_load_dwordx4 v[168:171], v93, s[52:55], 0 offen
  s_sub_u32 s4, s2, 192
  s_add_u32 s52, s46, 0x680000
  s_addc_u32 s53, s47, 0
  s_mov_b32 s54, 0x3600
  s_mov_b32 s55, 0x20000
  v_lshrrev_b32 v8, 3, v0
  v_and_b32 v9, 7, v0
  s_mov_b32 s8, 0xbfb8aa3b
  v_lshlrev_b32 v12, 2, v0
  v_add_u32 v12, 131072, v12
  s_waitcnt vmcnt(20)
  v_lshlrev_b32 v172, 16, v172
  v_mul_f32 v13, s8, v172
  v_exp_f32 v13, v13
  s_nop 0
  v_add_f32 v13, 1.0, v13
  v_rcp_f32 v13, v13
  s_nop 0
  v_mul_f32 v13, v172, v13
  v_cvt_pk_bf16_f32 v13, v13, v13
  v_lshlrev_b32 v13, 16, v13
  ds_write_b32 v12, v13 offset:0
  s_waitcnt vmcnt(19)
  v_lshlrev_b32 v173, 16, v173
  v_mul_f32 v13, s8, v173
  v_exp_f32 v13, v13
  s_nop 0
  v_add_f32 v13, 1.0, v13
  v_rcp_f32 v13, v13
  s_nop 0
  v_mul_f32 v13, v173, v13
  v_cvt_pk_bf16_f32 v13, v13, v13
  v_lshlrev_b32 v13, 16, v13
  ds_write_b32 v12, v13 offset:1024
  s_waitcnt vmcnt(18)
  v_lshlrev_b32 v174, 16, v174
  v_mul_f32 v13, s8, v174
  v_exp_f32 v13, v13
  s_nop 0
  v_add_f32 v13, 1.0, v13
  v_rcp_f32 v13, v13
  s_nop 0
  v_mul_f32 v13, v174, v13
  v_cvt_pk_bf16_f32 v13, v13, v13
  v_lshlrev_b32 v13, 16, v13
  ds_write_b32 v12, v13 offset:2048
  s_waitcnt lgkmcnt(0)
  s_barrier
  v_lshlrev_b32 v14, 2, v8
  v_add_u32 v14, 131072, v14
  ds_read_b32 v40, v14 offset:0
  ds_read_b32 v41, v14 offset:128
  ds_read_b32 v42, v14 offset:256
  ds_read_b32 v43, v14 offset:384
  ds_read_b32 v44, v14 offset:512
  ds_read_b32 v45, v14 offset:640
  ds_read_b32 v46, v14 offset:768
  ds_read_b32 v47, v14 offset:896
  ds_read_b32 v48, v14 offset:1024
  ds_read_b32 v49, v14 offset:1152
  ds_read_b32 v50, v14 offset:1280
  ds_read_b32 v51, v14 offset:1408
  ds_read_b32 v52, v14 offset:1536
  ds_read_b32 v53, v14 offset:1664
  ds_read_b32 v54, v14 offset:1792
  ds_read_b32 v55, v14 offset:1920
  ds_read_b32 v56, v14 offset:2048
  ds_read_b32 v57, v14 offset:2176
  s_mov_b32 s10, 0xffff0000
  s_waitcnt vmcnt(17)
  v_lshlrev_b32 v24, 16, v100
  v_and_b32 v25, s10, v100
  v_lshlrev_b32 v26, 16, v101
  v_and_b32 v27, s10, v101
  v_lshlrev_b32 v28, 16, v102
  v_and_b32 v29, s10, v102
  v_lshlrev_b32 v30, 16, v103
  v_and_b32 v31, s10, v103
  s_waitcnt lgkmcnt(15)
  v_pk_mul_f32 v[16:17], v[24:25], v[40:41] op_sel_hi:[1,0]
  v_pk_mul_f32 v[18:19], v[26:27], v[40:41] op_sel_hi:[1,0]
  v_pk_mul_f32 v[20:21], v[28:29], v[40:41] op_sel_hi:[1,0]
  v_pk_mul_f32 v[22:23], v[30:31], v[40:41] op_sel_hi:[1,0]
  s_waitcnt vmcnt(16)
  v_lshlrev_b32 v24, 16, v104
  v_and_b32 v25, s10, v104
  v_lshlrev_b32 v26, 16, v105
  v_and_b32 v27, s10, v105
  v_lshlrev_b32 v28, 16, v106
  v_and_b32 v29, s10, v106
  v_lshlrev_b32 v30, 16, v107
  v_and_b32 v31, s10, v107
  v_pk_fma_f32 v[16:17], v[24:25], v[40:41], v[16:17] op_sel:[0,1,0] op_sel_hi:[1,1,1]
  v_pk_fma_f32 v[18:19], v[26:27], v[40:41], v[18:19] op_sel:[0,1,0] op_sel_hi:[1,1,1]
  v_pk_fma_f32 v[20:21], v[28:29], v[40:41], v[20:21] op_sel:[0,1,0] op_sel_hi:[1,1,1]
  v_pk_fma_f32 v[22:23], v[30:31], v[40:41], v[22:23] op_sel:[0,1,0] op_sel_hi:[1,1,1]
  s_waitcnt vmcnt(15)
  v_lshlrev_b32 v24, 16, v108
  v_and_b32 v25, s10, v108
  v_lshlrev_b32 v26, 16, v109
  v_and_b32 v27, s10, v109
  v_lshlrev_b32 v28, 16, v110
  v_and_b32 v29, s10, v110
  v_lshlrev_b32 v30, 16, v111
  v_and_b32 v31, s10, v111
  s_waitcnt lgkmcnt(14)
  v_pk_fma_f32 v[16:17], v[24:25], v[42:43], v[16:17] op_sel_hi:[1,0,1]
  v_pk_fma_f32 v[18:19], v[26:27], v[42:43], v[18:19] op_sel_hi:[1,0,1]
  v_pk_fma_f32 v[20:21], v[28:29], v[42:43], v[20:21] op_sel_hi:[1,0,1]
  v_pk_fma_f32 v[22:23], v[30:31], v[42:43], v[22:23] op_sel_hi:[1,0,1]
  s_waitcnt vmcnt(14)
  v_lshlrev_b32 v24, 16, v112
  v_and_b32 v25, s10, v112
  v_lshlrev_b32 v26, 16, v113
  v_and_b32 v27, s10, v113
  v_lshlrev_b32 v28, 16, v114
  v_and_b32 v29, s10, v114
  v_lshlrev_b32 v30, 16, v115
  v_and_b32 v31, s10, v115
  v_pk_fma_f32 v[16:17], v[24:25], v[42:43], v[16:17] op_sel:[0,1,0] op_sel_hi:[1,1,1]
  v_pk_fma_f32 v[18:19], v[26:27], v[42:43], v[18:19] op_sel:[0,1,0] op_sel_hi:[1,1,1]
  v_pk_fma_f32 v[20:21], v[28:29], v[42:43], v[20:21] op_sel:[0,1,0] op_sel_hi:[1,1,1]
  v_pk_fma_f32 v[22:23], v[30:31], v[42:43], v[22:23] op_sel:[0,1,0] op_sel_hi:[1,1,1]
  s_waitcnt vmcnt(13)
  v_lshlrev_b32 v24, 16, v116
  v_and_b32 v25, s10, v116
  v_lshlrev_b32 v26, 16, v117
  v_and_b32 v27, s10, v117
  v_lshlrev_b32 v28, 16, v118
  v_and_b32 v29, s10, v118
  v_lshlrev_b32 v30, 16, v119
  v_and_b32 v31, s10, v119
  s_waitcnt lgkmcnt(12)
  v_pk_fma_f32 v[16:17], v[24:25], v[44:45], v[16:17] op_sel_hi:[1,0,1]
  v_pk_fma_f32 v[18:19], v[26:27], v[44:45], v[18:19] op_sel_hi:[1,0,1]
  v_pk_fma_f32 v[20:21], v[28:29], v[44:45], v[20:21] op_sel_hi:[1,0,1]
  v_pk_fma_f32 v[22:23], v[30:31], v[44:45], v[22:23] op_sel_hi:[1,0,1]
  s_waitcnt vmcnt(12)
  v_lshlrev_b32 v24, 16, v120
  v_and_b32 v25, s10, v120
  v_lshlrev_b32 v26, 16, v121
  v_and_b32 v27, s10, v121
  v_lshlrev_b32 v28, 16, v122
  v_and_b32 v29, s10, v122
  v_lshlrev_b32 v30, 16, v123
  v_and_b32 v31, s10, v123
  v_pk_fma_f32 v[16:17], v[24:25], v[44:45], v[16:17] op_sel:[0,1,0] op_sel_hi:[1,1,1]
  v_pk_fma_f32 v[18:19], v[26:27], v[44:45], v[18:19] op_sel:[0,1,0] op_sel_hi:[1,1,1]
  v_pk_fma_f32 v[20:21], v[28:29], v[44:45], v[20:21] op_sel:[0,1,0] op_sel_hi:[1,1,1]
  v_pk_fma_f32 v[22:23], v[30:31], v[44:45], v[22:23] op_sel:[0,1,0] op_sel_hi:[1,1,1]
  s_waitcnt vmcnt(11)
  v_lshlrev_b32 v24, 16, v124
  v_and_b32 v25, s10, v124
  v_lshlrev_b32 v26, 16, v125
  v_and_b32 v27, s10, v125
  v_lshlrev_b32 v28, 16, v126
  v_and_b32 v29, s10, v126
  v_lshlrev_b32 v30, 16, v127
  v_and_b32 v31, s10, v127
  s_waitcnt lgkmcnt(10)
  v_pk_fma_f32 v[16:17], v[24:25], v[46:47], v[16:17] op_sel_hi:[1,0,1]
  v_pk_fma_f32 v[18:19], v[26:27], v[46:47], v[18:19] op_sel_hi:[1,0,1]
  v_pk_fma_f32 v[20:21], v[28:29], v[46:47], v[20:21] op_sel_hi:[1,0,1]
  v_pk_fma_f32 v[22:23], v[30:31], v[46:47], v[22:23] op_sel_hi:[1,0,1]
  s_waitcnt vmcnt(10)
  v_lshlrev_b32 v24, 16, v128
  v_and_b32 v25, s10, v128
  v_lshlrev_b32 v26, 16, v129
  v_and_b32 v27, s10, v129
  v_lshlrev_b32 v28, 16, v130
  v_and_b32 v29, s10, v130
  v_lshlrev_b32 v30, 16, v131
  v_and_b32 v31, s10, v131
  v_pk_fma_f32 v[16:17], v[24:25], v[46:47], v[16:17] op_sel:[0,1,0] op_sel_hi:[1,1,1]
  v_pk_fma_f32 v[18:19], v[26:27], v[46:47], v[18:19] op_sel:[0,1,0] op_sel_hi:[1,1,1]
  v_pk_fma_f32 v[20:21], v[28:29], v[46:47], v[20:21] op_sel:[0,1,0] op_sel_hi:[1,1,1]
  v_pk_fma_f32 v[22:23], v[30:31], v[46:47], v[22:23] op_sel:[0,1,0] op_sel_hi:[1,1,1]
  s_waitcnt vmcnt(9)
  v_lshlrev_b32 v24, 16, v132
  v_and_b32 v25, s10, v132
  v_lshlrev_b32 v26, 16, v133
  v_and_b32 v27, s10, v133
  v_lshlrev_b32 v28, 16, v134
  v_and_b32 v29, s10, v134
  v_lshlrev_b32 v30, 16, v135
  v_and_b32 v31, s10, v135
  s_waitcnt lgkmcnt(8)
  v_pk_fma_f32 v[16:17], v[24:25], v[48:49], v[16:17] op_sel_hi:[1,0,1]
  v_pk_fma_f32 v[18:19], v[26:27], v[48:49], v[18:19] op_sel_hi:[1,0,1]
  v_pk_fma_f32 v[20:21], v[28:29], v[48:49], v[20:21] op_sel_hi:[1,0,1]
  v_pk_fma_f32 v[22:23], v[30:31], v[48:49], v[22:23] op_sel_hi:[1,0,1]
  s_waitcnt vmcnt(8)
  v_lshlrev_b32 v24, 16, v136
  v_and_b32 v25, s10, v136
  v_lshlrev_b32 v26, 16, v137
  v_and_b32 v27, s10, v137
  v_lshlrev_b32 v28, 16, v138
  v_and_b32 v29, s10, v138
  v_lshlrev_b32 v30, 16, v139
  v_and_b32 v31, s10, v139
  v_pk_fma_f32 v[16:17], v[24:25], v[48:49], v[16:17] op_sel:[0,1,0] op_sel_hi:[1,1,1]
  v_pk_fma_f32 v[18:19], v[26:27], v[48:49], v[18:19] op_sel:[0,1,0] op_sel_hi:[1,1,1]
  v_pk_fma_f32 v[20:21], v[28:29], v[48:49], v[20:21] op_sel:[0,1,0] op_sel_hi:[1,1,1]
  v_pk_fma_f32 v[22:23], v[30:31], v[48:49], v[22:23] op_sel:[0,1,0] op_sel_hi:[1,1,1]
  s_waitcnt vmcnt(7)
  v_lshlrev_b32 v24, 16, v140
  v_and_b32 v25, s10, v140
  v_lshlrev_b32 v26, 16, v141
  v_and_b32 v27, s10, v141
  v_lshlrev_b32 v28, 16, v142
  v_and_b32 v29, s10, v142
  v_lshlrev_b32 v30, 16, v143
  v_and_b32 v31, s10, v143
  s_waitcnt lgkmcnt(6)
  v_pk_fma_f32 v[16:17], v[24:25], v[50:51], v[16:17] op_sel_hi:[1,0,1]
  v_pk_fma_f32 v[18:19], v[26:27], v[50:51], v[18:19] op_sel_hi:[1,0,1]
  v_pk_fma_f32 v[20:21], v[28:29], v[50:51], v[20:21] op_sel_hi:[1,0,1]
  v_pk_fma_f32 v[22:23], v[30:31], v[50:51], v[22:23] op_sel_hi:[1,0,1]
  s_waitcnt vmcnt(6)
  v_lshlrev_b32 v24, 16, v144
  v_and_b32 v25, s10, v144
  v_lshlrev_b32 v26, 16, v145
  v_and_b32 v27, s10, v145
  v_lshlrev_b32 v28, 16, v146
  v_and_b32 v29, s10, v146
  v_lshlrev_b32 v30, 16, v147
  v_and_b32 v31, s10, v147
  v_pk_fma_f32 v[16:17], v[24:25], v[50:51], v[16:17] op_sel:[0,1,0] op_sel_hi:[1,1,1]
  v_pk_fma_f32 v[18:19], v[26:27], v[50:51], v[18:19] op_sel:[0,1,0] op_sel_hi:[1,1,1]
  v_pk_fma_f32 v[20:21], v[28:29], v[50:51], v[20:21] op_sel:[0,1,0] op_sel_hi:[1,1,1]
  v_pk_fma_f32 v[22:23], v[30:31], v[50:51], v[22:23] op_sel:[0,1,0] op_sel_hi:[1,1,1]
  s_waitcnt vmcnt(5)
  v_lshlrev_b32 v24, 16, v148
  v_and_b32 v25, s10, v148
  v_lshlrev_b32 v26, 16, v149
  v_and_b32 v27, s10, v149
  v_lshlrev_b32 v28, 16, v150
  v_and_b32 v29, s10, v150
  v_lshlrev_b32 v30, 16, v151
  v_and_b32 v31, s10, v151
  s_waitcnt lgkmcnt(4)
  v_pk_fma_f32 v[16:17], v[24:25], v[52:53], v[16:17] op_sel_hi:[1,0,1]
  v_pk_fma_f32 v[18:19], v[26:27], v[52:53], v[18:19] op_sel_hi:[1,0,1]
  v_pk_fma_f32 v[20:21], v[28:29], v[52:53], v[20:21] op_sel_hi:[1,0,1]
  v_pk_fma_f32 v[22:23], v[30:31], v[52:53], v[22:23] op_sel_hi:[1,0,1]
  s_waitcnt vmcnt(4)
  v_lshlrev_b32 v24, 16, v152
  v_and_b32 v25, s10, v152
  v_lshlrev_b32 v26, 16, v153
  v_and_b32 v27, s10, v153
  v_lshlrev_b32 v28, 16, v154
  v_and_b32 v29, s10, v154
  v_lshlrev_b32 v30, 16, v155
  v_and_b32 v31, s10, v155
  v_pk_fma_f32 v[16:17], v[24:25], v[52:53], v[16:17] op_sel:[0,1,0] op_sel_hi:[1,1,1]
  v_pk_fma_f32 v[18:19], v[26:27], v[52:53], v[18:19] op_sel:[0,1,0] op_sel_hi:[1,1,1]
  v_pk_fma_f32 v[20:21], v[28:29], v[52:53], v[20:21] op_sel:[0,1,0] op_sel_hi:[1,1,1]
  v_pk_fma_f32 v[22:23], v[30:31], v[52:53], v[22:23] op_sel:[0,1,0] op_sel_hi:[1,1,1]
  s_waitcnt vmcnt(3)
  v_lshlrev_b32 v24, 16, v156
  v_and_b32 v25, s10, v156
  v_lshlrev_b32 v26, 16, v157
  v_and_b32 v27, s10, v157
  v_lshlrev_b32 v28, 16, v158
  v_and_b32 v29, s10, v158
  v_lshlrev_b32 v30, 16, v159
  v_and_b32 v31, s10, v159
  s_waitcnt lgkmcnt(2)
  v_pk_fma_f32 v[16:17], v[24:25], v[54:55], v[16:17] op_sel_hi:[1,0,1]
  v_pk_fma_f32 v[18:19], v[26:27], v[54:55], v[18:19] op_sel_hi:[1,0,1]
  v_pk_fma_f32 v[20:21], v[28:29], v[54:55], v[20:21] op_sel_hi:[1,0,1]
  v_pk_fma_f32 v[22:23], v[30:31], v[54:55], v[22:23] op_sel_hi:[1,0,1]
  s_waitcnt vmcnt(2)
  v_lshlrev_b32 v24, 16, v160
  v_and_b32 v25, s10, v160
  v_lshlrev_b32 v26, 16, v161
  v_and_b32 v27, s10, v161
  v_lshlrev_b32 v28, 16, v162
  v_and_b32 v29, s10, v162
  v_lshlrev_b32 v30, 16, v163
  v_and_b32 v31, s10, v163
  v_pk_fma_f32 v[16:17], v[24:25], v[54:55], v[16:17] op_sel:[0,1,0] op_sel_hi:[1,1,1]
  v_pk_fma_f32 v[18:19], v[26:27], v[54:55], v[18:19] op_sel:[0,1,0] op_sel_hi:[1,1,1]
  v_pk_fma_f32 v[20:21], v[28:29], v[54:55], v[20:21] op_sel:[0,1,0] op_sel_hi:[1,1,1]
  v_pk_fma_f32 v[22:23], v[30:31], v[54:55], v[22:23] op_sel:[0,1,0] op_sel_hi:[1,1,1]
  s_waitcnt vmcnt(1)
  v_lshlrev_b32 v24, 16, v164
  v_and_b32 v25, s10, v164
  v_lshlrev_b32 v26, 16, v165
  v_and_b32 v27, s10, v165
  v_lshlrev_b32 v28, 16, v166
  v_and_b32 v29, s10, v166
  v_lshlrev_b32 v30, 16, v167
  v_and_b32 v31, s10, v167
  s_waitcnt lgkmcnt(0)
  v_pk_fma_f32 v[16:17], v[24:25], v[56:57], v[16:17] op_sel_hi:[1,0,1]
  v_pk_fma_f32 v[18:19], v[26:27], v[56:57], v[18:19] op_sel_hi:[1,0,1]
  v_pk_fma_f32 v[20:21], v[28:29], v[56:57], v[20:21] op_sel_hi:[1,0,1]
  v_pk_fma_f32 v[22:23], v[30:31], v[56:57], v[22:23] op_sel_hi:[1,0,1]
  s_waitcnt vmcnt(0)
  v_lshlrev_b32 v24, 16, v168
  v_and_b32 v25, s10, v168
  v_lshlrev_b32 v26, 16, v169
  v_and_b32 v27, s10, v169
  v_lshlrev_b32 v28, 16, v170
  v_and_b32 v29, s10, v170
  v_lshlrev_b32 v30, 16, v171
  v_and_b32 v31, s10, v171
  v_pk_fma_f32 v[16:17], v[24:25], v[56:57], v[16:17] op_sel:[0,1,0] op_sel_hi:[1,1,1]
  v_pk_fma_f32 v[18:19], v[26:27], v[56:57], v[18:19] op_sel:[0,1,0] op_sel_hi:[1,1,1]
  v_pk_fma_f32 v[20:21], v[28:29], v[56:57], v[20:21] op_sel:[0,1,0] op_sel_hi:[1,1,1]
  v_pk_fma_f32 v[22:23], v[30:31], v[56:57], v[22:23] op_sel:[0,1,0] op_sel_hi:[1,1,1]
  v_lshlrev_b32 v15, 8, v8
  v_lshl_add_u32 v15, v9, 5, v15
  v_add_u32 v15, 131072, v15
  ds_write_b128 v15, v[16:19] offset:4096
  ds_write_b128 v15, v[20:23] offset:4112
  s_waitcnt lgkmcnt(0)
  s_barrier
  s_cmp_lg_u32 s3, 0
  s_cbranch_scc1 L_mod_skip_49
  v_lshlrev_b32 v14, 2, v0
  v_add_u32 v14, 131072, v14
  ds_read_b32 v40, v14 offset:4096
  ds_read_b32 v41, v14 offset:4352
  ds_read_b32 v42, v14 offset:4608
  ds_read_b32 v43, v14 offset:4864
  ds_read_b32 v44, v14 offset:5120
  ds_read_b32 v45, v14 offset:5376
  ds_read_b32 v46, v14 offset:5632
  ds_read_b32 v47, v14 offset:5888
  ds_read_b32 v48, v14 offset:6144
  ds_read_b32 v49, v14 offset:6400
  ds_read_b32 v50, v14 offset:6656
  ds_read_b32 v51, v14 offset:6912
  ds_read_b32 v52, v14 offset:7168
  ds_read_b32 v53, v14 offset:7424
  ds_read_b32 v54, v14 offset:7680
  ds_read_b32 v55, v14 offset:7936
  ds_read_b32 v56, v14 offset:8192
  ds_read_b32 v57, v14 offset:8448
  ds_read_b32 v58, v14 offset:8704
  ds_read_b32 v59, v14 offset:8960
  ds_read_b32 v60, v14 offset:9216
  ds_read_b32 v61, v14 offset:9472
  ds_read_b32 v62, v14 offset:9728
  ds_read_b32 v63, v14 offset:9984
  ds_read_b32 v64, v14 offset:10240
  ds_read_b32 v65, v14 offset:10496
  ds_read_b32 v66, v14 offset:10752
  ds_read_b32 v67, v14 offset:11008
  ds_read_b32 v68, v14 offset:11264
  ds_read_b32 v69, v14 offset:11520
  ds_read_b32 v70, v14 offset:11776
  ds_read_b32 v71, v14 offset:12032
  s_waitcnt lgkmcnt(15)
  v_add_f32 v40, v40, v56
  s_waitcnt lgkmcnt(14)
  v_add_f32 v41, v41, v57
  s_waitcnt lgkmcnt(13)
  v_add_f32 v42, v42, v58
  s_waitcnt lgkmcnt(12)
  v_add_f32 v43, v43, v59
  s_waitcnt lgkmcnt(11)
  v_add_f32 v44, v44, v60
  s_waitcnt lgkmcnt(10)
  v_add_f32 v45, v45, v61
  s_waitcnt lgkmcnt(9)
  v_add_f32 v46, v46, v62
  s_waitcnt lgkmcnt(8)
  v_add_f32 v47, v47, v63
  s_waitcnt lgkmcnt(7)
  v_add_f32 v48, v48, v64
  s_waitcnt lgkmcnt(6)
  v_add_f32 v49, v49, v65
  s_waitcnt lgkmcnt(5)
  v_add_f32 v50, v50, v66
  s_waitcnt lgkmcnt(4)
  v_add_f32 v51, v51, v67
  s_waitcnt lgkmcnt(3)
  v_add_f32 v52, v52, v68
  s_waitcnt lgkmcnt(2)
  v_add_f32 v53, v53, v69
  s_waitcnt lgkmcnt(1)
  v_add_f32 v54, v54, v70
  s_waitcnt lgkmcnt(0)
  v_add_f32 v55, v55, v71
  v_add_f32 v40, v40, v48
  v_add_f32 v41, v41, v49
  v_add_f32 v42, v42, v50
  v_add_f32 v43, v43, v51
  v_add_f32 v44, v44, v52
  v_add_f32 v45, v45, v53
  v_add_f32 v46, v46, v54
  v_add_f32 v47, v47, v55
  v_add_f32 v40, v40, v44
  v_add_f32 v41, v41, v45
  v_add_f32 v42, v42, v46
  v_add_f32 v43, v43, v47
  v_add_f32 v40, v40, v42
  v_add_f32 v41, v41, v43
  v_add_f32 v40, v40, v41
  v_mov_b32 v16, v40
  v_cvt_pk_bf16_f32 v16, v16, v16
  v_lshlrev_b32 v16, 16, v16
  s_mul_i32 s9, s4, 7282
  s_lshr_b32 s9, s9, 16
  s_cmp_eq_u32 s9, 1
  s_cselect_b32 s11, 1, 0
  s_cmp_eq_u32 s9, 4
  s_cselect_b32 s11, 1, s11
  v_cvt_f32_u32 v17, s11
  v_add_f32 v16, v16, v17
  v_cvt_pk_bf16_f32 v16, v16, v16
  v_lshlrev_b32 v16, 16, v16
  s_lshl_b32 s6, s4, 8
  v_lshl_add_u32 v18, v0, 2, s6
  buffer_store_dword v16, v18, s[52:55], 0 offen sc1
L_mod_skip_49:
  s_waitcnt vmcnt(0) lgkmcnt(0)
  s_barrier
  s_cmp_lg_u32 s3, 0
  s_cbranch_scc1 L_arr_50
  s_mov_b64 exec, 1
  v_mov_b32 v252, 156672
  v_mov_b32 v253, 1
  buffer_atomic_add v253, v252, s[72:75], 0 offen sc1
L_ad_51:
  s_mov_b64 exec, -1
L_arr_50:
L_nomod_48:
  s_barrier
  s_mov_b32 s56, s34
  s_mov_b32 s57, s35
  s_mov_b32 s58, 0x510000
  s_mov_b32 s59, 0x20000
  s_mov_b32 s60, s36
  s_mov_b32 s61, s37
  s_mov_b32 s62, 0x510000
  s_mov_b32 s63, 0x20000
  s_add_u32 s68, s46, 0xf84000
  s_addc_u32 s69, s47, 0
  s_mov_b32 s70, 0xb64000
  s_mov_b32 s71, 0x20000
  s_sub_u32 s78, s2, 192
  s_lshl_b32 s78, s78, 2
  s_add_u32 s78, s78, s3
  s_mov_b32 s79, s78
  s_add_u32 s78, s78, 216
  s_cmp_ge_u32 s79, 216
  s_cselect_b32 s78, 511, s78
  s_cselect_b32 s79, 511, s79
  s_mov_b32 s77, 0
  s_cmp_ge_u32 s79, 432
  s_cbranch_scc1 L_a12_52
  s_cmp_ge_u32 s79, 216
  s_cbranch_scc1 L_t4_54
  s_mul_i32 s8, s79, 21846
  s_lshr_b32 s8, s8, 16
  s_mul_i32 s9, s8, 3
  s_sub_u32 s9, s79, s9
  s_mul_i32 s84, s9, 1769472
  s_lshl_b32 s10, s8, 7
  s_add_u32 s84, s84, s10
  s_mov_b32 s85, 294912
  s_movk_i32 s86, 9216
  s_mov_b32 s88, 0
  s_mul_i32 s10, s8, 7282
  s_lshr_b32 s10, s10, 16
  s_mul_i32 s11, s10, 9
  s_sub_u32 s11, s8, s11
  s_mov_b32 s12, 0
  s_branch L_tc_55
L_t4_54:
  s_sub_u32 s7, s79, 216
  s_mul_i32 s10, s7, 2428
  s_lshr_b32 s10, s10, 16
  s_mul_i32 s9, s10, 27
  s_sub_u32 s7, s7, s9
  s_mul_i32 s11, s7, 21846
  s_lshr_b32 s11, s11, 16
  s_mul_i32 s9, s11, 3
  s_sub_u32 s9, s7, s9
  s_mul_i32 s6, s10, 18
  s_mul_i32 s7, s9, 6
  s_add_u32 s6, s6, s7
  s_mul_i32 s84, s6, 36864
  s_lshl_b32 s6, s11, 7
  s_add_u32 s84, s84, s6
  s_mov_b32 s85, 36864
  s_movk_i32 s86, 1152
  s_mov_b32 s88, 1
  s_movk_i32 s12, 162
L_tc_55:
  s_sub_u32 s6, s11, 5
  s_cmp_lt_u32 s11, 4
  s_cselect_b32 s6, s11, s6
  s_lshl_b32 s7, s10, 2
  s_add_u32 s7, s7, s6
  s_mul_i32 s7, s7, 324
  s_add_u32 s7, s7, s12
  s_cmp_eq_u32 s88, 1
  s_cbranch_scc1 L_d4_56
  s_cmp_le_u32 s11, 4
  s_cselect_b32 s87, 5, 4
  s_cselect_b32 s8, 0, 90
  s_mov_b32 s89, s87
  s_add_u32 s80, s8, 0
  s_add_u32 s81, s8, 2
  s_add_u32 s82, s8, 1
  s_add_u32 s83, s8, 3
  s_mov_b32 s8, 4
  s_branch L_ddone_57
L_d4_56:
  s_cmp_le_u32 s11, 4
  s_cselect_b32 s87, 3, 2
  s_cselect_b32 s80, 0, 90
  s_cselect_b32 s82, 54, 126
  s_mov_b32 s89, 2
  s_add_u32 s81, s80, 1
  s_add_u32 s83, s82, 1
  s_mov_b32 s8, 2
L_ddone_57:
  s_mul_i32 s9, s9, 6
  s_cmp_eq_u32 s11, 4
  s_cbranch_scc1 L_ts_58
  s_mul_i32 s6, s9, s87
  s_add_u32 s6, s6, s7
  s_add_u32 s80, s80, s6
  s_lshl_b32 s80, s80, 10
  s_add_u32 s80, s80, 1327104
  s_mul_i32 s6, s9, s87
  s_add_u32 s6, s6, s7
  s_add_u32 s81, s81, s6
  s_lshl_b32 s81, s81, 10
  s_add_u32 s81, s81, 1327104
  s_mul_i32 s6, s9, s89
  s_add_u32 s6, s6, s7
  s_add_u32 s82, s82, s6
  s_lshl_b32 s82, s82, 10
  s_add_u32 s82, s82, 1327104
  s_mul_i32 s6, s9, s89
  s_add_u32 s6, s6, s7
  s_add_u32 s83, s83, s6
  s_lshl_b32 s83, s83, 10
  s_add_u32 s83, s83, 1327104
  s_branch L_td_59
L_ts_58:
  s_add_u32 s88, s88, 2
  s_mov_b32 s89, s87
  s_lshl_b32 s7, s10, 2
  s_mul_i32 s7, s7, 324
  s_add_u32 s7, s7, s12
  s_add_u32 s7, s7, s8
  s_mul_i32 s6, s9, s87
  s_add_u32 s7, s7, s6
  s_lshl_b32 s7, s7, 10
  s_add_u32 s7, s7, 1327104
  s_add_u32 s80, s7, 0
  s_add_u32 s81, s7, 331776
  s_add_u32 s82, s7, 663552
  s_add_u32 s83, s7, 995328
L_td_59:
  s_lshl_b32 s87, s87, 10
  s_lshl_b32 s89, s89, 10
  s_cmp_ge_u32 s79, 432
  s_cselect_b32 s80, 0x7f000000, s80
  s_cselect_b32 s81, 0x7f000000, s81
  s_cselect_b32 s82, 0x7f000000, s82
  s_cselect_b32 s83, 0x7f000000, s83
  s_cselect_b32 s84, 0x7f000000, s84
  s_cselect_b32 s85, 0, s85
  s_cselect_b32 s87, 0, s87
  s_cselect_b32 s89, 0, s89
  s_bitcmp1_b32 s88, 0
  s_cselect_b32 s64, s60, s56
  s_cselect_b32 s65, s61, s57
  s_cselect_b32 s66, s62, s58
  s_cselect_b32 s67, s63, s59
  s_branch L_adone_53
L_a12_52:
  s_sub_u32 s79, s79, 432
  s_cmp_ge_u32 s79, 27
  s_cselect_b32 s10, 1, 0
  s_cselect_b32 s7, 27, 0
  s_sub_u32 s7, s79, s7
  s_mul_i32 s8, s7, 21846
  s_lshr_b32 s8, s8, 16
  s_mul_i32 s9, s8, 3
  s_sub_u32 s9, s7, s9
  s_mul_i32 s84, s9, 221184
  s_lshl_b32 s6, s8, 7
  s_add_u32 s84, s84, s6
  s_mov_b32 s85, 36864
  s_movk_i32 s86, 1152
  s_movk_i32 s87, 1024
  s_mov_b32 s88, 2
  s_mul_i32 s7, s8, 72
  s_mul_i32 s6, s9, 6
  s_add_u32 s7, s7, s6
  s_lshl_b32 s7, s7, 10
  s_mul_i32 s6, s10, 663552
  s_add_u32 s7, s7, s6
  s_add_u32 s80, s7, 0
  s_add_u32 s81, s7, 18432
  s_add_u32 s82, s7, 36864
  s_add_u32 s83, s7, 55296
  s_cmp_eq_u32 s10, 1
  s_cselect_b32 s64, s32, s30
  s_cselect_b32 s65, s33, s31
  s_mov_b32 s66, 663552
  s_mov_b32 s67, 0x20000
  s_cmp_ge_u32 s79, 54
  s_cselect_b32 s80, 0x7f000000, s80
  s_cselect_b32 s81, 0x7f000000, s81
  s_cselect_b32 s82, 0x7f000000, s82
  s_cselect_b32 s83, 0x7f000000, s83
  s_cselect_b32 s84, 0x7f000000, s84
  s_cselect_b32 s85, 0, s85
  s_cselect_b32 s87, 0, s87
  s_cselect_b32 s89, 0, s89
L_adone_53:
  s_cmp_ge_u32 s78, 432
  s_cbranch_scc1 L_a12_60
  s_cmp_ge_u32 s78, 216
  s_cbranch_scc1 L_t4_62
  s_mul_i32 s8, s78, 21846
  s_lshr_b32 s8, s8, 16
  s_mul_i32 s9, s8, 3
  s_sub_u32 s9, s78, s9
  s_mul_i32 s94, s9, 1769472
  s_lshl_b32 s10, s8, 7
  s_add_u32 s94, s94, s10
  s_mov_b32 s95, 294912
  s_movk_i32 s96, 9216
  s_mov_b32 s98, 0
  s_mul_i32 s10, s8, 7282
  s_lshr_b32 s10, s10, 16
  s_mul_i32 s11, s10, 9
  s_sub_u32 s11, s8, s11
  s_mov_b32 s12, 0
  s_branch L_tc_63
L_t4_62:
  s_sub_u32 s7, s78, 216
  s_mul_i32 s10, s7, 2428
  s_lshr_b32 s10, s10, 16
  s_mul_i32 s9, s10, 27
  s_sub_u32 s7, s7, s9
  s_mul_i32 s11, s7, 21846
  s_lshr_b32 s11, s11, 16
  s_mul_i32 s9, s11, 3
  s_sub_u32 s9, s7, s9
  s_mul_i32 s6, s10, 18
  s_mul_i32 s7, s9, 6
  s_add_u32 s6, s6, s7
  s_mul_i32 s94, s6, 36864
  s_lshl_b32 s6, s11, 7
  s_add_u32 s94, s94, s6
  s_mov_b32 s95, 36864
  s_movk_i32 s96, 1152
  s_mov_b32 s98, 1
  s_movk_i32 s12, 162
L_tc_63:
  s_sub_u32 s6, s11, 5
  s_cmp_lt_u32 s11, 4
  s_cselect_b32 s6, s11, s6
  s_lshl_b32 s7, s10, 2
  s_add_u32 s7, s7, s6
  s_mul_i32 s7, s7, 324
  s_add_u32 s7, s7, s12
  s_cmp_eq_u32 s98, 1
  s_cbranch_scc1 L_d4_64
  s_cmp_le_u32 s11, 4
  s_cselect_b32 s97, 5, 4
  s_cselect_b32 s8, 0, 90
  s_mov_b32 s99, s97
  s_add_u32 s90, s8, 0
  s_add_u32 s91, s8, 2
  s_add_u32 s92, s8, 1
  s_add_u32 s93, s8, 3
  s_mov_b32 s8, 4
  s_branch L_ddone_65
L_d4_64:
  s_cmp_le_u32 s11, 4
  s_cselect_b32 s97, 3, 2
  s_cselect_b32 s90, 0, 90
  s_cselect_b32 s92, 54, 126
  s_mov_b32 s99, 2
  s_add_u32 s91, s90, 1
  s_add_u32 s93, s92, 1
  s_mov_b32 s8, 2
L_ddone_65:
  s_mul_i32 s9, s9, 6
  s_cmp_eq_u32 s11, 4
  s_cbranch_scc1 L_ts_66
  s_mul_i32 s6, s9, s97
  s_add_u32 s6, s6, s7
  s_add_u32 s90, s90, s6
  s_lshl_b32 s90, s90, 10
  s_add_u32 s90, s90, 1327104
  s_mul_i32 s6, s9, s97
  s_add_u32 s6, s6, s7
  s_add_u32 s91, s91, s6
  s_lshl_b32 s91, s91, 10
  s_add_u32 s91, s91, 1327104
  s_mul_i32 s6, s9, s99
  s_add_u32 s6, s6, s7
  s_add_u32 s92, s92, s6
  s_lshl_b32 s92, s92, 10
  s_add_u32 s92, s92, 1327104
  s_mul_i32 s6, s9, s99
  s_add_u32 s6, s6, s7
  s_add_u32 s93, s93, s6
  s_lshl_b32 s93, s93, 10
  s_add_u32 s93, s93, 1327104
  s_branch L_td_67
L_ts_66:
  s_add_u32 s98, s98, 2
  s_mov_b32 s99, s97
  s_lshl_b32 s7, s10, 2
  s_mul_i32 s7, s7, 324
  s_add_u32 s7, s7, s12
  s_add_u32 s7, s7, s8
  s_mul_i32 s6, s9, s97
  s_add_u32 s7, s7, s6
  s_lshl_b32 s7, s7, 10
  s_add_u32 s7, s7, 1327104
  s_add_u32 s90, s7, 0
  s_add_u32 s91, s7, 331776
  s_add_u32 s92, s7, 663552
  s_add_u32 s93, s7, 995328
L_td_67:
  s_lshl_b32 s97, s97, 10
  s_lshl_b32 s99, s99, 10
  s_cmp_ge_u32 s78, 432
  s_cselect_b32 s90, 0x7f000000, s90
  s_cselect_b32 s91, 0x7f000000, s91
  s_cselect_b32 s92, 0x7f000000, s92
  s_cselect_b32 s93, 0x7f000000, s93
  s_cselect_b32 s94, 0x7f000000, s94
  s_cselect_b32 s95, 0, s95
  s_cselect_b32 s97, 0, s97
  s_cselect_b32 s99, 0, s99
  s_bitcmp1_b32 s98, 0
  s_cselect_b32 s48, s60, s56
  s_cselect_b32 s49, s61, s57
  s_cselect_b32 s50, s62, s58
  s_cselect_b32 s51, s63, s59
  s_branch L_adone_61
L_a12_60:
  s_sub_u32 s78, s78, 432
  s_cmp_ge_u32 s78, 27
  s_cselect_b32 s10, 1, 0
  s_cselect_b32 s7, 27, 0
  s_sub_u32 s7, s78, s7
  s_mul_i32 s8, s7, 21846
  s_lshr_b32 s8, s8, 16
  s_mul_i32 s9, s8, 3
  s_sub_u32 s9, s7, s9
  s_mul_i32 s94, s9, 221184
  s_lshl_b32 s6, s8, 7
  s_add_u32 s94, s94, s6
  s_mov_b32 s95, 36864
  s_movk_i32 s96, 1152
  s_movk_i32 s97, 1024
  s_mov_b32 s98, 2
  s_mul_i32 s7, s8, 72
  s_mul_i32 s6, s9, 6
  s_add_u32 s7, s7, s6
  s_lshl_b32 s7, s7, 10
  s_mul_i32 s6, s10, 663552
  s_add_u32 s7, s7, s6
  s_add_u32 s90, s7, 0
  s_add_u32 s91, s7, 18432
  s_add_u32 s92, s7, 36864
  s_add_u32 s93, s7, 55296
  s_cmp_eq_u32 s10, 1
  s_cselect_b32 s48, s32, s30
  s_cselect_b32 s49, s33, s31
  s_mov_b32 s50, 663552
  s_mov_b32 s51, 0x20000
  s_cmp_ge_u32 s78, 54
  s_cselect_b32 s90, 0x7f000000, s90
  s_cselect_b32 s91, 0x7f000000, s91
  s_cselect_b32 s92, 0x7f000000, s92
  s_cselect_b32 s93, 0x7f000000, s93
  s_cselect_b32 s94, 0x7f000000, s94
  s_cselect_b32 s95, 0, s95
  s_cselect_b32 s97, 0, s97
  s_cselect_b32 s99, 0, s99
L_adone_61:
  v_lshrrev_b32 v178, 3, v1
  v_and_b32 v179, 7, v1
  v_lshlrev_b32 v179, 4, v179
  v_mad_u32_u24 v176, v178, s86, v179
  v_add_u32 v176, s84, v176
  v_mad_u32_u24 v177, v178, s96, v179
  v_add_u32 v177, s94, v177
  s_lshl_b32 s100, s86, 3
  s_mov_b32 s101, s85
  s_mov_b32 s78, 0
  s_mul_i32 s15, s3, 32768
  s_mov_b32 s14, s15
  s_add_u32 s13, s15, 32768
L_prime_68:
  s_cmp_lg_u32 s78, 6
  s_cbranch_scc1 L_is_69
  v_mov_b32 v176, v177
  s_lshl_b32 s100, s96, 3
  s_mov_b32 s101, s95
  s_mov_b32 s64, s48
  s_mov_b32 s65, s49
  s_mov_b32 s66, s50
  s_mov_b32 s67, s51
L_is_69:
  s_cmp_eq_u32 s78, 12
  s_cselect_b32 s7, 0x7f000000, 0
  v_add_u32 v176, s7, v176
  v_mov_b32 v178, v176
  s_add_u32 m0, s14, 0
  s_nop 0
  buffer_load_dwordx4 v178, s[64:67], 0 offen lds
  s_add_u32 m0, s14, 1024
  v_add_u32 v178, s100, v178
  buffer_load_dwordx4 v178, s[64:67], 0 offen lds
  s_add_u32 m0, s14, 2048
  v_add_u32 v178, s100, v178
  buffer_load_dwordx4 v178, s[64:67], 0 offen lds
  s_add_u32 m0, s14, 3072
  v_add_u32 v178, s100, v178
  buffer_load_dwordx4 v178, s[64:67], 0 offen lds
  v_add_u32 v176, s101, v176
  s_add_u32 s78, s78, 1
  s_add_u32 s14, s14, 4096
  s_cmp_ge_u32 s14, s13
  s_cselect_b32 s14, s15, s14
  s_cmp_lt_u32 s78, 7
  s_cbranch_scc1 L_prime_68
  v_bfe_u32 v4, v1, 4, 1
  v_lshrrev_b32 v5, 5, v1
  v_bfe_u32 v9, v1, 2, 2
  v_and_b32 v10, 3, v1
  v_lshl_add_u32 v14, v5, 3, v9
  v_lshlrev_b32 v14, 7, v14
  v_lshl_add_u32 v14, v4, 5, v14
  v_lshl_add_u32 v14, v10, 3, v14
  v_lshl_add_u32 v15, v5, 2, v9
  v_lshlrev_b32 v15, 7, v15
  v_and_b32 v11, 1, v10
  v_lshl_add_u32 v15, v11, 5, v15
  v_lshl_add_u32 v15, v4, 4, v15
  v_lshrrev_b32 v11, 1, v10
  v_lshl_add_u32 v15, v11, 3, v15
  v_lshrrev_b32 v11, 4, v1
  v_lshl_add_u32 v16, v11, 3, v9
  v_lshlrev_b32 v16, 7, v16
  v_lshl_add_u32 v16, v10, 3, v16
  v_lshl_add_u32 v17, v5, 2, v4
  v_lshl_add_u32 v17, v17, 2, v9
  v_lshlrev_b32 v17, 7, v17
  v_lshl_add_u32 v17, v10, 3, v17
  v_lshlrev_b32 v8, 4, v1
  s_waitcnt vmcnt(0)
  s_mov_b32 s79, 0
  s_mov_b32 s12, s15
L_ptl_70:
  s_cmp_lg_u32 s78, 6
  s_cbranch_scc1 L_is_71
  v_mov_b32 v176, v177
  s_lshl_b32 s100, s96, 3
  s_mov_b32 s101, s95
  s_mov_b32 s64, s48
  s_mov_b32 s65, s49
  s_mov_b32 s66, s50
  s_mov_b32 s67, s51
L_is_71:
  s_cmp_eq_u32 s78, 12
  s_cselect_b32 s7, 0x7f000000, 0
  v_add_u32 v176, s7, v176
  v_mov_b32 v178, v176
  s_add_u32 m0, s14, 0
  s_nop 0
  buffer_load_dwordx4 v178, s[64:67], 0 offen lds
  s_add_u32 m0, s14, 1024
  v_add_u32 v178, s100, v178
  buffer_load_dwordx4 v178, s[64:67], 0 offen lds
  s_add_u32 m0, s14, 2048
  v_add_u32 v178, s100, v178
  buffer_load_dwordx4 v178, s[64:67], 0 offen lds
  s_add_u32 m0, s14, 3072
  v_add_u32 v178, s100, v178
  buffer_load_dwordx4 v178, s[64:67], 0 offen lds
  v_add_u32 v176, s101, v176
  s_add_u32 s78, s78, 1
  s_add_u32 s14, s14, 4096
  s_cmp_ge_u32 s14, s13
  s_cselect_b32 s14, s15, s14
  s_cmp_lg_u32 s79, 6
  s_cbranch_scc1 L_ps_72
  s_waitcnt vmcnt(0) lgkmcnt(0)
  s_barrier
  s_cmp_lg_u32 s3, 0
  s_cbranch_scc1 L_arr_73
  s_mov_b64 exec, 1
  v_mov_b32 v252, 913920
  v_mov_b32 v253, 1
  buffer_atomic_add v253, v252, s[72:75], 0 offen sc1
L_ad_74:
  s_mov_b64 exec, -1
L_arr_73:
  s_mov_b32 s80, s90
  s_mov_b32 s81, s91
  s_mov_b32 s82, s92
  s_mov_b32 s83, s93
  s_mov_b32 s87, s97
  s_mov_b32 s88, s98
  s_mov_b32 s89, s99
L_ps_72:
  s_waitcnt vmcnt(56)
  s_cmp_eq_u32 s88, 1
  s_cbranch_scc1 L_k1_76
  s_cmp_eq_u32 s88, 2
  s_cbranch_scc1 L_k2_77
  s_cmp_eq_u32 s88, 3
  s_cbranch_scc1 L_k3_78
  v_add_u32 v10, s12, v14
  ds_read_b64_tr_b16 v[20:21], v10 offset:0
  ds_read_b64_tr_b16 v[22:23], v10 offset:512
  ds_read_b64_tr_b16 v[24:25], v10 offset:2048
  ds_read_b64_tr_b16 v[26:27], v10 offset:2560
  ds_read_b64_tr_b16 v[28:29], v10 offset:64
  ds_read_b64_tr_b16 v[30:31], v10 offset:576
  ds_read_b64_tr_b16 v[32:33], v10 offset:2112
  ds_read_b64_tr_b16 v[34:35], v10 offset:2624
  s_branch L_ke_79
L_k1_76:
  v_add_u32 v10, s12, v15
  ds_read_b64_tr_b16 v[20:21], v10 offset:0
  ds_read_b64_tr_b16 v[22:23], v10 offset:1024
  ds_read_b64_tr_b16 v[24:25], v10 offset:2048
  ds_read_b64_tr_b16 v[26:27], v10 offset:3072
  ds_read_b64_tr_b16 v[28:29], v10 offset:64
  ds_read_b64_tr_b16 v[30:31], v10 offset:1088
  ds_read_b64_tr_b16 v[32:33], v10 offset:2112
  ds_read_b64_tr_b16 v[34:35], v10 offset:3136
  s_branch L_ke_79
L_k2_77:
  v_add_u32 v10, s12, v16
  ds_read_b64_tr_b16 v[20:21], v10 offset:0
  ds_read_b64_tr_b16 v[22:23], v10 offset:512
  ds_read_b64_tr_b16 v[24:25], v10 offset:32
  ds_read_b64_tr_b16 v[26:27], v10 offset:544
  ds_read_b64_tr_b16 v[28:29], v10 offset:64
  ds_read_b64_tr_b16 v[30:31], v10 offset:576
  ds_read_b64_tr_b16 v[32:33], v10 offset:96
  ds_read_b64_tr_b16 v[34:35], v10 offset:608
  s_branch L_ke_79
L_k3_78:
  v_add_u32 v10, s12, v17
  ds_read_b64_tr_b16 v[20:21], v10 offset:0
  ds_read_b64_tr_b16 v[22:23], v10 offset:1024
  ds_read_b64_tr_b16 v[24:25], v10 offset:32
  ds_read_b64_tr_b16 v[26:27], v10 offset:1056
  ds_read_b64_tr_b16 v[28:29], v10 offset:64
  ds_read_b64_tr_b16 v[30:31], v10 offset:1088
  ds_read_b64_tr_b16 v[32:33], v10 offset:96
  ds_read_b64_tr_b16 v[34:35], v10 offset:1120
L_ke_79:
  s_waitcnt lgkmcnt(0)
  v_add_u32 v11, s80, v8
  s_add_u32 s80, s80, s87
  buffer_store_dwordx4 v[20:23], v11, s[68:71], 0 offen sc1
  s_nop 1
  v_add_u32 v11, s81, v8
  s_add_u32 s81, s81, s87
  buffer_store_dwordx4 v[24:27], v11, s[68:71], 0 offen sc1
  s_nop 1
  v_add_u32 v11, s82, v8
  s_add_u32 s82, s82, s89
  buffer_store_dwordx4 v[28:31], v11, s[68:71], 0 offen sc1
  s_nop 1
  v_add_u32 v11, s83, v8
  s_add_u32 s83, s83, s89
  buffer_store_dwordx4 v[32:35], v11, s[68:71], 0 offen sc1
  s_add_u32 s12, s12, 4096
  s_cmp_ge_u32 s12, s13
  s_cselect_b32 s12, s15, s12
  s_add_u32 s79, s79, 1
  s_cmp_lt_u32 s79, 12
  s_cbranch_scc1 L_ptl_70
  s_waitcnt vmcnt(0)
  s_waitcnt vmcnt(0) lgkmcnt(0)
  s_barrier
  s_cmp_lg_u32 s3, 0
  s_cbranch_scc1 L_arr_80
  s_mov_b64 exec, 1
  v_mov_b32 v252, 174080
  v_mov_b32 v253, 1
  buffer_atomic_add v253, v252, s[72:75], 0 offen sc0 sc1
  s_waitcnt vmcnt(0)
  v_readfirstlane_b32 s76, v253
  s_nop 3
  s_cmp_lg_u32 s76, 62
  s_cbranch_scc1 L_ad_81
  v_mov_b32 v252, 178432
  v_mov_b32 v253, 1
  buffer_store_dword v253, v252, s[72:75], 0 offen sc1
L_ad_81:
  s_mov_b64 exec, -1
L_arr_80:
L_pt_skip:
  s_cmp_lg_u32 s3, 0
  s_cbranch_scc1 L_wt_82
  v_mov_b32 v252, 178432
  v_mov_b32 v254, 1
  s_mov_b32 s77, 0
  s_mov_b64 exec, 0x1
L_poll_83:
  buffer_load_dword v253, v252, s[72:75], 0 offen sc1
  s_waitcnt vmcnt(0)
  v_cmp_lt_u32 vcc, v253, v254
  s_add_u32 s77, s77, 1
  s_cmp_ge_u32 s77, 131072
  s_cbranch_scc1 L_poll_83_x
  s_cbranch_vccz L_poll_83_x
  s_sleep 1
  s_branch L_poll_83
L_poll_83_x:
  s_mov_b64 exec, -1
L_wt_82:
  s_barrier
  s_and_b32 s4, s2, 3
  s_lshl_b32 s4, s4, 1
  s_bfe_u32 s76, s2, 0x10003
  s_add_u32 s4, s4, s76
  s_bfe_u32 s5, s2, 0x10002
  s_lshl_b32 s5, s5, 4
  s_lshr_b32 s76, s2, 4
  s_add_u32 s5, s5, s76
  s_sub_u32 s5, s2, 192
  s_lshr_b32 s5, s5, 4
  s_waitcnt vmcnt(0)
  s_and_b32 s10, s2, 3
  s_lshl_b32 s10, s10, 1
  s_bfe_u32 s76, s2, 0x10003
  s_add_u32 s10, s10, s76
  s_bfe_u32 s11, s2, 0x10002
  s_lshl_b32 s11, s11, 4
  s_lshr_b32 s76, s2, 4
  s_add_u32 s11, s11, s76
  s_add_u32 s64, s46, 0x10c8000
  s_addc_u32 s65, s47, 0
  s_mov_b32 s66, 0xa20000
  s_mov_b32 s67, 0x20000
  s_lshl_b32 s6, s10, 2
  s_add_u32 s6, s6, s3
  s_mul_i32 s6, s6, 331776
  v_lshl_add_u32 v160, v1, 4, s6
  buffer_load_dwordx4 a[0:3], v160, s[64:67], 0 offen offset:0 sc1
  buffer_load_dwordx4 a[72:75], v160, s[64:67], 0 offen offset:1024 sc1
  buffer_load_dwordx4 a[144:147], v160, s[64:67], 0 offen offset:2048 sc1
  buffer_load_dwordx4 a[4:7], v160, s[64:67], 0 offen offset:3072 sc1
  v_add_u32 v160, 4096, v160
  buffer_load_dwordx4 a[76:79], v160, s[64:67], 0 offen offset:0 sc1
  buffer_load_dwordx4 a[148:151], v160, s[64:67], 0 offen offset:1024 sc1
  buffer_load_dwordx4 a[8:11], v160, s[64:67], 0 offen offset:2048 sc1
  buffer_load_dwordx4 a[80:83], v160, s[64:67], 0 offen offset:3072 sc1
  v_add_u32 v160, 4096, v160
  buffer_load_dwordx4 a[152:155], v160, s[64:67], 0 offen offset:0 sc1
  buffer_load_dwordx4 a[12:15], v160, s[64:67], 0 offen offset:1024 sc1
  buffer_load_dwordx4 a[84:87], v160, s[64:67], 0 offen offset:2048 sc1
  buffer_load_dwordx4 a[156:159], v160, s[64:67], 0 offen offset:3072 sc1
  v_add_u32 v160, 4096, v160
  buffer_load_dwordx4 a[16:19], v160, s[64:67], 0 offen offset:0 sc1
  buffer_load_dwordx4 a[88:91], v160, s[64:67], 0 offen offset:1024 sc1
  buffer_load_dwordx4 a[160:163], v160, s[64:67], 0 offen offset:2048 sc1
  buffer_load_dwordx4 a[20:23], v160, s[64:67], 0 offen offset:3072 sc1
  v_add_u32 v160, 4096, v160
  buffer_load_dwordx4 a[92:95], v160, s[64:67], 0 offen offset:0 sc1
  buffer_load_dwordx4 a[164:167], v160, s[64:67], 0 offen offset:1024 sc1
  buffer_load_dwordx4 a[24:27], v160, s[64:67], 0 offen offset:2048 sc1
  buffer_load_dwordx4 a[96:99], v160, s[64:67], 0 offen offset:3072 sc1
  v_add_u32 v160, 4096, v160
  buffer_load_dwordx4 a[168:171], v160, s[64:67], 0 offen offset:0 sc1
  buffer_load_dwordx4 a[28:31], v160, s[64:67], 0 offen offset:1024 sc1
  buffer_load_dwordx4 a[100:103], v160, s[64:67], 0 offen offset:2048 sc1
  buffer_load_dwordx4 a[172:175], v160, s[64:67], 0 offen offset:3072 sc1
  v_add_u32 v160, 4096, v160
  buffer_load_dwordx4 a[32:35], v160, s[64:67], 0 offen offset:0 sc1
  buffer_load_dwordx4 a[104:107], v160, s[64:67], 0 offen offset:1024 sc1
  buffer_load_dwordx4 a[176:179], v160, s[64:67], 0 offen offset:2048 sc1
  s_waitcnt lgkmcnt(0)
L_mlp:
  s_and_b32 s4, s2, 3
  s_lshl_b32 s4, s4, 1
  s_bfe_u32 s76, s2, 0x10003
  s_add_u32 s4, s4, s76
  s_bfe_u32 s5, s2, 0x10002
  s_lshl_b32 s5, s5, 4
  s_lshr_b32 s76, s2, 4
  s_add_u32 s5, s5, s76
  s_cmp_lg_u32 s3, 0
  s_cbranch_scc1 L_wt_84
  s_lshl_b32 s6, s5, 1
  v_add_u32 v252, s6, v1
  v_mul_u32_u24 v252, 4352, v252
  v_add_u32 v252, 461312, v252
  v_mov_b32 v254, 3
  v_mov_b32 v255, 178432
  v_mov_b32 v251, 1
  v_cmp_eq_u32 vcc, 2, v1
  s_nop 1
  v_cndmask_b32 v252, v252, v255, vcc
  s_nop 0
  v_cndmask_b32 v254, v254, v251, vcc
  s_mov_b32 s77, 0
  s_mov_b64 exec, 0x7
L_poll_85:
  buffer_load_dword v253, v252, s[72:75], 0 offen sc1
  s_waitcnt vmcnt(0)
  v_cmp_lt_u32 vcc, v253, v254
  s_add_u32 s77, s77, 1
  s_cmp_ge_u32 s77, 131072
  s_cbranch_scc1 L_poll_85_x
  s_cbranch_vccz L_poll_85_x
  s_sleep 1
  s_branch L_poll_85
L_poll_85_x:
  s_mov_b64 exec, -1
L_wt_84:
  s_barrier
L_mlp2:
  s_add_u32 s48, s46, 0xd44000
  s_addc_u32 s49, s47, 0
  s_mov_b32 s50, 0x240000
  s_mov_b32 s51, 0x20000
  s_mov_b32 s99, 0xffff0000
  s_mov_b32 s98, 0x3ae38e39
  s_mov_b32 s97, 0x3727c5ac
  v_lshrrev_b32 v3, 3, v1
  v_and_b32 v4, 7, v1
  s_lshl_b32 s6, s5, 6
  s_lshl_b32 s7, s3, 4
  s_add_u32 s6, s6, s7
  v_add_u32 v5, s6, v3
  s_movk_i32 s7, 1152
  v_mul_lo_u32 v5, v5, s7
  v_lshl_add_u32 v5, v4, 4, v5
  v_add_u32 v6, 9216, v5
  s_add_u32 s52, s46, 0x2ce8000
  s_addc_u32 s53, s47, 0
  s_mov_b32 s54, 0xc000
  s_mov_b32 s55, 0x20000
  s_lshl_b32 s6, s5, 6
  s_lshl_b32 s7, s3, 4
  s_add_u32 s6, s6, s7
  v_add_u32 v7, s6, v3
  v_lshlrev_b32 v7, 3, v7
  v_mul_u32_u24 v8, 16384, v4
  v_add_u32 v7, v7, v8
  v_cmp_gt_u32 vcc, 3, v4
  v_mov_b32 v8, 0x7f000000
  s_nop 0
  v_cndmask_b32 v7, v8, v7, vcc
  buffer_load_dwordx2 v[200:201], v7, s[52:55], 0 offen sc1
  buffer_load_dwordx2 v[202:203], v7, s[52:55], 0 offen offset:64 sc1
  buffer_load_dwordx4 v[64:67], v5, s[48:51], 0 offen offset:0 sc1
  buffer_load_dwordx4 v[68:71], v5, s[48:51], 0 offen offset:128 sc1
  buffer_load_dwordx4 v[72:75], v5, s[48:51], 0 offen offset:256 sc1
  buffer_load_dwordx4 v[76:79], v5, s[48:51], 0 offen offset:384 sc1
  buffer_load_dwordx4 v[80:83], v5, s[48:51], 0 offen offset:512 sc1
  buffer_load_dwordx4 v[84:87], v5, s[48:51], 0 offen offset:640 sc1
  buffer_load_dwordx4 v[88:91], v5, s[48:51], 0 offen offset:768 sc1
  buffer_load_dwordx4 v[92:95], v5, s[48:51], 0 offen offset:896 sc1
  buffer_load_dwordx4 v[96:99], v5, s[48:51], 0 offen offset:1024 sc1
  buffer_load_dwordx4 v[100:103], v6, s[48:51], 0 offen offset:0 sc1
  buffer_load_dwordx4 v[104:107], v6, s[48:51], 0 offen offset:128 sc1
  buffer_load_dwordx4 v[108:111], v6, s[48:51], 0 offen offset:256 sc1
  buffer_load_dwordx4 v[112:115], v6, s[48:51], 0 offen offset:384 sc1
  buffer_load_dwordx4 v[116:119], v6, s[48:51], 0 offen offset:512 sc1
  buffer_load_dwordx4 v[120:123], v6, s[48:51], 0 offen offset:640 sc1
  buffer_load_dwordx4 v[124:127], v6, s[48:51], 0 offen offset:768 sc1
  buffer_load_dwordx4 v[128:131], v6, s[48:51], 0 offen offset:896 sc1
  buffer_load_dwordx4 v[132:135], v6, s[48:51], 0 offen offset:1024 sc1
  s_add_u32 s64, s46, 0x10c8000
  s_addc_u32 s65, s47, 0
  s_mov_b32 s66, 0xa20000
  s_mov_b32 s67, 0x20000
  s_lshl_b32 s6, s4, 2
  s_add_u32 s6, s6, s3
  s_mul_i32 s6, s6, 331776
  s_add_u32 s6, s6, 24576
  v_lshl_add_u32 v2, v1, 4, s6
  v_lshrrev_b32 v7, 1, v4
  v_lshlrev_b32 v9, 11, v7
  s_lshr_b32 s6, s3, 1
  s_lshl_b32 s6, s6, 10
  v_add_u32 v9, s6, v9
  v_and_b32 v7, 1, v4
  v_lshlrev_b32 v7, 5, v7
  s_and_b32 s6, s3, 1
  s_lshl_b32 s6, s6, 4
  v_add_u32 v7, s6, v7
  v_add_u32 v7, v7, v3
  v_add_u32 v10, 0, v7
  v_xor_b32 v10, v10, v4
  v_lshl_add_u32 v11, v10, 4, v9
  v_add_u32 v10, 8, v7
  v_xor_b32 v10, v10, v4
  v_lshl_add_u32 v12, v10, 4, v9
  s_waitcnt vmcnt(19)
  v_add_f32_dpp v200, v200, v200 quad_perm:[1,0,3,2] row_mask:0xf bank_mask:0xf
  v_add_f32_dpp v201, v201, v201 quad_perm:[1,0,3,2] row_mask:0xf bank_mask:0xf
  s_nop 0
  v_add_f32_dpp v200, v200, v200 quad_perm:[2,3,0,1] row_mask:0xf bank_mask:0xf
  s_nop 0
  v_add_f32_dpp v201, v201, v201 quad_perm:[2,3,0,1] row_mask:0xf bank_mask:0xf
  s_nop 0
  v_add_f32_dpp v200, v200, v200 row_half_mirror row_mask:0xf bank_mask:0xf
  s_nop 0
  v_add_f32_dpp v201, v201, v201 row_half_mirror row_mask:0xf bank_mask:0xf
  s_waitcnt vmcnt(18)
  v_add_f32_dpp v202, v202, v202 quad_perm:[1,0,3,2] row_mask:0xf bank_mask:0xf
  v_add_f32_dpp v203, v203, v203 quad_perm:[1,0,3,2] row_mask:0xf bank_mask:0xf
  s_nop 0
  v_add_f32_dpp v202, v202, v202 quad_perm:[2,3,0,1] row_mask:0xf bank_mask:0xf
  s_nop 0
  v_add_f32_dpp v203, v203, v203 quad_perm:[2,3,0,1] row_mask:0xf bank_mask:0xf
  s_nop 0
  v_add_f32_dpp v202, v202, v202 row_half_mirror row_mask:0xf bank_mask:0xf
  s_nop 0
  v_add_f32_dpp v203, v203, v203 row_half_mirror row_mask:0xf bank_mask:0xf
  v_mul_f32 v200, s98, v200
  v_mul_f32 v201, s98, v201
  v_fma_f32 v201, -v200, v200, v201
  v_max_f32 v201, 0, v201
  v_add_f32 v201, s97, v201
  v_rsq_f32 v208, v201
  s_nop 0
  v_mul_f32 v209, -v200, v208
  v_mul_f32 v202, s98, v202
  v_mul_f32 v203, s98, v203
  v_fma_f32 v203, -v202, v202, v203
  v_max_f32 v203, 0, v203
  v_add_f32 v203, s97, v203
  v_rsq_f32 v210, v203
  s_nop 0
  v_mul_f32 v211, -v202, v210
  s_waitcnt vmcnt(17)
  v_lshlrev_b32 v136, 16, v64
  v_and_b32 v137, s99, v64
  v_lshlrev_b32 v138, 16, v65
  v_and_b32 v139, s99, v65
  v_lshlrev_b32 v140, 16, v66
  v_and_b32 v141, s99, v66
  v_lshlrev_b32 v142, 16, v67
  v_and_b32 v143, s99, v67
  v_pk_fma_f32 v[136:137], v[136:137], v[208:209], v[208:209] op_sel:[0,0,1] op_sel_hi:[1,0,1]
  v_pk_fma_f32 v[138:139], v[138:139], v[208:209], v[208:209] op_sel:[0,0,1] op_sel_hi:[1,0,1]
  v_pk_fma_f32 v[140:141], v[140:141], v[208:209], v[208:209] op_sel:[0,0,1] op_sel_hi:[1,0,1]
  v_pk_fma_f32 v[142:143], v[142:143], v[208:209], v[208:209] op_sel:[0,0,1] op_sel_hi:[1,0,1]
  v_cvt_pk_bf16_f32 v64, v136, v137
  v_cvt_pk_bf16_f32 v65, v138, v139
  v_cvt_pk_bf16_f32 v66, v140, v141
  v_cvt_pk_bf16_f32 v67, v142, v143
  ds_write_b128 v11, v[64:67] offset:0
  buffer_load_dwordx4 a[36:39], v2, s[64:67], 0 offen offset:3072 sc1
  v_add_u32 v2, 4096, v2
  buffer_load_dwordx4 a[108:111], v2, s[64:67], 0 offen offset:0 sc1
  s_waitcnt vmcnt(18)
  v_lshlrev_b32 v144, 16, v68
  v_and_b32 v145, s99, v68
  v_lshlrev_b32 v146, 16, v69
  v_and_b32 v147, s99, v69
  v_lshlrev_b32 v148, 16, v70
  v_and_b32 v149, s99, v70
  v_lshlrev_b32 v150, 16, v71
  v_and_b32 v151, s99, v71
  v_pk_fma_f32 v[144:145], v[144:145], v[208:209], v[208:209] op_sel:[0,0,1] op_sel_hi:[1,0,1]
  v_pk_fma_f32 v[146:147], v[146:147], v[208:209], v[208:209] op_sel:[0,0,1] op_sel_hi:[1,0,1]
  v_pk_fma_f32 v[148:149], v[148:149], v[208:209], v[208:209] op_sel:[0,0,1] op_sel_hi:[1,0,1]
  v_pk_fma_f32 v[150:151], v[150:151], v[208:209], v[208:209] op_sel:[0,0,1] op_sel_hi:[1,0,1]
  v_cvt_pk_bf16_f32 v68, v144, v145
  v_cvt_pk_bf16_f32 v69, v146, v147
  v_cvt_pk_bf16_f32 v70, v148, v149
  v_cvt_pk_bf16_f32 v71, v150, v151
  ds_write_b128 v11, v[68:71] offset:8192
  buffer_load_dwordx4 a[180:183], v2, s[64:67], 0 offen offset:1024 sc1
  buffer_load_dwordx4 a[40:43], v2, s[64:67], 0 offen offset:2048 sc1
  s_waitcnt vmcnt(19)
  v_lshlrev_b32 v136, 16, v72
  v_and_b32 v137, s99, v72
  v_lshlrev_b32 v138, 16, v73
  v_and_b32 v139, s99, v73
  v_lshlrev_b32 v140, 16, v74
  v_and_b32 v141, s99, v74
  v_lshlrev_b32 v142, 16, v75
  v_and_b32 v143, s99, v75
  v_pk_fma_f32 v[136:137], v[136:137], v[208:209], v[208:209] op_sel:[0,0,1] op_sel_hi:[1,0,1]
  v_pk_fma_f32 v[138:139], v[138:139], v[208:209], v[208:209] op_sel:[0,0,1] op_sel_hi:[1,0,1]
  v_pk_fma_f32 v[140:141], v[140:141], v[208:209], v[208:209] op_sel:[0,0,1] op_sel_hi:[1,0,1]
  v_pk_fma_f32 v[142:143], v[142:143], v[208:209], v[208:209] op_sel:[0,0,1] op_sel_hi:[1,0,1]
  v_cvt_pk_bf16_f32 v72, v136, v137
  v_cvt_pk_bf16_f32 v73, v138, v139
  v_cvt_pk_bf16_f32 v74, v140, v141
  v_cvt_pk_bf16_f32 v75, v142, v143
  ds_write_b128 v11, v[72:75] offset:16384
  buffer_load_dwordx4 a[112:115], v2, s[64:67], 0 offen offset:3072 sc1
  v_add_u32 v2, 4096, v2
  buffer_load_dwordx4 a[184:187], v2, s[64:67], 0 offen offset:0 sc1
  s_waitcnt vmcnt(20)
  v_lshlrev_b32 v144, 16, v76
  v_and_b32 v145, s99, v76
  v_lshlrev_b32 v146, 16, v77
  v_and_b32 v147, s99, v77
  v_lshlrev_b32 v148, 16, v78
  v_and_b32 v149, s99, v78
  v_lshlrev_b32 v150, 16, v79
  v_and_b32 v151, s99, v79
  v_pk_fma_f32 v[144:145], v[144:145], v[208:209], v[208:209] op_sel:[0,0,1] op_sel_hi:[1,0,1]
  v_pk_fma_f32 v[146:147], v[146:147], v[208:209], v[208:209] op_sel:[0,0,1] op_sel_hi:[1,0,1]
  v_pk_fma_f32 v[148:149], v[148:149], v[208:209], v[208:209] op_sel:[0,0,1] op_sel_hi:[1,0,1]
  v_pk_fma_f32 v[150:151], v[150:151], v[208:209], v[208:209] op_sel:[0,0,1] op_sel_hi:[1,0,1]
  v_cvt_pk_bf16_f32 v76, v144, v145
  v_cvt_pk_bf16_f32 v77, v146, v147
  v_cvt_pk_bf16_f32 v78, v148, v149
  v_cvt_pk_bf16_f32 v79, v150, v151
  ds_write_b128 v11, v[76:79] offset:24576
  buffer_load_dwordx4 a[44:47], v2, s[64:67], 0 offen offset:1024 sc1
  buffer_load_dwordx4 a[116:119], v2, s[64:67], 0 offen offset:2048 sc1
  s_waitcnt vmcnt(21)
  v_lshlrev_b32 v136, 16, v80
  v_and_b32 v137, s99, v80
  v_lshlrev_b32 v138, 16, v81
  v_and_b32 v139, s99, v81
  v_lshlrev_b32 v140, 16, v82
  v_and_b32 v141, s99, v82
  v_lshlrev_b32 v142, 16, v83
  v_and_b32 v143, s99, v83
  v_pk_fma_f32 v[136:137], v[136:137], v[208:209], v[208:209] op_sel:[0,0,1] op_sel_hi:[1,0,1]
  v_pk_fma_f32 v[138:139], v[138:139], v[208:209], v[208:209] op_sel:[0,0,1] op_sel_hi:[1,0,1]
  v_pk_fma_f32 v[140:141], v[140:141], v[208:209], v[208:209] op_sel:[0,0,1] op_sel_hi:[1,0,1]
  v_pk_fma_f32 v[142:143], v[142:143], v[208:209], v[208:209] op_sel:[0,0,1] op_sel_hi:[1,0,1]
  v_cvt_pk_bf16_f32 v80, v136, v137
  v_cvt_pk_bf16_f32 v81, v138, v139
  v_cvt_pk_bf16_f32 v82, v140, v141
  v_cvt_pk_bf16_f32 v83, v142, v143
  ds_write_b128 v11, v[80:83] offset:32768
  buffer_load_dwordx4 a[188:191], v2, s[64:67], 0 offen offset:3072 sc1
  v_add_u32 v2, 4096, v2
  buffer_load_dwordx4 a[48:51], v2, s[64:67], 0 offen offset:0 sc1
  s_waitcnt vmcnt(22)
  v_lshlrev_b32 v144, 16, v84
  v_and_b32 v145, s99, v84
  v_lshlrev_b32 v146, 16, v85
  v_and_b32 v147, s99, v85
  v_lshlrev_b32 v148, 16, v86
  v_and_b32 v149, s99, v86
  v_lshlrev_b32 v150, 16, v87
  v_and_b32 v151, s99, v87
  v_pk_fma_f32 v[144:145], v[144:145], v[208:209], v[208:209] op_sel:[0,0,1] op_sel_hi:[1,0,1]
  v_pk_fma_f32 v[146:147], v[146:147], v[208:209], v[208:209] op_sel:[0,0,1] op_sel_hi:[1,0,1]
  v_pk_fma_f32 v[148:149], v[148:149], v[208:209], v[208:209] op_sel:[0,0,1] op_sel_hi:[1,0,1]
  v_pk_fma_f32 v[150:151], v[150:151], v[208:209], v[208:209] op_sel:[0,0,1] op_sel_hi:[1,0,1]
  v_cvt_pk_bf16_f32 v84, v144, v145
  v_cvt_pk_bf16_f32 v85, v146, v147
  v_cvt_pk_bf16_f32 v86, v148, v149
  v_cvt_pk_bf16_f32 v87, v150, v151
  ds_write_b128 v11, v[84:87] offset:40960
  buffer_load_dwordx4 a[120:123], v2, s[64:67], 0 offen offset:1024 sc1
  buffer_load_dwordx4 a[192:195], v2, s[64:67], 0 offen offset:2048 sc1
  s_waitcnt vmcnt(23)
  v_lshlrev_b32 v136, 16, v88
  v_and_b32 v137, s99, v88
  v_lshlrev_b32 v138, 16, v89
  v_and_b32 v139, s99, v89
  v_lshlrev_b32 v140, 16, v90
  v_and_b32 v141, s99, v90
  v_lshlrev_b32 v142, 16, v91
  v_and_b32 v143, s99, v91
  v_pk_fma_f32 v[136:137], v[136:137], v[208:209], v[208:209] op_sel:[0,0,1] op_sel_hi:[1,0,1]
  v_pk_fma_f32 v[138:139], v[138:139], v[208:209], v[208:209] op_sel:[0,0,1] op_sel_hi:[1,0,1]
  v_pk_fma_f32 v[140:141], v[140:141], v[208:209], v[208:209] op_sel:[0,0,1] op_sel_hi:[1,0,1]
  v_pk_fma_f32 v[142:143], v[142:143], v[208:209], v[208:209] op_sel:[0,0,1] op_sel_hi:[1,0,1]
  v_cvt_pk_bf16_f32 v88, v136, v137
  v_cvt_pk_bf16_f32 v89, v138, v139
  v_cvt_pk_bf16_f32 v90, v140, v141
  v_cvt_pk_bf16_f32 v91, v142, v143
  ds_write_b128 v11, v[88:91] offset:49152
  buffer_load_dwordx4 a[52:55], v2, s[64:67], 0 offen offset:3072 sc1
  v_add_u32 v2, 4096, v2
  buffer_load_dwordx4 a[124:127], v2, s[64:67], 0 offen offset:0 sc1
  s_waitcnt vmcnt(24)
  v_lshlrev_b32 v144, 16, v92
  v_and_b32 v145, s99, v92
  v_lshlrev_b32 v146, 16, v93
  v_and_b32 v147, s99, v93
  v_lshlrev_b32 v148, 16, v94
  v_and_b32 v149, s99, v94
  v_lshlrev_b32 v150, 16, v95
  v_and_b32 v151, s99, v95
  v_pk_fma_f32 v[144:145], v[144:145], v[208:209], v[208:209] op_sel:[0,0,1] op_sel_hi:[1,0,1]
  v_pk_fma_f32 v[146:147], v[146:147], v[208:209], v[208:209] op_sel:[0,0,1] op_sel_hi:[1,0,1]
  v_pk_fma_f32 v[148:149], v[148:149], v[208:209], v[208:209] op_sel:[0,0,1] op_sel_hi:[1,0,1]
  v_pk_fma_f32 v[150:151], v[150:151], v[208:209], v[208:209] op_sel:[0,0,1] op_sel_hi:[1,0,1]
  v_cvt_pk_bf16_f32 v92, v144, v145
  v_cvt_pk_bf16_f32 v93, v146, v147
  v_cvt_pk_bf16_f32 v94, v148, v149
  v_cvt_pk_bf16_f32 v95, v150, v151
  ds_write_b128 v11, v[92:95] offset:57344
  buffer_load_dwordx4 a[196:199], v2, s[64:67], 0 offen offset:1024 sc1
  buffer_load_dwordx4 a[56:59], v2, s[64:67], 0 offen offset:2048 sc1
  s_waitcnt vmcnt(25)
  v_lshlrev_b32 v136, 16, v96
  v_and_b32 v137, s99, v96
  v_lshlrev_b32 v138, 16, v97
  v_and_b32 v139, s99, v97
  v_lshlrev_b32 v140, 16, v98
  v_and_b32 v141, s99, v98
  v_lshlrev_b32 v142, 16, v99
  v_and_b32 v143, s99, v99
  v_pk_fma_f32 v[136:137], v[136:137], v[208:209], v[208:209] op_sel:[0,0,1] op_sel_hi:[1,0,1]
  v_pk_fma_f32 v[138:139], v[138:139], v[208:209], v[208:209] op_sel:[0,0,1] op_sel_hi:[1,0,1]
  v_pk_fma_f32 v[140:141], v[140:141], v[208:209], v[208:209] op_sel:[0,0,1] op_sel_hi:[1,0,1]
  v_pk_fma_f32 v[142:143], v[142:143], v[208:209], v[208:209] op_sel:[0,0,1] op_sel_hi:[1,0,1]
  v_cvt_pk_bf16_f32 v96, v136, v137
  v_cvt_pk_bf16_f32 v97, v138, v139
  v_cvt_pk_bf16_f32 v98, v140, v141
  v_cvt_pk_bf16_f32 v99, v142, v143
  v_add_u32 v13, 65536, v11
  ds_write_b128 v13, v[96:99]
  buffer_load_dwordx4 a[128:131], v2, s[64:67], 0 offen offset:3072 sc1
  v_add_u32 v2, 4096, v2
  buffer_load_dwordx4 a[200:203], v2, s[64:67], 0 offen offset:0 sc1
  s_waitcnt vmcnt(26)
  v_lshlrev_b32 v136, 16, v100
  v_and_b32 v137, s99, v100
  v_lshlrev_b32 v138, 16, v101
  v_and_b32 v139, s99, v101
  v_lshlrev_b32 v140, 16, v102
  v_and_b32 v141, s99, v102
  v_lshlrev_b32 v142, 16, v103
  v_and_b32 v143, s99, v103
  v_pk_fma_f32 v[136:137], v[136:137], v[210:211], v[210:211] op_sel:[0,0,1] op_sel_hi:[1,0,1]
  v_pk_fma_f32 v[138:139], v[138:139], v[210:211], v[210:211] op_sel:[0,0,1] op_sel_hi:[1,0,1]
  v_pk_fma_f32 v[140:141], v[140:141], v[210:211], v[210:211] op_sel:[0,0,1] op_sel_hi:[1,0,1]
  v_pk_fma_f32 v[142:143], v[142:143], v[210:211], v[210:211] op_sel:[0,0,1] op_sel_hi:[1,0,1]
  v_cvt_pk_bf16_f32 v100, v136, v137
  v_cvt_pk_bf16_f32 v101, v138, v139
  v_cvt_pk_bf16_f32 v102, v140, v141
  v_cvt_pk_bf16_f32 v103, v142, v143
  ds_write_b128 v12, v[100:103] offset:0
  buffer_load_dwordx4 a[60:63], v2, s[64:67], 0 offen offset:1024 sc1
  buffer_load_dwordx4 a[132:135], v2, s[64:67], 0 offen offset:2048 sc1
  s_waitcnt vmcnt(27)
  v_lshlrev_b32 v144, 16, v104
  v_and_b32 v145, s99, v104
  v_lshlrev_b32 v146, 16, v105
  v_and_b32 v147, s99, v105
  v_lshlrev_b32 v148, 16, v106
  v_and_b32 v149, s99, v106
  v_lshlrev_b32 v150, 16, v107
  v_and_b32 v151, s99, v107
  v_pk_fma_f32 v[144:145], v[144:145], v[210:211], v[210:211] op_sel:[0,0,1] op_sel_hi:[1,0,1]
  v_pk_fma_f32 v[146:147], v[146:147], v[210:211], v[210:211] op_sel:[0,0,1] op_sel_hi:[1,0,1]
  v_pk_fma_f32 v[148:149], v[148:149], v[210:211], v[210:211] op_sel:[0,0,1] op_sel_hi:[1,0,1]
  v_pk_fma_f32 v[150:151], v[150:151], v[210:211], v[210:211] op_sel:[0,0,1] op_sel_hi:[1,0,1]
  v_cvt_pk_bf16_f32 v104, v144, v145
  v_cvt_pk_bf16_f32 v105, v146, v147
  v_cvt_pk_bf16_f32 v106, v148, v149
  v_cvt_pk_bf16_f32 v107, v150, v151
  ds_write_b128 v12, v[104:107] offset:8192
  buffer_load_dwordx4 a[204:207], v2, s[64:67], 0 offen offset:3072 sc1
  v_add_u32 v2, 4096, v2
  buffer_load_dwordx4 a[64:67], v2, s[64:67], 0 offen offset:0 sc1
  s_waitcnt vmcnt(28)
  v_lshlrev_b32 v136, 16, v108
  v_and_b32 v137, s99, v108
  v_lshlrev_b32 v138, 16, v109
  v_and_b32 v139, s99, v109
  v_lshlrev_b32 v140, 16, v110
  v_and_b32 v141, s99, v110
  v_lshlrev_b32 v142, 16, v111
  v_and_b32 v143, s99, v111
  v_pk_fma_f32 v[136:137], v[136:137], v[210:211], v[210:211] op_sel:[0,0,1] op_sel_hi:[1,0,1]
  v_pk_fma_f32 v[138:139], v[138:139], v[210:211], v[210:211] op_sel:[0,0,1] op_sel_hi:[1,0,1]
  v_pk_fma_f32 v[140:141], v[140:141], v[210:211], v[210:211] op_sel:[0,0,1] op_sel_hi:[1,0,1]
  v_pk_fma_f32 v[142:143], v[142:143], v[210:211], v[210:211] op_sel:[0,0,1] op_sel_hi:[1,0,1]
  v_cvt_pk_bf16_f32 v108, v136, v137
  v_cvt_pk_bf16_f32 v109, v138, v139
  v_cvt_pk_bf16_f32 v110, v140, v141
  v_cvt_pk_bf16_f32 v111, v142, v143
  ds_write_b128 v12, v[108:111] offset:16384
  buffer_load_dwordx4 a[136:139], v2, s[64:67], 0 offen offset:1024 sc1
  buffer_load_dwordx4 a[208:211], v2, s[64:67], 0 offen offset:2048 sc1
  s_waitcnt vmcnt(29)
  v_lshlrev_b32 v144, 16, v112
  v_and_b32 v145, s99, v112
  v_lshlrev_b32 v146, 16, v113
  v_and_b32 v147, s99, v113
  v_lshlrev_b32 v148, 16, v114
  v_and_b32 v149, s99, v114
  v_lshlrev_b32 v150, 16, v115
  v_and_b32 v151, s99, v115
  v_pk_fma_f32 v[144:145], v[144:145], v[210:211], v[210:211] op_sel:[0,0,1] op_sel_hi:[1,0,1]
  v_pk_fma_f32 v[146:147], v[146:147], v[210:211], v[210:211] op_sel:[0,0,1] op_sel_hi:[1,0,1]
  v_pk_fma_f32 v[148:149], v[148:149], v[210:211], v[210:211] op_sel:[0,0,1] op_sel_hi:[1,0,1]
  v_pk_fma_f32 v[150:151], v[150:151], v[210:211], v[210:211] op_sel:[0,0,1] op_sel_hi:[1,0,1]
  v_cvt_pk_bf16_f32 v112, v144, v145
  v_cvt_pk_bf16_f32 v113, v146, v147
  v_cvt_pk_bf16_f32 v114, v148, v149
  v_cvt_pk_bf16_f32 v115, v150, v151
  ds_write_b128 v12, v[112:115] offset:24576
  buffer_load_dwordx4 a[68:71], v2, s[64:67], 0 offen offset:3072 sc1
  v_add_u32 v2, 4096, v2
  buffer_load_dwordx4 a[140:143], v2, s[64:67], 0 offen offset:0 sc1
  s_waitcnt vmcnt(30)
  v_lshlrev_b32 v136, 16, v116
  v_and_b32 v137, s99, v116
  v_lshlrev_b32 v138, 16, v117
  v_and_b32 v139, s99, v117
  v_lshlrev_b32 v140, 16, v118
  v_and_b32 v141, s99, v118
  v_lshlrev_b32 v142, 16, v119
  v_and_b32 v143, s99, v119
  v_pk_fma_f32 v[136:137], v[136:137], v[210:211], v[210:211] op_sel:[0,0,1] op_sel_hi:[1,0,1]
  v_pk_fma_f32 v[138:139], v[138:139], v[210:211], v[210:211] op_sel:[0,0,1] op_sel_hi:[1,0,1]
  v_pk_fma_f32 v[140:141], v[140:141], v[210:211], v[210:211] op_sel:[0,0,1] op_sel_hi:[1,0,1]
  v_pk_fma_f32 v[142:143], v[142:143], v[210:211], v[210:211] op_sel:[0,0,1] op_sel_hi:[1,0,1]
  v_cvt_pk_bf16_f32 v116, v136, v137
  v_cvt_pk_bf16_f32 v117, v138, v139
  v_cvt_pk_bf16_f32 v118, v140, v141
  v_cvt_pk_bf16_f32 v119, v142, v143
  ds_write_b128 v12, v[116:119] offset:32768
  buffer_load_dwordx4 a[212:215], v2, s[64:67], 0 offen offset:1024 sc1
  s_waitcnt vmcnt(30)
  v_lshlrev_b32 v144, 16, v120
  v_and_b32 v145, s99, v120
  v_lshlrev_b32 v146, 16, v121
  v_and_b32 v147, s99, v121
  v_lshlrev_b32 v148, 16, v122
  v_and_b32 v149, s99, v122
  v_lshlrev_b32 v150, 16, v123
  v_and_b32 v151, s99, v123
  v_pk_fma_f32 v[144:145], v[144:145], v[210:211], v[210:211] op_sel:[0,0,1] op_sel_hi:[1,0,1]
  v_pk_fma_f32 v[146:147], v[146:147], v[210:211], v[210:211] op_sel:[0,0,1] op_sel_hi:[1,0,1]
  v_pk_fma_f32 v[148:149], v[148:149], v[210:211], v[210:211] op_sel:[0,0,1] op_sel_hi:[1,0,1]
  v_pk_fma_f32 v[150:151], v[150:151], v[210:211], v[210:211] op_sel:[0,0,1] op_sel_hi:[1,0,1]
  v_cvt_pk_bf16_f32 v120, v144, v145
  v_cvt_pk_bf16_f32 v121, v146, v147
  v_cvt_pk_bf16_f32 v122, v148, v149
  v_cvt_pk_bf16_f32 v123, v150, v151
  ds_write_b128 v12, v[120:123] offset:40960
  s_waitcnt vmcnt(29)
  v_lshlrev_b32 v136, 16, v124
  v_and_b32 v137, s99, v124
  v_lshlrev_b32 v138, 16, v125
  v_and_b32 v139, s99, v125
  v_lshlrev_b32 v140, 16, v126
  v_and_b32 v141, s99, v126
  v_lshlrev_b32 v142, 16, v127
  v_and_b32 v143, s99, v127
  v_pk_fma_f32 v[136:137], v[136:137], v[210:211], v[210:211] op_sel:[0,0,1] op_sel_hi:[1,0,1]
  v_pk_fma_f32 v[138:139], v[138:139], v[210:211], v[210:211] op_sel:[0,0,1] op_sel_hi:[1,0,1]
  v_pk_fma_f32 v[140:141], v[140:141], v[210:211], v[210:211] op_sel:[0,0,1] op_sel_hi:[1,0,1]
  v_pk_fma_f32 v[142:143], v[142:143], v[210:211], v[210:211] op_sel:[0,0,1] op_sel_hi:[1,0,1]
  v_cvt_pk_bf16_f32 v124, v136, v137
  v_cvt_pk_bf16_f32 v125, v138, v139
  v_cvt_pk_bf16_f32 v126, v140, v141
  v_cvt_pk_bf16_f32 v127, v142, v143
  ds_write_b128 v12, v[124:127] offset:49152
  s_waitcnt vmcnt(28)
  v_lshlrev_b32 v144, 16, v128
  v_and_b32 v145, s99, v128
  v_lshlrev_b32 v146, 16, v129
  v_and_b32 v147, s99, v129
  v_lshlrev_b32 v148, 16, v130
  v_and_b32 v149, s99, v130
  v_lshlrev_b32 v150, 16, v131
  v_and_b32 v151, s99, v131
  v_pk_fma_f32 v[144:145], v[144:145], v[210:211], v[210:211] op_sel:[0,0,1] op_sel_hi:[1,0,1]
  v_pk_fma_f32 v[146:147], v[146:147], v[210:211], v[210:211] op_sel:[0,0,1] op_sel_hi:[1,0,1]
  v_pk_fma_f32 v[148:149], v[148:149], v[210:211], v[210:211] op_sel:[0,0,1] op_sel_hi:[1,0,1]
  v_pk_fma_f32 v[150:151], v[150:151], v[210:211], v[210:211] op_sel:[0,0,1] op_sel_hi:[1,0,1]
  v_cvt_pk_bf16_f32 v128, v144, v145
  v_cvt_pk_bf16_f32 v129, v146, v147
  v_cvt_pk_bf16_f32 v130, v148, v149
  v_cvt_pk_bf16_f32 v131, v150, v151
  ds_write_b128 v12, v[128:131] offset:57344
  s_waitcnt vmcnt(27)
  v_lshlrev_b32 v136, 16, v132
  v_and_b32 v137, s99, v132
  v_lshlrev_b32 v138, 16, v133
  v_and_b32 v139, s99, v133
  v_lshlrev_b32 v140, 16, v134
  v_and_b32 v141, s99, v134
  v_lshlrev_b32 v142, 16, v135
  v_and_b32 v143, s99, v135
  v_pk_fma_f32 v[136:137], v[136:137], v[210:211], v[210:211] op_sel:[0,0,1] op_sel_hi:[1,0,1]
  v_pk_fma_f32 v[138:139], v[138:139], v[210:211], v[210:211] op_sel:[0,0,1] op_sel_hi:[1,0,1]
  v_pk_fma_f32 v[140:141], v[140:141], v[210:211], v[210:211] op_sel:[0,0,1] op_sel_hi:[1,0,1]
  v_pk_fma_f32 v[142:143], v[142:143], v[210:211], v[210:211] op_sel:[0,0,1] op_sel_hi:[1,0,1]
  v_cvt_pk_bf16_f32 v132, v136, v137
  v_cvt_pk_bf16_f32 v133, v138, v139
  v_cvt_pk_bf16_f32 v134, v140, v141
  v_cvt_pk_bf16_f32 v135, v142, v143
  v_add_u32 v13, 65536, v12
  ds_write_b128 v13, v[132:135]
  s_waitcnt lgkmcnt(0)
  s_barrier
  s_mov_b32 s8, 0xc0135761
  s_mov_b32 s9, 0xbdd2d3e8
  v_mov_b32 v20, s9
  v_lshrrev_b32 v3, 5, v1
  v_add_u32 v4, 0, v3
  v_xor_b32 v4, v4, v1
  v_lshlrev_b32 v14, 4, v4
  v_add_u32 v24, 65536, v14
  v_add_u32 v4, 2, v3
  v_xor_b32 v4, v4, v1
  v_lshlrev_b32 v15, 4, v4
  v_add_u32 v25, 65536, v15
  v_add_u32 v4, 4, v3
  v_xor_b32 v4, v4, v1
  v_lshlrev_b32 v16, 4, v4
  v_add_u32 v26, 65536, v16
  v_add_u32 v4, 6, v3
  v_xor_b32 v4, v4, v1
  v_lshlrev_b32 v17, 4, v4
  v_add_u32 v27, 65536, v17
  v_and_b32 v4, 15, v1
  v_bfe_u32 v5, v1, 4, 1
  v_lshl_add_u32 v4, v5, 5, v4
  v_lshlrev_b32 v6, 1, v3
  v_add_u32 v6, 0, v6
  v_add_u32 v6, v6, v5
  v_xor_b32 v6, v6, v4
  v_lshlrev_b32 v6, 4, v6
  v_lshl_add_u32 v28, v3, 11, v6
  v_lshlrev_b32 v6, 1, v3
  v_add_u32 v6, 4, v6
  v_add_u32 v6, v6, v5
  v_xor_b32 v6, v6, v4
  v_lshlrev_b32 v6, 4, v6
  v_lshl_add_u32 v29, v3, 11, v6
  v_add_u32 v30, 65536, v28
  v_add_u32 v31, 65536, v29
  s_mul_i32 s6, s3, 18432
  s_add_u32 s6, s6, 73728
  v_lshl_add_u32 v59, v1, 4, s6
  v_lshlrev_b32 v18, 4, v1
  v_add_u32 v18, 73728, v18
  v_add_u32 v19, 65536, v18
  v_lshlrev_b32 v60, 4, v4
  v_lshl_add_u32 v60, v3, 11, v60
  v_add_u32 v60, 73728, v60
  v_add_u32 v61, 65536, v60
  s_lshl_b32 s6, s3, 13
  v_add_u32 v22, s6, v18
  s_add_u32 s6, s6, 40960
  v_add_u32 v23, s6, v18
  v_lshlrev_b32 v62, 4, v4
  v_lshl_add_u32 v62, v3, 3, v62
  s_add_u32 s6, s3, 16
  s_lshl_b32 s6, s6, 11
  s_add_u32 s6, s6, 73728
  v_add_u32 v62, s6, v62
  s_add_u32 s68, s46, 0x1ae8000
  s_addc_u32 s69, s47, 0
  s_mov_b32 s70, 0x1200000
  s_mov_b32 s71, 0x20000
  v_bfe_u32 v5, v1, 3, 2
  v_mul_u32_u24 v5, 73728, v5
  v_and_b32 v6, 7, v1
  v_lshl_add_u32 v5, v6, 5, v5
  v_lshl_add_u32 v5, v3, 4, v5
  s_lshl_b32 s6, s5, 6
  s_add_u32 s6, s6, s4
  s_mul_i32 s6, s6, 9216
  v_add_u32 v21, s6, v5
  v_bfe_u32 v5, v1, 3, 1
  v_mul_u32_u24 v5, 73728, v5
  v_and_b32 v6, 7, v1
  v_lshl_add_u32 v5, v6, 5, v5
  v_lshrrev_b32 v6, 4, v1
  v_lshl_add_u32 v5, v6, 3, v5
  s_lshl_b32 s7, s3, 8
  s_add_u32 s7, s7, s6
  s_add_u32 s7, s7, 8192
  v_add_u32 v63, s7, v5
  ds_read_b128 v[224:227], v14 offset:0
  ds_read_b128 v[228:231], v14 offset:1024
  ds_read_b128 v[232:235], v15 offset:2048
  ds_read_b128 v[236:239], v15 offset:3072
  ds_read_b128 v[240:243], v16 offset:4096
  ds_read_b128 v[244:247], v16 offset:5120
  ds_read_b128 v[144:147], v28 offset:0
  ds_read_b128 v[148:151], v28 offset:256
  ds_read_b128 v[152:155], v28 offset:1024
  ds_read_b128 v[156:159], v28 offset:1280
  s_waitcnt lgkmcnt(8)
  v_mfma_f32_32x32x16_bf16 v[64:79], a[0:3], v[224:227], 0
  v_mfma_f32_32x32x16_bf16 v[80:95], a[0:3], v[228:231], 0
  buffer_load_dwordx4 a[0:3], v2, s[64:67], 0 offen offset:2048 sc1
  v_mfma_f32_32x32x16_bf16 v[96:111], a[72:75], v[224:227], 0
  s_add_u32 s52, s46, 0x684000
  v_mfma_f32_32x32x16_bf16 v[112:127], a[72:75], v[228:231], 0
  buffer_load_dwordx4 a[72:75], v2, s[64:67], 0 offen offset:3072 sc1
  ds_read_b128 v[224:227], v17 offset:6144
  ds_read_b128 v[228:231], v17 offset:7168
  s_waitcnt lgkmcnt(8)
  v_mfma_f32_32x32x16_bf16 v[64:79], a[144:147], v[232:235], v[64:79]
  s_addc_u32 s53, s47, 0
  v_mfma_f32_32x32x16_bf16 v[80:95], a[144:147], v[236:239], v[80:95]
  v_add_u32 v2, 4096, v2
  buffer_load_dwordx4 a[144:147], v2, s[64:67], 0 offen offset:0 sc1
  v_mfma_f32_32x32x16_bf16 v[96:111], a[4:7], v[232:235], v[96:111]
  s_mov_b32 s54, 0x240000
  v_mfma_f32_32x32x16_bf16 v[112:127], a[4:7], v[236:239], v[112:127]
  buffer_load_dwordx4 a[4:7], v2, s[64:67], 0 offen offset:1024 sc1
  s_waitcnt lgkmcnt(2)
  v_mfma_f32_16x16x32_bf16 v[128:131], a[76:79], v[144:147], 0
  v_mfma_f32_16x16x32_bf16 v[132:135], a[76:79], v[148:151], 0
  v_mfma_f32_16x16x32_bf16 v[136:139], a[76:79], v[152:155], 0
  v_mfma_f32_16x16x32_bf16 v[140:143], a[76:79], v[156:159], 0
  s_mov_b32 s55, 0x20000
  buffer_load_dwordx4 a[76:79], v2, s[64:67], 0 offen offset:2048 sc1
  ds_read_b128 v[232:235], v14 offset:8192
  ds_read_b128 v[236:239], v14 offset:9216
  ds_read_b128 v[144:147], v29 offset:4096
  ds_read_b128 v[148:151], v29 offset:4352
  ds_read_b128 v[152:155], v29 offset:5120
  ds_read_b128 v[156:159], v29 offset:5376
  v_mfma_f32_32x32x16_bf16 v[64:79], a[148:151], v[240:243], v[64:79]
  v_mfma_f32_32x32x16_bf16 v[80:95], a[148:151], v[244:247], v[80:95]
  s_add_u32 s56, s46, 0xd44000
  buffer_load_dwordx4 a[148:151], v2, s[64:67], 0 offen offset:3072 sc1
  v_mfma_f32_32x32x16_bf16 v[96:111], a[8:11], v[240:243], v[96:111]
  v_mfma_f32_32x32x16_bf16 v[112:127], a[8:11], v[244:247], v[112:127]
  s_addc_u32 s57, s47, 0
  v_add_u32 v2, 4096, v2
  buffer_load_dwordx4 a[8:11], v2, s[64:67], 0 offen offset:0 sc1
  ds_read_b128 v[240:243], v15 offset:10240
  ds_read_b128 v[244:247], v15 offset:11264
  s_waitcnt lgkmcnt(8)
  v_mfma_f32_32x32x16_bf16 v[64:79], a[80:83], v[224:227], v[64:79]
  v_mfma_f32_32x32x16_bf16 v[80:95], a[80:83], v[228:231], v[80:95]
  s_mov_b32 s58, 0x240000
  buffer_load_dwordx4 a[80:83], v2, s[64:67], 0 offen offset:1024 sc1
  v_mfma_f32_32x32x16_bf16 v[96:111], a[152:155], v[224:227], v[96:111]
  v_mfma_f32_32x32x16_bf16 v[112:127], a[152:155], v[228:231], v[112:127]
  s_mov_b32 s59, 0x20000
  buffer_load_dwordx4 a[152:155], v2, s[64:67], 0 offen offset:2048 sc1
  s_waitcnt lgkmcnt(2)
  v_mfma_f32_16x16x32_bf16 v[128:131], a[12:15], v[144:147], v[128:131]
  v_mfma_f32_16x16x32_bf16 v[132:135], a[12:15], v[148:151], v[132:135]
  v_mfma_f32_16x16x32_bf16 v[136:139], a[12:15], v[152:155], v[136:139]
  v_mfma_f32_16x16x32_bf16 v[140:143], a[12:15], v[156:159], v[140:143]
  buffer_load_dwordx4 a[12:15], v2, s[64:67], 0 offen offset:3072 sc1
  ds_read_b128 v[224:227], v16 offset:12288
  ds_read_b128 v[228:231], v16 offset:13312
  ds_read_b128 v[144:147], v28 offset:8192
  ds_read_b128 v[148:151], v28 offset:8448
  ds_read_b128 v[152:155], v28 offset:9216
  ds_read_b128 v[156:159], v28 offset:9472
  v_mfma_f32_32x32x16_bf16 v[64:79], a[84:87], v[232:235], v[64:79]
  s_mov_b32 s60, s42
  v_mfma_f32_32x32x16_bf16 v[80:95], a[84:87], v[236:239], v[80:95]
  v_add_u32 v2, 4096, v2
  buffer_load_dwordx4 a[84:87], v2, s[64:67], 0 offen offset:0 sc1
  v_mfma_f32_32x32x16_bf16 v[96:111], a[156:159], v[232:235], v[96:111]
  s_mov_b32 s61, s43
  v_mfma_f32_32x32x16_bf16 v[112:127], a[156:159], v[236:239], v[112:127]
  buffer_load_dwordx4 a[156:159], v2, s[64:67], 0 offen offset:1024 sc1
  ds_read_b128 v[232:235], v17 offset:14336
  ds_read_b128 v[236:239], v17 offset:15360
  s_waitcnt lgkmcnt(8)
  v_mfma_f32_32x32x16_bf16 v[64:79], a[16:19], v[240:243], v[64:79]
  s_mov_b32 s62, 0x240000
  v_mfma_f32_32x32x16_bf16 v[80:95], a[16:19], v[244:247], v[80:95]
  buffer_load_dwordx4 a[16:19], v2, s[64:67], 0 offen offset:2048 sc1
  v_mfma_f32_32x32x16_bf16 v[96:111], a[88:91], v[240:243], v[96:111]
  s_mov_b32 s63, 0x20000
  v_mfma_f32_32x32x16_bf16 v[112:127], a[88:91], v[244:247], v[112:127]
  buffer_load_dwordx4 a[88:91], v2, s[64:67], 0 offen offset:3072 sc1
  s_waitcnt lgkmcnt(2)
  v_mfma_f32_16x16x32_bf16 v[128:131], a[160:163], v[144:147], v[128:131]
  v_mfma_f32_16x16x32_bf16 v[132:135], a[160:163], v[148:151], v[132:135]
  v_mfma_f32_16x16x32_bf16 v[136:139], a[160:163], v[152:155], v[136:139]
  v_mfma_f32_16x16x32_bf16 v[140:143], a[160:163], v[156:159], v[140:143]
  s_add_u32 s48, s46, 0x680000
  v_add_u32 v2, 4096, v2
  buffer_load_dwordx4 a[160:163], v2, s[64:67], 0 offen offset:0 sc1
  ds_read_b128 v[240:243], v14 offset:16384
  ds_read_b128 v[244:247], v14 offset:17408
  ds_read_b128 v[144:147], v29 offset:12288
  ds_read_b128 v[148:151], v29 offset:12544
  ds_read_b128 v[152:155], v29 offset:13312
  ds_read_b128 v[156:159], v29 offset:13568
  v_mfma_f32_32x32x16_bf16 v[64:79], a[20:23], v[224:227], v[64:79]
  v_mfma_f32_32x32x16_bf16 v[80:95], a[20:23], v[228:231], v[80:95]
  s_addc_u32 s49, s47, 0
  buffer_load_dwordx4 a[20:23], v2, s[64:67], 0 offen offset:1024 sc1
  v_mfma_f32_32x32x16_bf16 v[96:111], a[92:95], v[224:227], v[96:111]
  v_mfma_f32_32x32x16_bf16 v[112:127], a[92:95], v[228:231], v[112:127]
  buffer_load_dwordx4 a[92:95], v2, s[64:67], 0 offen offset:2048 sc1
  ds_read_b128 v[224:227], v15 offset:18432
  ds_read_b128 v[228:231], v15 offset:19456
  s_waitcnt lgkmcnt(8)
  v_mfma_f32_32x32x16_bf16 v[64:79], a[164:167], v[232:235], v[64:79]
  s_mov_b32 s50, 0x3600
  v_mfma_f32_32x32x16_bf16 v[80:95], a[164:167], v[236:239], v[80:95]
  buffer_load_dwordx4 a[164:167], v2, s[64:67], 0 offen offset:3072 sc1
  v_mfma_f32_32x32x16_bf16 v[96:111], a[24:27], v[232:235], v[96:111]
  s_mov_b32 s51, 0x20000
  v_mfma_f32_32x32x16_bf16 v[112:127], a[24:27], v[236:239], v[112:127]
  v_add_u32 v2, 4096, v2
  buffer_load_dwordx4 a[24:27], v2, s[64:67], 0 offen offset:0 sc1
  s_waitcnt lgkmcnt(2)
  v_mfma_f32_16x16x32_bf16 v[128:131], a[96:99], v[144:147], v[128:131]
  v_mfma_f32_16x16x32_bf16 v[132:135], a[96:99], v[148:151], v[132:135]
  v_mfma_f32_16x16x32_bf16 v[136:139], a[96:99], v[152:155], v[136:139]
  v_mfma_f32_16x16x32_bf16 v[140:143], a[96:99], v[156:159], v[140:143]
  s_mov_b32 s99, 0xffff0000
  buffer_load_dwordx4 a[96:99], v2, s[64:67], 0 offen offset:1024 sc1
  ds_read_b128 v[232:235], v16 offset:20480
  ds_read_b128 v[236:239], v16 offset:21504
  ds_read_b128 v[144:147], v28 offset:16384
  ds_read_b128 v[148:151], v28 offset:16640
  ds_read_b128 v[152:155], v28 offset:17408
  ds_read_b128 v[156:159], v28 offset:17664
  v_mfma_f32_32x32x16_bf16 v[64:79], a[168:171], v[240:243], v[64:79]
  v_mfma_f32_32x32x16_bf16 v[80:95], a[168:171], v[244:247], v[80:95]
  s_lshl_b32 s6, s5, 3
  buffer_load_dwordx4 a[168:171], v2, s[64:67], 0 offen offset:2048 sc1
  v_mfma_f32_32x32x16_bf16 v[96:111], a[28:31], v[240:243], v[96:111]
  v_mfma_f32_32x32x16_bf16 v[112:127], a[28:31], v[244:247], v[112:127]
  s_add_u32 s6, s6, s4
  buffer_load_dwordx4 a[28:31], v2, s[64:67], 0 offen offset:3072 sc1
  ds_read_b128 v[240:243], v17 offset:22528
  ds_read_b128 v[244:247], v17 offset:23552
  s_waitcnt lgkmcnt(8)
  v_mfma_f32_32x32x16_bf16 v[64:79], a[100:103], v[224:227], v[64:79]
  v_mfma_f32_32x32x16_bf16 v[80:95], a[100:103], v[228:231], v[80:95]
  s_mul_i32 s6, s6, 73728
  v_add_u32 v2, 4096, v2
  buffer_load_dwordx4 a[100:103], v2, s[64:67], 0 offen offset:0 sc1
  v_mfma_f32_32x32x16_bf16 v[96:111], a[172:175], v[224:227], v[96:111]
  v_mfma_f32_32x32x16_bf16 v[112:127], a[172:175], v[228:231], v[112:127]
  v_lshl_add_u32 v4, v0, 4, s6
  buffer_load_dwordx4 a[172:175], v2, s[64:67], 0 offen offset:1024 sc1
  s_waitcnt lgkmcnt(2)
  v_mfma_f32_16x16x32_bf16 v[128:131], a[32:35], v[144:147], v[128:131]
  v_mfma_f32_16x16x32_bf16 v[132:135], a[32:35], v[148:151], v[132:135]
  v_mfma_f32_16x16x32_bf16 v[136:139], a[32:35], v[152:155], v[136:139]
  v_mfma_f32_16x16x32_bf16 v[140:143], a[32:35], v[156:159], v[140:143]
  buffer_load_dwordx4 a[32:35], v2, s[64:67], 0 offen offset:2048 sc1
  ds_read_b128 v[224:227], v14 offset:24576
  ds_read_b128 v[228:231], v14 offset:25600
  ds_read_b128 v[144:147], v29 offset:20480
  ds_read_b128 v[148:151], v29 offset:20736
  ds_read_b128 v[152:155], v29 offset:21504
  ds_read_b128 v[156:159], v29 offset:21760
  v_mfma_f32_32x32x16_bf16 v[64:79], a[104:107], v[232:235], v[64:79]
  v_cmp_gt_u32 vcc, 128, v0
  v_mfma_f32_32x32x16_bf16 v[80:95], a[104:107], v[236:239], v[80:95]
  buffer_load_dwordx4 a[104:107], v2, s[64:67], 0 offen offset:3072 sc1
  v_mfma_f32_32x32x16_bf16 v[96:111], a[176:179], v[232:235], v[96:111]
  v_mov_b32 v10, 0x7f000000
  v_mfma_f32_32x32x16_bf16 v[112:127], a[176:179], v[236:239], v[112:127]
  v_add_u32 v2, 4096, v2
  buffer_load_dwordx4 a[176:179], v2, s[64:67], 0 offen offset:0 sc1
  ds_read_b128 v[232:235], v15 offset:26624
  ds_read_b128 v[236:239], v15 offset:27648
  s_waitcnt vmcnt(52) lgkmcnt(8)
  v_mfma_f32_32x32x16_bf16 v[64:79], a[36:39], v[240:243], v[64:79]
  v_lshlrev_b32 v5, 3, v0
  v_mfma_f32_32x32x16_bf16 v[80:95], a[36:39], v[244:247], v[80:95]
  buffer_load_dwordx4 a[36:39], v2, s[64:67], 0 offen offset:1024 sc1
  v_mfma_f32_32x32x16_bf16 v[96:111], a[108:111], v[240:243], v[96:111]
  v_add_u32 v5, s6, v5
  v_mfma_f32_32x32x16_bf16 v[112:127], a[108:111], v[244:247], v[112:127]
  buffer_load_dwordx4 a[108:111], v2, s[64:67], 0 offen offset:2048 sc1
  s_waitcnt vmcnt(53) lgkmcnt(2)
  v_mfma_f32_16x16x32_bf16 v[128:131], a[180:183], v[144:147], v[128:131]
  v_mfma_f32_16x16x32_bf16 v[132:135], a[180:183], v[148:151], v[132:135]
  v_mfma_f32_16x16x32_bf16 v[136:139], a[180:183], v[152:155], v[136:139]
  v_mfma_f32_16x16x32_bf16 v[140:143], a[180:183], v[156:159], v[140:143]
  v_add_u32 v5, 8192, v5
  buffer_load_dwordx4 a[180:183], v2, s[64:67], 0 offen offset:3072 sc1
  ds_read_b128 v[240:243], v16 offset:28672
  ds_read_b128 v[244:247], v16 offset:29696
  ds_read_b128 v[144:147], v28 offset:24576
  ds_read_b128 v[148:151], v28 offset:24832
  ds_read_b128 v[152:155], v28 offset:25600
  ds_read_b128 v[156:159], v28 offset:25856
  s_waitcnt vmcnt(52)
  v_mfma_f32_32x32x16_bf16 v[64:79], a[40:43], v[224:227], v[64:79]
  v_mfma_f32_32x32x16_bf16 v[80:95], a[40:43], v[228:231], v[80:95]
  v_cndmask_b32 v5, v10, v5, vcc
  v_add_u32 v2, 4096, v2
  buffer_load_dwordx4 a[40:43], v2, s[64:67], 0 offen offset:0 sc1
  v_mfma_f32_32x32x16_bf16 v[96:111], a[112:115], v[224:227], v[96:111]
  v_mfma_f32_32x32x16_bf16 v[112:127], a[112:115], v[228:231], v[112:127]
  v_bfe_u32 v11, v0, 1, 3
  buffer_load_dwordx4 a[112:115], v2, s[64:67], 0 offen offset:1024 sc1
  ds_read_b128 v[224:227], v17 offset:30720
  ds_read_b128 v[228:231], v17 offset:31744
  s_waitcnt vmcnt(52) lgkmcnt(8)
  v_mfma_f32_32x32x16_bf16 v[64:79], a[184:187], v[232:235], v[64:79]
  v_mfma_f32_32x32x16_bf16 v[80:95], a[184:187], v[236:239], v[80:95]
  s_lshl_b32 s6, s5, 6
  buffer_load_dwordx4 a[184:187], v2, s[64:67], 0 offen offset:2048 sc1
  v_mfma_f32_32x32x16_bf16 v[96:111], a[44:47], v[232:235], v[96:111]
  v_mfma_f32_32x32x16_bf16 v[112:127], a[44:47], v[236:239], v[112:127]
  buffer_load_dwordx4 a[44:47], v2, s[64:67], 0 offen offset:3072 sc1
  s_waitcnt vmcnt(53) lgkmcnt(2)
  v_mfma_f32_16x16x32_bf16 v[128:131], a[116:119], v[144:147], v[128:131]
  v_mfma_f32_16x16x32_bf16 v[132:135], a[116:119], v[148:151], v[132:135]
  v_mfma_f32_16x16x32_bf16 v[136:139], a[116:119], v[152:155], v[136:139]
  v_mfma_f32_16x16x32_bf16 v[140:143], a[116:119], v[156:159], v[140:143]
  s_lshl_b32 s7, s4, 3
  v_add_u32 v2, 4096, v2
  buffer_load_dwordx4 a[116:119], v2, s[64:67], 0 offen offset:0 sc1
  ds_read_b128 v[232:235], v14 offset:32768
  ds_read_b128 v[236:239], v14 offset:33792
  ds_read_b128 v[144:147], v29 offset:28672
  ds_read_b128 v[148:151], v29 offset:28928
  ds_read_b128 v[152:155], v29 offset:29696
  ds_read_b128 v[156:159], v29 offset:29952
  s_waitcnt vmcnt(52)
  v_mfma_f32_32x32x16_bf16 v[64:79], a[188:191], v[240:243], v[64:79]
  v_mfma_f32_32x32x16_bf16 v[80:95], a[188:191], v[244:247], v[80:95]
  s_add_u32 s6, s6, s7
  buffer_load_dwordx4 a[188:191], v2, s[64:67], 0 offen offset:1024 sc1
  v_mfma_f32_32x32x16_bf16 v[96:111], a[48:51], v[240:243], v[96:111]
  v_mfma_f32_32x32x16_bf16 v[112:127], a[48:51], v[244:247], v[112:127]
  v_add_u32 v11, s6, v11
  buffer_load_dwordx4 a[48:51], v2, s[64:67], 0 offen offset:2048 sc1
  ds_read_b128 v[240:243], v15 offset:34816
  ds_read_b128 v[244:247], v15 offset:35840
  s_waitcnt vmcnt(52) lgkmcnt(8)
  v_mfma_f32_32x32x16_bf16 v[64:79], a[120:123], v[224:227], v[64:79]
  v_mfma_f32_32x32x16_bf16 v[80:95], a[120:123], v[228:231], v[80:95]
  s_movk_i32 s7, 1152
  buffer_load_dwordx4 a[120:123], v2, s[64:67], 0 offen offset:3072 sc1
  v_mfma_f32_32x32x16_bf16 v[96:111], a[192:195], v[224:227], v[96:111]
  v_mfma_f32_32x32x16_bf16 v[112:127], a[192:195], v[228:231], v[112:127]
  v_mul_lo_u32 v11, v11, s7
  v_add_u32 v2, 4096, v2
  buffer_load_dwordx4 a[192:195], v2, s[64:67], 0 offen offset:0 sc1
  s_waitcnt vmcnt(53) lgkmcnt(2)
  v_mfma_f32_16x16x32_bf16 v[128:131], a[52:55], v[144:147], v[128:131]
  v_mfma_f32_16x16x32_bf16 v[132:135], a[52:55], v[148:151], v[132:135]
  v_mfma_f32_16x16x32_bf16 v[136:139], a[52:55], v[152:155], v[136:139]
  v_mfma_f32_16x16x32_bf16 v[140:143], a[52:55], v[156:159], v[140:143]
  buffer_load_dwordx4 a[52:55], v2, s[64:67], 0 offen offset:1024 sc1
  ds_read_b128 v[224:227], v16 offset:36864
  ds_read_b128 v[228:231], v16 offset:37888
  ds_read_b128 v[144:147], v28 offset:32768
  ds_read_b128 v[148:151], v28 offset:33024
  ds_read_b128 v[152:155], v28 offset:33792
  ds_read_b128 v[156:159], v28 offset:34048
  s_waitcnt vmcnt(52)
  v_mfma_f32_32x32x16_bf16 v[64:79], a[124:127], v[232:235], v[64:79]
  v_bfe_u32 v12, v0, 5, 2
  v_mfma_f32_32x32x16_bf16 v[80:95], a[124:127], v[236:239], v[80:95]
  buffer_load_dwordx4 a[124:127], v2, s[64:67], 0 offen offset:2048 sc1
  v_mfma_f32_32x32x16_bf16 v[96:111], a[196:199], v[232:235], v[96:111]
  v_lshlrev_b32 v12, 6, v12
  v_mfma_f32_32x32x16_bf16 v[112:127], a[196:199], v[236:239], v[112:127]
  buffer_load_dwordx4 a[196:199], v2, s[64:67], 0 offen offset:3072 sc1
  ds_read_b128 v[232:235], v17 offset:38912
  ds_read_b128 v[236:239], v17 offset:39936
  s_waitcnt vmcnt(52) lgkmcnt(8)
  v_mfma_f32_32x32x16_bf16 v[64:79], a[56:59], v[240:243], v[64:79]
  v_lshrrev_b32 v13, 7, v0
  v_mfma_f32_32x32x16_bf16 v[80:95], a[56:59], v[244:247], v[80:95]
  v_add_u32 v2, 4096, v2
  buffer_load_dwordx4 a[56:59], v2, s[64:67], 0 offen offset:0 sc1
  v_mfma_f32_32x32x16_bf16 v[96:111], a[128:131], v[240:243], v[96:111]
  v_lshl_add_u32 v12, v13, 5, v12
  v_mfma_f32_32x32x16_bf16 v[112:127], a[128:131], v[244:247], v[112:127]
  buffer_load_dwordx4 a[128:131], v2, s[64:67], 0 offen offset:1024 sc1
  s_waitcnt vmcnt(53) lgkmcnt(2)
  v_mfma_f32_16x16x32_bf16 v[128:131], a[200:203], v[144:147], v[128:131]
  v_mfma_f32_16x16x32_bf16 v[132:135], a[200:203], v[148:151], v[132:135]
  v_mfma_f32_16x16x32_bf16 v[136:139], a[200:203], v[152:155], v[136:139]
  v_mfma_f32_16x16x32_bf16 v[140:143], a[200:203], v[156:159], v[140:143]
  v_and_b32 v13, 1, v0
  buffer_load_dwordx4 a[200:203], v2, s[64:67], 0 offen offset:2048 sc1
  ds_read_b128 v[240:243], v14 offset:40960
  ds_read_b128 v[244:247], v14 offset:41984
  ds_read_b128 v[144:147], v29 offset:36864
  ds_read_b128 v[148:151], v29 offset:37120
  ds_read_b128 v[152:155], v29 offset:37888
  ds_read_b128 v[156:159], v29 offset:38144
  s_waitcnt vmcnt(52)
  v_mfma_f32_32x32x16_bf16 v[64:79], a[60:63], v[224:227], v[64:79]
  v_mfma_f32_32x32x16_bf16 v[80:95], a[60:63], v[228:231], v[80:95]
  v_lshl_add_u32 v12, v13, 4, v12
  buffer_load_dwordx4 a[60:63], v2, s[64:67], 0 offen offset:3072 sc1
  v_mfma_f32_32x32x16_bf16 v[96:111], a[132:135], v[224:227], v[96:111]
  v_mfma_f32_32x32x16_bf16 v[112:127], a[132:135], v[228:231], v[112:127]
  v_bfe_u32 v13, v0, 4, 1
  v_add_u32 v2, 4096, v2
  buffer_load_dwordx4 a[132:135], v2, s[64:67], 0 offen offset:0 sc1
  ds_read_b128 v[224:227], v15 offset:43008
  ds_read_b128 v[228:231], v15 offset:44032
  s_waitcnt vmcnt(52) lgkmcnt(8)
  v_mfma_f32_32x32x16_bf16 v[64:79], a[204:207], v[232:235], v[64:79]
  v_mfma_f32_32x32x16_bf16 v[80:95], a[204:207], v[236:239], v[80:95]
  v_lshl_add_u32 v12, v13, 3, v12
  buffer_load_dwordx4 a[204:207], v2, s[64:67], 0 offen offset:1024 sc1
  v_mfma_f32_32x32x16_bf16 v[96:111], a[64:67], v[232:235], v[96:111]
  v_mfma_f32_32x32x16_bf16 v[112:127], a[64:67], v[236:239], v[112:127]
  v_lshl_add_u32 v6, v12, 1, v11
  buffer_load_dwordx4 a[64:67], v2, s[64:67], 0 offen offset:2048 sc1
  s_waitcnt vmcnt(53) lgkmcnt(2)
  v_mfma_f32_16x16x32_bf16 v[128:131], a[136:139], v[144:147], v[128:131]
  v_mfma_f32_16x16x32_bf16 v[132:135], a[136:139], v[148:151], v[132:135]
  v_mfma_f32_16x16x32_bf16 v[136:139], a[136:139], v[152:155], v[136:139]
  v_mfma_f32_16x16x32_bf16 v[140:143], a[136:139], v[156:159], v[140:143]
  buffer_load_dwordx4 a[136:139], v2, s[64:67], 0 offen offset:3072 sc1
  ds_read_b128 v[232:235], v16 offset:45056
  ds_read_b128 v[236:239], v16 offset:46080
  ds_read_b128 v[144:147], v28 offset:40960
  ds_read_b128 v[148:151], v28 offset:41216
  ds_read_b128 v[152:155], v28 offset:41984
  ds_read_b128 v[156:159], v28 offset:42240
  s_waitcnt vmcnt(52)
  v_mfma_f32_32x32x16_bf16 v[64:79], a[208:211], v[240:243], v[64:79]
  v_mfma_f32_32x32x16_bf16 v[80:95], a[208:211], v[244:247], v[80:95]
  v_lshlrev_b32 v7, 2, v12
  v_add_u32 v2, 4096, v2
  buffer_load_dwordx4 a[208:211], v2, s[64:67], 0 offen offset:0 sc1
  v_mfma_f32_32x32x16_bf16 v[96:111], a[68:71], v[240:243], v[96:111]
  v_mfma_f32_32x32x16_bf16 v[112:127], a[68:71], v[244:247], v[112:127]
  v_add_u32 v7, 11520, v7
  buffer_load_dwordx4 a[68:71], v2, s[64:67], 0 offen offset:1024 sc1
  ds_read_b128 v[240:243], v17 offset:47104
  ds_read_b128 v[244:247], v17 offset:48128
  s_waitcnt vmcnt(52) lgkmcnt(8)
  v_mfma_f32_32x32x16_bf16 v[64:79], a[140:143], v[224:227], v[64:79]
  v_mfma_f32_32x32x16_bf16 v[80:95], a[140:143], v[228:231], v[80:95]
  v_bfe_u32 v11, v0, 2, 3
  buffer_load_dwordx4 a[140:143], v2, s[64:67], 0 offen offset:2048 sc1
  v_mfma_f32_32x32x16_bf16 v[96:111], a[212:215], v[224:227], v[96:111]
  v_mfma_f32_32x32x16_bf16 v[112:127], a[212:215], v[228:231], v[112:127]
  v_add_u32 v11, s6, v11
  buffer_load_dwordx4 a[212:215], v2, s[64:67], 0 offen offset:3072 sc1
  s_waitcnt vmcnt(53) lgkmcnt(2)
  v_mfma_f32_16x16x32_bf16 v[128:131], a[0:3], v[144:147], v[128:131]
  v_mfma_f32_16x16x32_bf16 v[132:135], a[0:3], v[148:151], v[132:135]
  v_mfma_f32_16x16x32_bf16 v[136:139], a[0:3], v[152:155], v[136:139]
  v_mfma_f32_16x16x32_bf16 v[140:143], a[0:3], v[156:159], v[140:143]
  v_add_u32 v2, 4096, v2
  buffer_load_dwordx4 a[0:3], v2, s[64:67], 0 offen offset:0 sc1
  ds_read_b128 v[224:227], v14 offset:49152
  ds_read_b128 v[228:231], v14 offset:50176
  ds_read_b128 v[144:147], v29 offset:45056
  ds_read_b128 v[148:151], v29 offset:45312
  ds_read_b128 v[152:155], v29 offset:46080
  ds_read_b128 v[156:159], v29 offset:46336
  s_waitcnt vmcnt(52)
  v_mfma_f32_32x32x16_bf16 v[64:79], a[72:75], v[232:235], v[64:79]
  v_mul_lo_u32 v11, v11, s7
  v_mfma_f32_32x32x16_bf16 v[80:95], a[72:75], v[236:239], v[80:95]
  buffer_load_dwordx4 a[72:75], v2, s[64:67], 0 offen offset:1024 sc1
  v_mfma_f32_32x32x16_bf16 v[96:111], a[144:147], v[232:235], v[96:111]
  v_lshrrev_b32 v12, 5, v0
  v_mfma_f32_32x32x16_bf16 v[112:127], a[144:147], v[236:239], v[112:127]
  buffer_load_dwordx4 a[144:147], v2, s[64:67], 0 offen offset:2048 sc1
  ds_read_b128 v[232:235], v15 offset:51200
  ds_read_b128 v[236:239], v15 offset:52224
  s_waitcnt vmcnt(52) lgkmcnt(8)
  v_mfma_f32_32x32x16_bf16 v[64:79], a[4:7], v[240:243], v[64:79]
  v_lshlrev_b32 v12, 4, v12
  v_mfma_f32_32x32x16_bf16 v[80:95], a[4:7], v[244:247], v[80:95]
  buffer_load_dwordx4 a[4:7], v2, s[64:67], 0 offen offset:3072 sc1
  v_mfma_f32_32x32x16_bf16 v[96:111], a[76:79], v[240:243], v[96:111]
  v_and_b32 v13, 3, v0
  v_mfma_f32_32x32x16_bf16 v[112:127], a[76:79], v[244:247], v[112:127]
  v_add_u32 v2, 4096, v2
  buffer_load_dwordx4 a[76:79], v2, s[64:67], 0 offen offset:0 sc1
  s_waitcnt vmcnt(53) lgkmcnt(2)
  v_mfma_f32_16x16x32_bf16 v[128:131], a[148:151], v[144:147], v[128:131]
  v_mfma_f32_16x16x32_bf16 v[132:135], a[148:151], v[148:151], v[132:135]
  v_mfma_f32_16x16x32_bf16 v[136:139], a[148:151], v[152:155], v[136:139]
  v_mfma_f32_16x16x32_bf16 v[140:143], a[148:151], v[156:159], v[140:143]
  v_lshl_add_u32 v12, v13, 2, v12
  buffer_load_dwordx4 a[148:151], v2, s[64:67], 0 offen offset:1024 sc1
  ds_read_b128 v[240:243], v16 offset:53248
  ds_read_b128 v[244:247], v16 offset:54272
  ds_read_b128 v[144:147], v28 offset:49152
  ds_read_b128 v[148:151], v28 offset:49408
  ds_read_b128 v[152:155], v28 offset:50176
  ds_read_b128 v[156:159], v28 offset:50432
  s_waitcnt vmcnt(52)
  v_mfma_f32_32x32x16_bf16 v[64:79], a[8:11], v[224:227], v[64:79]
  v_mfma_f32_32x32x16_bf16 v[80:95], a[8:11], v[228:231], v[80:95]
  v_add_u32 v12, 256, v12
  buffer_load_dwordx4 a[8:11], v2, s[64:67], 0 offen offset:2048 sc1
  v_mfma_f32_32x32x16_bf16 v[96:111], a[80:83], v[224:227], v[96:111]
  v_mfma_f32_32x32x16_bf16 v[112:127], a[80:83], v[228:231], v[112:127]
  v_lshl_add_u32 v8, v12, 1, v11
  buffer_load_dwordx4 a[80:83], v2, s[64:67], 0 offen offset:3072 sc1
  ds_read_b128 v[224:227], v17 offset:55296
  ds_read_b128 v[228:231], v17 offset:56320
  s_waitcnt vmcnt(52) lgkmcnt(8)
  v_mfma_f32_32x32x16_bf16 v[64:79], a[152:155], v[232:235], v[64:79]
  v_mfma_f32_32x32x16_bf16 v[80:95], a[152:155], v[236:239], v[80:95]
  v_lshlrev_b32 v9, 2, v12
  v_add_u32 v2, 4096, v2
  buffer_load_dwordx4 a[152:155], v2, s[64:67], 0 offen offset:0 sc1
  v_mfma_f32_32x32x16_bf16 v[96:111], a[12:15], v[232:235], v[96:111]
  v_mfma_f32_32x32x16_bf16 v[112:127], a[12:15], v[236:239], v[112:127]
  v_add_u32 v9, 11520, v9
  buffer_load_dwordx4 a[12:15], v2, s[64:67], 0 offen offset:1024 sc1
  s_waitcnt vmcnt(53) lgkmcnt(2)
  v_mfma_f32_16x16x32_bf16 v[128:131], a[84:87], v[144:147], v[128:131]
  v_mfma_f32_16x16x32_bf16 v[132:135], a[84:87], v[148:151], v[132:135]
  v_mfma_f32_16x16x32_bf16 v[136:139], a[84:87], v[152:155], v[136:139]
  v_mfma_f32_16x16x32_bf16 v[140:143], a[84:87], v[156:159], v[140:143]
  buffer_load_dwordx4 a[84:87], v2, s[64:67], 0 offen offset:2048 sc1
  ds_read_b128 v[232:235], v14 offset:57344
  ds_read_b128 v[236:239], v14 offset:58368
  ds_read_b128 v[144:147], v29 offset:53248
  ds_read_b128 v[148:151], v29 offset:53504
  ds_read_b128 v[152:155], v29 offset:54272
  ds_read_b128 v[156:159], v29 offset:54528
  s_waitcnt vmcnt(52)
  v_mfma_f32_32x32x16_bf16 v[64:79], a[156:159], v[240:243], v[64:79]
  v_cndmask_b32 v8, v10, v8, vcc
  v_mfma_f32_32x32x16_bf16 v[80:95], a[156:159], v[244:247], v[80:95]
  buffer_load_dwordx4 a[156:159], v2, s[64:67], 0 offen offset:3072 sc1
  v_mfma_f32_32x32x16_bf16 v[96:111], a[16:19], v[240:243], v[96:111]
  v_cndmask_b32 v9, v10, v9, vcc
  v_mfma_f32_32x32x16_bf16 v[112:127], a[16:19], v[244:247], v[112:127]
  v_add_u32 v2, 4096, v2
  buffer_load_dwordx4 a[16:19], v2, s[64:67], 0 offen offset:0 sc1
  ds_read_b128 v[240:243], v15 offset:59392
  ds_read_b128 v[244:247], v15 offset:60416
  s_waitcnt vmcnt(52) lgkmcnt(8)
  v_mfma_f32_32x32x16_bf16 v[64:79], a[88:91], v[224:227], v[64:79]
  v_mfma_f32_32x32x16_bf16 v[80:95], a[88:91], v[228:231], v[80:95]
  buffer_load_dwordx4 a[88:91], v2, s[64:67], 0 offen offset:1024 sc1
  v_mfma_f32_32x32x16_bf16 v[96:111], a[160:163], v[224:227], v[96:111]
  v_mfma_f32_32x32x16_bf16 v[112:127], a[160:163], v[228:231], v[112:127]
  buffer_load_dwordx4 a[160:163], v2, s[64:67], 0 offen offset:2048 sc1
  s_waitcnt vmcnt(53) lgkmcnt(2)
  v_mfma_f32_16x16x32_bf16 v[128:131], a[20:23], v[144:147], v[128:131]
  v_mfma_f32_16x16x32_bf16 v[132:135], a[20:23], v[148:151], v[132:135]
  v_mfma_f32_16x16x32_bf16 v[136:139], a[20:23], v[152:155], v[136:139]
  v_mfma_f32_16x16x32_bf16 v[140:143], a[20:23], v[156:159], v[140:143]
  buffer_load_dwordx4 a[20:23], v2, s[64:67], 0 offen offset:3072 sc1
  ds_read_b128 v[224:227], v16 offset:61440
  ds_read_b128 v[228:231], v16 offset:62464
  ds_read_b128 v[144:147], v28 offset:57344
  ds_read_b128 v[148:151], v28 offset:57600
  ds_read_b128 v[152:155], v28 offset:58368
  ds_read_b128 v[156:159], v28 offset:58624
  s_waitcnt vmcnt(52)
  v_mfma_f32_32x32x16_bf16 v[64:79], a[92:95], v[232:235], v[64:79]
  v_mfma_f32_32x32x16_bf16 v[80:95], a[92:95], v[236:239], v[80:95]
  v_add_u32 v2, 4096, v2
  buffer_load_dwordx4 a[92:95], v2, s[64:67], 0 offen offset:0 sc1
  v_mfma_f32_32x32x16_bf16 v[96:111], a[164:167], v[232:235], v[96:111]
  v_mfma_f32_32x32x16_bf16 v[112:127], a[164:167], v[236:239], v[112:127]
  buffer_load_dwordx4 a[164:167], v2, s[64:67], 0 offen offset:1024 sc1
  ds_read_b128 v[232:235], v17 offset:63488
  ds_read_b128 v[236:239], v17 offset:64512
  s_waitcnt vmcnt(52) lgkmcnt(8)
  v_mfma_f32_32x32x16_bf16 v[64:79], a[24:27], v[240:243], v[64:79]
  v_mfma_f32_32x32x16_bf16 v[80:95], a[24:27], v[244:247], v[80:95]
  buffer_load_dwordx4 a[24:27], v2, s[64:67], 0 offen offset:2048 sc1
  v_mfma_f32_32x32x16_bf16 v[96:111], a[96:99], v[240:243], v[96:111]
  v_mfma_f32_32x32x16_bf16 v[112:127], a[96:99], v[244:247], v[112:127]
  buffer_load_dwordx4 a[96:99], v2, s[64:67], 0 offen offset:3072 sc1
  s_waitcnt vmcnt(53) lgkmcnt(2)
  v_mfma_f32_16x16x32_bf16 v[128:131], a[168:171], v[144:147], v[128:131]
  v_mfma_f32_16x16x32_bf16 v[132:135], a[168:171], v[148:151], v[132:135]
  v_mfma_f32_16x16x32_bf16 v[136:139], a[168:171], v[152:155], v[136:139]
  v_mfma_f32_16x16x32_bf16 v[140:143], a[168:171], v[156:159], v[140:143]
  v_add_u32 v2, 4096, v2
  buffer_load_dwordx4 a[168:171], v2, s[64:67], 0 offen offset:0 sc1
  ds_read_b128 v[240:243], v24 offset:0
  ds_read_b128 v[244:247], v24 offset:1024
  ds_read_b128 v[144:147], v29 offset:61440
  ds_read_b128 v[148:151], v29 offset:61696
  ds_read_b128 v[152:155], v29 offset:62464
  ds_read_b128 v[156:159], v29 offset:62720
  s_waitcnt vmcnt(52)
  v_mfma_f32_32x32x16_bf16 v[64:79], a[28:31], v[224:227], v[64:79]
  v_mfma_f32_32x32x16_bf16 v[80:95], a[28:31], v[228:231], v[80:95]
  buffer_load_dwordx4 a[28:31], v2, s[64:67], 0 offen offset:1024 sc1
  v_mfma_f32_32x32x16_bf16 v[96:111], a[100:103], v[224:227], v[96:111]
  v_mfma_f32_32x32x16_bf16 v[112:127], a[100:103], v[228:231], v[112:127]
  buffer_load_dwordx4 a[100:103], v2, s[64:67], 0 offen offset:2048 sc1
  ds_read_b128 v[224:227], v25 offset:2048
  ds_read_b128 v[228:231], v25 offset:3072
  s_waitcnt vmcnt(52) lgkmcnt(8)
  v_mfma_f32_32x32x16_bf16 v[64:79], a[172:175], v[232:235], v[64:79]
  v_mfma_f32_32x32x16_bf16 v[80:95], a[172:175], v[236:239], v[80:95]
  buffer_load_dwordx4 a[172:175], v2, s[64:67], 0 offen offset:3072 sc1
  v_mfma_f32_32x32x16_bf16 v[96:111], a[32:35], v[232:235], v[96:111]
  v_mfma_f32_32x32x16_bf16 v[112:127], a[32:35], v[236:239], v[112:127]
  v_add_u32 v2, 4096, v2
  buffer_load_dwordx4 a[32:35], v2, s[64:67], 0 offen offset:0 sc1
  s_waitcnt vmcnt(53) lgkmcnt(2)
  v_mfma_f32_16x16x32_bf16 v[128:131], a[104:107], v[144:147], v[128:131]
  v_mfma_f32_16x16x32_bf16 v[132:135], a[104:107], v[148:151], v[132:135]
  v_mfma_f32_16x16x32_bf16 v[136:139], a[104:107], v[152:155], v[136:139]
  v_mfma_f32_16x16x32_bf16 v[140:143], a[104:107], v[156:159], v[140:143]
  buffer_load_dwordx4 a[104:107], v2, s[64:67], 0 offen offset:1024 sc1
  ds_read_b128 v[232:235], v26 offset:4096
  ds_read_b128 v[236:239], v26 offset:5120
  ds_read_b128 v[144:147], v30 offset:0
  ds_read_b128 v[148:151], v30 offset:256
  ds_read_b128 v[152:155], v30 offset:1024
  ds_read_b128 v[156:159], v30 offset:1280
  s_waitcnt vmcnt(52)
  v_mfma_f32_32x32x16_bf16 v[64:79], a[176:179], v[240:243], v[64:79]
  v_mfma_f32_32x32x16_bf16 v[80:95], a[176:179], v[244:247], v[80:95]
  buffer_load_dwordx4 a[176:179], v2, s[64:67], 0 offen offset:2048 sc1
  v_mfma_f32_32x32x16_bf16 v[96:111], a[36:39], v[240:243], v[96:111]
  v_mfma_f32_32x32x16_bf16 v[112:127], a[36:39], v[244:247], v[112:127]
  buffer_load_dwordx4 a[36:39], v2, s[64:67], 0 offen offset:3072 sc1
  ds_read_b128 v[240:243], v27 offset:6144
  ds_read_b128 v[244:247], v27 offset:7168
  s_waitcnt vmcnt(52) lgkmcnt(8)
  v_mfma_f32_32x32x16_bf16 v[64:79], a[108:111], v[224:227], v[64:79]
  v_mfma_f32_32x32x16_bf16 v[80:95], a[108:111], v[228:231], v[80:95]
  v_add_u32 v2, 4096, v2
  buffer_load_dwordx4 a[108:111], v2, s[64:67], 0 offen offset:0 sc1
  v_mfma_f32_32x32x16_bf16 v[96:111], a[180:183], v[224:227], v[96:111]
  v_mfma_f32_32x32x16_bf16 v[112:127], a[180:183], v[228:231], v[112:127]
  buffer_load_dwordx4 a[180:183], v2, s[64:67], 0 offen offset:1024 sc1
  s_waitcnt vmcnt(53) lgkmcnt(2)
  v_mfma_f32_16x16x32_bf16 v[128:131], a[40:43], v[144:147], v[128:131]
  v_mfma_f32_16x16x32_bf16 v[132:135], a[40:43], v[148:151], v[132:135]
  v_mfma_f32_16x16x32_bf16 v[136:139], a[40:43], v[152:155], v[136:139]
  v_mfma_f32_16x16x32_bf16 v[140:143], a[40:43], v[156:159], v[140:143]
  buffer_load_dwordx4 a[40:43], v2, s[64:67], 0 offen offset:2048 sc1
  ds_read_b128 v[144:147], v31 offset:4096
  ds_read_b128 v[148:151], v31 offset:4352
  ds_read_b128 v[152:155], v31 offset:5120
  ds_read_b128 v[156:159], v31 offset:5376
  s_waitcnt vmcnt(52)
  v_mfma_f32_32x32x16_bf16 v[64:79], a[112:115], v[232:235], v[64:79]
  v_mfma_f32_32x32x16_bf16 v[80:95], a[112:115], v[236:239], v[80:95]
  buffer_load_dwordx4 a[112:115], v2, s[64:67], 0 offen offset:3072 sc1
  v_mfma_f32_32x32x16_bf16 v[96:111], a[184:187], v[232:235], v[96:111]
  v_mfma_f32_32x32x16_bf16 v[112:127], a[184:187], v[236:239], v[112:127]
  v_add_u32 v2, 4096, v2
  buffer_load_dwordx4 a[184:187], v2, s[64:67], 0 offen offset:0 sc1
  s_waitcnt vmcnt(52) lgkmcnt(4)
  v_mfma_f32_32x32x16_bf16 v[64:79], a[44:47], v[240:243], v[64:79]
  v_mfma_f32_32x32x16_bf16 v[80:95], a[44:47], v[244:247], v[80:95]
  buffer_load_dwordx4 a[44:47], v2, s[64:67], 0 offen offset:1024 sc1
  v_mfma_f32_32x32x16_bf16 v[96:111], a[116:119], v[240:243], v[96:111]
  v_mfma_f32_32x32x16_bf16 v[112:127], a[116:119], v[244:247], v[112:127]
  buffer_load_dwordx4 a[116:119], v2, s[64:67], 0 offen offset:2048 sc1
  s_waitcnt vmcnt(53) lgkmcnt(0)
  v_mfma_f32_16x16x32_bf16 v[128:131], a[188:191], v[144:147], v[128:131]
  v_mfma_f32_16x16x32_bf16 v[132:135], a[188:191], v[148:151], v[132:135]
  v_mfma_f32_16x16x32_bf16 v[136:139], a[188:191], v[152:155], v[136:139]
  v_mfma_f32_16x16x32_bf16 v[140:143], a[188:191], v[156:159], v[140:143]
  buffer_load_dwordx4 a[188:191], v2, s[64:67], 0 offen offset:3072 sc1
  ds_read_b128 v[224:227], v14 offset:0
  ds_read_b128 v[228:231], v14 offset:1024
  ds_read_b128 v[232:235], v15 offset:2048
  ds_read_b128 v[236:239], v15 offset:3072
  ds_read_b128 v[240:243], v16 offset:4096
  ds_read_b128 v[244:247], v16 offset:5120
  s_waitcnt vmcnt(52) lgkmcnt(4)
  v_mfma_f32_32x32x16_bf16 v[160:175], a[48:51], v[224:227], 0
  v_mul_f32 v32, v64, v64
  v_mul_f32 v33, v65, v65
  v_mul_f32 v34, v66, v66
  v_mul_f32 v35, v67, v67
  v_mfma_f32_32x32x16_bf16 v[176:191], a[48:51], v[228:231], 0
  v_fma_f32 v32, v32, v20, s8
  v_fma_f32 v33, v33, v20, s8
  v_fma_f32 v34, v34, v20, s8
  v_fma_f32 v35, v35, v20, s8
  v_add_u32 v2, 4096, v2
  buffer_load_dwordx4 a[48:51], v2, s[64:67], 0 offen offset:0 sc1
  v_mfma_f32_32x32x16_bf16 v[192:207], a[120:123], v[224:227], 0
  v_mul_f32 v32, v32, v64
  v_mul_f32 v33, v33, v65
  v_mul_f32 v34, v34, v66
  v_mul_f32 v35, v35, v67
  v_exp_f32 v32, v32
  v_mfma_f32_32x32x16_bf16 v[208:223], a[120:123], v[228:231], 0
  v_exp_f32 v33, v33
  v_exp_f32 v34, v34
  v_exp_f32 v35, v35
  v_add_f32 v32, 1.0, v32
  buffer_load_dwordx4 a[120:123], v2, s[64:67], 0 offen offset:1024 sc1
  ds_read_b128 v[224:227], v17 offset:6144
  ds_read_b128 v[228:231], v17 offset:7168
  s_waitcnt vmcnt(52) lgkmcnt(4)
  v_mfma_f32_32x32x16_bf16 v[160:175], a[192:195], v[232:235], v[160:175]
  v_add_f32 v33, 1.0, v33
  v_add_f32 v34, 1.0, v34
  v_add_f32 v35, 1.0, v35
  v_rcp_f32 v32, v32
  v_rcp_f32 v33, v33
  v_mfma_f32_32x32x16_bf16 v[176:191], a[192:195], v[236:239], v[176:191]
  v_rcp_f32 v34, v34
  v_rcp_f32 v35, v35
  v_mul_f32 v32, v64, v32
  v_mul_f32 v33, v65, v33
  buffer_load_dwordx4 a[192:195], v2, s[64:67], 0 offen offset:2048 sc1
  v_mfma_f32_32x32x16_bf16 v[192:207], a[52:55], v[232:235], v[192:207]
  v_mul_f32 v34, v66, v34
  v_mul_f32 v35, v67, v35
  v_cvt_pk_bf16_f32 v40, v32, v33
  v_cvt_pk_bf16_f32 v41, v34, v35
  v_mul_f32 v36, v68, v68
  v_mfma_f32_32x32x16_bf16 v[208:223], a[52:55], v[236:239], v[208:223]
  v_mul_f32 v37, v69, v69
  v_mul_f32 v38, v70, v70
  v_mul_f32 v39, v71, v71
  v_fma_f32 v36, v36, v20, s8
  buffer_load_dwordx4 a[52:55], v2, s[64:67], 0 offen offset:3072 sc1
  ds_read_b128 v[232:235], v14 offset:8192
  ds_read_b128 v[236:239], v14 offset:9216
  s_waitcnt vmcnt(52) lgkmcnt(4)
  v_mfma_f32_32x32x16_bf16 v[160:175], a[124:127], v[240:243], v[160:175]
  v_fma_f32 v37, v37, v20, s8
  v_fma_f32 v38, v38, v20, s8
  v_fma_f32 v39, v39, v20, s8
  v_mul_f32 v36, v36, v68
  v_mfma_f32_32x32x16_bf16 v[176:191], a[124:127], v[244:247], v[176:191]
  v_mul_f32 v37, v37, v69
  v_mul_f32 v38, v38, v70
  v_mul_f32 v39, v39, v71
  v_exp_f32 v36, v36
  v_exp_f32 v37, v37
  v_add_u32 v2, 4096, v2
  buffer_load_dwordx4 a[124:127], v2, s[64:67], 0 offen offset:0 sc1
  v_mfma_f32_32x32x16_bf16 v[192:207], a[196:199], v[240:243], v[192:207]
  v_exp_f32 v38, v38
  v_exp_f32 v39, v39
  v_add_f32 v36, 1.0, v36
  v_add_f32 v37, 1.0, v37
  v_mfma_f32_32x32x16_bf16 v[208:223], a[196:199], v[244:247], v[208:223]
  v_add_f32 v38, 1.0, v38
  v_add_f32 v39, 1.0, v39
  v_rcp_f32 v36, v36
  v_rcp_f32 v37, v37
  v_rcp_f32 v38, v38
  buffer_load_dwordx4 a[196:199], v2, s[64:67], 0 offen offset:1024 sc1
  ds_read_b128 v[240:243], v15 offset:10240
  ds_read_b128 v[244:247], v15 offset:11264
  s_waitcnt vmcnt(52) lgkmcnt(4)
  v_mfma_f32_32x32x16_bf16 v[160:175], a[56:59], v[224:227], v[160:175]
  v_rcp_f32 v39, v39
  v_mul_f32 v36, v68, v36
  v_mul_f32 v37, v69, v37
  v_mul_f32 v38, v70, v38
  v_mfma_f32_32x32x16_bf16 v[176:191], a[56:59], v[228:231], v[176:191]
  v_mul_f32 v39, v71, v39
  v_cvt_pk_bf16_f32 v42, v36, v37
  v_cvt_pk_bf16_f32 v43, v38, v39
  ds_write_b128 v22, v[40:43] offset:0
  v_mul_f32 v32, v72, v72
  buffer_load_dwordx4 a[56:59], v2, s[64:67], 0 offen offset:2048 sc1
  v_mfma_f32_32x32x16_bf16 v[192:207], a[128:131], v[224:227], v[192:207]
  v_mul_f32 v33, v73, v73
  v_mul_f32 v34, v74, v74
  v_mul_f32 v35, v75, v75
  v_fma_f32 v32, v32, v20, s8
  v_mfma_f32_32x32x16_bf16 v[208:223], a[128:131], v[228:231], v[208:223]
  v_fma_f32 v33, v33, v20, s8
  v_fma_f32 v34, v34, v20, s8
  v_fma_f32 v35, v35, v20, s8
  v_mul_f32 v32, v32, v72
  buffer_load_dwordx4 a[128:131], v2, s[64:67], 0 offen offset:3072 sc1
  ds_read_b128 v[224:227], v16 offset:12288
  ds_read_b128 v[228:231], v16 offset:13312
  s_waitcnt vmcnt(52) lgkmcnt(5)
  v_mfma_f32_32x32x16_bf16 v[160:175], a[200:203], v[232:235], v[160:175]
  v_mul_f32 v33, v33, v73
  v_mul_f32 v34, v34, v74
  v_mul_f32 v35, v35, v75
  v_exp_f32 v32, v32
  v_exp_f32 v33, v33
  v_mfma_f32_32x32x16_bf16 v[176:191], a[200:203], v[236:239], v[176:191]
  v_exp_f32 v34, v34
  v_exp_f32 v35, v35
  v_add_f32 v32, 1.0, v32
  v_add_f32 v33, 1.0, v33
  v_add_u32 v2, 4096, v2
  buffer_load_dwordx4 a[200:203], v2, s[64:67], 0 offen offset:0 sc1
  v_mfma_f32_32x32x16_bf16 v[192:207], a[60:63], v[232:235], v[192:207]
  v_add_f32 v34, 1.0, v34
  v_add_f32 v35, 1.0, v35
  v_rcp_f32 v32, v32
  v_rcp_f32 v33, v33
  v_rcp_f32 v34, v34
  v_mfma_f32_32x32x16_bf16 v[208:223], a[60:63], v[236:239], v[208:223]
  v_rcp_f32 v35, v35
  v_mul_f32 v32, v72, v32
  v_mul_f32 v33, v73, v33
  v_mul_f32 v34, v74, v34
  buffer_load_dwordx4 a[60:63], v2, s[64:67], 0 offen offset:1024 sc1
  ds_read_b128 v[232:235], v17 offset:14336
  ds_read_b128 v[236:239], v17 offset:15360
  s_waitcnt vmcnt(52) lgkmcnt(5)
  v_mfma_f32_32x32x16_bf16 v[160:175], a[132:135], v[240:243], v[160:175]
  v_mul_f32 v35, v75, v35
  v_cvt_pk_bf16_f32 v44, v32, v33
  v_cvt_pk_bf16_f32 v45, v34, v35
  v_mul_f32 v36, v76, v76
  v_mul_f32 v37, v77, v77
  v_mfma_f32_32x32x16_bf16 v[176:191], a[132:135], v[244:247], v[176:191]
  v_mul_f32 v38, v78, v78
  v_mul_f32 v39, v79, v79
  v_fma_f32 v36, v36, v20, s8
  v_fma_f32 v37, v37, v20, s8
  buffer_load_dwordx4 a[132:135], v2, s[64:67], 0 offen offset:2048 sc1
  v_mfma_f32_32x32x16_bf16 v[192:207], a[204:207], v[240:243], v[192:207]
  v_fma_f32 v38, v38, v20, s8
  v_fma_f32 v39, v39, v20, s8
  v_mul_f32 v36, v36, v76
  v_mul_f32 v37, v37, v77
  v_mul_f32 v38, v38, v78
  v_mfma_f32_32x32x16_bf16 v[208:223], a[204:207], v[244:247], v[208:223]
  v_mul_f32 v39, v39, v79
  v_exp_f32 v36, v36
  v_exp_f32 v37, v37
  v_exp_f32 v38, v38
  buffer_load_dwordx4 a[204:207], v2, s[64:67], 0 offen offset:3072 sc1
  ds_read_b128 v[240:243], v14 offset:16384
  ds_read_b128 v[244:247], v14 offset:17408
  s_waitcnt vmcnt(52) lgkmcnt(4)
  v_mfma_f32_32x32x16_bf16 v[160:175], a[64:67], v[224:227], v[160:175]
  v_exp_f32 v39, v39
  v_add_f32 v36, 1.0, v36
  v_add_f32 v37, 1.0, v37
  v_add_f32 v38, 1.0, v38
  v_mfma_f32_32x32x16_bf16 v[176:191], a[64:67], v[228:231], v[176:191]
  v_add_f32 v39, 1.0, v39
  v_rcp_f32 v36, v36
  v_rcp_f32 v37, v37
  v_rcp_f32 v38, v38
  v_rcp_f32 v39, v39
  v_add_u32 v2, 4096, v2
  buffer_load_dwordx4 a[64:67], v2, s[64:67], 0 offen offset:0 sc1
  v_mfma_f32_32x32x16_bf16 v[192:207], a[136:139], v[224:227], v[192:207]
  v_mul_f32 v36, v76, v36
  v_mul_f32 v37, v77, v37
  v_mul_f32 v38, v78, v38
  v_mul_f32 v39, v79, v39
  v_mfma_f32_32x32x16_bf16 v[208:223], a[136:139], v[228:231], v[208:223]
  v_cvt_pk_bf16_f32 v46, v36, v37
  v_cvt_pk_bf16_f32 v47, v38, v39
  ds_write_b128 v22, v[44:47] offset:2048
  v_mul_f32 v32, v80, v80
  v_mul_f32 v33, v81, v81
  buffer_load_dwordx4 a[136:139], v2, s[64:67], 0 offen offset:1024 sc1
  ds_read_b128 v[224:227], v15 offset:18432
  ds_read_b128 v[228:231], v15 offset:19456
  s_waitcnt vmcnt(52) lgkmcnt(5)
  v_mfma_f32_32x32x16_bf16 v[160:175], a[208:211], v[232:235], v[160:175]
  v_mul_f32 v34, v82, v82
  v_mul_f32 v35, v83, v83
  v_fma_f32 v32, v32, v20, s8
  v_fma_f32 v33, v33, v20, s8
  v_mfma_f32_32x32x16_bf16 v[176:191], a[208:211], v[236:239], v[176:191]
  v_fma_f32 v34, v34, v20, s8
  v_fma_f32 v35, v35, v20, s8
  v_mul_f32 v32, v32, v80
  v_mul_f32 v33, v33, v81
  v_mul_f32 v34, v34, v82
  buffer_load_dwordx4 a[208:211], v2, s[64:67], 0 offen offset:2048 sc1
  v_mfma_f32_32x32x16_bf16 v[192:207], a[68:71], v[232:235], v[192:207]
  v_mul_f32 v35, v35, v83
  v_exp_f32 v32, v32
  v_exp_f32 v33, v33
  v_exp_f32 v34, v34
  v_mfma_f32_32x32x16_bf16 v[208:223], a[68:71], v[236:239], v[208:223]
  v_exp_f32 v35, v35
  v_add_f32 v32, 1.0, v32
  v_add_f32 v33, 1.0, v33
  v_add_f32 v34, 1.0, v34
  buffer_load_dwordx4 a[68:71], v2, s[64:67], 0 offen offset:3072 sc1
  ds_read_b128 v[232:235], v16 offset:20480
  ds_read_b128 v[236:239], v16 offset:21504
  s_waitcnt vmcnt(52) lgkmcnt(5)
  v_mfma_f32_32x32x16_bf16 v[160:175], a[140:143], v[240:243], v[160:175]
  v_add_f32 v35, 1.0, v35
  v_rcp_f32 v32, v32
  v_rcp_f32 v33, v33
  v_rcp_f32 v34, v34
  v_rcp_f32 v35, v35
  v_mfma_f32_32x32x16_bf16 v[176:191], a[140:143], v[244:247], v[176:191]
  v_mul_f32 v32, v80, v32
  v_mul_f32 v33, v81, v33
  v_mul_f32 v34, v82, v34
  v_mul_f32 v35, v83, v35
  v_add_u32 v2, 4096, v2
  buffer_load_dwordx4 a[140:143], v2, s[64:67], 0 offen offset:0 sc1
  v_mfma_f32_32x32x16_bf16 v[192:207], a[212:215], v[240:243], v[192:207]
  v_cvt_pk_bf16_f32 v40, v32, v33
  v_cvt_pk_bf16_f32 v41, v34, v35
  v_mul_f32 v36, v84, v84
  v_mul_f32 v37, v85, v85
  v_mul_f32 v38, v86, v86
  v_mfma_f32_32x32x16_bf16 v[208:223], a[212:215], v[244:247], v[208:223]
  v_mul_f32 v39, v87, v87
  v_fma_f32 v36, v36, v20, s8
  v_fma_f32 v37, v37, v20, s8
  v_fma_f32 v38, v38, v20, s8
  buffer_load_dwordx4 a[212:215], v2, s[64:67], 0 offen offset:1024 sc1
  ds_read_b128 v[240:243], v17 offset:22528
  ds_read_b128 v[244:247], v17 offset:23552
  s_waitcnt vmcnt(52) lgkmcnt(4)
  v_mfma_f32_32x32x16_bf16 v[160:175], a[0:3], v[224:227], v[160:175]
  v_fma_f32 v39, v39, v20, s8
  v_mul_f32 v36, v36, v84
  v_mul_f32 v37, v37, v85
  v_mul_f32 v38, v38, v86
  v_mul_f32 v39, v39, v87
  v_mfma_f32_32x32x16_bf16 v[176:191], a[0:3], v[228:231], v[176:191]
  v_exp_f32 v36, v36
  v_exp_f32 v37, v37
  v_exp_f32 v38, v38
  v_exp_f32 v39, v39
  buffer_load_dwordx4 a[0:3], v2, s[64:67], 0 offen offset:2048 sc1
  v_mfma_f32_32x32x16_bf16 v[192:207], a[72:75], v[224:227], v[192:207]
  v_add_f32 v36, 1.0, v36
  v_add_f32 v37, 1.0, v37
  v_add_f32 v38, 1.0, v38
  v_add_f32 v39, 1.0, v39
  v_mfma_f32_32x32x16_bf16 v[208:223], a[72:75], v[228:231], v[208:223]
  v_rcp_f32 v36, v36
  v_rcp_f32 v37, v37
  v_rcp_f32 v38, v38
  v_rcp_f32 v39, v39
  v_mul_f32 v36, v84, v36
  v_add_u32 v3, 57344, v2
  buffer_load_dwordx4 a[72:75], v3, s[64:67], 0 offen offset:0 sc1
  ds_read_b128 v[224:227], v14 offset:24576
  ds_read_b128 v[228:231], v14 offset:25600
  s_waitcnt vmcnt(52) lgkmcnt(4)
  v_mfma_f32_32x32x16_bf16 v[160:175], a[144:147], v[232:235], v[160:175]
  v_mul_f32 v37, v85, v37
  v_mul_f32 v38, v86, v38
  v_mul_f32 v39, v87, v39
  v_cvt_pk_bf16_f32 v42, v36, v37
  v_mfma_f32_32x32x16_bf16 v[176:191], a[144:147], v[236:239], v[176:191]
  v_cvt_pk_bf16_f32 v43, v38, v39
  ds_write_b128 v22, v[40:43] offset:1024
  v_mul_f32 v32, v88, v88
  v_mul_f32 v33, v89, v89
  v_mul_f32 v34, v90, v90
  buffer_load_dwordx4 a[144:147], v2, s[64:67], 0 offen offset:3072 sc1
  v_mfma_f32_32x32x16_bf16 v[192:207], a[4:7], v[232:235], v[192:207]
  v_mul_f32 v35, v91, v91
  v_fma_f32 v32, v32, v20, s8
  v_fma_f32 v33, v33, v20, s8
  v_fma_f32 v34, v34, v20, s8
  v_mfma_f32_32x32x16_bf16 v[208:223], a[4:7], v[236:239], v[208:223]
  v_fma_f32 v35, v35, v20, s8
  v_mul_f32 v32, v32, v88
  v_mul_f32 v33, v33, v89
  v_mul_f32 v34, v34, v90
  v_mul_f32 v35, v35, v91
  buffer_load_dwordx4 a[4:7], v3, s[64:67], 0 offen offset:1024 sc1
  ds_read_b128 v[232:235], v15 offset:26624
  ds_read_b128 v[236:239], v15 offset:27648
  s_waitcnt vmcnt(52) lgkmcnt(5)
  v_mfma_f32_32x32x16_bf16 v[160:175], a[76:79], v[240:243], v[160:175]
  v_exp_f32 v32, v32
  v_exp_f32 v33, v33
  v_exp_f32 v34, v34
  v_exp_f32 v35, v35
  v_mfma_f32_32x32x16_bf16 v[176:191], a[76:79], v[244:247], v[176:191]
  v_add_f32 v32, 1.0, v32
  v_add_f32 v33, 1.0, v33
  v_add_f32 v34, 1.0, v34
  v_add_f32 v35, 1.0, v35
  v_rcp_f32 v32, v32
  v_add_u32 v2, 4096, v2
  buffer_load_dwordx4 a[76:79], v2, s[64:67], 0 offen offset:0 sc1
  v_mfma_f32_32x32x16_bf16 v[192:207], a[148:151], v[240:243], v[192:207]
  v_rcp_f32 v33, v33
  v_rcp_f32 v34, v34
  v_rcp_f32 v35, v35
  v_mul_f32 v32, v88, v32
  v_mfma_f32_32x32x16_bf16 v[208:223], a[148:151], v[244:247], v[208:223]
  v_mul_f32 v33, v89, v33
  v_mul_f32 v34, v90, v34
  v_mul_f32 v35, v91, v35
  v_cvt_pk_bf16_f32 v44, v32, v33
  buffer_load_dwordx4 a[148:151], v2, s[64:67], 0 offen offset:1024 sc1
  ds_read_b128 v[240:243], v16 offset:28672
  ds_read_b128 v[244:247], v16 offset:29696
  s_waitcnt vmcnt(52) lgkmcnt(5)
  v_mfma_f32_32x32x16_bf16 v[160:175], a[8:11], v[224:227], v[160:175]
  v_cvt_pk_bf16_f32 v45, v34, v35
  v_mul_f32 v36, v92, v92
  v_mul_f32 v37, v93, v93
  v_mul_f32 v38, v94, v94
  v_mul_f32 v39, v95, v95
  v_mfma_f32_32x32x16_bf16 v[176:191], a[8:11], v[228:231], v[176:191]
  v_fma_f32 v36, v36, v20, s8
  v_fma_f32 v37, v37, v20, s8
  v_fma_f32 v38, v38, v20, s8
  v_fma_f32 v39, v39, v20, s8
  buffer_load_dwordx4 a[8:11], v3, s[64:67], 0 offen offset:2048 sc1
  v_mfma_f32_32x32x16_bf16 v[192:207], a[80:83], v[224:227], v[192:207]
  v_mul_f32 v36, v36, v92
  v_mul_f32 v37, v37, v93
  v_mul_f32 v38, v38, v94
  v_mul_f32 v39, v39, v95
  v_exp_f32 v36, v36
  v_mfma_f32_32x32x16_bf16 v[208:223], a[80:83], v[228:231], v[208:223]
  v_exp_f32 v37, v37
  v_exp_f32 v38, v38
  v_exp_f32 v39, v39
  v_add_f32 v36, 1.0, v36
  buffer_load_dwordx4 a[80:83], v2, s[64:67], 0 offen offset:2048 sc1
  ds_read_b128 v[224:227], v17 offset:30720
  ds_read_b128 v[228:231], v17 offset:31744
  s_waitcnt vmcnt(52) lgkmcnt(4)
  v_mfma_f32_32x32x16_bf16 v[160:175], a[152:155], v[232:235], v[160:175]
  v_add_f32 v37, 1.0, v37
  v_add_f32 v38, 1.0, v38
  v_add_f32 v39, 1.0, v39
  v_rcp_f32 v36, v36
  v_rcp_f32 v37, v37
  v_mfma_f32_32x32x16_bf16 v[176:191], a[152:155], v[236:239], v[176:191]
  v_rcp_f32 v38, v38
  v_rcp_f32 v39, v39
  v_mul_f32 v36, v92, v36
  v_mul_f32 v37, v93, v37
  buffer_load_dwordx4 a[152:155], v3, s[64:67], 0 offen offset:3072 sc1
  v_mfma_f32_32x32x16_bf16 v[192:207], a[12:15], v[232:235], v[192:207]
  v_mul_f32 v38, v94, v38
  v_mul_f32 v39, v95, v39
  v_cvt_pk_bf16_f32 v46, v36, v37
  v_cvt_pk_bf16_f32 v47, v38, v39
  v_mfma_f32_32x32x16_bf16 v[208:223], a[12:15], v[236:239], v[208:223]
  ds_write_b128 v22, v[44:47] offset:3072
  v_mul_f32 v32, v96, v96
  v_mul_f32 v33, v97, v97
  v_mul_f32 v34, v98, v98
  v_mul_f32 v35, v99, v99
  buffer_load_dwordx4 a[12:15], v2, s[64:67], 0 offen offset:3072 sc1
  ds_read_b128 v[232:235], v14 offset:32768
  ds_read_b128 v[236:239], v14 offset:33792
  s_waitcnt vmcnt(52) lgkmcnt(5)
  v_mfma_f32_32x32x16_bf16 v[160:175], a[84:87], v[240:243], v[160:175]
  v_fma_f32 v32, v32, v20, s8
  v_fma_f32 v33, v33, v20, s8
  v_fma_f32 v34, v34, v20, s8
  v_fma_f32 v35, v35, v20, s8
  v_mfma_f32_32x32x16_bf16 v[176:191], a[84:87], v[244:247], v[176:191]
  v_mul_f32 v32, v32, v96
  v_mul_f32 v33, v33, v97
  v_mul_f32 v34, v34, v98
  v_mul_f32 v35, v35, v99
  v_exp_f32 v32, v32
  v_add_u32 v2, 4096, v2
  buffer_load_dwordx4 a[84:87], v2, s[64:67], 0 offen offset:0 sc1
  v_mfma_f32_32x32x16_bf16 v[192:207], a[156:159], v[240:243], v[192:207]
  v_exp_f32 v33, v33
  v_exp_f32 v34, v34
  v_exp_f32 v35, v35
  v_add_f32 v32, 1.0, v32
  v_mfma_f32_32x32x16_bf16 v[208:223], a[156:159], v[244:247], v[208:223]
  v_add_f32 v33, 1.0, v33
  v_add_f32 v34, 1.0, v34
  v_add_f32 v35, 1.0, v35
  v_rcp_f32 v32, v32
  v_rcp_f32 v33, v33
  v_add_u32 v3, 4096, v3
  buffer_load_dwordx4 a[156:159], v3, s[64:67], 0 offen offset:0 sc1
  ds_read_b128 v[240:243], v15 offset:34816
  ds_read_b128 v[244:247], v15 offset:35840
  s_waitcnt vmcnt(52) lgkmcnt(5)
  v_mfma_f32_32x32x16_bf16 v[160:175], a[16:19], v[224:227], v[160:175]
  v_rcp_f32 v34, v34
  v_rcp_f32 v35, v35
  v_mul_f32 v32, v96, v32
  v_mul_f32 v33, v97, v33
  v_mfma_f32_32x32x16_bf16 v[176:191], a[16:19], v[228:231], v[176:191]
  v_mul_f32 v34, v98, v34
  v_mul_f32 v35, v99, v35
  v_cvt_pk_bf16_f32 v40, v32, v33
  v_cvt_pk_bf16_f32 v41, v34, v35
  buffer_load_dwordx4 a[16:19], v2, s[64:67], 0 offen offset:1024 sc1
  v_mfma_f32_32x32x16_bf16 v[192:207], a[88:91], v[224:227], v[192:207]
  v_mul_f32 v36, v100, v100
  v_mul_f32 v37, v101, v101
  v_mul_f32 v38, v102, v102
  v_mul_f32 v39, v103, v103
  v_fma_f32 v36, v36, v20, s8
  v_mfma_f32_32x32x16_bf16 v[208:223], a[88:91], v[228:231], v[208:223]
  v_fma_f32 v37, v37, v20, s8
  v_fma_f32 v38, v38, v20, s8
  v_fma_f32 v39, v39, v20, s8
  v_mul_f32 v36, v36, v100
  buffer_load_dwordx4 a[88:91], v3, s[64:67], 0 offen offset:1024 sc1
  ds_read_b128 v[224:227], v16 offset:36864
  ds_read_b128 v[228:231], v16 offset:37888
  s_waitcnt vmcnt(52) lgkmcnt(4)
  v_mfma_f32_32x32x16_bf16 v[160:175], a[160:163], v[232:235], v[160:175]
  v_mul_f32 v37, v37, v101
  v_mul_f32 v38, v38, v102
  v_mul_f32 v39, v39, v103
  v_exp_f32 v36, v36
  v_exp_f32 v37, v37
  v_mfma_f32_32x32x16_bf16 v[176:191], a[160:163], v[236:239], v[176:191]
  v_exp_f32 v38, v38
  v_exp_f32 v39, v39
  v_add_f32 v36, 1.0, v36
  v_add_f32 v37, 1.0, v37
  buffer_load_dwordx4 a[160:163], v2, s[64:67], 0 offen offset:2048 sc1
  v_mfma_f32_32x32x16_bf16 v[192:207], a[20:23], v[232:235], v[192:207]
  v_add_f32 v38, 1.0, v38
  v_add_f32 v39, 1.0, v39
  v_rcp_f32 v36, v36
  v_rcp_f32 v37, v37
  v_rcp_f32 v38, v38
  v_mfma_f32_32x32x16_bf16 v[208:223], a[20:23], v[236:239], v[208:223]
  v_rcp_f32 v39, v39
  v_mul_f32 v36, v100, v36
  v_mul_f32 v37, v101, v37
  v_mul_f32 v38, v102, v38
  buffer_load_dwordx4 a[20:23], v2, s[64:67], 0 offen offset:3072 sc1
  ds_read_b128 v[232:235], v17 offset:38912
  ds_read_b128 v[236:239], v17 offset:39936
  s_waitcnt vmcnt(52) lgkmcnt(4)
  v_mfma_f32_32x32x16_bf16 v[160:175], a[92:95], v[240:243], v[160:175]
  v_mul_f32 v39, v103, v39
  v_cvt_pk_bf16_f32 v42, v36, v37
  v_cvt_pk_bf16_f32 v43, v38, v39
  ds_write_b128 v22, v[40:43] offset:4096
  v_mul_f32 v32, v104, v104
  v_mfma_f32_32x32x16_bf16 v[176:191], a[92:95], v[244:247], v[176:191]
  v_mul_f32 v33, v105, v105
  v_mul_f32 v34, v106, v106
  v_mul_f32 v35, v107, v107
  v_fma_f32 v32, v32, v20, s8
  buffer_load_dwordx4 a[92:95], v3, s[64:67], 0 offen offset:2048 sc1
  v_mfma_f32_32x32x16_bf16 v[192:207], a[164:167], v[240:243], v[192:207]
  v_fma_f32 v33, v33, v20, s8
  v_fma_f32 v34, v34, v20, s8
  v_fma_f32 v35, v35, v20, s8
  v_mul_f32 v32, v32, v104
  v_mfma_f32_32x32x16_bf16 v[208:223], a[164:167], v[244:247], v[208:223]
  v_mul_f32 v33, v33, v105
  v_mul_f32 v34, v34, v106
  v_mul_f32 v35, v35, v107
  v_exp_f32 v32, v32
  v_exp_f32 v33, v33
  v_add_u32 v2, 4096, v2
  buffer_load_dwordx4 a[164:167], v2, s[64:67], 0 offen offset:0 sc1
  ds_read_b128 v[240:243], v14 offset:40960
  ds_read_b128 v[244:247], v14 offset:41984
  s_waitcnt vmcnt(52) lgkmcnt(5)
  v_mfma_f32_32x32x16_bf16 v[160:175], a[24:27], v[224:227], v[160:175]
  v_exp_f32 v34, v34
  v_exp_f32 v35, v35
  v_add_f32 v32, 1.0, v32
  v_add_f32 v33, 1.0, v33
  v_mfma_f32_32x32x16_bf16 v[176:191], a[24:27], v[228:231], v[176:191]
  v_add_f32 v34, 1.0, v34
  v_add_f32 v35, 1.0, v35
  v_rcp_f32 v32, v32
  v_rcp_f32 v33, v33
  v_rcp_f32 v34, v34
  buffer_load_dwordx4 a[24:27], v3, s[64:67], 0 offen offset:3072 sc1
  v_mfma_f32_32x32x16_bf16 v[192:207], a[96:99], v[224:227], v[192:207]
  v_rcp_f32 v35, v35
  v_mul_f32 v32, v104, v32
  v_mul_f32 v33, v105, v33
  v_mul_f32 v34, v106, v34
  v_mfma_f32_32x32x16_bf16 v[208:223], a[96:99], v[228:231], v[208:223]
  v_mul_f32 v35, v107, v35
  v_cvt_pk_bf16_f32 v44, v32, v33
  v_cvt_pk_bf16_f32 v45, v34, v35
  v_mul_f32 v36, v108, v108
  v_mul_f32 v37, v109, v109
  buffer_load_dwordx4 a[96:99], v2, s[64:67], 0 offen offset:1024 sc1
  ds_read_b128 v[224:227], v15 offset:43008
  ds_read_b128 v[228:231], v15 offset:44032
  s_waitcnt vmcnt(52) lgkmcnt(5)
  v_mfma_f32_32x32x16_bf16 v[160:175], a[168:171], v[232:235], v[160:175]
  v_mul_f32 v38, v110, v110
  v_mul_f32 v39, v111, v111
  v_fma_f32 v36, v36, v20, s8
  v_fma_f32 v37, v37, v20, s8
  v_mfma_f32_32x32x16_bf16 v[176:191], a[168:171], v[236:239], v[176:191]
  v_fma_f32 v38, v38, v20, s8
  v_fma_f32 v39, v39, v20, s8
  v_mul_f32 v36, v36, v108
  v_mul_f32 v37, v37, v109
  buffer_load_dwordx4 a[168:171], v2, s[64:67], 0 offen offset:2048 sc1
  v_mfma_f32_32x32x16_bf16 v[192:207], a[28:31], v[232:235], v[192:207]
  v_mul_f32 v38, v38, v110
  v_mul_f32 v39, v39, v111
  v_exp_f32 v36, v36
  v_exp_f32 v37, v37
  v_exp_f32 v38, v38
  v_mfma_f32_32x32x16_bf16 v[208:223], a[28:31], v[236:239], v[208:223]
  v_exp_f32 v39, v39
  v_add_f32 v36, 1.0, v36
  v_add_f32 v37, 1.0, v37
  v_add_f32 v38, 1.0, v38
  v_add_u32 v3, 4096, v3
  buffer_load_dwordx4 a[28:31], v3, s[64:67], 0 offen offset:0 sc1
  ds_read_b128 v[232:235], v16 offset:45056
  ds_read_b128 v[236:239], v16 offset:46080
  s_waitcnt vmcnt(52) lgkmcnt(4)
  v_mfma_f32_32x32x16_bf16 v[160:175], a[100:103], v[240:243], v[160:175]
  v_add_f32 v39, 1.0, v39
  v_rcp_f32 v36, v36
  v_rcp_f32 v37, v37
  v_rcp_f32 v38, v38
  v_rcp_f32 v39, v39
  v_mfma_f32_32x32x16_bf16 v[176:191], a[100:103], v[244:247], v[176:191]
  v_mul_f32 v36, v108, v36
  v_mul_f32 v37, v109, v37
  v_mul_f32 v38, v110, v38
  v_mul_f32 v39, v111, v39
  buffer_load_dwordx4 a[100:103], v2, s[64:67], 0 offen offset:3072 sc1
  v_mfma_f32_32x32x16_bf16 v[192:207], a[172:175], v[240:243], v[192:207]
  v_cvt_pk_bf16_f32 v46, v36, v37
  v_cvt_pk_bf16_f32 v47, v38, v39
  ds_write_b128 v22, v[44:47] offset:6144
  v_mul_f32 v32, v112, v112
  v_mul_f32 v33, v113, v113
  v_mfma_f32_32x32x16_bf16 v[208:223], a[172:175], v[244:247], v[208:223]
  v_mul_f32 v34, v114, v114
  v_mul_f32 v35, v115, v115
  v_fma_f32 v32, v32, v20, s8
  v_fma_f32 v33, v33, v20, s8
  buffer_load_dwordx4 a[172:175], v3, s[64:67], 0 offen offset:1024 sc1
  ds_read_b128 v[240:243], v17 offset:47104
  ds_read_b128 v[244:247], v17 offset:48128
  s_waitcnt vmcnt(52) lgkmcnt(5)
  v_mfma_f32_32x32x16_bf16 v[160:175], a[32:35], v[224:227], v[160:175]
  v_fma_f32 v34, v34, v20, s8
  v_fma_f32 v35, v35, v20, s8
  v_mul_f32 v32, v32, v112
  v_mul_f32 v33, v33, v113
  v_mfma_f32_32x32x16_bf16 v[176:191], a[32:35], v[228:231], v[176:191]
  v_mul_f32 v34, v34, v114
  v_mul_f32 v35, v35, v115
  v_exp_f32 v32, v32
  v_exp_f32 v33, v33
  v_exp_f32 v34, v34
  v_add_u32 v2, 4096, v2
  buffer_load_dwordx4 a[32:35], v2, s[64:67], 0 offen offset:0 sc1
  v_mfma_f32_32x32x16_bf16 v[192:207], a[104:107], v[224:227], v[192:207]
  v_exp_f32 v35, v35
  v_add_f32 v32, 1.0, v32
  v_add_f32 v33, 1.0, v33
  v_add_f32 v34, 1.0, v34
  v_mfma_f32_32x32x16_bf16 v[208:223], a[104:107], v[228:231], v[208:223]
  v_add_f32 v35, 1.0, v35
  v_rcp_f32 v32, v32
  v_rcp_f32 v33, v33
  v_rcp_f32 v34, v34
  v_rcp_f32 v35, v35
  buffer_load_dwordx4 a[104:107], v2, s[64:67], 0 offen offset:1024 sc1
  ds_read_b128 v[224:227], v14 offset:49152
  ds_read_b128 v[228:231], v14 offset:50176
  s_waitcnt vmcnt(52) lgkmcnt(5)
  v_mfma_f32_32x32x16_bf16 v[160:175], a[176:179], v[232:235], v[160:175]
  v_mul_f32 v32, v112, v32
  v_mul_f32 v33, v113, v33
  v_mul_f32 v34, v114, v34
  v_mul_f32 v35, v115, v35
  v_mfma_f32_32x32x16_bf16 v[176:191], a[176:179], v[236:239], v[176:191]
  v_cvt_pk_bf16_f32 v40, v32, v33
  v_cvt_pk_bf16_f32 v41, v34, v35
  v_mul_f32 v36, v116, v116
  v_mul_f32 v37, v117, v117
  v_mul_f32 v38, v118, v118
  buffer_load_dwordx4 a[176:179], v3, s[64:67], 0 offen offset:2048 sc1
  v_mfma_f32_32x32x16_bf16 v[192:207], a[36:39], v[232:235], v[192:207]
  v_mul_f32 v39, v119, v119
  v_fma_f32 v36, v36, v20, s8
  v_fma_f32 v37, v37, v20, s8
  v_fma_f32 v38, v38, v20, s8
  v_mfma_f32_32x32x16_bf16 v[208:223], a[36:39], v[236:239], v[208:223]
  v_fma_f32 v39, v39, v20, s8
  v_mul_f32 v36, v36, v116
  v_mul_f32 v37, v37, v117
  v_mul_f32 v38, v38, v118
  v_mul_f32 v39, v39, v119
  buffer_load_dwordx4 a[36:39], v2, s[64:67], 0 offen offset:2048 sc1
  ds_read_b128 v[232:235], v15 offset:51200
  ds_read_b128 v[236:239], v15 offset:52224
  s_waitcnt vmcnt(52) lgkmcnt(4)
  v_mfma_f32_32x32x16_bf16 v[160:175], a[108:111], v[240:243], v[160:175]
  v_exp_f32 v36, v36
  v_exp_f32 v37, v37
  v_exp_f32 v38, v38
  v_exp_f32 v39, v39
  v_mfma_f32_32x32x16_bf16 v[176:191], a[108:111], v[244:247], v[176:191]
  v_add_f32 v36, 1.0, v36
  v_add_f32 v37, 1.0, v37
  v_add_f32 v38, 1.0, v38
  v_add_f32 v39, 1.0, v39
  buffer_load_dwordx4 a[108:111], v3, s[64:67], 0 offen offset:3072 sc1
  v_mfma_f32_32x32x16_bf16 v[192:207], a[180:183], v[240:243], v[192:207]
  v_rcp_f32 v36, v36
  v_rcp_f32 v37, v37
  v_rcp_f32 v38, v38
  v_rcp_f32 v39, v39
  v_mul_f32 v36, v116, v36
  v_mfma_f32_32x32x16_bf16 v[208:223], a[180:183], v[244:247], v[208:223]
  v_mul_f32 v37, v117, v37
  v_mul_f32 v38, v118, v38
  v_mul_f32 v39, v119, v39
  v_cvt_pk_bf16_f32 v42, v36, v37
  buffer_load_dwordx4 a[180:183], v2, s[64:67], 0 offen offset:3072 sc1
  ds_read_b128 v[240:243], v16 offset:53248
  ds_read_b128 v[244:247], v16 offset:54272
  s_waitcnt vmcnt(52) lgkmcnt(4)
  v_mfma_f32_32x32x16_bf16 v[160:175], a[40:43], v[224:227], v[160:175]
  v_cvt_pk_bf16_f32 v43, v38, v39
  ds_write_b128 v22, v[40:43] offset:5120
  v_mul_f32 v32, v120, v120
  v_mul_f32 v33, v121, v121
  v_mul_f32 v34, v122, v122
  v_mfma_f32_32x32x16_bf16 v[176:191], a[40:43], v[228:231], v[176:191]
  v_mul_f32 v35, v123, v123
  v_fma_f32 v32, v32, v20, s8
  v_fma_f32 v33, v33, v20, s8
  v_fma_f32 v34, v34, v20, s8
  v_add_u32 v2, 4096, v2
  buffer_load_dwordx4 a[40:43], v2, s[64:67], 0 offen offset:0 sc1
  v_mfma_f32_32x32x16_bf16 v[192:207], a[112:115], v[224:227], v[192:207]
  v_fma_f32 v35, v35, v20, s8
  v_mul_f32 v32, v32, v120
  v_mul_f32 v33, v33, v121
  v_mul_f32 v34, v34, v122
  v_mul_f32 v35, v35, v123
  v_mfma_f32_32x32x16_bf16 v[208:223], a[112:115], v[228:231], v[208:223]
  v_exp_f32 v32, v32
  v_exp_f32 v33, v33
  v_exp_f32 v34, v34
  v_exp_f32 v35, v35
  v_add_u32 v3, 4096, v3
  buffer_load_dwordx4 a[112:115], v3, s[64:67], 0 offen offset:0 sc1
  ds_read_b128 v[224:227], v17 offset:55296
  ds_read_b128 v[228:231], v17 offset:56320
  s_waitcnt vmcnt(52) lgkmcnt(5)
  v_mfma_f32_32x32x16_bf16 v[160:175], a[184:187], v[232:235], v[160:175]
  v_add_f32 v32, 1.0, v32
  v_add_f32 v33, 1.0, v33
  v_add_f32 v34, 1.0, v34
  v_add_f32 v35, 1.0, v35
  v_mfma_f32_32x32x16_bf16 v[176:191], a[184:187], v[236:239], v[176:191]
  v_rcp_f32 v32, v32
  v_rcp_f32 v33, v33
  v_rcp_f32 v34, v34
  v_rcp_f32 v35, v35
  v_mul_f32 v32, v120, v32
  buffer_load_dwordx4 a[184:187], v2, s[64:67], 0 offen offset:1024 sc1
  v_mfma_f32_32x32x16_bf16 v[192:207], a[44:47], v[232:235], v[192:207]
  v_mul_f32 v33, v121, v33
  v_mul_f32 v34, v122, v34
  v_mul_f32 v35, v123, v35
  v_cvt_pk_bf16_f32 v44, v32, v33
  v_mfma_f32_32x32x16_bf16 v[208:223], a[44:47], v[236:239], v[208:223]
  v_cvt_pk_bf16_f32 v45, v34, v35
  v_mul_f32 v36, v124, v124
  v_mul_f32 v37, v125, v125
  v_mul_f32 v38, v126, v126
  v_mul_f32 v39, v127, v127
  buffer_load_dwordx4 a[44:47], v3, s[64:67], 0 offen offset:1024 sc1
  ds_read_b128 v[232:235], v14 offset:57344
  ds_read_b128 v[236:239], v14 offset:58368
  s_waitcnt vmcnt(52) lgkmcnt(5)
  v_mfma_f32_32x32x16_bf16 v[160:175], a[116:119], v[240:243], v[160:175]
  v_fma_f32 v36, v36, v20, s8
  v_fma_f32 v37, v37, v20, s8
  v_fma_f32 v38, v38, v20, s8
  v_fma_f32 v39, v39, v20, s8
  v_mfma_f32_32x32x16_bf16 v[176:191], a[116:119], v[244:247], v[176:191]
  v_mul_f32 v36, v36, v124
  v_mul_f32 v37, v37, v125
  v_mul_f32 v38, v38, v126
  v_mul_f32 v39, v39, v127
  v_exp_f32 v36, v36
  buffer_load_dwordx4 a[116:119], v2, s[64:67], 0 offen offset:2048 sc1
  v_mfma_f32_32x32x16_bf16 v[192:207], a[188:191], v[240:243], v[192:207]
  v_exp_f32 v37, v37
  v_exp_f32 v38, v38
  v_exp_f32 v39, v39
  v_add_f32 v36, 1.0, v36
  v_mfma_f32_32x32x16_bf16 v[208:223], a[188:191], v[244:247], v[208:223]
  v_add_f32 v37, 1.0, v37
  v_add_f32 v38, 1.0, v38
  v_add_f32 v39, 1.0, v39
  v_rcp_f32 v36, v36
  buffer_load_dwordx4 a[188:191], v2, s[64:67], 0 offen offset:3072 sc1
  ds_read_b128 v[240:243], v15 offset:59392
  ds_read_b128 v[244:247], v15 offset:60416
  s_waitcnt vmcnt(52) lgkmcnt(4)
  v_mfma_f32_32x32x16_bf16 v[160:175], a[48:51], v[224:227], v[160:175]
  v_rcp_f32 v37, v37
  v_rcp_f32 v38, v38
  v_rcp_f32 v39, v39
  v_mul_f32 v36, v124, v36
  v_mul_f32 v37, v125, v37
  v_mfma_f32_32x32x16_bf16 v[176:191], a[48:51], v[228:231], v[176:191]
  v_mul_f32 v38, v126, v38
  v_mul_f32 v39, v127, v39
  v_cvt_pk_bf16_f32 v46, v36, v37
  v_cvt_pk_bf16_f32 v47, v38, v39
  buffer_load_dwordx4 a[48:51], v3, s[64:67], 0 offen offset:2048 sc1
  v_mfma_f32_32x32x16_bf16 v[192:207], a[120:123], v[224:227], v[192:207]
  ds_write_b128 v22, v[44:47] offset:7168
  v_mul_f32 v32, v128, v128
  v_mul_f32 v33, v129, v129
  v_mul_f32 v34, v130, v130
  v_mul_f32 v35, v131, v131
  v_mfma_f32_32x32x16_bf16 v[208:223], a[120:123], v[228:231], v[208:223]
  v_fma_f32 v32, v32, v20, s8
  v_fma_f32 v33, v33, v20, s8
  v_fma_f32 v34, v34, v20, s8
  v_fma_f32 v35, v35, v20, s8
  v_add_u32 v2, 4096, v2
  buffer_load_dwordx4 a[120:123], v2, s[64:67], 0 offen offset:0 sc1
  ds_read_b128 v[224:227], v16 offset:61440
  ds_read_b128 v[228:231], v16 offset:62464
  s_waitcnt vmcnt(52) lgkmcnt(5)
  v_mfma_f32_32x32x16_bf16 v[160:175], a[192:195], v[232:235], v[160:175]
  v_mul_f32 v32, v32, v128
  v_mul_f32 v33, v33, v129
  v_mul_f32 v34, v34, v130
  v_mul_f32 v35, v35, v131
  v_exp_f32 v32, v32
  v_mfma_f32_32x32x16_bf16 v[176:191], a[192:195], v[236:239], v[176:191]
  v_exp_f32 v33, v33
  v_exp_f32 v34, v34
  v_exp_f32 v35, v35
  v_add_f32 v32, 1.0, v32
  buffer_load_dwordx4 a[192:195], v3, s[64:67], 0 offen offset:3072 sc1
  v_mfma_f32_32x32x16_bf16 v[192:207], a[52:55], v[232:235], v[192:207]
  v_add_f32 v33, 1.0, v33
  v_add_f32 v34, 1.0, v34
  v_add_f32 v35, 1.0, v35
  v_rcp_f32 v32, v32
  v_rcp_f32 v33, v33
  v_mfma_f32_32x32x16_bf16 v[208:223], a[52:55], v[236:239], v[208:223]
  v_rcp_f32 v34, v34
  v_rcp_f32 v35, v35
  v_mul_f32 v32, v128, v32
  v_mul_f32 v33, v129, v33
  buffer_load_dwordx4 a[52:55], v2, s[64:67], 0 offen offset:1024 sc1
  ds_read_b128 v[232:235], v17 offset:63488
  ds_read_b128 v[236:239], v17 offset:64512
  s_waitcnt vmcnt(52) lgkmcnt(5)
  v_mfma_f32_32x32x16_bf16 v[160:175], a[124:127], v[240:243], v[160:175]
  v_mul_f32 v34, v130, v34
  v_mul_f32 v35, v131, v35
  v_cvt_pk_bf16_f32 v40, v32, v33
  v_cvt_pk_bf16_f32 v41, v34, v35
  v_mfma_f32_32x32x16_bf16 v[176:191], a[124:127], v[244:247], v[176:191]
  ds_write_b64 v62, v[40:41] offset:0
  v_mul_f32 v36, v132, v132
  v_mul_f32 v37, v133, v133
  v_mul_f32 v38, v134, v134
  v_mul_f32 v39, v135, v135
  buffer_load_dwordx4 a[124:127], v2, s[64:67], 0 offen offset:2048 sc1
  v_mfma_f32_32x32x16_bf16 v[192:207], a[196:199], v[240:243], v[192:207]
  v_fma_f32 v36, v36, v20, s8
  v_fma_f32 v37, v37, v20, s8
  v_fma_f32 v38, v38, v20, s8
  v_fma_f32 v39, v39, v20, s8
  v_mfma_f32_32x32x16_bf16 v[208:223], a[196:199], v[244:247], v[208:223]
  v_mul_f32 v36, v36, v132
  v_mul_f32 v37, v37, v133
  v_mul_f32 v38, v38, v134
  v_mul_f32 v39, v39, v135
  v_exp_f32 v36, v36
  v_add_u32 v3, 4096, v3
  buffer_load_dwordx4 a[196:199], v3, s[64:67], 0 offen offset:0 sc1
  ds_read_b128 v[240:243], v24 offset:0
  ds_read_b128 v[244:247], v24 offset:1024
  s_waitcnt vmcnt(52) lgkmcnt(5)
  v_mfma_f32_32x32x16_bf16 v[160:175], a[56:59], v[224:227], v[160:175]
  v_exp_f32 v37, v37
  v_exp_f32 v38, v38
  v_exp_f32 v39, v39
  v_add_f32 v36, 1.0, v36
  v_mfma_f32_32x32x16_bf16 v[176:191], a[56:59], v[228:231], v[176:191]
  v_add_f32 v37, 1.0, v37
  v_add_f32 v38, 1.0, v38
  v_add_f32 v39, 1.0, v39
  v_rcp_f32 v36, v36
  v_rcp_f32 v37, v37
  buffer_load_dwordx4 a[56:59], v2, s[64:67], 0 offen offset:3072 sc1
  v_mfma_f32_32x32x16_bf16 v[192:207], a[128:131], v[224:227], v[192:207]
  v_rcp_f32 v38, v38
  v_rcp_f32 v39, v39
  v_mul_f32 v36, v132, v36
  v_mul_f32 v37, v133, v37
  v_mfma_f32_32x32x16_bf16 v[208:223], a[128:131], v[228:231], v[208:223]
  v_mul_f32 v38, v134, v38
  v_mul_f32 v39, v135, v39
  v_cvt_pk_bf16_f32 v42, v36, v37
  v_cvt_pk_bf16_f32 v43, v38, v39
  buffer_load_dwordx4 a[128:131], v3, s[64:67], 0 offen offset:1024 sc1
  ds_read_b128 v[224:227], v25 offset:2048
  ds_read_b128 v[228:231], v25 offset:3072
  s_waitcnt vmcnt(52) lgkmcnt(5)
  v_mfma_f32_32x32x16_bf16 v[160:175], a[200:203], v[232:235], v[160:175]
  ds_write_b64 v62, v[42:43] offset:256
  v_mul_f32 v32, v136, v136
  v_mul_f32 v33, v137, v137
  v_mul_f32 v34, v138, v138
  v_mul_f32 v35, v139, v139
  v_mfma_f32_32x32x16_bf16 v[176:191], a[200:203], v[236:239], v[176:191]
  v_fma_f32 v32, v32, v20, s8
  v_fma_f32 v33, v33, v20, s8
  v_fma_f32 v34, v34, v20, s8
  v_fma_f32 v35, v35, v20, s8
  v_add_u32 v2, 4096, v2
  buffer_load_dwordx4 a[200:203], v2, s[64:67], 0 offen offset:0 sc1
  v_mfma_f32_32x32x16_bf16 v[192:207], a[60:63], v[232:235], v[192:207]
  v_mul_f32 v32, v32, v136
  v_mul_f32 v33, v33, v137
  v_mul_f32 v34, v34, v138
  v_mul_f32 v35, v35, v139
  v_exp_f32 v32, v32
  v_mfma_f32_32x32x16_bf16 v[208:223], a[60:63], v[236:239], v[208:223]
  v_exp_f32 v33, v33
  v_exp_f32 v34, v34
  v_exp_f32 v35, v35
  v_add_f32 v32, 1.0, v32
  buffer_load_dwordx4 a[60:63], v2, s[64:67], 0 offen offset:1024 sc1
  ds_read_b128 v[232:235], v26 offset:4096
  ds_read_b128 v[236:239], v26 offset:5120
  s_waitcnt vmcnt(52) lgkmcnt(5)
  v_mfma_f32_32x32x16_bf16 v[160:175], a[132:135], v[240:243], v[160:175]
  v_add_f32 v33, 1.0, v33
  v_add_f32 v34, 1.0, v34
  v_add_f32 v35, 1.0, v35
  v_rcp_f32 v32, v32
  v_rcp_f32 v33, v33
  v_mfma_f32_32x32x16_bf16 v[176:191], a[132:135], v[244:247], v[176:191]
  v_rcp_f32 v34, v34
  v_rcp_f32 v35, v35
  v_mul_f32 v32, v136, v32
  v_mul_f32 v33, v137, v33
  buffer_load_dwordx4 a[132:135], v3, s[64:67], 0 offen offset:2048 sc1
  v_mfma_f32_32x32x16_bf16 v[192:207], a[204:207], v[240:243], v[192:207]
  v_mul_f32 v34, v138, v34
  v_mul_f32 v35, v139, v35
  v_cvt_pk_bf16_f32 v40, v32, v33
  v_cvt_pk_bf16_f32 v41, v34, v35
  v_mfma_f32_32x32x16_bf16 v[208:223], a[204:207], v[244:247], v[208:223]
  ds_write_b64 v62, v[40:41] offset:1024
  v_mul_f32 v36, v140, v140
  v_mul_f32 v37, v141, v141
  v_mul_f32 v38, v142, v142
  v_mul_f32 v39, v143, v143
  buffer_load_dwordx4 a[204:207], v2, s[64:67], 0 offen offset:2048 sc1
  ds_read_b128 v[240:243], v27 offset:6144
  ds_read_b128 v[244:247], v27 offset:7168
  s_waitcnt vmcnt(52) lgkmcnt(6)
  v_mfma_f32_32x32x16_bf16 v[160:175], a[64:67], v[224:227], v[160:175]
  v_fma_f32 v36, v36, v20, s8
  v_fma_f32 v37, v37, v20, s8
  v_fma_f32 v38, v38, v20, s8
  v_fma_f32 v39, v39, v20, s8
  v_mfma_f32_32x32x16_bf16 v[176:191], a[64:67], v[228:231], v[176:191]
  v_mul_f32 v36, v36, v140
  v_mul_f32 v37, v37, v141
  v_mul_f32 v38, v38, v142
  v_mul_f32 v39, v39, v143
  v_exp_f32 v36, v36
  buffer_load_dwordx4 a[64:67], v3, s[64:67], 0 offen offset:3072 sc1
  v_mfma_f32_32x32x16_bf16 v[192:207], a[136:139], v[224:227], v[192:207]
  v_exp_f32 v37, v37
  v_exp_f32 v38, v38
  v_exp_f32 v39, v39
  v_add_f32 v36, 1.0, v36
  v_mfma_f32_32x32x16_bf16 v[208:223], a[136:139], v[228:231], v[208:223]
  v_add_f32 v37, 1.0, v37
  v_add_f32 v38, 1.0, v38
  v_add_f32 v39, 1.0, v39
  v_rcp_f32 v36, v36
  v_rcp_f32 v37, v37
  buffer_load_dwordx4 a[136:139], v2, s[64:67], 0 offen offset:3072 sc1
  s_waitcnt vmcnt(52) lgkmcnt(3)
  v_mfma_f32_32x32x16_bf16 v[160:175], a[208:211], v[232:235], v[160:175]
  v_rcp_f32 v38, v38
  v_rcp_f32 v39, v39
  v_mul_f32 v36, v140, v36
  v_mul_f32 v37, v141, v37
  v_mfma_f32_32x32x16_bf16 v[176:191], a[208:211], v[236:239], v[176:191]
  v_mul_f32 v38, v142, v38
  v_mul_f32 v39, v143, v39
  v_cvt_pk_bf16_f32 v42, v36, v37
  v_cvt_pk_bf16_f32 v43, v38, v39
  ds_write_b64 v62, v[42:43] offset:1280
  v_add_u32 v2, 4096, v2
  buffer_load_dwordx4 a[208:211], v2, s[64:67], 0 offen offset:0 sc1
  v_mfma_f32_32x32x16_bf16 v[192:207], a[68:71], v[232:235], v[192:207]
  v_mfma_f32_32x32x16_bf16 v[208:223], a[68:71], v[236:239], v[208:223]
  buffer_load_dwordx4 a[68:71], v2, s[64:67], 0 offen offset:1024 sc1
  s_waitcnt vmcnt(52) lgkmcnt(1)
  v_mfma_f32_32x32x16_bf16 v[160:175], a[140:143], v[240:243], v[160:175]
  v_mfma_f32_32x32x16_bf16 v[176:191], a[140:143], v[244:247], v[176:191]
  buffer_load_dwordx4 a[140:143], v2, s[64:67], 0 offen offset:2048 sc1
  v_mfma_f32_32x32x16_bf16 v[192:207], a[212:215], v[240:243], v[192:207]
  v_mfma_f32_32x32x16_bf16 v[208:223], a[212:215], v[244:247], v[208:223]
  buffer_load_dwordx4 a[212:215], v2, s[64:67], 0 offen offset:3072 sc1
  s_waitcnt lgkmcnt(0)
  s_barrier
  s_lshl_b32 s10, s3, 9
  ds_read_b128 v[224:227], v18 offset:0
  ds_read_b128 v[228:231], v18 offset:1024
  ds_read_b128 v[232:235], v18 offset:2048
  ds_read_b128 v[236:239], v18 offset:3072
  ds_read_b128 v[240:243], v18 offset:4096
  ds_read_b128 v[244:247], v18 offset:5120
  ds_read_b128 v[144:147], v60 offset:0
  ds_read_b128 v[148:151], v60 offset:256
  ds_read_b128 v[152:155], v60 offset:1024
  ds_read_b128 v[156:159], v60 offset:1280
  s_waitcnt vmcnt(52) lgkmcnt(8)
  v_mfma_f32_32x32x16_bf16 v[64:79], a[0:3], v[224:227], 0
  v_mul_f32 v32, v160, v160
  v_mul_f32 v33, v161, v161
  v_mul_f32 v34, v162, v162
  v_mul_f32 v35, v163, v163
  v_fma_f32 v32, v32, v20, s8
  v_mfma_f32_32x32x16_bf16 v[80:95], a[0:3], v[228:231], 0
  v_fma_f32 v33, v33, v20, s8
  v_fma_f32 v34, v34, v20, s8
  v_fma_f32 v35, v35, v20, s8
  v_mul_f32 v32, v32, v160
  v_mul_f32 v33, v33, v161
  v_mul_f32 v34, v34, v162
  v_add_u32 v2, 4096, v2
  buffer_load_dwordx4 a[0:3], v2, s[64:67], 0 offen offset:0 sc1
  v_mfma_f32_32x32x16_bf16 v[96:111], a[72:75], v[224:227], 0
  v_mul_f32 v35, v35, v163
  v_exp_f32 v32, v32
  v_exp_f32 v33, v33
  v_exp_f32 v34, v34
  v_exp_f32 v35, v35
  v_add_f32 v32, 1.0, v32
  v_mfma_f32_32x32x16_bf16 v[112:127], a[72:75], v[228:231], 0
  v_add_f32 v33, 1.0, v33
  v_add_f32 v34, 1.0, v34
  v_add_f32 v35, 1.0, v35
  v_rcp_f32 v32, v32
  v_rcp_f32 v33, v33
  buffer_load_dwordx4 a[72:75], v2, s[64:67], 0 offen offset:1024 sc1
  ds_read_b128 v[224:227], v18 offset:6144
  ds_read_b128 v[228:231], v18 offset:7168
  s_waitcnt vmcnt(52) lgkmcnt(8)
  v_mfma_f32_32x32x16_bf16 v[64:79], a[144:147], v[232:235], v[64:79]
  v_rcp_f32 v34, v34
  v_rcp_f32 v35, v35
  v_mul_f32 v32, v160, v32
  v_mul_f32 v33, v161, v33
  v_mul_f32 v34, v162, v34
  v_mul_f32 v35, v163, v35
  v_mfma_f32_32x32x16_bf16 v[80:95], a[144:147], v[236:239], v[80:95]
  v_cvt_pk_bf16_f32 v40, v32, v33
  v_cvt_pk_bf16_f32 v41, v34, v35
  v_mul_f32 v36, v164, v164
  v_mul_f32 v37, v165, v165
  v_mul_f32 v38, v166, v166
  v_mul_f32 v39, v167, v167
  buffer_load_dwordx4 a[144:147], v2, s[64:67], 0 offen offset:2048 sc1
  v_mfma_f32_32x32x16_bf16 v[96:111], a[4:7], v[232:235], v[96:111]
  v_fma_f32 v36, v36, v20, s8
  v_fma_f32 v37, v37, v20, s8
  v_fma_f32 v38, v38, v20, s8
  v_fma_f32 v39, v39, v20, s8
  v_mul_f32 v36, v36, v164
  v_mfma_f32_32x32x16_bf16 v[112:127], a[4:7], v[236:239], v[112:127]
  v_mul_f32 v37, v37, v165
  v_mul_f32 v38, v38, v166
  v_mul_f32 v39, v39, v167
  v_exp_f32 v36, v36
  v_exp_f32 v37, v37
  v_exp_f32 v38, v38
  buffer_load_dwordx4 a[4:7], v2, s[64:67], 0 offen offset:3072 sc1
  s_waitcnt vmcnt(53) lgkmcnt(2)
  v_mfma_f32_16x16x32_bf16 v[128:131], a[76:79], v[144:147], 0
  v_mfma_f32_16x16x32_bf16 v[132:135], a[76:79], v[148:151], 0
  v_mfma_f32_16x16x32_bf16 v[136:139], a[76:79], v[152:155], 0
  v_mfma_f32_16x16x32_bf16 v[140:143], a[76:79], v[156:159], 0
  v_exp_f32 v39, v39
  v_add_f32 v36, 1.0, v36
  v_add_f32 v37, 1.0, v37
  v_add_f32 v38, 1.0, v38
  v_add_f32 v39, 1.0, v39
  v_rcp_f32 v36, v36
  v_add_u32 v2, 4096, v2
  buffer_load_dwordx4 a[76:79], v2, s[64:67], 0 offen offset:0 sc1
  ds_read_b128 v[232:235], v18 offset:8192
  ds_read_b128 v[236:239], v18 offset:9216
  ds_read_b128 v[144:147], v60 offset:4096
  ds_read_b128 v[148:151], v60 offset:4352
  ds_read_b128 v[152:155], v60 offset:5120
  ds_read_b128 v[156:159], v60 offset:5376
  s_waitcnt vmcnt(52)
  v_mfma_f32_32x32x16_bf16 v[64:79], a[148:151], v[240:243], v[64:79]
  v_rcp_f32 v37, v37
  v_rcp_f32 v38, v38
  v_rcp_f32 v39, v39
  v_mul_f32 v36, v164, v36
  v_mul_f32 v37, v165, v37
  v_mfma_f32_32x32x16_bf16 v[80:95], a[148:151], v[244:247], v[80:95]
  v_mul_f32 v38, v166, v38
  v_mul_f32 v39, v167, v39
  v_cvt_pk_bf16_f32 v42, v36, v37
  v_cvt_pk_bf16_f32 v43, v38, v39
  ds_write_b128 v23, v[40:43] offset:0
  v_mul_f32 v32, v168, v168
  buffer_load_dwordx4 a[148:151], v2, s[64:67], 0 offen offset:1024 sc1
  v_mfma_f32_32x32x16_bf16 v[96:111], a[8:11], v[240:243], v[96:111]
  v_mul_f32 v33, v169, v169
  v_mul_f32 v34, v170, v170
  v_mul_f32 v35, v171, v171
  v_fma_f32 v32, v32, v20, s8
  v_fma_f32 v33, v33, v20, s8
  v_fma_f32 v34, v34, v20, s8
  v_mfma_f32_32x32x16_bf16 v[112:127], a[8:11], v[244:247], v[112:127]
  v_fma_f32 v35, v35, v20, s8
  v_mul_f32 v32, v32, v168
  v_mul_f32 v33, v33, v169
  v_mul_f32 v34, v34, v170
  v_mul_f32 v35, v35, v171
  buffer_load_dwordx4 a[8:11], v2, s[64:67], 0 offen offset:2048 sc1
  ds_read_b128 v[240:243], v18 offset:10240
  ds_read_b128 v[244:247], v18 offset:11264
  s_waitcnt vmcnt(52) lgkmcnt(9)
  v_mfma_f32_32x32x16_bf16 v[64:79], a[80:83], v[224:227], v[64:79]
  v_exp_f32 v32, v32
  v_exp_f32 v33, v33
  v_exp_f32 v34, v34
  v_exp_f32 v35, v35
  v_add_f32 v32, 1.0, v32
  v_add_f32 v33, 1.0, v33
  v_mfma_f32_32x32x16_bf16 v[80:95], a[80:83], v[228:231], v[80:95]
  v_add_f32 v34, 1.0, v34
  v_add_f32 v35, 1.0, v35
  v_rcp_f32 v32, v32
  v_rcp_f32 v33, v33
  v_rcp_f32 v34, v34
  v_rcp_f32 v35, v35
  buffer_load_dwordx4 a[80:83], v2, s[64:67], 0 offen offset:3072 sc1
  v_mfma_f32_32x32x16_bf16 v[96:111], a[152:155], v[224:227], v[96:111]
  v_mul_f32 v32, v168, v32
  v_mul_f32 v33, v169, v33
  v_mul_f32 v34, v170, v34
  v_mul_f32 v35, v171, v35
  v_cvt_pk_bf16_f32 v44, v32, v33
  v_mfma_f32_32x32x16_bf16 v[112:127], a[152:155], v[228:231], v[112:127]
  v_cvt_pk_bf16_f32 v45, v34, v35
  v_mul_f32 v36, v172, v172
  v_mul_f32 v37, v173, v173
  v_mul_f32 v38, v174, v174
  v_mul_f32 v39, v175, v175
  v_fma_f32 v36, v36, v20, s8
  v_add_u32 v2, 4096, v2
  buffer_load_dwordx4 a[152:155], v2, s[64:67], 0 offen offset:0 sc1
  s_waitcnt vmcnt(53) lgkmcnt(3)
  v_mfma_f32_16x16x32_bf16 v[128:131], a[12:15], v[144:147], v[128:131]
  v_mfma_f32_16x16x32_bf16 v[132:135], a[12:15], v[148:151], v[132:135]
  v_mfma_f32_16x16x32_bf16 v[136:139], a[12:15], v[152:155], v[136:139]
  v_mfma_f32_16x16x32_bf16 v[140:143], a[12:15], v[156:159], v[140:143]
  v_fma_f32 v37, v37, v20, s8
  v_fma_f32 v38, v38, v20, s8
  v_fma_f32 v39, v39, v20, s8
  v_mul_f32 v36, v36, v172
  v_mul_f32 v37, v37, v173
  v_mul_f32 v38, v38, v174
  buffer_load_dwordx4 a[12:15], v2, s[64:67], 0 offen offset:1024 sc1
  ds_read_b128 v[224:227], v18 offset:12288
  ds_read_b128 v[228:231], v18 offset:13312
  ds_read_b128 v[144:147], v60 offset:8192
  ds_read_b128 v[148:151], v60 offset:8448
  ds_read_b128 v[152:155], v60 offset:9216
  ds_read_b128 v[156:159], v60 offset:9472
  s_waitcnt vmcnt(52)
  v_mfma_f32_32x32x16_bf16 v[64:79], a[84:87], v[232:235], v[64:79]
  v_mul_f32 v39, v39, v175
  v_exp_f32 v36, v36
  v_exp_f32 v37, v37
  v_exp_f32 v38, v38
  v_exp_f32 v39, v39
  v_mfma_f32_32x32x16_bf16 v[80:95], a[84:87], v[236:239], v[80:95]
  v_add_f32 v36, 1.0, v36
  v_add_f32 v37, 1.0, v37
  v_add_f32 v38, 1.0, v38
  v_add_f32 v39, 1.0, v39
  v_rcp_f32 v36, v36
  v_rcp_f32 v37, v37
  buffer_load_dwordx4 a[84:87], v2, s[64:67], 0 offen offset:2048 sc1
  v_mfma_f32_32x32x16_bf16 v[96:111], a[156:159], v[232:235], v[96:111]
  v_rcp_f32 v38, v38
  v_rcp_f32 v39, v39
  v_mul_f32 v36, v172, v36
  v_mul_f32 v37, v173, v37
  v_mul_f32 v38, v174, v38
  v_mul_f32 v39, v175, v39
  v_mfma_f32_32x32x16_bf16 v[112:127], a[156:159], v[236:239], v[112:127]
  v_cvt_pk_bf16_f32 v46, v36, v37
  v_cvt_pk_bf16_f32 v47, v38, v39
  ds_write_b128 v23, v[44:47] offset:2048
  v_mul_f32 v32, v176, v176
  v_mul_f32 v33, v177, v177
  buffer_load_dwordx4 a[156:159], v2, s[64:67], 0 offen offset:3072 sc1
  ds_read_b128 v[232:235], v18 offset:14336
  ds_read_b128 v[236:239], v18 offset:15360
  s_waitcnt vmcnt(52) lgkmcnt(9)
  v_mfma_f32_32x32x16_bf16 v[64:79], a[16:19], v[240:243], v[64:79]
  v_mul_f32 v34, v178, v178
  v_mul_f32 v35, v179, v179
  v_fma_f32 v32, v32, v20, s8
  v_fma_f32 v33, v33, v20, s8
  v_fma_f32 v34, v34, v20, s8
  v_fma_f32 v35, v35, v20, s8
  v_mfma_f32_32x32x16_bf16 v[80:95], a[16:19], v[244:247], v[80:95]
  v_mul_f32 v32, v32, v176
  v_mul_f32 v33, v33, v177
  v_mul_f32 v34, v34, v178
  v_mul_f32 v35, v35, v179
  v_exp_f32 v32, v32
  v_exp_f32 v33, v33
  v_add_u32 v2, 4096, v2
  buffer_load_dwordx4 a[16:19], v2, s[64:67], 0 offen offset:0 sc1
  v_mfma_f32_32x32x16_bf16 v[96:111], a[88:91], v[240:243], v[96:111]
  v_exp_f32 v34, v34
  v_exp_f32 v35, v35
  v_add_f32 v32, 1.0, v32
  v_add_f32 v33, 1.0, v33
  v_add_f32 v34, 1.0, v34
  v_mfma_f32_32x32x16_bf16 v[112:127], a[88:91], v[244:247], v[112:127]
  v_add_f32 v35, 1.0, v35
  v_rcp_f32 v32, v32
  v_rcp_f32 v33, v33
  v_rcp_f32 v34, v34
  v_rcp_f32 v35, v35
  v_mul_f32 v32, v176, v32
  buffer_load_dwordx4 a[88:91], v2, s[64:67], 0 offen offset:1024 sc1
  s_waitcnt vmcnt(53) lgkmcnt(3)
  v_mfma_f32_16x16x32_bf16 v[128:131], a[160:163], v[144:147], v[128:131]
  v_mfma_f32_16x16x32_bf16 v[132:135], a[160:163], v[148:151], v[132:135]
  v_mfma_f32_16x16x32_bf16 v[136:139], a[160:163], v[152:155], v[136:139]
  v_mfma_f32_16x16x32_bf16 v[140:143], a[160:163], v[156:159], v[140:143]
  v_mul_f32 v33, v177, v33
  v_mul_f32 v34, v178, v34
  v_mul_f32 v35, v179, v35
  v_cvt_pk_bf16_f32 v40, v32, v33
  v_cvt_pk_bf16_f32 v41, v34, v35
  v_mul_f32 v36, v180, v180
  buffer_load_dwordx4 a[160:163], v2, s[64:67], 0 offen offset:2048 sc1
  ds_read_b128 v[240:243], v18 offset:16384
  ds_read_b128 v[244:247], v18 offset:17408
  ds_read_b128 v[144:147], v60 offset:12288
  ds_read_b128 v[148:151], v60 offset:12544
  ds_read_b128 v[152:155], v60 offset:13312
  ds_read_b128 v[156:159], v60 offset:13568
  s_waitcnt vmcnt(52)
  v_mfma_f32_32x32x16_bf16 v[64:79], a[20:23], v[224:227], v[64:79]
  v_mul_f32 v37, v181, v181
  v_mul_f32 v38, v182, v182
  v_mul_f32 v39, v183, v183
  v_fma_f32 v36, v36, v20, s8
  v_fma_f32 v37, v37, v20, s8
  v_mfma_f32_32x32x16_bf16 v[80:95], a[20:23], v[228:231], v[80:95]
  v_fma_f32 v38, v38, v20, s8
  v_fma_f32 v39, v39, v20, s8
  v_mul_f32 v36, v36, v180
  v_mul_f32 v37, v37, v181
  v_mul_f32 v38, v38, v182
  v_mul_f32 v39, v39, v183
  buffer_load_dwordx4 a[20:23], v2, s[64:67], 0 offen offset:3072 sc1
  v_mfma_f32_32x32x16_bf16 v[96:111], a[92:95], v[224:227], v[96:111]
  v_exp_f32 v36, v36
  v_exp_f32 v37, v37
  v_exp_f32 v38, v38
  v_exp_f32 v39, v39
  v_add_f32 v36, 1.0, v36
  v_add_f32 v37, 1.0, v37
  v_mfma_f32_32x32x16_bf16 v[112:127], a[92:95], v[228:231], v[112:127]
  v_add_f32 v38, 1.0, v38
  v_add_f32 v39, 1.0, v39
  v_rcp_f32 v36, v36
  v_rcp_f32 v37, v37
  v_rcp_f32 v38, v38
  v_add_u32 v2, 4096, v2
  buffer_load_dwordx4 a[92:95], v2, s[64:67], 0 offen offset:0 sc1
  ds_read_b128 v[224:227], v18 offset:18432
  ds_read_b128 v[228:231], v18 offset:19456
  s_waitcnt vmcnt(52) lgkmcnt(8)
  v_mfma_f32_32x32x16_bf16 v[64:79], a[164:167], v[232:235], v[64:79]
  v_rcp_f32 v39, v39
  v_mul_f32 v36, v180, v36
  v_mul_f32 v37, v181, v37
  v_mul_f32 v38, v182, v38
  v_mul_f32 v39, v183, v39
  v_cvt_pk_bf16_f32 v42, v36, v37
  v_mfma_f32_32x32x16_bf16 v[80:95], a[164:167], v[236:239], v[80:95]
  v_cvt_pk_bf16_f32 v43, v38, v39
  ds_write_b128 v23, v[40:43] offset:1024
  v_mul_f32 v32, v184, v184
  v_mul_f32 v33, v185, v185
  v_mul_f32 v34, v186, v186
  v_mul_f32 v35, v187, v187
  buffer_load_dwordx4 a[164:167], v2, s[64:67], 0 offen offset:1024 sc1
  v_mfma_f32_32x32x16_bf16 v[96:111], a[24:27], v[232:235], v[96:111]
  v_fma_f32 v32, v32, v20, s8
  v_fma_f32 v33, v33, v20, s8
  v_fma_f32 v34, v34, v20, s8
  v_fma_f32 v35, v35, v20, s8
  v_mul_f32 v32, v32, v184
  v_mfma_f32_32x32x16_bf16 v[112:127], a[24:27], v[236:239], v[112:127]
  v_mul_f32 v33, v33, v185
  v_mul_f32 v34, v34, v186
  v_mul_f32 v35, v35, v187
  v_exp_f32 v32, v32
  v_exp_f32 v33, v33
  v_exp_f32 v34, v34
  buffer_load_dwordx4 a[24:27], v2, s[64:67], 0 offen offset:2048 sc1
  s_waitcnt vmcnt(53) lgkmcnt(3)
  v_mfma_f32_16x16x32_bf16 v[128:131], a[96:99], v[144:147], v[128:131]
  v_mfma_f32_16x16x32_bf16 v[132:135], a[96:99], v[148:151], v[132:135]
  v_mfma_f32_16x16x32_bf16 v[136:139], a[96:99], v[152:155], v[136:139]
  v_mfma_f32_16x16x32_bf16 v[140:143], a[96:99], v[156:159], v[140:143]
  v_exp_f32 v35, v35
  v_add_f32 v32, 1.0, v32
  v_add_f32 v33, 1.0, v33
  v_add_f32 v34, 1.0, v34
  v_add_f32 v35, 1.0, v35
  v_rcp_f32 v32, v32
  buffer_load_dwordx4 a[96:99], v2, s[64:67], 0 offen offset:3072 sc1
  ds_read_b128 v[232:235], v18 offset:20480
  ds_read_b128 v[236:239], v18 offset:21504
  ds_read_b128 v[144:147], v60 offset:16384
  ds_read_b128 v[148:151], v60 offset:16640
  ds_read_b128 v[152:155], v60 offset:17408
  ds_read_b128 v[156:159], v60 offset:17664
  s_waitcnt vmcnt(52)
  v_mfma_f32_32x32x16_bf16 v[64:79], a[168:171], v[240:243], v[64:79]
  v_rcp_f32 v33, v33
  v_rcp_f32 v34, v34
  v_rcp_f32 v35, v35
  v_mul_f32 v32, v184, v32
  v_mul_f32 v33, v185, v33
  v_mfma_f32_32x32x16_bf16 v[80:95], a[168:171], v[244:247], v[80:95]
  v_mul_f32 v34, v186, v34
  v_mul_f32 v35, v187, v35
  v_cvt_pk_bf16_f32 v44, v32, v33
  v_cvt_pk_bf16_f32 v45, v34, v35
  v_mul_f32 v36, v188, v188
  v_mul_f32 v37, v189, v189
  v_add_u32 v3, 4096, v3
  buffer_load_dwordx4 a[168:171], v3, s[64:67], 0 offen offset:0 sc1
  v_mfma_f32_32x32x16_bf16 v[96:111], a[28:31], v[240:243], v[96:111]
  v_mul_f32 v38, v190, v190
  v_mul_f32 v39, v191, v191
  v_fma_f32 v36, v36, v20, s8
  v_fma_f32 v37, v37, v20, s8
  v_fma_f32 v38, v38, v20, s8
  v_fma_f32 v39, v39, v20, s8
  v_mfma_f32_32x32x16_bf16 v[112:127], a[28:31], v[244:247], v[112:127]
  v_mul_f32 v36, v36, v188
  v_mul_f32 v37, v37, v189
  v_mul_f32 v38, v38, v190
  v_mul_f32 v39, v39, v191
  v_exp_f32 v36, v36
  buffer_load_dwordx4 a[28:31], v3, s[64:67], 0 offen offset:1024 sc1
  ds_read_b128 v[240:243], v18 offset:22528
  ds_read_b128 v[244:247], v18 offset:23552
  s_waitcnt vmcnt(52) lgkmcnt(9)
  v_mfma_f32_32x32x16_bf16 v[64:79], a[100:103], v[224:227], v[64:79]
  v_exp_f32 v37, v37
  v_exp_f32 v38, v38
  v_exp_f32 v39, v39
  v_add_f32 v36, 1.0, v36
  v_add_f32 v37, 1.0, v37
  v_add_f32 v38, 1.0, v38
  v_mfma_f32_32x32x16_bf16 v[80:95], a[100:103], v[228:231], v[80:95]
  v_add_f32 v39, 1.0, v39
  v_rcp_f32 v36, v36
  v_rcp_f32 v37, v37
  v_rcp_f32 v38, v38
  v_rcp_f32 v39, v39
  v_mul_f32 v36, v188, v36
  buffer_load_dwordx4 a[100:103], v3, s[64:67], 0 offen offset:2048 sc1
  v_mfma_f32_32x32x16_bf16 v[96:111], a[172:175], v[224:227], v[96:111]
  v_mul_f32 v37, v189, v37
  v_mul_f32 v38, v190, v38
  v_mul_f32 v39, v191, v39
  v_cvt_pk_bf16_f32 v46, v36, v37
  v_cvt_pk_bf16_f32 v47, v38, v39
  ds_write_b128 v23, v[44:47] offset:3072
  v_mfma_f32_32x32x16_bf16 v[112:127], a[172:175], v[228:231], v[112:127]
  v_mul_f32 v32, v192, v192
  v_mul_f32 v33, v193, v193
  v_mul_f32 v34, v194, v194
  v_mul_f32 v35, v195, v195
  v_fma_f32 v32, v32, v20, s8
  buffer_load_dwordx4 a[172:175], v3, s[64:67], 0 offen offset:3072 sc1
  s_waitcnt vmcnt(53) lgkmcnt(3)
  v_mfma_f32_16x16x32_bf16 v[128:131], a[32:35], v[144:147], v[128:131]
  v_mfma_f32_16x16x32_bf16 v[132:135], a[32:35], v[148:151], v[132:135]
  v_mfma_f32_16x16x32_bf16 v[136:139], a[32:35], v[152:155], v[136:139]
  v_mfma_f32_16x16x32_bf16 v[140:143], a[32:35], v[156:159], v[140:143]
  v_fma_f32 v33, v33, v20, s8
  v_fma_f32 v34, v34, v20, s8
  v_fma_f32 v35, v35, v20, s8
  v_mul_f32 v32, v32, v192
  v_mul_f32 v33, v33, v193
  v_mul_f32 v34, v34, v194
  v_add_u32 v3, 4096, v3
  buffer_load_dwordx4 a[32:35], v3, s[64:67], 0 offen offset:0 sc1
  ds_read_b128 v[224:227], v18 offset:24576
  ds_read_b128 v[228:231], v18 offset:25600
  ds_read_b128 v[144:147], v60 offset:20480
  ds_read_b128 v[148:151], v60 offset:20736
  ds_read_b128 v[152:155], v60 offset:21504
  ds_read_b128 v[156:159], v60 offset:21760
  s_waitcnt vmcnt(52)
  v_mfma_f32_32x32x16_bf16 v[64:79], a[104:107], v[232:235], v[64:79]
  v_mul_f32 v35, v35, v195
  v_exp_f32 v32, v32
  v_exp_f32 v33, v33
  v_exp_f32 v34, v34
  v_exp_f32 v35, v35
  v_add_f32 v32, 1.0, v32
  v_mfma_f32_32x32x16_bf16 v[80:95], a[104:107], v[236:239], v[80:95]
  v_add_f32 v33, 1.0, v33
  v_add_f32 v34, 1.0, v34
  v_add_f32 v35, 1.0, v35
  v_rcp_f32 v32, v32
  v_rcp_f32 v33, v33
  buffer_load_dwordx4 a[104:107], v3, s[64:67], 0 offen offset:1024 sc1
  v_mfma_f32_32x32x16_bf16 v[96:111], a[176:179], v[232:235], v[96:111]
  v_rcp_f32 v34, v34
  v_rcp_f32 v35, v35
  v_mul_f32 v32, v192, v32
  v_mul_f32 v33, v193, v33
  v_mul_f32 v34, v194, v34
  v_mul_f32 v35, v195, v35
  v_mfma_f32_32x32x16_bf16 v[112:127], a[176:179], v[236:239], v[112:127]
  v_cvt_pk_bf16_f32 v40, v32, v33
  v_cvt_pk_bf16_f32 v41, v34, v35
  v_mul_f32 v36, v196, v196
  v_mul_f32 v37, v197, v197
  v_mul_f32 v38, v198, v198
  v_mul_f32 v39, v199, v199
  buffer_load_dwordx4 a[176:179], v3, s[64:67], 0 offen offset:2048 sc1
  ds_read_b128 v[232:235], v18 offset:26624
  ds_read_b128 v[236:239], v18 offset:27648
  s_waitcnt vmcnt(52) lgkmcnt(9)
  v_mfma_f32_32x32x16_bf16 v[64:79], a[36:39], v[240:243], v[64:79]
  v_fma_f32 v36, v36, v20, s8
  v_fma_f32 v37, v37, v20, s8
  v_fma_f32 v38, v38, v20, s8
  v_fma_f32 v39, v39, v20, s8
  v_mul_f32 v36, v36, v196
  v_mfma_f32_32x32x16_bf16 v[80:95], a[36:39], v[244:247], v[80:95]
  v_mul_f32 v37, v37, v197
  v_mul_f32 v38, v38, v198
  v_mul_f32 v39, v39, v199
  v_exp_f32 v36, v36
  v_exp_f32 v37, v37
  v_exp_f32 v38, v38
  buffer_load_dwordx4 a[36:39], v3, s[64:67], 0 offen offset:3072 sc1
  v_mfma_f32_32x32x16_bf16 v[96:111], a[108:111], v[240:243], v[96:111]
  v_exp_f32 v39, v39
  v_add_f32 v36, 1.0, v36
  v_add_f32 v37, 1.0, v37
  v_add_f32 v38, 1.0, v38
  v_add_f32 v39, 1.0, v39
  v_rcp_f32 v36, v36
  v_mfma_f32_32x32x16_bf16 v[112:127], a[108:111], v[244:247], v[112:127]
  v_rcp_f32 v37, v37
  v_rcp_f32 v38, v38
  v_rcp_f32 v39, v39
  v_mul_f32 v36, v196, v36
  v_mul_f32 v37, v197, v37
  v_add_u32 v3, 4096, v3
  buffer_load_dwordx4 a[108:111], v3, s[64:67], 0 offen offset:0 sc1
  s_waitcnt vmcnt(53) lgkmcnt(2)
  v_mfma_f32_16x16x32_bf16 v[128:131], a[180:183], v[144:147], v[128:131]
  v_mfma_f32_16x16x32_bf16 v[132:135], a[180:183], v[148:151], v[132:135]
  v_mfma_f32_16x16x32_bf16 v[136:139], a[180:183], v[152:155], v[136:139]
  v_mfma_f32_16x16x32_bf16 v[140:143], a[180:183], v[156:159], v[140:143]
  v_mul_f32 v38, v198, v38
  v_mul_f32 v39, v199, v39
  v_cvt_pk_bf16_f32 v42, v36, v37
  v_cvt_pk_bf16_f32 v43, v38, v39
  ds_write_b128 v23, v[40:43] offset:4096
  v_mul_f32 v32, v200, v200
  buffer_load_dwordx4 a[180:183], v3, s[64:67], 0 offen offset:1024 sc1
  ds_read_b128 v[240:243], v18 offset:28672
  ds_read_b128 v[244:247], v18 offset:29696
  ds_read_b128 v[144:147], v60 offset:24576
  ds_read_b128 v[148:151], v60 offset:24832
  ds_read_b128 v[152:155], v60 offset:25600
  ds_read_b128 v[156:159], v60 offset:25856
  s_waitcnt vmcnt(52)
  v_mfma_f32_32x32x16_bf16 v[64:79], a[40:43], v[224:227], v[64:79]
  v_mul_f32 v33, v201, v201
  v_mul_f32 v34, v202, v202
  v_mul_f32 v35, v203, v203
  v_fma_f32 v32, v32, v20, s8
  v_fma_f32 v33, v33, v20, s8
  v_fma_f32 v34, v34, v20, s8
  v_mfma_f32_32x32x16_bf16 v[80:95], a[40:43], v[228:231], v[80:95]
  v_fma_f32 v35, v35, v20, s8
  v_mul_f32 v32, v32, v200
  v_mul_f32 v33, v33, v201
  v_mul_f32 v34, v34, v202
  v_mul_f32 v35, v35, v203
  buffer_load_dwordx4 a[40:43], v3, s[64:67], 0 offen offset:2048 sc1
  v_mfma_f32_32x32x16_bf16 v[96:111], a[112:115], v[224:227], v[96:111]
  v_exp_f32 v32, v32
  v_exp_f32 v33, v33
  v_exp_f32 v34, v34
  v_exp_f32 v35, v35
  v_add_f32 v32, 1.0, v32
  v_add_f32 v33, 1.0, v33
  v_mfma_f32_32x32x16_bf16 v[112:127], a[112:115], v[228:231], v[112:127]
  v_add_f32 v34, 1.0, v34
  v_add_f32 v35, 1.0, v35
  v_rcp_f32 v32, v32
  v_rcp_f32 v33, v33
  v_rcp_f32 v34, v34
  v_rcp_f32 v35, v35
  buffer_load_dwordx4 a[112:115], v3, s[64:67], 0 offen offset:3072 sc1
  ds_read_b128 v[224:227], v18 offset:30720
  ds_read_b128 v[228:231], v18 offset:31744
  s_waitcnt vmcnt(52) lgkmcnt(9)
  v_mfma_f32_32x32x16_bf16 v[64:79], a[184:187], v[232:235], v[64:79]
  v_mul_f32 v32, v200, v32
  v_mul_f32 v33, v201, v33
  v_mul_f32 v34, v202, v34
  v_mul_f32 v35, v203, v35
  v_cvt_pk_bf16_f32 v44, v32, v33
  v_mfma_f32_32x32x16_bf16 v[80:95], a[184:187], v[236:239], v[80:95]
  v_cvt_pk_bf16_f32 v45, v34, v35
  v_mul_f32 v36, v204, v204
  v_mul_f32 v37, v205, v205
  v_mul_f32 v38, v206, v206
  v_mul_f32 v39, v207, v207
  v_fma_f32 v36, v36, v20, s8
  v_add_u32 v3, 4096, v3
  buffer_load_dwordx4 a[184:187], v3, s[64:67], 0 offen offset:0 sc1
  v_mfma_f32_32x32x16_bf16 v[96:111], a[44:47], v[232:235], v[96:111]
  v_fma_f32 v37, v37, v20, s8
  v_fma_f32 v38, v38, v20, s8
  v_fma_f32 v39, v39, v20, s8
  v_mul_f32 v36, v36, v204
  v_mul_f32 v37, v37, v205
  v_mul_f32 v38, v38, v206
  v_mfma_f32_32x32x16_bf16 v[112:127], a[44:47], v[236:239], v[112:127]
  v_mul_f32 v39, v39, v207
  v_exp_f32 v36, v36
  v_exp_f32 v37, v37
  v_exp_f32 v38, v38
  v_exp_f32 v39, v39
  buffer_load_dwordx4 a[44:47], v3, s[64:67], 0 offen offset:1024 sc1
  s_waitcnt vmcnt(53) lgkmcnt(2)
  v_mfma_f32_16x16x32_bf16 v[128:131], a[116:119], v[144:147], v[128:131]
  v_mfma_f32_16x16x32_bf16 v[132:135], a[116:119], v[148:151], v[132:135]
  v_mfma_f32_16x16x32_bf16 v[136:139], a[116:119], v[152:155], v[136:139]
  v_mfma_f32_16x16x32_bf16 v[140:143], a[116:119], v[156:159], v[140:143]
  v_add_f32 v36, 1.0, v36
  v_add_f32 v37, 1.0, v37
  v_add_f32 v38, 1.0, v38
  v_add_f32 v39, 1.0, v39
  v_rcp_f32 v36, v36
  v_rcp_f32 v37, v37
  buffer_load_dwordx4 a[116:119], v3, s[64:67], 0 offen offset:2048 sc1
  ds_read_b128 v[232:235], v18 offset:32768
  ds_read_b128 v[236:239], v18 offset:33792
  ds_read_b128 v[144:147], v60 offset:28672
  ds_read_b128 v[148:151], v60 offset:28928
  ds_read_b128 v[152:155], v60 offset:29696
  ds_read_b128 v[156:159], v60 offset:29952
  s_waitcnt vmcnt(52)
  v_mfma_f32_32x32x16_bf16 v[64:79], a[188:191], v[240:243], v[64:79]
  v_rcp_f32 v38, v38
  v_rcp_f32 v39, v39
  v_mul_f32 v36, v204, v36
  v_mul_f32 v37, v205, v37
  v_mul_f32 v38, v206, v38
  v_mul_f32 v39, v207, v39
  v_mfma_f32_32x32x16_bf16 v[80:95], a[188:191], v[244:247], v[80:95]
  v_cvt_pk_bf16_f32 v46, v36, v37
  v_cvt_pk_bf16_f32 v47, v38, v39
  ds_write_b128 v23, v[44:47] offset:6144
  v_mul_f32 v32, v208, v208
  v_mul_f32 v33, v209, v209
  buffer_load_dwordx4 a[188:191], v3, s[64:67], 0 offen offset:3072 sc1
  v_mfma_f32_32x32x16_bf16 v[96:111], a[48:51], v[240:243], v[96:111]
  v_mul_f32 v34, v210, v210
  v_mul_f32 v35, v211, v211
  v_fma_f32 v32, v32, v20, s8
  v_fma_f32 v33, v33, v20, s8
  v_fma_f32 v34, v34, v20, s8
  v_fma_f32 v35, v35, v20, s8
  v_mfma_f32_32x32x16_bf16 v[112:127], a[48:51], v[244:247], v[112:127]
  v_mul_f32 v32, v32, v208
  v_mul_f32 v33, v33, v209
  v_mul_f32 v34, v34, v210
  v_mul_f32 v35, v35, v211
  v_exp_f32 v32, v32
  v_exp_f32 v33, v33
  v_add_u32 v2, 40960, v2
  buffer_load_dwordx4 a[48:51], v2, s[64:67], 0 offen offset:0 sc1
  ds_read_b128 v[240:243], v18 offset:34816
  ds_read_b128 v[244:247], v18 offset:35840
  s_waitcnt vmcnt(52) lgkmcnt(9)
  v_mfma_f32_32x32x16_bf16 v[64:79], a[120:123], v[224:227], v[64:79]
  v_exp_f32 v34, v34
  v_exp_f32 v35, v35
  v_add_f32 v32, 1.0, v32
  v_add_f32 v33, 1.0, v33
  v_add_f32 v34, 1.0, v34
  v_mfma_f32_32x32x16_bf16 v[80:95], a[120:123], v[228:231], v[80:95]
  v_add_f32 v35, 1.0, v35
  v_rcp_f32 v32, v32
  v_rcp_f32 v33, v33
  v_rcp_f32 v34, v34
  v_rcp_f32 v35, v35
  v_mul_f32 v32, v208, v32
  buffer_load_dwordx4 a[120:123], v2, s[64:67], 0 offen offset:1024 sc1
  v_mfma_f32_32x32x16_bf16 v[96:111], a[192:195], v[224:227], v[96:111]
  v_mul_f32 v33, v209, v33
  v_mul_f32 v34, v210, v34
  v_mul_f32 v35, v211, v35
  v_cvt_pk_bf16_f32 v40, v32, v33
  v_cvt_pk_bf16_f32 v41, v34, v35
  v_mul_f32 v36, v212, v212
  v_mfma_f32_32x32x16_bf16 v[112:127], a[192:195], v[228:231], v[112:127]
  v_mul_f32 v37, v213, v213
  v_mul_f32 v38, v214, v214
  v_mul_f32 v39, v215, v215
  v_fma_f32 v36, v36, v20, s8
  v_fma_f32 v37, v37, v20, s8
  buffer_load_dwordx4 a[192:195], v2, s[64:67], 0 offen offset:2048 sc1
  s_waitcnt vmcnt(53) lgkmcnt(3)
  v_mfma_f32_16x16x32_bf16 v[128:131], a[52:55], v[144:147], v[128:131]
  v_mfma_f32_16x16x32_bf16 v[132:135], a[52:55], v[148:151], v[132:135]
  v_mfma_f32_16x16x32_bf16 v[136:139], a[52:55], v[152:155], v[136:139]
  v_mfma_f32_16x16x32_bf16 v[140:143], a[52:55], v[156:159], v[140:143]
  v_fma_f32 v38, v38, v20, s8
  v_fma_f32 v39, v39, v20, s8
  v_mul_f32 v36, v36, v212
  v_mul_f32 v37, v37, v213
  v_mul_f32 v38, v38, v214
  v_mul_f32 v39, v39, v215
  buffer_load_dwordx4 a[52:55], v2, s[64:67], 0 offen offset:3072 sc1
  ds_read_b128 v[224:227], v18 offset:36864
  ds_read_b128 v[228:231], v18 offset:37888
  ds_read_b128 v[144:147], v60 offset:32768
  ds_read_b128 v[148:151], v60 offset:33024
  ds_read_b128 v[152:155], v60 offset:33792
  ds_read_b128 v[156:159], v60 offset:34048
  s_waitcnt vmcnt(52)
  v_mfma_f32_32x32x16_bf16 v[64:79], a[124:127], v[232:235], v[64:79]
  v_exp_f32 v36, v36
  v_exp_f32 v37, v37
  v_exp_f32 v38, v38
  v_exp_f32 v39, v39
  v_add_f32 v36, 1.0, v36
  v_add_f32 v37, 1.0, v37
  v_mfma_f32_32x32x16_bf16 v[80:95], a[124:127], v[236:239], v[80:95]
  v_add_f32 v38, 1.0, v38
  v_add_f32 v39, 1.0, v39
  v_rcp_f32 v36, v36
  v_rcp_f32 v37, v37
  v_rcp_f32 v38, v38
  v_add_u32 v2, 4096, v2
  buffer_load_dwordx4 a[124:127], v2, s[64:67], 0 offen offset:0 sc1
  v_mfma_f32_32x32x16_bf16 v[96:111], a[196:199], v[232:235], v[96:111]
  v_rcp_f32 v39, v39
  v_mul_f32 v36, v212, v36
  v_mul_f32 v37, v213, v37
  v_mul_f32 v38, v214, v38
  v_mul_f32 v39, v215, v39
  v_cvt_pk_bf16_f32 v42, v36, v37
  v_mfma_f32_32x32x16_bf16 v[112:127], a[196:199], v[236:239], v[112:127]
  v_cvt_pk_bf16_f32 v43, v38, v39
  ds_write_b128 v23, v[40:43] offset:5120
  v_mul_f32 v32, v216, v216
  v_mul_f32 v33, v217, v217
  v_mul_f32 v34, v218, v218
  v_mul_f32 v35, v219, v219
  buffer_load_dwordx4 a[196:199], v2, s[64:67], 0 offen offset:1024 sc1
  ds_read_b128 v[232:235], v18 offset:38912
  ds_read_b128 v[236:239], v18 offset:39936
  s_waitcnt vmcnt(52) lgkmcnt(9)
  v_mfma_f32_32x32x16_bf16 v[64:79], a[56:59], v[240:243], v[64:79]
  v_fma_f32 v32, v32, v20, s8
  v_fma_f32 v33, v33, v20, s8
  v_fma_f32 v34, v34, v20, s8
  v_fma_f32 v35, v35, v20, s8
  v_mul_f32 v32, v32, v216
  v_mfma_f32_32x32x16_bf16 v[80:95], a[56:59], v[244:247], v[80:95]
  v_mul_f32 v33, v33, v217
  v_mul_f32 v34, v34, v218
  v_mul_f32 v35, v35, v219
  v_exp_f32 v32, v32
  v_exp_f32 v33, v33
  v_exp_f32 v34, v34
  buffer_load_dwordx4 a[56:59], v2, s[64:67], 0 offen offset:2048 sc1
  v_mfma_f32_32x32x16_bf16 v[96:111], a[128:131], v[240:243], v[96:111]
  v_exp_f32 v35, v35
  v_add_f32 v32, 1.0, v32
  v_add_f32 v33, 1.0, v33
  v_add_f32 v34, 1.0, v34
  v_add_f32 v35, 1.0, v35
  v_rcp_f32 v32, v32
  v_mfma_f32_32x32x16_bf16 v[112:127], a[128:131], v[244:247], v[112:127]
  v_rcp_f32 v33, v33
  v_rcp_f32 v34, v34
  v_rcp_f32 v35, v35
  v_mul_f32 v32, v216, v32
  v_mul_f32 v33, v217, v33
  buffer_load_dwordx4 a[128:131], v2, s[64:67], 0 offen offset:3072 sc1
  s_waitcnt vmcnt(53) lgkmcnt(3)
  v_mfma_f32_16x16x32_bf16 v[128:131], a[200:203], v[144:147], v[128:131]
  v_mfma_f32_16x16x32_bf16 v[132:135], a[200:203], v[148:151], v[132:135]
  v_mfma_f32_16x16x32_bf16 v[136:139], a[200:203], v[152:155], v[136:139]
  v_mfma_f32_16x16x32_bf16 v[140:143], a[200:203], v[156:159], v[140:143]
  v_mul_f32 v34, v218, v34
  v_mul_f32 v35, v219, v35
  v_cvt_pk_bf16_f32 v44, v32, v33
  v_cvt_pk_bf16_f32 v45, v34, v35
  v_mul_f32 v36, v220, v220
  v_mul_f32 v37, v221, v221
  v_add_u32 v2, 4096, v2
  buffer_load_dwordx4 a[200:203], v2, s[64:67], 0 offen offset:0 sc1
  ds_read_b128 v[144:147], v60 offset:36864
  ds_read_b128 v[148:151], v60 offset:37120
  ds_read_b128 v[152:155], v60 offset:37888
  ds_read_b128 v[156:159], v60 offset:38144
  s_waitcnt vmcnt(52)
  v_mfma_f32_32x32x16_bf16 v[64:79], a[60:63], v[224:227], v[64:79]
  v_mul_f32 v38, v222, v222
  v_mul_f32 v39, v223, v223
  v_fma_f32 v36, v36, v20, s8
  v_fma_f32 v37, v37, v20, s8
  v_fma_f32 v38, v38, v20, s8
  v_fma_f32 v39, v39, v20, s8
  v_mfma_f32_32x32x16_bf16 v[80:95], a[60:63], v[228:231], v[80:95]
  v_mul_f32 v36, v36, v220
  v_mul_f32 v37, v37, v221
  v_mul_f32 v38, v38, v222
  v_mul_f32 v39, v39, v223
  v_exp_f32 v36, v36
  buffer_load_dwordx4 a[60:63], v2, s[64:67], 0 offen offset:1024 sc1
  v_mfma_f32_32x32x16_bf16 v[96:111], a[132:135], v[224:227], v[96:111]
  v_exp_f32 v37, v37
  v_exp_f32 v38, v38
  v_exp_f32 v39, v39
  v_add_f32 v36, 1.0, v36
  v_add_f32 v37, 1.0, v37
  v_add_f32 v38, 1.0, v38
  v_mfma_f32_32x32x16_bf16 v[112:127], a[132:135], v[228:231], v[112:127]
  v_add_f32 v39, 1.0, v39
  v_rcp_f32 v36, v36
  v_rcp_f32 v37, v37
  v_rcp_f32 v38, v38
  v_rcp_f32 v39, v39
  v_mul_f32 v36, v220, v36
  buffer_load_dwordx4 a[132:135], v2, s[64:67], 0 offen offset:2048 sc1
  s_waitcnt vmcnt(52) lgkmcnt(4)
  v_mfma_f32_32x32x16_bf16 v[64:79], a[204:207], v[232:235], v[64:79]
  v_mul_f32 v37, v221, v37
  v_mul_f32 v38, v222, v38
  v_mul_f32 v39, v223, v39
  v_cvt_pk_bf16_f32 v46, v36, v37
  v_cvt_pk_bf16_f32 v47, v38, v39
  ds_write_b128 v23, v[44:47] offset:7168
  v_mfma_f32_32x32x16_bf16 v[80:95], a[204:207], v[236:239], v[80:95]
  buffer_load_dwordx4 a[204:207], v2, s[64:67], 0 offen offset:3072 sc1
  v_mfma_f32_32x32x16_bf16 v[96:111], a[64:67], v[232:235], v[96:111]
  v_mfma_f32_32x32x16_bf16 v[112:127], a[64:67], v[236:239], v[112:127]
  v_add_u32 v2, 4096, v2
  buffer_load_dwordx4 a[64:67], v2, s[64:67], 0 offen offset:0 sc1
  s_waitcnt vmcnt(53) lgkmcnt(1)
  v_mfma_f32_16x16x32_bf16 v[128:131], a[136:139], v[144:147], v[128:131]
  v_mfma_f32_16x16x32_bf16 v[132:135], a[136:139], v[148:151], v[132:135]
  v_mfma_f32_16x16x32_bf16 v[136:139], a[136:139], v[152:155], v[136:139]
  v_mfma_f32_16x16x32_bf16 v[140:143], a[136:139], v[156:159], v[140:143]
  buffer_load_dwordx4 a[136:139], v2, s[64:67], 0 offen offset:1024 sc1
  s_waitcnt lgkmcnt(0)
  s_barrier
  ds_read_b128 v[240:243], v18 offset:40960
  ds_read_b128 v[244:247], v18 offset:41984
  ds_read_b128 v[224:227], v18 offset:43008
  ds_read_b128 v[228:231], v18 offset:44032
  ds_read_b128 v[232:235], v18 offset:45056
  ds_read_b128 v[236:239], v18 offset:46080
  ds_read_b128 v[144:147], v60 offset:40960
  ds_read_b128 v[148:151], v60 offset:41216
  ds_read_b128 v[152:155], v60 offset:41984
  ds_read_b128 v[156:159], v60 offset:42240
  s_waitcnt vmcnt(53) lgkmcnt(8)
  v_mfma_f32_32x32x16_bf16 v[64:79], a[208:211], v[240:243], v[64:79]
  v_mfma_f32_32x32x16_bf16 v[80:95], a[208:211], v[244:247], v[80:95]
  buffer_load_dwordx4 a[208:211], v2, s[64:67], 0 offen offset:2048 sc1
  ds_read_b128 v[240:243], v18 offset:47104
  ds_read_b128 v[244:247], v18 offset:48128
  s_waitcnt vmcnt(53) lgkmcnt(8)
  v_mfma_f32_32x32x16_bf16 v[64:79], a[68:71], v[224:227], v[64:79]
  v_mfma_f32_32x32x16_bf16 v[80:95], a[68:71], v[228:231], v[80:95]
  buffer_load_dwordx4 a[68:71], v2, s[64:67], 0 offen offset:3072 sc1
  s_waitcnt vmcnt(53) lgkmcnt(2)
  v_mfma_f32_16x16x32_bf16 v[128:131], a[140:143], v[144:147], v[128:131]
  v_mfma_f32_16x16x32_bf16 v[132:135], a[140:143], v[148:151], v[132:135]
  v_mfma_f32_16x16x32_bf16 v[136:139], a[140:143], v[152:155], v[136:139]
  v_mfma_f32_16x16x32_bf16 v[140:143], a[140:143], v[156:159], v[140:143]
  v_add_u32 v2, 4096, v2
  buffer_load_dwordx4 a[140:143], v2, s[64:67], 0 offen offset:0 sc1
  ds_read_b128 v[224:227], v18 offset:49152
  ds_read_b128 v[228:231], v18 offset:50176
  ds_read_b128 v[144:147], v60 offset:45056
  ds_read_b128 v[148:151], v60 offset:45312
  ds_read_b128 v[152:155], v60 offset:46080
  ds_read_b128 v[156:159], v60 offset:46336
  s_waitcnt vmcnt(53)
  v_mfma_f32_32x32x16_bf16 v[64:79], a[212:215], v[232:235], v[64:79]
  v_mfma_f32_32x32x16_bf16 v[80:95], a[212:215], v[236:239], v[80:95]
  buffer_load_dwordx4 a[212:215], v2, s[64:67], 0 offen offset:1024 sc1
  ds_read_b128 v[232:235], v18 offset:51200
  ds_read_b128 v[236:239], v18 offset:52224
  s_waitcnt vmcnt(53) lgkmcnt(8)
  v_mfma_f32_32x32x16_bf16 v[64:79], a[0:3], v[240:243], v[64:79]
  v_mfma_f32_32x32x16_bf16 v[80:95], a[0:3], v[244:247], v[80:95]
  buffer_load_dwordx4 a[0:3], v2, s[64:67], 0 offen offset:2048 sc1
  s_waitcnt vmcnt(53) lgkmcnt(2)
  v_mfma_f32_16x16x32_bf16 v[128:131], a[72:75], v[144:147], v[128:131]
  v_mfma_f32_16x16x32_bf16 v[132:135], a[72:75], v[148:151], v[132:135]
  v_mfma_f32_16x16x32_bf16 v[136:139], a[72:75], v[152:155], v[136:139]
  v_mfma_f32_16x16x32_bf16 v[140:143], a[72:75], v[156:159], v[140:143]
  buffer_load_dwordx4 a[72:75], v2, s[64:67], 0 offen offset:3072 sc1
  ds_read_b128 v[240:243], v18 offset:53248
  ds_read_b128 v[244:247], v18 offset:54272
  ds_read_b128 v[144:147], v60 offset:49152
  ds_read_b128 v[148:151], v60 offset:49408
  ds_read_b128 v[152:155], v60 offset:50176
  ds_read_b128 v[156:159], v60 offset:50432
  s_waitcnt vmcnt(53)
  v_mfma_f32_32x32x16_bf16 v[64:79], a[144:147], v[224:227], v[64:79]
  v_mfma_f32_32x32x16_bf16 v[80:95], a[144:147], v[228:231], v[80:95]
  v_add_u32 v2, 4096, v2
  buffer_load_dwordx4 a[144:147], v2, s[64:67], 0 offen offset:0 sc1
  ds_read_b128 v[224:227], v18 offset:55296
  ds_read_b128 v[228:231], v18 offset:56320
  s_waitcnt vmcnt(53) lgkmcnt(8)
  v_mfma_f32_32x32x16_bf16 v[64:79], a[4:7], v[232:235], v[64:79]
  v_mfma_f32_32x32x16_bf16 v[80:95], a[4:7], v[236:239], v[80:95]
  buffer_load_dwordx4 a[4:7], v2, s[64:67], 0 offen offset:1024 sc1
  s_waitcnt vmcnt(53) lgkmcnt(2)
  v_mfma_f32_16x16x32_bf16 v[128:131], a[76:79], v[144:147], v[128:131]
  v_mfma_f32_16x16x32_bf16 v[132:135], a[76:79], v[148:151], v[132:135]
  v_mfma_f32_16x16x32_bf16 v[136:139], a[76:79], v[152:155], v[136:139]
  v_mfma_f32_16x16x32_bf16 v[140:143], a[76:79], v[156:159], v[140:143]
  buffer_load_dwordx4 a[76:79], v2, s[64:67], 0 offen offset:2048 sc1
  ds_read_b128 v[232:235], v18 offset:57344
  ds_read_b128 v[236:239], v18 offset:58368
  ds_read_b128 v[144:147], v60 offset:53248
  ds_read_b128 v[148:151], v60 offset:53504
  ds_read_b128 v[152:155], v60 offset:54272
  ds_read_b128 v[156:159], v60 offset:54528
  s_waitcnt vmcnt(53)
  v_mfma_f32_32x32x16_bf16 v[64:79], a[148:151], v[240:243], v[64:79]
  v_mfma_f32_32x32x16_bf16 v[80:95], a[148:151], v[244:247], v[80:95]
  buffer_load_dwordx4 a[148:151], v2, s[64:67], 0 offen offset:3072 sc1
  ds_read_b128 v[240:243], v18 offset:59392
  ds_read_b128 v[244:247], v18 offset:60416
  s_waitcnt vmcnt(53) lgkmcnt(8)
  v_mfma_f32_32x32x16_bf16 v[64:79], a[8:11], v[224:227], v[64:79]
  v_mfma_f32_32x32x16_bf16 v[80:95], a[8:11], v[228:231], v[80:95]
  v_add_u32 v2, 4096, v2
  buffer_load_dwordx4 a[8:11], v2, s[64:67], 0 offen offset:0 sc1
  s_waitcnt vmcnt(53) lgkmcnt(2)
  v_mfma_f32_16x16x32_bf16 v[128:131], a[80:83], v[144:147], v[128:131]
  v_mfma_f32_16x16x32_bf16 v[132:135], a[80:83], v[148:151], v[132:135]
  v_mfma_f32_16x16x32_bf16 v[136:139], a[80:83], v[152:155], v[136:139]
  v_mfma_f32_16x16x32_bf16 v[140:143], a[80:83], v[156:159], v[140:143]
  buffer_load_dwordx4 a[80:83], v2, s[64:67], 0 offen offset:1024 sc1
  ds_read_b128 v[224:227], v18 offset:61440
  ds_read_b128 v[228:231], v18 offset:62464
  ds_read_b128 v[144:147], v60 offset:57344
  ds_read_b128 v[148:151], v60 offset:57600
  ds_read_b128 v[152:155], v60 offset:58368
  ds_read_b128 v[156:159], v60 offset:58624
  s_waitcnt vmcnt(53)
  v_mfma_f32_32x32x16_bf16 v[64:79], a[152:155], v[232:235], v[64:79]
  v_mfma_f32_32x32x16_bf16 v[80:95], a[152:155], v[236:239], v[80:95]
  buffer_load_dwordx4 a[152:155], v2, s[64:67], 0 offen offset:2048 sc1
  ds_read_b128 v[232:235], v18 offset:63488
  ds_read_b128 v[236:239], v18 offset:64512
  s_waitcnt vmcnt(53) lgkmcnt(8)
  v_mfma_f32_32x32x16_bf16 v[64:79], a[12:15], v[240:243], v[64:79]
  v_mfma_f32_32x32x16_bf16 v[80:95], a[12:15], v[244:247], v[80:95]
  buffer_load_dwordx4 a[12:15], v2, s[64:67], 0 offen offset:3072 sc1
  s_waitcnt vmcnt(53) lgkmcnt(2)
  v_mfma_f32_16x16x32_bf16 v[128:131], a[84:87], v[144:147], v[128:131]
  v_mfma_f32_16x16x32_bf16 v[132:135], a[84:87], v[148:151], v[132:135]
  v_mfma_f32_16x16x32_bf16 v[136:139], a[84:87], v[152:155], v[136:139]
  v_mfma_f32_16x16x32_bf16 v[140:143], a[84:87], v[156:159], v[140:143]
  v_add_u32 v2, 4096, v2
  buffer_load_dwordx4 a[84:87], v2, s[64:67], 0 offen offset:0 sc1
  ds_read_b128 v[240:243], v19 offset:0
  ds_read_b128 v[244:247], v19 offset:1024
  ds_read_b128 v[144:147], v60 offset:61440
  ds_read_b128 v[148:151], v60 offset:61696
  ds_read_b128 v[152:155], v60 offset:62464
  ds_read_b128 v[156:159], v60 offset:62720
  s_waitcnt vmcnt(53)
  v_mfma_f32_32x32x16_bf16 v[64:79], a[156:159], v[224:227], v[64:79]
  v_mfma_f32_32x32x16_bf16 v[80:95], a[156:159], v[228:231], v[80:95]
  buffer_load_dwordx4 a[156:159], v2, s[64:67], 0 offen offset:1024 sc1
  ds_read_b128 v[224:227], v19 offset:2048
  ds_read_b128 v[228:231], v19 offset:3072
  s_waitcnt vmcnt(53) lgkmcnt(8)
  v_mfma_f32_32x32x16_bf16 v[64:79], a[16:19], v[232:235], v[64:79]
  v_mfma_f32_32x32x16_bf16 v[80:95], a[16:19], v[236:239], v[80:95]
  buffer_load_dwordx4 a[16:19], v2, s[64:67], 0 offen offset:2048 sc1
  s_waitcnt vmcnt(53) lgkmcnt(2)
  v_mfma_f32_16x16x32_bf16 v[128:131], a[88:91], v[144:147], v[128:131]
  v_mfma_f32_16x16x32_bf16 v[132:135], a[88:91], v[148:151], v[132:135]
  v_mfma_f32_16x16x32_bf16 v[136:139], a[88:91], v[152:155], v[136:139]
  v_mfma_f32_16x16x32_bf16 v[140:143], a[88:91], v[156:159], v[140:143]
  buffer_load_dwordx4 a[88:91], v2, s[64:67], 0 offen offset:3072 sc1
  ds_read_b128 v[232:235], v19 offset:4096
  ds_read_b128 v[236:239], v19 offset:5120
  ds_read_b128 v[144:147], v61 offset:0
  ds_read_b128 v[148:151], v61 offset:256
  ds_read_b128 v[152:155], v61 offset:1024
  ds_read_b128 v[156:159], v61 offset:1280
  s_waitcnt vmcnt(53)
  v_mfma_f32_32x32x16_bf16 v[64:79], a[160:163], v[240:243], v[64:79]
  v_mfma_f32_32x32x16_bf16 v[80:95], a[160:163], v[244:247], v[80:95]
  v_add_u32 v2, 4096, v2
  buffer_load_dwordx4 a[160:163], v2, s[64:67], 0 offen offset:0 sc1
  ds_read_b128 v[240:243], v19 offset:6144
  ds_read_b128 v[244:247], v19 offset:7168
  s_waitcnt vmcnt(53) lgkmcnt(8)
  v_mfma_f32_32x32x16_bf16 v[64:79], a[20:23], v[224:227], v[64:79]
  v_mfma_f32_32x32x16_bf16 v[80:95], a[20:23], v[228:231], v[80:95]
  buffer_load_dwordx4 a[20:23], v2, s[64:67], 0 offen offset:1024 sc1
  s_waitcnt vmcnt(53) lgkmcnt(2)
  v_mfma_f32_16x16x32_bf16 v[128:131], a[92:95], v[144:147], v[128:131]
  v_mfma_f32_16x16x32_bf16 v[132:135], a[92:95], v[148:151], v[132:135]
  v_mfma_f32_16x16x32_bf16 v[136:139], a[92:95], v[152:155], v[136:139]
  v_mfma_f32_16x16x32_bf16 v[140:143], a[92:95], v[156:159], v[140:143]
  buffer_load_dwordx4 a[92:95], v2, s[64:67], 0 offen offset:2048 sc1
  ds_read_b128 v[144:147], v61 offset:4096
  ds_read_b128 v[148:151], v61 offset:4352
  ds_read_b128 v[152:155], v61 offset:5120
  ds_read_b128 v[156:159], v61 offset:5376
  s_waitcnt vmcnt(53)
  v_mfma_f32_32x32x16_bf16 v[64:79], a[164:167], v[232:235], v[64:79]
  v_mfma_f32_32x32x16_bf16 v[80:95], a[164:167], v[236:239], v[80:95]
  buffer_load_dwordx4 a[164:167], v2, s[64:67], 0 offen offset:3072 sc1
  s_waitcnt vmcnt(53) lgkmcnt(4)
  v_mfma_f32_32x32x16_bf16 v[64:79], a[24:27], v[240:243], v[64:79]
  v_mfma_f32_32x32x16_bf16 v[80:95], a[24:27], v[244:247], v[80:95]
  v_add_u32 v2, 4096, v2
  buffer_load_dwordx4 a[24:27], v2, s[64:67], 0 offen offset:0 sc1
  s_waitcnt vmcnt(53) lgkmcnt(0)
  v_mfma_f32_16x16x32_bf16 v[128:131], a[96:99], v[144:147], v[128:131]
  v_mfma_f32_16x16x32_bf16 v[132:135], a[96:99], v[148:151], v[132:135]
  v_mfma_f32_16x16x32_bf16 v[136:139], a[96:99], v[152:155], v[136:139]
  v_mfma_f32_16x16x32_bf16 v[140:143], a[96:99], v[156:159], v[140:143]
  buffer_load_dwordx4 a[96:99], v2, s[64:67], 0 offen offset:1024 sc1
  ds_read_b128 v[240:243], v18 offset:40960
  ds_read_b128 v[244:247], v18 offset:41984
  ds_read_b128 v[224:227], v18 offset:43008
  ds_read_b128 v[228:231], v18 offset:44032
  ds_read_b128 v[232:235], v18 offset:45056
  ds_read_b128 v[236:239], v18 offset:46080
  s_waitcnt vmcnt(53) lgkmcnt(4)
  v_mfma_f32_32x32x16_bf16 v[96:111], a[168:171], v[240:243], v[96:111]
  v_cvt_pk_bf16_f32 v44, v64, v65
  v_mfma_f32_32x32x16_bf16 v[112:127], a[168:171], v[244:247], v[112:127]
  v_cvt_pk_bf16_f32 v45, v66, v67
  buffer_load_dwordx4 a[168:171], v2, s[64:67], 0 offen offset:2048 sc1
  ds_read_b128 v[240:243], v18 offset:47104
  ds_read_b128 v[244:247], v18 offset:48128
  s_waitcnt vmcnt(53) lgkmcnt(4)
  v_mfma_f32_32x32x16_bf16 v[96:111], a[28:31], v[224:227], v[96:111]
  v_cvt_pk_bf16_f32 v46, v68, v69
  v_cvt_pk_bf16_f32 v47, v70, v71
  v_mfma_f32_32x32x16_bf16 v[112:127], a[28:31], v[228:231], v[112:127]
  v_cvt_pk_bf16_f32 v48, v72, v73
  buffer_load_dwordx4 a[28:31], v2, s[64:67], 0 offen offset:3072 sc1
  ds_read_b128 v[224:227], v18 offset:49152
  ds_read_b128 v[228:231], v18 offset:50176
  s_waitcnt vmcnt(53) lgkmcnt(4)
  v_mfma_f32_32x32x16_bf16 v[96:111], a[100:103], v[232:235], v[96:111]
  v_cvt_pk_bf16_f32 v49, v74, v75
  v_mfma_f32_32x32x16_bf16 v[112:127], a[100:103], v[236:239], v[112:127]
  v_cvt_pk_bf16_f32 v50, v76, v77
  v_cvt_pk_bf16_f32 v51, v78, v79
  v_add_u32 v2, 4096, v2
  buffer_load_dwordx4 a[100:103], v2, s[64:67], 0 offen offset:0 sc1
  ds_read_b128 v[232:235], v18 offset:51200
  ds_read_b128 v[236:239], v18 offset:52224
  s_waitcnt vmcnt(53) lgkmcnt(4)
  v_mfma_f32_32x32x16_bf16 v[96:111], a[172:175], v[240:243], v[96:111]
  s_add_u32 s7, s10, 0
  v_mfma_f32_32x32x16_bf16 v[112:127], a[172:175], v[244:247], v[112:127]
  buffer_store_dwordx4 v[44:47], v21, s[68:71], s7 offen sc1
  buffer_load_dwordx4 a[172:175], v2, s[64:67], 0 offen offset:1024 sc1
  ds_read_b128 v[240:243], v18 offset:53248
  ds_read_b128 v[244:247], v18 offset:54272
  s_waitcnt vmcnt(54) lgkmcnt(4)
  v_mfma_f32_32x32x16_bf16 v[96:111], a[32:35], v[224:227], v[96:111]
  buffer_store_dwordx4 v[48:51], v21, s[68:71], s7 offen offset:256 sc1
  v_cvt_pk_bf16_f32 v52, v80, v81
  v_mfma_f32_32x32x16_bf16 v[112:127], a[32:35], v[228:231], v[112:127]
  v_cvt_pk_bf16_f32 v53, v82, v83
  buffer_load_dwordx4 a[32:35], v2, s[64:67], 0 offen offset:2048 sc1
  ds_read_b128 v[224:227], v18 offset:55296
  ds_read_b128 v[228:231], v18 offset:56320
  s_waitcnt vmcnt(55) lgkmcnt(4)
  v_mfma_f32_32x32x16_bf16 v[96:111], a[104:107], v[232:235], v[96:111]
  v_cvt_pk_bf16_f32 v54, v84, v85
  v_mfma_f32_32x32x16_bf16 v[112:127], a[104:107], v[236:239], v[112:127]
  v_cvt_pk_bf16_f32 v55, v86, v87
  v_cvt_pk_bf16_f32 v56, v88, v89
  buffer_load_dwordx4 a[104:107], v2, s[64:67], 0 offen offset:3072 sc1
  ds_read_b128 v[232:235], v18 offset:57344
  ds_read_b128 v[236:239], v18 offset:58368
  s_waitcnt vmcnt(55) lgkmcnt(4)
  v_mfma_f32_32x32x16_bf16 v[96:111], a[176:179], v[240:243], v[96:111]
  v_cvt_pk_bf16_f32 v57, v90, v91
  v_mfma_f32_32x32x16_bf16 v[112:127], a[176:179], v[244:247], v[112:127]
  v_cvt_pk_bf16_f32 v58, v92, v93
  v_cvt_pk_bf16_f32 v59, v94, v95
  v_add_u32 v2, 4096, v2
  buffer_load_dwordx4 a[176:179], v2, s[64:67], 0 offen offset:0 sc1
  ds_read_b128 v[240:243], v18 offset:59392
  ds_read_b128 v[244:247], v18 offset:60416
  s_waitcnt vmcnt(55) lgkmcnt(4)
  v_mfma_f32_32x32x16_bf16 v[96:111], a[36:39], v[224:227], v[96:111]
  s_add_u32 s7, s10, 294912
  v_mfma_f32_32x32x16_bf16 v[112:127], a[36:39], v[228:231], v[112:127]
  buffer_store_dwordx4 v[52:55], v21, s[68:71], s7 offen sc1
  buffer_load_dwordx4 a[36:39], v2, s[64:67], 0 offen offset:1024 sc1
  ds_read_b128 v[224:227], v18 offset:61440
  ds_read_b128 v[228:231], v18 offset:62464
  s_waitcnt vmcnt(56) lgkmcnt(4)
  v_mfma_f32_32x32x16_bf16 v[96:111], a[108:111], v[232:235], v[96:111]
  buffer_store_dwordx4 v[56:59], v21, s[68:71], s7 offen offset:256 sc1
  v_cvt_pk_bf16_f32 v32, v128, v129
  v_mfma_f32_32x32x16_bf16 v[112:127], a[108:111], v[236:239], v[112:127]
  v_cvt_pk_bf16_f32 v33, v130, v131
  buffer_load_dwordx4 a[108:111], v2, s[64:67], 0 offen offset:2048 sc1
  ds_read_b128 v[232:235], v18 offset:63488
  ds_read_b128 v[236:239], v18 offset:64512
  s_waitcnt vmcnt(57) lgkmcnt(4)
  v_mfma_f32_32x32x16_bf16 v[96:111], a[180:183], v[240:243], v[96:111]
  s_mov_b32 s7, 0
  v_mfma_f32_32x32x16_bf16 v[112:127], a[180:183], v[244:247], v[112:127]
  buffer_store_dwordx2 v[32:33], v63, s[68:71], s7 offen sc1
  v_cvt_pk_bf16_f32 v34, v132, v133
  buffer_load_dwordx4 a[180:183], v2, s[64:67], 0 offen offset:3072 sc1
  ds_read_b128 v[240:243], v19 offset:0
  ds_read_b128 v[244:247], v19 offset:1024
  s_waitcnt vmcnt(58) lgkmcnt(4)
  v_mfma_f32_32x32x16_bf16 v[96:111], a[40:43], v[224:227], v[96:111]
  v_cvt_pk_bf16_f32 v35, v134, v135
  v_mfma_f32_32x32x16_bf16 v[112:127], a[40:43], v[228:231], v[112:127]
  s_mov_b32 s7, 147456
  v_add_u32 v2, 4096, v2
  buffer_load_dwordx4 a[40:43], v2, s[64:67], 0 offen offset:0 sc1
  ds_read_b128 v[224:227], v19 offset:2048
  ds_read_b128 v[228:231], v19 offset:3072
  s_waitcnt vmcnt(58) lgkmcnt(4)
  v_mfma_f32_32x32x16_bf16 v[96:111], a[112:115], v[232:235], v[96:111]
  buffer_store_dwordx2 v[34:35], v63, s[68:71], s7 offen sc1
  v_cvt_pk_bf16_f32 v36, v136, v137
  v_mfma_f32_32x32x16_bf16 v[112:127], a[112:115], v[236:239], v[112:127]
  v_cvt_pk_bf16_f32 v37, v138, v139
  buffer_load_dwordx4 a[112:115], v2, s[64:67], 0 offen offset:1024 sc1
  ds_read_b128 v[232:235], v19 offset:4096
  ds_read_b128 v[236:239], v19 offset:5120
  s_waitcnt vmcnt(59) lgkmcnt(4)
  v_mfma_f32_32x32x16_bf16 v[96:111], a[184:187], v[240:243], v[96:111]
  s_mov_b32 s7, 294912
  v_mfma_f32_32x32x16_bf16 v[112:127], a[184:187], v[244:247], v[112:127]
  buffer_store_dwordx2 v[36:37], v63, s[68:71], s7 offen sc1
  v_cvt_pk_bf16_f32 v38, v140, v141
  buffer_load_dwordx4 a[184:187], v2, s[64:67], 0 offen offset:2048 sc1
  ds_read_b128 v[240:243], v19 offset:6144
  ds_read_b128 v[244:247], v19 offset:7168
  s_waitcnt vmcnt(60) lgkmcnt(4)
  v_mfma_f32_32x32x16_bf16 v[96:111], a[44:47], v[224:227], v[96:111]
  v_cvt_pk_bf16_f32 v39, v142, v143
  v_mfma_f32_32x32x16_bf16 v[112:127], a[44:47], v[228:231], v[112:127]
  s_mov_b32 s7, 442368
  buffer_store_dwordx2 v[38:39], v63, s[68:71], s7 offen sc1
  buffer_load_dwordx4 a[44:47], v2, s[64:67], 0 offen offset:3072 sc1
  s_waitcnt vmcnt(61) lgkmcnt(2)
  v_mfma_f32_32x32x16_bf16 v[96:111], a[116:119], v[232:235], v[96:111]
  v_mfma_f32_32x32x16_bf16 v[112:127], a[116:119], v[236:239], v[112:127]
  v_add_u32 v2, 4096, v2
  buffer_load_dwordx4 a[116:119], v2, s[64:67], 0 offen offset:0 sc1
  s_waitcnt vmcnt(61) lgkmcnt(0)
  v_mfma_f32_32x32x16_bf16 v[96:111], a[188:191], v[240:243], v[96:111]
  v_mfma_f32_32x32x16_bf16 v[112:127], a[188:191], v[244:247], v[112:127]
  buffer_load_dwordx4 a[188:191], v2, s[64:67], 0 offen offset:1024 sc1
  buffer_load_dwordx4 v[208:211], v6, s[52:55], 0 offen offset:0 sc1
  buffer_load_dwordx4 v[212:215], v6, s[56:59], 0 offen offset:0 sc1
  buffer_load_dwordx4 v[216:219], v7, s[48:51], 0 offen offset:0 sc1
  buffer_load_dwordx4 v[220:223], v7, s[48:51], 0 offen offset:16 sc1
  buffer_load_dwordx4 v[24:27], v6, s[52:55], 0 offen offset:640 sc1
  buffer_load_dwordx4 v[28:31], v6, s[56:59], 0 offen offset:640 sc1
  buffer_load_dwordx4 v[144:147], v7, s[48:51], 0 offen offset:1280 sc1
  buffer_load_dwordx4 v[148:151], v7, s[48:51], 0 offen offset:1296 sc1
  buffer_load_dwordx2 v[152:153], v8, s[52:55], 0 offen sc1
  buffer_load_dwordx2 v[154:155], v8, s[56:59], 0 offen sc1
  buffer_load_dwordx4 v[156:159], v9, s[48:51], 0 offen sc1
  ds_read_b128 v[224:227], v18 offset:0
  ds_read_b128 v[228:231], v18 offset:1024
  ds_read_b128 v[232:235], v18 offset:2048
  ds_read_b128 v[236:239], v18 offset:3072
  ds_read_b128 v[240:243], v18 offset:4096
  ds_read_b128 v[244:247], v18 offset:5120
  s_waitcnt vmcnt(63) lgkmcnt(4)
  v_mfma_f32_32x32x16_bf16 v[64:79], a[48:51], v[224:227], 0
  v_mfma_f32_32x32x16_bf16 v[80:95], a[48:51], v[228:231], 0
  v_cvt_pk_bf16_f32 v44, v96, v97
  buffer_load_dwordx4 a[48:51], v2, s[64:67], 0 offen offset:2048 sc1
  ds_read_b128 v[224:227], v18 offset:6144
  ds_read_b128 v[228:231], v18 offset:7168
  s_waitcnt vmcnt(63) lgkmcnt(4)
  v_mfma_f32_32x32x16_bf16 v[64:79], a[120:123], v[232:235], v[64:79]
  v_cvt_pk_bf16_f32 v45, v98, v99
  v_mfma_f32_32x32x16_bf16 v[80:95], a[120:123], v[236:239], v[80:95]
  v_cvt_pk_bf16_f32 v46, v100, v101
  buffer_load_dwordx4 a[120:123], v2, s[64:67], 0 offen offset:3072 sc1
  ds_read_b128 v[232:235], v18 offset:8192
  ds_read_b128 v[236:239], v18 offset:9216
  s_waitcnt vmcnt(63) lgkmcnt(4)
  v_mfma_f32_32x32x16_bf16 v[64:79], a[192:195], v[240:243], v[64:79]
  v_cvt_pk_bf16_f32 v47, v102, v103
  v_mfma_f32_32x32x16_bf16 v[80:95], a[192:195], v[244:247], v[80:95]
  v_cvt_pk_bf16_f32 v48, v104, v105
  v_add_u32 v2, 4096, v2
  buffer_load_dwordx4 a[192:195], v2, s[64:67], 0 offen offset:0 sc1
  ds_read_b128 v[240:243], v18 offset:10240
  ds_read_b128 v[244:247], v18 offset:11264
  s_waitcnt vmcnt(63) lgkmcnt(4)
  v_mfma_f32_32x32x16_bf16 v[64:79], a[52:55], v[224:227], v[64:79]
  v_cvt_pk_bf16_f32 v49, v106, v107
  v_mfma_f32_32x32x16_bf16 v[80:95], a[52:55], v[228:231], v[80:95]
  v_cvt_pk_bf16_f32 v50, v108, v109
  buffer_load_dwordx4 a[52:55], v2, s[64:67], 0 offen offset:1024 sc1
  ds_read_b128 v[224:227], v18 offset:12288
  ds_read_b128 v[228:231], v18 offset:13312
  s_waitcnt vmcnt(63) lgkmcnt(4)
  v_mfma_f32_32x32x16_bf16 v[64:79], a[124:127], v[232:235], v[64:79]
  v_cvt_pk_bf16_f32 v51, v110, v111
  v_mfma_f32_32x32x16_bf16 v[80:95], a[124:127], v[236:239], v[80:95]
  s_add_u32 s7, s10, 2048
  buffer_load_dwordx4 a[124:127], v2, s[64:67], 0 offen offset:2048 sc1
  ds_read_b128 v[232:235], v18 offset:14336
  ds_read_b128 v[236:239], v18 offset:15360
  s_waitcnt vmcnt(63) lgkmcnt(4)
  v_mfma_f32_32x32x16_bf16 v[64:79], a[196:199], v[240:243], v[64:79]
  buffer_store_dwordx4 v[44:47], v21, s[68:71], s7 offen sc1
  v_mfma_f32_32x32x16_bf16 v[80:95], a[196:199], v[244:247], v[80:95]
  buffer_load_dwordx4 a[196:199], v2, s[64:67], 0 offen offset:3072 sc1
  ds_read_b128 v[240:243], v18 offset:16384
  ds_read_b128 v[244:247], v18 offset:17408
  s_waitcnt vmcnt(63) lgkmcnt(4)
  v_mfma_f32_32x32x16_bf16 v[64:79], a[56:59], v[224:227], v[64:79]
  buffer_store_dwordx4 v[48:51], v21, s[68:71], s7 offen offset:256 sc1
  v_mfma_f32_32x32x16_bf16 v[80:95], a[56:59], v[228:231], v[80:95]
  v_cvt_pk_bf16_f32 v52, v112, v113
  v_add_u32 v2, 4096, v2
  buffer_load_dwordx4 a[56:59], v2, s[64:67], 0 offen offset:0 sc1
  ds_read_b128 v[224:227], v18 offset:18432
  ds_read_b128 v[228:231], v18 offset:19456
  s_waitcnt vmcnt(63) lgkmcnt(4)
  v_mfma_f32_32x32x16_bf16 v[64:79], a[128:131], v[232:235], v[64:79]
  v_cvt_pk_bf16_f32 v53, v114, v115
  v_mfma_f32_32x32x16_bf16 v[80:95], a[128:131], v[236:239], v[80:95]
  v_cvt_pk_bf16_f32 v54, v116, v117
  buffer_load_dwordx4 a[128:131], v2, s[64:67], 0 offen offset:1024 sc1
  ds_read_b128 v[232:235], v18 offset:20480
  ds_read_b128 v[236:239], v18 offset:21504
  s_waitcnt vmcnt(63) lgkmcnt(4)
  v_mfma_f32_32x32x16_bf16 v[64:79], a[200:203], v[240:243], v[64:79]
  v_cvt_pk_bf16_f32 v55, v118, v119
  v_mfma_f32_32x32x16_bf16 v[80:95], a[200:203], v[244:247], v[80:95]
  v_cvt_pk_bf16_f32 v56, v120, v121
  buffer_load_dwordx4 a[200:203], v2, s[64:67], 0 offen offset:2048 sc1
  ds_read_b128 v[240:243], v18 offset:22528
  ds_read_b128 v[244:247], v18 offset:23552
  s_waitcnt vmcnt(63) lgkmcnt(4)
  v_mfma_f32_32x32x16_bf16 v[64:79], a[60:63], v[224:227], v[64:79]
  v_cvt_pk_bf16_f32 v57, v122, v123
  v_mfma_f32_32x32x16_bf16 v[80:95], a[60:63], v[228:231], v[80:95]
  v_cvt_pk_bf16_f32 v58, v124, v125
  buffer_load_dwordx4 a[60:63], v2, s[64:67], 0 offen offset:3072 sc1
  ds_read_b128 v[224:227], v18 offset:24576
  ds_read_b128 v[228:231], v18 offset:25600
  s_waitcnt vmcnt(63) lgkmcnt(4)
  v_mfma_f32_32x32x16_bf16 v[64:79], a[132:135], v[232:235], v[64:79]
  v_cvt_pk_bf16_f32 v59, v126, v127
  v_mfma_f32_32x32x16_bf16 v[80:95], a[132:135], v[236:239], v[80:95]
  s_add_u32 s7, s10, 296960
  v_add_u32 v2, 4096, v2
  buffer_load_dwordx4 a[132:135], v2, s[64:67], 0 offen offset:0 sc1
  ds_read_b128 v[232:235], v18 offset:26624
  ds_read_b128 v[236:239], v18 offset:27648
  s_waitcnt vmcnt(63) lgkmcnt(4)
  v_mfma_f32_32x32x16_bf16 v[64:79], a[204:207], v[240:243], v[64:79]
  buffer_store_dwordx4 v[52:55], v21, s[68:71], s7 offen sc1
  v_mfma_f32_32x32x16_bf16 v[80:95], a[204:207], v[244:247], v[80:95]
  buffer_load_dwordx4 a[204:207], v2, s[64:67], 0 offen offset:1024 sc1
  ds_read_b128 v[240:243], v18 offset:28672
  ds_read_b128 v[244:247], v18 offset:29696
  s_waitcnt vmcnt(63) lgkmcnt(4)
  v_mfma_f32_32x32x16_bf16 v[64:79], a[64:67], v[224:227], v[64:79]
  buffer_store_dwordx4 v[56:59], v21, s[68:71], s7 offen offset:256 sc1
  v_mfma_f32_32x32x16_bf16 v[80:95], a[64:67], v[228:231], v[80:95]
  buffer_load_dwordx4 a[64:67], v2, s[64:67], 0 offen offset:2048 sc1
  ds_read_b128 v[224:227], v18 offset:30720
  ds_read_b128 v[228:231], v18 offset:31744
  s_waitcnt vmcnt(63) lgkmcnt(4)
  v_mfma_f32_32x32x16_bf16 v[64:79], a[136:139], v[232:235], v[64:79]
  v_mfma_f32_32x32x16_bf16 v[80:95], a[136:139], v[236:239], v[80:95]
  buffer_load_dwordx4 a[136:139], v2, s[64:67], 0 offen offset:3072 sc1
  ds_read_b128 v[232:235], v18 offset:32768
  ds_read_b128 v[236:239], v18 offset:33792
  s_waitcnt vmcnt(63) lgkmcnt(4)
  v_mfma_f32_32x32x16_bf16 v[64:79], a[208:211], v[240:243], v[64:79]
  v_mfma_f32_32x32x16_bf16 v[80:95], a[208:211], v[244:247], v[80:95]
  v_add_u32 v2, 4096, v2
  buffer_load_dwordx4 a[208:211], v2, s[64:67], 0 offen offset:0 sc1
  ds_read_b128 v[240:243], v18 offset:34816
  ds_read_b128 v[244:247], v18 offset:35840
  s_waitcnt vmcnt(63) lgkmcnt(4)
  v_mfma_f32_32x32x16_bf16 v[64:79], a[68:71], v[224:227], v[64:79]
  v_mfma_f32_32x32x16_bf16 v[80:95], a[68:71], v[228:231], v[80:95]
  buffer_load_dwordx4 a[68:71], v2, s[64:67], 0 offen offset:1024 sc1
  ds_read_b128 v[224:227], v18 offset:36864
  ds_read_b128 v[228:231], v18 offset:37888
  s_waitcnt vmcnt(63) lgkmcnt(4)
  v_mfma_f32_32x32x16_bf16 v[64:79], a[140:143], v[232:235], v[64:79]
  v_mfma_f32_32x32x16_bf16 v[80:95], a[140:143], v[236:239], v[80:95]
  buffer_load_dwordx4 a[140:143], v2, s[64:67], 0 offen offset:2048 sc1
  ds_read_b128 v[232:235], v18 offset:38912
  ds_read_b128 v[236:239], v18 offset:39936
  s_waitcnt vmcnt(63) lgkmcnt(4)
  v_mfma_f32_32x32x16_bf16 v[64:79], a[212:215], v[240:243], v[64:79]
  v_mfma_f32_32x32x16_bf16 v[80:95], a[212:215], v[244:247], v[80:95]
  buffer_load_dwordx4 a[212:215], v2, s[64:67], 0 offen offset:3072 sc1
  ds_read_b128 v[240:243], v18 offset:40960
  ds_read_b128 v[244:247], v18 offset:41984
  s_waitcnt vmcnt(63) lgkmcnt(4)
  v_mfma_f32_32x32x16_bf16 v[64:79], a[0:3], v[224:227], v[64:79]
  v_mfma_f32_32x32x16_bf16 v[80:95], a[0:3], v[228:231], v[80:95]
  ds_read_b128 v[224:227], v18 offset:43008
  ds_read_b128 v[228:231], v18 offset:44032
  s_waitcnt vmcnt(63) lgkmcnt(4)
  v_mfma_f32_32x32x16_bf16 v[64:79], a[72:75], v[232:235], v[64:79]
  v_mfma_f32_32x32x16_bf16 v[80:95], a[72:75], v[236:239], v[80:95]
  ds_read_b128 v[232:235], v18 offset:45056
  ds_read_b128 v[236:239], v18 offset:46080
  s_waitcnt vmcnt(63) lgkmcnt(4)
  v_mfma_f32_32x32x16_bf16 v[64:79], a[144:147], v[240:243], v[64:79]
  v_mfma_f32_32x32x16_bf16 v[80:95], a[144:147], v[244:247], v[80:95]
  ds_read_b128 v[240:243], v18 offset:47104
  ds_read_b128 v[244:247], v18 offset:48128
  s_waitcnt vmcnt(63) lgkmcnt(4)
  v_mfma_f32_32x32x16_bf16 v[64:79], a[4:7], v[224:227], v[64:79]
  v_mfma_f32_32x32x16_bf16 v[80:95], a[4:7], v[228:231], v[80:95]
  ds_read_b128 v[224:227], v18 offset:49152
  ds_read_b128 v[228:231], v18 offset:50176
  s_waitcnt vmcnt(63) lgkmcnt(4)
  v_mfma_f32_32x32x16_bf16 v[64:79], a[76:79], v[232:235], v[64:79]
  v_mfma_f32_32x32x16_bf16 v[80:95], a[76:79], v[236:239], v[80:95]
  ds_read_b128 v[232:235], v18 offset:51200
  ds_read_b128 v[236:239], v18 offset:52224
  s_waitcnt vmcnt(63) lgkmcnt(4)
  v_mfma_f32_32x32x16_bf16 v[64:79], a[148:151], v[240:243], v[64:79]
  v_mfma_f32_32x32x16_bf16 v[80:95], a[148:151], v[244:247], v[80:95]
  ds_read_b128 v[240:243], v18 offset:53248
  ds_read_b128 v[244:247], v18 offset:54272
  s_waitcnt vmcnt(63) lgkmcnt(4)
  v_mfma_f32_32x32x16_bf16 v[64:79], a[8:11], v[224:227], v[64:79]
  v_mfma_f32_32x32x16_bf16 v[80:95], a[8:11], v[228:231], v[80:95]
  ds_read_b128 v[224:227], v18 offset:55296
  ds_read_b128 v[228:231], v18 offset:56320
  s_waitcnt vmcnt(63) lgkmcnt(4)
  v_mfma_f32_32x32x16_bf16 v[64:79], a[80:83], v[232:235], v[64:79]
  v_mfma_f32_32x32x16_bf16 v[80:95], a[80:83], v[236:239], v[80:95]
  ds_read_b128 v[232:235], v18 offset:57344
  ds_read_b128 v[236:239], v18 offset:58368
  s_waitcnt vmcnt(63) lgkmcnt(4)
  v_mfma_f32_32x32x16_bf16 v[64:79], a[152:155], v[240:243], v[64:79]
  v_mfma_f32_32x32x16_bf16 v[80:95], a[152:155], v[244:247], v[80:95]
  ds_read_b128 v[240:243], v18 offset:59392
  ds_read_b128 v[244:247], v18 offset:60416
  s_waitcnt vmcnt(63) lgkmcnt(4)
  v_mfma_f32_32x32x16_bf16 v[64:79], a[12:15], v[224:227], v[64:79]
  v_mfma_f32_32x32x16_bf16 v[80:95], a[12:15], v[228:231], v[80:95]
  ds_read_b128 v[224:227], v18 offset:61440
  ds_read_b128 v[228:231], v18 offset:62464
  s_waitcnt vmcnt(63) lgkmcnt(4)
  v_mfma_f32_32x32x16_bf16 v[64:79], a[84:87], v[232:235], v[64:79]
  v_mfma_f32_32x32x16_bf16 v[80:95], a[84:87], v[236:239], v[80:95]
  ds_read_b128 v[232:235], v18 offset:63488
  ds_read_b128 v[236:239], v18 offset:64512
  s_waitcnt vmcnt(63) lgkmcnt(4)
  v_mfma_f32_32x32x16_bf16 v[64:79], a[156:159], v[240:243], v[64:79]
  v_mfma_f32_32x32x16_bf16 v[80:95], a[156:159], v[244:247], v[80:95]
  s_waitcnt vmcnt(6)
  s_barrier
  s_mul_i32 s76, s5, 4352
  s_add_u32 s76, s76, 922624
  s_cmp_eq_u32 s3, 0
  s_cselect_b32 s76, s76, 0x7f000000
  v_mov_b32 v252, s76
  v_mov_b32 v253, 1
  s_mov_b64 exec, 1
  buffer_atomic_add v253, v252, s[72:75], 0 offen sc1
  s_mov_b64 exec, -1
  ds_read_b128 v[240:243], v19 offset:0
  ds_read_b128 v[244:247], v19 offset:1024
  s_waitcnt lgkmcnt(4)
  v_mfma_f32_32x32x16_bf16 v[64:79], a[16:19], v[224:227], v[64:79]
  v_mfma_f32_32x32x16_bf16 v[80:95], a[16:19], v[228:231], v[80:95]
  ds_read_b128 v[224:227], v19 offset:2048
  ds_read_b128 v[228:231], v19 offset:3072
  s_waitcnt lgkmcnt(4)
  v_mfma_f32_32x32x16_bf16 v[64:79], a[88:91], v[232:235], v[64:79]
  v_mfma_f32_32x32x16_bf16 v[80:95], a[88:91], v[236:239], v[80:95]
  ds_read_b128 v[232:235], v19 offset:4096
  ds_read_b128 v[236:239], v19 offset:5120
  s_waitcnt lgkmcnt(4)
  v_mfma_f32_32x32x16_bf16 v[64:79], a[160:163], v[240:243], v[64:79]
  v_mfma_f32_32x32x16_bf16 v[80:95], a[160:163], v[244:247], v[80:95]
  ds_read_b128 v[240:243], v19 offset:6144
  ds_read_b128 v[244:247], v19 offset:7168
  s_waitcnt lgkmcnt(4)
  v_mfma_f32_32x32x16_bf16 v[64:79], a[20:23], v[224:227], v[64:79]
  v_mfma_f32_32x32x16_bf16 v[80:95], a[20:23], v[228:231], v[80:95]
  s_waitcnt lgkmcnt(2)
  v_mfma_f32_32x32x16_bf16 v[64:79], a[92:95], v[232:235], v[64:79]
  v_mfma_f32_32x32x16_bf16 v[80:95], a[92:95], v[236:239], v[80:95]
  s_waitcnt lgkmcnt(0)
  v_mfma_f32_32x32x16_bf16 v[64:79], a[164:167], v[240:243], v[64:79]
  v_mfma_f32_32x32x16_bf16 v[80:95], a[164:167], v[244:247], v[80:95]
  ds_read_b128 v[224:227], v18 offset:0
  ds_read_b128 v[228:231], v18 offset:1024
  ds_read_b128 v[232:235], v18 offset:2048
  ds_read_b128 v[236:239], v18 offset:3072
  ds_read_b128 v[240:243], v18 offset:4096
  ds_read_b128 v[244:247], v18 offset:5120
  s_waitcnt lgkmcnt(4)
  v_mfma_f32_32x32x16_bf16 v[96:111], a[24:27], v[224:227], 0
  v_mfma_f32_32x32x16_bf16 v[112:127], a[24:27], v[228:231], 0
  s_nop 1
  v_cvt_pk_bf16_f32 v44, v64, v65
  ds_read_b128 v[224:227], v18 offset:6144
  ds_read_b128 v[228:231], v18 offset:7168
  s_waitcnt lgkmcnt(4)
  v_mfma_f32_32x32x16_bf16 v[96:111], a[96:99], v[232:235], v[96:111]
  v_cvt_pk_bf16_f32 v45, v66, v67
  v_mfma_f32_32x32x16_bf16 v[112:127], a[96:99], v[236:239], v[112:127]
  v_cvt_pk_bf16_f32 v46, v68, v69
  ds_read_b128 v[232:235], v18 offset:8192
  ds_read_b128 v[236:239], v18 offset:9216
  s_waitcnt lgkmcnt(4)
  v_mfma_f32_32x32x16_bf16 v[96:111], a[168:171], v[240:243], v[96:111]
  v_cvt_pk_bf16_f32 v47, v70, v71
  v_mfma_f32_32x32x16_bf16 v[112:127], a[168:171], v[244:247], v[112:127]
  v_cvt_pk_bf16_f32 v48, v72, v73
  ds_read_b128 v[240:243], v18 offset:10240
  ds_read_b128 v[244:247], v18 offset:11264
  s_waitcnt lgkmcnt(4)
  v_mfma_f32_32x32x16_bf16 v[96:111], a[28:31], v[224:227], v[96:111]
  v_cvt_pk_bf16_f32 v49, v74, v75
  v_mfma_f32_32x32x16_bf16 v[112:127], a[28:31], v[228:231], v[112:127]
  v_cvt_pk_bf16_f32 v50, v76, v77
  ds_read_b128 v[224:227], v18 offset:12288
  ds_read_b128 v[228:231], v18 offset:13312
  s_waitcnt lgkmcnt(4)
  v_mfma_f32_32x32x16_bf16 v[96:111], a[100:103], v[232:235], v[96:111]
  v_cvt_pk_bf16_f32 v51, v78, v79
  v_mfma_f32_32x32x16_bf16 v[112:127], a[100:103], v[236:239], v[112:127]
  s_add_u32 s7, s10, 4096
  ds_read_b128 v[232:235], v18 offset:14336
  ds_read_b128 v[236:239], v18 offset:15360
  s_waitcnt lgkmcnt(4)
  v_mfma_f32_32x32x16_bf16 v[96:111], a[172:175], v[240:243], v[96:111]
  buffer_store_dwordx4 v[44:47], v21, s[68:71], s7 offen sc1
  v_mfma_f32_32x32x16_bf16 v[112:127], a[172:175], v[244:247], v[112:127]
  ds_read_b128 v[240:243], v18 offset:16384
  ds_read_b128 v[244:247], v18 offset:17408
  s_waitcnt lgkmcnt(4)
  v_mfma_f32_32x32x16_bf16 v[96:111], a[32:35], v[224:227], v[96:111]
  buffer_store_dwordx4 v[48:51], v21, s[68:71], s7 offen offset:256 sc1
  v_mfma_f32_32x32x16_bf16 v[112:127], a[32:35], v[228:231], v[112:127]
  v_cvt_pk_bf16_f32 v52, v80, v81
  ds_read_b128 v[224:227], v18 offset:18432
  ds_read_b128 v[228:231], v18 offset:19456
  s_waitcnt lgkmcnt(4)
  v_mfma_f32_32x32x16_bf16 v[96:111], a[104:107], v[232:235], v[96:111]
  v_cvt_pk_bf16_f32 v53, v82, v83
  v_mfma_f32_32x32x16_bf16 v[112:127], a[104:107], v[236:239], v[112:127]
  v_cvt_pk_bf16_f32 v54, v84, v85
  ds_read_b128 v[232:235], v18 offset:20480
  ds_read_b128 v[236:239], v18 offset:21504
  s_waitcnt lgkmcnt(4)
  v_mfma_f32_32x32x16_bf16 v[96:111], a[176:179], v[240:243], v[96:111]
  v_cvt_pk_bf16_f32 v55, v86, v87
  v_mfma_f32_32x32x16_bf16 v[112:127], a[176:179], v[244:247], v[112:127]
  v_cvt_pk_bf16_f32 v56, v88, v89
  ds_read_b128 v[240:243], v18 offset:22528
  ds_read_b128 v[244:247], v18 offset:23552
  s_waitcnt lgkmcnt(4)
  v_mfma_f32_32x32x16_bf16 v[96:111], a[36:39], v[224:227], v[96:111]
  v_cvt_pk_bf16_f32 v57, v90, v91
  v_mfma_f32_32x32x16_bf16 v[112:127], a[36:39], v[228:231], v[112:127]
  v_cvt_pk_bf16_f32 v58, v92, v93
  ds_read_b128 v[224:227], v18 offset:24576
  ds_read_b128 v[228:231], v18 offset:25600
  s_waitcnt lgkmcnt(4)
  v_mfma_f32_32x32x16_bf16 v[96:111], a[108:111], v[232:235], v[96:111]
  v_cvt_pk_bf16_f32 v59, v94, v95
  v_mfma_f32_32x32x16_bf16 v[112:127], a[108:111], v[236:239], v[112:127]
  s_add_u32 s7, s10, 299008
  ds_read_b128 v[232:235], v18 offset:26624
  ds_read_b128 v[236:239], v18 offset:27648
  s_waitcnt lgkmcnt(4)
  v_mfma_f32_32x32x16_bf16 v[96:111], a[180:183], v[240:243], v[96:111]
  buffer_store_dwordx4 v[52:55], v21, s[68:71], s7 offen sc1
  v_mfma_f32_32x32x16_bf16 v[112:127], a[180:183], v[244:247], v[112:127]
  ds_read_b128 v[240:243], v18 offset:28672
  ds_read_b128 v[244:247], v18 offset:29696
  s_waitcnt lgkmcnt(4)
  v_mfma_f32_32x32x16_bf16 v[96:111], a[40:43], v[224:227], v[96:111]
  buffer_store_dwordx4 v[56:59], v21, s[68:71], s7 offen offset:256 sc1
  v_mfma_f32_32x32x16_bf16 v[112:127], a[40:43], v[228:231], v[112:127]
  ds_read_b128 v[224:227], v18 offset:30720
  ds_read_b128 v[228:231], v18 offset:31744
  s_waitcnt lgkmcnt(4)
  v_mfma_f32_32x32x16_bf16 v[96:111], a[112:115], v[232:235], v[96:111]
  v_mfma_f32_32x32x16_bf16 v[112:127], a[112:115], v[236:239], v[112:127]
  ds_read_b128 v[232:235], v18 offset:32768
  ds_read_b128 v[236:239], v18 offset:33792
  s_waitcnt lgkmcnt(4)
  v_mfma_f32_32x32x16_bf16 v[96:111], a[184:187], v[240:243], v[96:111]
  v_mfma_f32_32x32x16_bf16 v[112:127], a[184:187], v[244:247], v[112:127]
  ds_read_b128 v[240:243], v18 offset:34816
  ds_read_b128 v[244:247], v18 offset:35840
  s_waitcnt lgkmcnt(4)
  v_mfma_f32_32x32x16_bf16 v[96:111], a[44:47], v[224:227], v[96:111]
  v_mfma_f32_32x32x16_bf16 v[112:127], a[44:47], v[228:231], v[112:127]
  ds_read_b128 v[224:227], v18 offset:36864
  ds_read_b128 v[228:231], v18 offset:37888
  s_waitcnt lgkmcnt(4)
  v_mfma_f32_32x32x16_bf16 v[96:111], a[116:119], v[232:235], v[96:111]
  v_mfma_f32_32x32x16_bf16 v[112:127], a[116:119], v[236:239], v[112:127]
  ds_read_b128 v[232:235], v18 offset:38912
  ds_read_b128 v[236:239], v18 offset:39936
  s_waitcnt lgkmcnt(4)
  v_mfma_f32_32x32x16_bf16 v[96:111], a[188:191], v[240:243], v[96:111]
  v_mfma_f32_32x32x16_bf16 v[112:127], a[188:191], v[244:247], v[112:127]
  s_mul_i32 s76, s5, 4352
  s_add_u32 s76, s76, 922624
  v_mov_b32 v252, s76
  buffer_load_dword v253, v252, s[72:75], 0 offen sc1
  ds_read_b128 v[240:243], v18 offset:40960
  ds_read_b128 v[244:247], v18 offset:41984
  s_waitcnt lgkmcnt(4)
  v_mfma_f32_32x32x16_bf16 v[96:111], a[48:51], v[224:227], v[96:111]
  v_mfma_f32_32x32x16_bf16 v[112:127], a[48:51], v[228:231], v[112:127]
  ds_read_b128 v[224:227], v18 offset:43008
  ds_read_b128 v[228:231], v18 offset:44032
  s_waitcnt lgkmcnt(4)
  v_mfma_f32_32x32x16_bf16 v[96:111], a[120:123], v[232:235], v[96:111]
  v_mfma_f32_32x32x16_bf16 v[112:127], a[120:123], v[236:239], v[112:127]
  ds_read_b128 v[232:235], v18 offset:45056
  ds_read_b128 v[236:239], v18 offset:46080
  s_waitcnt lgkmcnt(4)
  v_mfma_f32_32x32x16_bf16 v[96:111], a[192:195], v[240:243], v[96:111]
  v_mfma_f32_32x32x16_bf16 v[112:127], a[192:195], v[244:247], v[112:127]
  ds_read_b128 v[240:243], v18 offset:47104
  ds_read_b128 v[244:247], v18 offset:48128
  s_waitcnt lgkmcnt(4)
  v_mfma_f32_32x32x16_bf16 v[96:111], a[52:55], v[224:227], v[96:111]
  v_mfma_f32_32x32x16_bf16 v[112:127], a[52:55], v[228:231], v[112:127]
  ds_read_b128 v[224:227], v18 offset:49152
  ds_read_b128 v[228:231], v18 offset:50176
  s_waitcnt lgkmcnt(4)
  v_mfma_f32_32x32x16_bf16 v[96:111], a[124:127], v[232:235], v[96:111]
  v_mfma_f32_32x32x16_bf16 v[112:127], a[124:127], v[236:239], v[112:127]
  ds_read_b128 v[232:235], v18 offset:51200
  ds_read_b128 v[236:239], v18 offset:52224
  s_waitcnt lgkmcnt(4)
  v_mfma_f32_32x32x16_bf16 v[96:111], a[196:199], v[240:243], v[96:111]
  v_mfma_f32_32x32x16_bf16 v[112:127], a[196:199], v[244:247], v[112:127]
  ds_read_b128 v[240:243], v18 offset:53248
  ds_read_b128 v[244:247], v18 offset:54272
  s_waitcnt lgkmcnt(4)
  v_mfma_f32_32x32x16_bf16 v[96:111], a[56:59], v[224:227], v[96:111]
  v_mfma_f32_32x32x16_bf16 v[112:127], a[56:59], v[228:231], v[112:127]
  ds_read_b128 v[224:227], v18 offset:55296
  ds_read_b128 v[228:231], v18 offset:56320
  s_waitcnt lgkmcnt(4)
  v_mfma_f32_32x32x16_bf16 v[96:111], a[128:131], v[232:235], v[96:111]
  v_mfma_f32_32x32x16_bf16 v[112:127], a[128:131], v[236:239], v[112:127]
  ds_read_b128 v[232:235], v18 offset:57344
  ds_read_b128 v[236:239], v18 offset:58368
  s_waitcnt lgkmcnt(4)
  v_mfma_f32_32x32x16_bf16 v[96:111], a[200:203], v[240:243], v[96:111]
  v_mfma_f32_32x32x16_bf16 v[112:127], a[200:203], v[244:247], v[112:127]
  ds_read_b128 v[240:243], v18 offset:59392
  ds_read_b128 v[244:247], v18 offset:60416
  s_waitcnt lgkmcnt(4)
  v_mfma_f32_32x32x16_bf16 v[96:111], a[60:63], v[224:227], v[96:111]
  v_mfma_f32_32x32x16_bf16 v[112:127], a[60:63], v[228:231], v[112:127]
  s_waitcnt vmcnt(0)
  v_cmp_gt_u32 vcc, 8, v253
  s_mov_b32 s77, 0
  s_nop 2
  s_cbranch_vccz L_p0ok_86
L_p0_87:
  buffer_load_dword v253, v252, s[72:75], 0 offen sc1
  s_waitcnt vmcnt(0)
  v_cmp_gt_u32 vcc, 8, v253
  s_add_u32 s77, s77, 1
  s_cmp_ge_u32 s77, 131072
  s_cbranch_scc1 L_p0ok_86
  s_cbranch_vccnz L_p0_87
L_p0ok_86:
  s_mov_b32 s7, 0
  buffer_load_dwordx4 v[160:163], v4, s[68:71], s7 offen sc1
  s_mov_b32 s7, 9216
  buffer_load_dwordx4 v[164:167], v4, s[68:71], s7 offen sc1
  s_mov_b32 s7, 18432
  buffer_load_dwordx4 v[168:171], v4, s[68:71], s7 offen sc1
  s_mov_b32 s7, 27648
  buffer_load_dwordx4 v[172:175], v4, s[68:71], s7 offen sc1
  s_mov_b32 s7, 36864
  buffer_load_dwordx4 v[176:179], v4, s[68:71], s7 offen sc1
  s_mov_b32 s7, 46080
  buffer_load_dwordx4 v[180:183], v4, s[68:71], s7 offen sc1
  s_mov_b32 s7, 55296
  buffer_load_dwordx4 v[184:187], v4, s[68:71], s7 offen sc1
  s_mov_b32 s7, 64512
  buffer_load_dwordx4 v[188:191], v4, s[68:71], s7 offen sc1
  s_mov_b32 s7, 0
  buffer_load_dwordx2 v[192:193], v5, s[68:71], s7 offen sc1
  s_mov_b32 s7, 9216
  buffer_load_dwordx2 v[194:195], v5, s[68:71], s7 offen sc1
  s_mov_b32 s7, 18432
  buffer_load_dwordx2 v[196:197], v5, s[68:71], s7 offen sc1
  s_mov_b32 s7, 27648
  buffer_load_dwordx2 v[198:199], v5, s[68:71], s7 offen sc1
  s_mov_b32 s7, 36864
  buffer_load_dwordx2 v[200:201], v5, s[68:71], s7 offen sc1
  s_mov_b32 s7, 46080
  buffer_load_dwordx2 v[202:203], v5, s[68:71], s7 offen sc1
  s_mov_b32 s7, 55296
  buffer_load_dwordx2 v[204:205], v5, s[68:71], s7 offen sc1
  s_mov_b32 s7, 64512
  buffer_load_dwordx2 v[206:207], v5, s[68:71], s7 offen sc1
  ds_read_b128 v[224:227], v18 offset:61440
  ds_read_b128 v[228:231], v18 offset:62464
  s_waitcnt lgkmcnt(4)
  v_mfma_f32_32x32x16_bf16 v[96:111], a[132:135], v[232:235], v[96:111]
  v_mfma_f32_32x32x16_bf16 v[112:127], a[132:135], v[236:239], v[112:127]
  ds_read_b128 v[232:235], v18 offset:63488
  ds_read_b128 v[236:239], v18 offset:64512
  s_waitcnt lgkmcnt(4)
  v_mfma_f32_32x32x16_bf16 v[96:111], a[204:207], v[240:243], v[96:111]
  v_mfma_f32_32x32x16_bf16 v[112:127], a[204:207], v[244:247], v[112:127]
  ds_read_b128 v[240:243], v19 offset:0
  ds_read_b128 v[244:247], v19 offset:1024
  s_waitcnt lgkmcnt(4)
  v_mfma_f32_32x32x16_bf16 v[96:111], a[64:67], v[224:227], v[96:111]
  v_mfma_f32_32x32x16_bf16 v[112:127], a[64:67], v[228:231], v[112:127]
  ds_read_b128 v[224:227], v19 offset:2048
  ds_read_b128 v[228:231], v19 offset:3072
  s_waitcnt lgkmcnt(4)
  v_mfma_f32_32x32x16_bf16 v[96:111], a[136:139], v[232:235], v[96:111]
  v_mfma_f32_32x32x16_bf16 v[112:127], a[136:139], v[236:239], v[112:127]
  ds_read_b128 v[232:235], v19 offset:4096
  ds_read_b128 v[236:239], v19 offset:5120
  s_waitcnt lgkmcnt(4)
  v_mfma_f32_32x32x16_bf16 v[96:111], a[208:211], v[240:243], v[96:111]
  v_mfma_f32_32x32x16_bf16 v[112:127], a[208:211], v[244:247], v[112:127]
  ds_read_b128 v[240:243], v19 offset:6144
  ds_read_b128 v[244:247], v19 offset:7168
  s_waitcnt lgkmcnt(4)
  v_mfma_f32_32x32x16_bf16 v[96:111], a[68:71], v[224:227], v[96:111]
  v_mfma_f32_32x32x16_bf16 v[112:127], a[68:71], v[228:231], v[112:127]
  s_waitcnt lgkmcnt(2)
  v_mfma_f32_32x32x16_bf16 v[96:111], a[140:143], v[232:235], v[96:111]
  v_mfma_f32_32x32x16_bf16 v[112:127], a[140:143], v[236:239], v[112:127]
  s_waitcnt lgkmcnt(0)
  v_mfma_f32_32x32x16_bf16 v[96:111], a[212:215], v[240:243], v[96:111]
  v_mfma_f32_32x32x16_bf16 v[112:127], a[212:215], v[244:247], v[112:127]
  s_nop 10
  v_cvt_pk_bf16_f32 v44, v96, v97
  s_nop 9
  v_cvt_pk_bf16_f32 v45, v98, v99
  s_nop 8
  v_cvt_pk_bf16_f32 v46, v100, v101
  s_nop 7
  v_cvt_pk_bf16_f32 v47, v102, v103
  s_nop 6
  v_cvt_pk_bf16_f32 v48, v104, v105
  s_nop 5
  v_cvt_pk_bf16_f32 v49, v106, v107
  s_nop 4
  v_cvt_pk_bf16_f32 v50, v108, v109
  s_nop 3
  v_cvt_pk_bf16_f32 v51, v110, v111
  s_add_u32 s7, s10, 6144
  buffer_store_dwordx4 v[44:47], v21, s[68:71], s7 offen sc1
  buffer_store_dwordx4 v[48:51], v21, s[68:71], s7 offen offset:256 sc1
  s_nop 0
  v_cvt_pk_bf16_f32 v52, v112, v113
  v_cvt_pk_bf16_f32 v53, v114, v115
  v_cvt_pk_bf16_f32 v54, v116, v117
  v_cvt_pk_bf16_f32 v55, v118, v119
  v_cvt_pk_bf16_f32 v56, v120, v121
  v_cvt_pk_bf16_f32 v57, v122, v123
  v_cvt_pk_bf16_f32 v58, v124, v125
  v_cvt_pk_bf16_f32 v59, v126, v127
  s_add_u32 s7, s10, 301056
  buffer_store_dwordx4 v[52:55], v21, s[68:71], s7 offen sc1
  buffer_store_dwordx4 v[56:59], v21, s[68:71], s7 offen offset:256 sc1
  s_waitcnt vmcnt(0) lgkmcnt(0)
  s_barrier
  s_cmp_lg_u32 s3, 0
  s_cbranch_scc1 L_arr_88
  s_mov_b64 exec, 1
  s_mul_i32 s76, s5, 4352
  s_add_u32 s76, s76, 739840
  v_mov_b32 v252, s76
  v_mov_b32 v253, 1
  buffer_atomic_add v253, v252, s[72:75], 0 offen sc1
L_ad_89:
  s_mov_b64 exec, -1
L_arr_88:
  v_lshlrev_b32 v32, 16, v160
  v_and_b32 v33, s99, v160
  v_lshlrev_b32 v34, 16, v161
  v_and_b32 v35, s99, v161
  v_lshlrev_b32 v36, 16, v162
  v_and_b32 v37, s99, v162
  v_lshlrev_b32 v38, 16, v163
  v_and_b32 v39, s99, v163
  v_lshlrev_b32 v48, 16, v164
  v_and_b32 v49, s99, v164
  v_lshlrev_b32 v50, 16, v165
  v_and_b32 v51, s99, v165
  v_lshlrev_b32 v52, 16, v166
  v_and_b32 v53, s99, v166
  v_lshlrev_b32 v54, 16, v167
  v_and_b32 v55, s99, v167
  v_pk_add_f32 v[32:33], v[32:33], v[48:49]
  v_pk_add_f32 v[34:35], v[34:35], v[50:51]
  v_pk_add_f32 v[36:37], v[36:37], v[52:53]
  v_pk_add_f32 v[38:39], v[38:39], v[54:55]
  v_lshlrev_b32 v40, 16, v168
  v_and_b32 v41, s99, v168
  v_lshlrev_b32 v42, 16, v169
  v_and_b32 v43, s99, v169
  v_lshlrev_b32 v44, 16, v170
  v_and_b32 v45, s99, v170
  v_lshlrev_b32 v46, 16, v171
  v_and_b32 v47, s99, v171
  v_pk_add_f32 v[32:33], v[32:33], v[40:41]
  v_pk_add_f32 v[34:35], v[34:35], v[42:43]
  v_pk_add_f32 v[36:37], v[36:37], v[44:45]
  v_pk_add_f32 v[38:39], v[38:39], v[46:47]
  v_lshlrev_b32 v48, 16, v172
  v_and_b32 v49, s99, v172
  v_lshlrev_b32 v50, 16, v173
  v_and_b32 v51, s99, v173
  v_lshlrev_b32 v52, 16, v174
  v_and_b32 v53, s99, v174
  v_lshlrev_b32 v54, 16, v175
  v_and_b32 v55, s99, v175
  v_pk_add_f32 v[32:33], v[32:33], v[48:49]
  v_pk_add_f32 v[34:35], v[34:35], v[50:51]
  v_pk_add_f32 v[36:37], v[36:37], v[52:53]
  v_pk_add_f32 v[38:39], v[38:39], v[54:55]
  v_lshlrev_b32 v40, 16, v176
  v_and_b32 v41, s99, v176
  v_lshlrev_b32 v42, 16, v177
  v_and_b32 v43, s99, v177
  v_lshlrev_b32 v44, 16, v178
  v_and_b32 v45, s99, v178
  v_lshlrev_b32 v46, 16, v179
  v_and_b32 v47, s99, v179
  v_pk_add_f32 v[32:33], v[32:33], v[40:41]
  v_pk_add_f32 v[34:35], v[34:35], v[42:43]
  v_pk_add_f32 v[36:37], v[36:37], v[44:45]
  v_pk_add_f32 v[38:39], v[38:39], v[46:47]
  v_lshlrev_b32 v48, 16, v180
  v_and_b32 v49, s99, v180
  v_lshlrev_b32 v50, 16, v181
  v_and_b32 v51, s99, v181
  v_lshlrev_b32 v52, 16, v182
  v_and_b32 v53, s99, v182
  v_lshlrev_b32 v54, 16, v183
  v_and_b32 v55, s99, v183
  v_pk_add_f32 v[32:33], v[32:33], v[48:49]
  v_pk_add_f32 v[34:35], v[34:35], v[50:51]
  v_pk_add_f32 v[36:37], v[36:37], v[52:53]
  v_pk_add_f32 v[38:39], v[38:39], v[54:55]
  v_lshlrev_b32 v40, 16, v184
  v_and_b32 v41, s99, v184
  v_lshlrev_b32 v42, 16, v185
  v_and_b32 v43, s99, v185
  v_lshlrev_b32 v44, 16, v186
  v_and_b32 v45, s99, v186
  v_lshlrev_b32 v46, 16, v187
  v_and_b32 v47, s99, v187
  v_pk_add_f32 v[32:33], v[32:33], v[40:41]
  v_pk_add_f32 v[34:35], v[34:35], v[42:43]
  v_pk_add_f32 v[36:37], v[36:37], v[44:45]
  v_pk_add_f32 v[38:39], v[38:39], v[46:47]
  v_lshlrev_b32 v48, 16, v188
  v_and_b32 v49, s99, v188
  v_lshlrev_b32 v50, 16, v189
  v_and_b32 v51, s99, v189
  v_lshlrev_b32 v52, 16, v190
  v_and_b32 v53, s99, v190
  v_lshlrev_b32 v54, 16, v191
  v_and_b32 v55, s99, v191
  v_pk_add_f32 v[32:33], v[32:33], v[48:49]
  v_pk_add_f32 v[34:35], v[34:35], v[50:51]
  v_pk_add_f32 v[36:37], v[36:37], v[52:53]
  v_pk_add_f32 v[38:39], v[38:39], v[54:55]
  v_lshlrev_b32 v40, 16, v212
  v_and_b32 v41, s99, v212
  v_lshlrev_b32 v42, 16, v213
  v_and_b32 v43, s99, v213
  v_lshlrev_b32 v44, 16, v214
  v_and_b32 v45, s99, v214
  v_lshlrev_b32 v46, 16, v215
  v_and_b32 v47, s99, v215
  v_pk_add_f32 v[32:33], v[32:33], v[40:41]
  v_pk_add_f32 v[34:35], v[34:35], v[42:43]
  v_pk_add_f32 v[36:37], v[36:37], v[44:45]
  v_pk_add_f32 v[38:39], v[38:39], v[46:47]
  v_lshlrev_b32 v40, 16, v208
  v_and_b32 v41, s99, v208
  v_lshlrev_b32 v42, 16, v209
  v_and_b32 v43, s99, v209
  v_lshlrev_b32 v44, 16, v210
  v_and_b32 v45, s99, v210
  v_lshlrev_b32 v46, 16, v211
  v_and_b32 v47, s99, v211
  v_pk_fma_f32 v[32:33], v[32:33], v[216:217], v[40:41]
  v_pk_fma_f32 v[34:35], v[34:35], v[218:219], v[42:43]
  v_pk_fma_f32 v[36:37], v[36:37], v[220:221], v[44:45]
  v_pk_fma_f32 v[38:39], v[38:39], v[222:223], v[46:47]
  v_cvt_pk_bf16_f32 v56, v32, v33
  v_cvt_pk_bf16_f32 v57, v34, v35
  v_cvt_pk_bf16_f32 v58, v36, v37
  v_cvt_pk_bf16_f32 v59, v38, v39
  buffer_store_dwordx4 v[56:59], v6, s[60:63], 0 offen offset:0
  v_lshlrev_b32 v32, 16, v192
  v_and_b32 v33, s99, v192
  v_lshlrev_b32 v34, 16, v193
  v_and_b32 v35, s99, v193
  v_lshlrev_b32 v48, 16, v194
  v_and_b32 v49, s99, v194
  v_lshlrev_b32 v50, 16, v195
  v_and_b32 v51, s99, v195
  v_pk_add_f32 v[32:33], v[32:33], v[48:49]
  v_pk_add_f32 v[34:35], v[34:35], v[50:51]
  v_lshlrev_b32 v40, 16, v196
  v_and_b32 v41, s99, v196
  v_lshlrev_b32 v42, 16, v197
  v_and_b32 v43, s99, v197
  v_pk_add_f32 v[32:33], v[32:33], v[40:41]
  v_pk_add_f32 v[34:35], v[34:35], v[42:43]
  v_lshlrev_b32 v48, 16, v198
  v_and_b32 v49, s99, v198
  v_lshlrev_b32 v50, 16, v199
  v_and_b32 v51, s99, v199
  v_pk_add_f32 v[32:33], v[32:33], v[48:49]
  v_pk_add_f32 v[34:35], v[34:35], v[50:51]
  v_lshlrev_b32 v40, 16, v200
  v_and_b32 v41, s99, v200
  v_lshlrev_b32 v42, 16, v201
  v_and_b32 v43, s99, v201
  v_pk_add_f32 v[32:33], v[32:33], v[40:41]
  v_pk_add_f32 v[34:35], v[34:35], v[42:43]
  v_lshlrev_b32 v48, 16, v202
  v_and_b32 v49, s99, v202
  v_lshlrev_b32 v50, 16, v203
  v_and_b32 v51, s99, v203
  v_pk_add_f32 v[32:33], v[32:33], v[48:49]
  v_pk_add_f32 v[34:35], v[34:35], v[50:51]
  v_lshlrev_b32 v40, 16, v204
  v_and_b32 v41, s99, v204
  v_lshlrev_b32 v42, 16, v205
  v_and_b32 v43, s99, v205
  v_pk_add_f32 v[32:33], v[32:33], v[40:41]
  v_pk_add_f32 v[34:35], v[34:35], v[42:43]
  v_lshlrev_b32 v48, 16, v206
  v_and_b32 v49, s99, v206
  v_lshlrev_b32 v50, 16, v207
  v_and_b32 v51, s99, v207
  v_pk_add_f32 v[32:33], v[32:33], v[48:49]
  v_pk_add_f32 v[34:35], v[34:35], v[50:51]
  v_lshlrev_b32 v40, 16, v154
  v_and_b32 v41, s99, v154
  v_lshlrev_b32 v42, 16, v155
  v_and_b32 v43, s99, v155
  v_pk_add_f32 v[32:33], v[32:33], v[40:41]
  v_pk_add_f32 v[34:35], v[34:35], v[42:43]
  v_lshlrev_b32 v40, 16, v152
  v_and_b32 v41, s99, v152
  v_lshlrev_b32 v42, 16, v153
  v_and_b32 v43, s99, v153
  v_pk_fma_f32 v[32:33], v[32:33], v[156:157], v[40:41]
  v_pk_fma_f32 v[34:35], v[34:35], v[158:159], v[42:43]
  v_cvt_pk_bf16_f32 v60, v32, v33
  v_cvt_pk_bf16_f32 v61, v34, v35
  buffer_store_dwordx2 v[60:61], v8, s[60:63], 0 offen
  s_cmp_lg_u32 s3, 0
  s_cbranch_scc1 L_wt_90
  s_mul_i32 s6, s5, 4352
  s_add_u32 s6, s6, 739840
  v_mov_b32 v252, s6
  v_mov_b32 v254, 8
  s_mov_b32 s77, 0
  s_mov_b64 exec, 0x1
L_poll_91:
  buffer_load_dword v253, v252, s[72:75], 0 offen sc1
  s_waitcnt vmcnt(0)
  v_cmp_lt_u32 vcc, v253, v254
  s_add_u32 s77, s77, 1
  s_cmp_ge_u32 s77, 131072
  s_cbranch_scc1 L_poll_91_x
  s_cbranch_vccz L_poll_91_x
  s_sleep 1
  s_branch L_poll_91
L_poll_91_x:
  s_mov_b64 exec, -1
L_wt_90:
  s_barrier
  s_mov_b32 s7, 4096
  buffer_load_dwordx4 v[160:163], v4, s[68:71], s7 offen sc1
  s_mov_b32 s7, 13312
  buffer_load_dwordx4 v[164:167], v4, s[68:71], s7 offen sc1
  s_mov_b32 s7, 22528
  buffer_load_dwordx4 v[168:171], v4, s[68:71], s7 offen sc1
  s_mov_b32 s7, 31744
  buffer_load_dwordx4 v[172:175], v4, s[68:71], s7 offen sc1
  s_mov_b32 s7, 40960
  buffer_load_dwordx4 v[176:179], v4, s[68:71], s7 offen sc1
  s_mov_b32 s7, 50176
  buffer_load_dwordx4 v[180:183], v4, s[68:71], s7 offen sc1
  s_mov_b32 s7, 59392
  buffer_load_dwordx4 v[184:187], v4, s[68:71], s7 offen sc1
  s_mov_b32 s7, 68608
  buffer_load_dwordx4 v[188:191], v4, s[68:71], s7 offen sc1
  s_waitcnt vmcnt(7)
  v_lshlrev_b32 v32, 16, v160
  v_and_b32 v33, s99, v160
  v_lshlrev_b32 v34, 16, v161
  v_and_b32 v35, s99, v161
  v_lshlrev_b32 v36, 16, v162
  v_and_b32 v37, s99, v162
  v_lshlrev_b32 v38, 16, v163
  v_and_b32 v39, s99, v163
  s_waitcnt vmcnt(6)
  v_lshlrev_b32 v48, 16, v164
  v_and_b32 v49, s99, v164
  v_lshlrev_b32 v50, 16, v165
  v_and_b32 v51, s99, v165
  v_lshlrev_b32 v52, 16, v166
  v_and_b32 v53, s99, v166
  v_lshlrev_b32 v54, 16, v167
  v_and_b32 v55, s99, v167
  v_pk_add_f32 v[32:33], v[32:33], v[48:49]
  v_pk_add_f32 v[34:35], v[34:35], v[50:51]
  v_pk_add_f32 v[36:37], v[36:37], v[52:53]
  v_pk_add_f32 v[38:39], v[38:39], v[54:55]
  s_waitcnt vmcnt(5)
  v_lshlrev_b32 v40, 16, v168
  v_and_b32 v41, s99, v168
  v_lshlrev_b32 v42, 16, v169
  v_and_b32 v43, s99, v169
  v_lshlrev_b32 v44, 16, v170
  v_and_b32 v45, s99, v170
  v_lshlrev_b32 v46, 16, v171
  v_and_b32 v47, s99, v171
  v_pk_add_f32 v[32:33], v[32:33], v[40:41]
  v_pk_add_f32 v[34:35], v[34:35], v[42:43]
  v_pk_add_f32 v[36:37], v[36:37], v[44:45]
  v_pk_add_f32 v[38:39], v[38:39], v[46:47]
  s_waitcnt vmcnt(4)
  v_lshlrev_b32 v48, 16, v172
  v_and_b32 v49, s99, v172
  v_lshlrev_b32 v50, 16, v173
  v_and_b32 v51, s99, v173
  v_lshlrev_b32 v52, 16, v174
  v_and_b32 v53, s99, v174
  v_lshlrev_b32 v54, 16, v175
  v_and_b32 v55, s99, v175
  v_pk_add_f32 v[32:33], v[32:33], v[48:49]
  v_pk_add_f32 v[34:35], v[34:35], v[50:51]
  v_pk_add_f32 v[36:37], v[36:37], v[52:53]
  v_pk_add_f32 v[38:39], v[38:39], v[54:55]
  s_waitcnt vmcnt(3)
  v_lshlrev_b32 v40, 16, v176
  v_and_b32 v41, s99, v176
  v_lshlrev_b32 v42, 16, v177
  v_and_b32 v43, s99, v177
  v_lshlrev_b32 v44, 16, v178
  v_and_b32 v45, s99, v178
  v_lshlrev_b32 v46, 16, v179
  v_and_b32 v47, s99, v179
  v_pk_add_f32 v[32:33], v[32:33], v[40:41]
  v_pk_add_f32 v[34:35], v[34:35], v[42:43]
  v_pk_add_f32 v[36:37], v[36:37], v[44:45]
  v_pk_add_f32 v[38:39], v[38:39], v[46:47]
  s_waitcnt vmcnt(2)
  v_lshlrev_b32 v48, 16, v180
  v_and_b32 v49, s99, v180
  v_lshlrev_b32 v50, 16, v181
  v_and_b32 v51, s99, v181
  v_lshlrev_b32 v52, 16, v182
  v_and_b32 v53, s99, v182
  v_lshlrev_b32 v54, 16, v183
  v_and_b32 v55, s99, v183
  v_pk_add_f32 v[32:33], v[32:33], v[48:49]
  v_pk_add_f32 v[34:35], v[34:35], v[50:51]
  v_pk_add_f32 v[36:37], v[36:37], v[52:53]
  v_pk_add_f32 v[38:39], v[38:39], v[54:55]
  s_waitcnt vmcnt(1)
  v_lshlrev_b32 v40, 16, v184
  v_and_b32 v41, s99, v184
  v_lshlrev_b32 v42, 16, v185
  v_and_b32 v43, s99, v185
  v_lshlrev_b32 v44, 16, v186
  v_and_b32 v45, s99, v186
  v_lshlrev_b32 v46, 16, v187
  v_and_b32 v47, s99, v187
  v_pk_add_f32 v[32:33], v[32:33], v[40:41]
  v_pk_add_f32 v[34:35], v[34:35], v[42:43]
  v_pk_add_f32 v[36:37], v[36:37], v[44:45]
  v_pk_add_f32 v[38:39], v[38:39], v[46:47]
  s_waitcnt vmcnt(0)
  v_lshlrev_b32 v48, 16, v188
  v_and_b32 v49, s99, v188
  v_lshlrev_b32 v50, 16, v189
  v_and_b32 v51, s99, v189
  v_lshlrev_b32 v52, 16, v190
  v_and_b32 v53, s99, v190
  v_lshlrev_b32 v54, 16, v191
  v_and_b32 v55, s99, v191
  v_pk_add_f32 v[32:33], v[32:33], v[48:49]
  v_pk_add_f32 v[34:35], v[34:35], v[50:51]
  v_pk_add_f32 v[36:37], v[36:37], v[52:53]
  v_pk_add_f32 v[38:39], v[38:39], v[54:55]
  v_lshlrev_b32 v40, 16, v28
  v_and_b32 v41, s99, v28
  v_lshlrev_b32 v42, 16, v29
  v_and_b32 v43, s99, v29
  v_lshlrev_b32 v44, 16, v30
  v_and_b32 v45, s99, v30
  v_lshlrev_b32 v46, 16, v31
  v_and_b32 v47, s99, v31
  v_pk_add_f32 v[32:33], v[32:33], v[40:41]
  v_pk_add_f32 v[34:35], v[34:35], v[42:43]
  v_pk_add_f32 v[36:37], v[36:37], v[44:45]
  v_pk_add_f32 v[38:39], v[38:39], v[46:47]
  v_lshlrev_b32 v40, 16, v24
  v_and_b32 v41, s99, v24
  v_lshlrev_b32 v42, 16, v25
  v_and_b32 v43, s99, v25
  v_lshlrev_b32 v44, 16, v26
  v_and_b32 v45, s99, v26
  v_lshlrev_b32 v46, 16, v27
  v_and_b32 v47, s99, v27
  v_pk_fma_f32 v[32:33], v[32:33], v[144:145], v[40:41]
  v_pk_fma_f32 v[34:35], v[34:35], v[146:147], v[42:43]
  v_pk_fma_f32 v[36:37], v[36:37], v[148:149], v[44:45]
  v_pk_fma_f32 v[38:39], v[38:39], v[150:151], v[46:47]
  v_cvt_pk_bf16_f32 v56, v32, v33
  v_cvt_pk_bf16_f32 v57, v34, v35
  v_cvt_pk_bf16_f32 v58, v36, v37
  v_cvt_pk_bf16_f32 v59, v38, v39
  buffer_store_dwordx4 v[56:59], v6, s[60:63], 0 offen offset:640
  s_waitcnt vmcnt(0)
L_end:
  s_endpgm
.section .rodata,"a"
.p2align 6
.amdhsa_kernel adaLN_cond__ssm_conv_h3__mixer_s_mlp__prompt_kernel
  .amdhsa_next_free_vgpr 512
  .amdhsa_next_free_sgpr 102
  .amdhsa_accum_offset 256
  .amdhsa_group_segment_fixed_size 0
  .amdhsa_kernarg_size 128
  .amdhsa_user_sgpr_count 2
  .amdhsa_user_sgpr_kernarg_segment_ptr 1
  .amdhsa_system_sgpr_workgroup_id_x 1
.end_amdhsa_kernel
```
